```python
import torch

def _softmax(x, axis=-1):
    return torch.softmax(x, dim=axis)

def _gelu(x):
    return torch.nn.functional.gelu(x, approximate='tanh')

def _silu(x):
    return torch.nn.functional.silu(x)

def _sigmoid(x):
    return torch.sigmoid(x)

def _layernorm(x, axis=-1, eps=1e-05):
    m = x.mean(dim=axis, keepdim=True)
    v = x.var(dim=axis, keepdim=True, unbiased=False)
    return (x - m) / torch.sqrt(v + eps)

def _scatter_add(tgt, idx, src, axis=0):
    return tgt.clone().index_add_(axis, idx, src)

def _segment_sum(src, seg, n):
    out = torch.zeros((n,) + src.shape[1:], dtype=src.dtype)
    return out.index_add_(0, seg, src)

def _pad(x, pw):
    flat = tuple((v for pair in reversed(pw) for v in pair))
    return torch.nn.functional.pad(x, flat)
kernel_name = 'interleave_layers__linear_kernel_hedgehog__mixer_gmlp__prompt'

def setup_inputs():

    _w = lambda a: (lambda t: t.to(torch.bfloat16) if t.is_floating_point() else t)(torch.as_tensor(a))

    def _A_setup():
        B, S, D, H = (1, 2048, 640, 32)
        Dh = D // H
        return {'x': _w((lambda *s: torch.randn(*s, dtype=torch.bfloat16) * 0.05)(B, S, D)), 'wqkv': _w((lambda *s: torch.randn(*s, dtype=torch.bfloat16) * 0.4)(D, 3 * D)), 'w_phi': _w((lambda *s: torch.randn(*s, dtype=torch.bfloat16) * 0.4)(H, Dh, Dh) * Dh ** (-0.5)), 'wo': _w((lambda *s: torch.randn(*s, dtype=torch.bfloat16) * 0.05)(D, D))}
    _A_in = _A_setup()

    def _B_setup():
        B, S, D, F = (1, 2048, 640, 1536)
        Fh = F // 2
        return {'x': _w((lambda *s: torch.randn(*s, dtype=torch.bfloat16) * 0.05)(B, S, D)), 'w_in': _w((lambda *s: torch.randn(*s, dtype=torch.bfloat16) * 0.4)(D, 2 * Fh)), 'w_sp': _w(0.01 * (lambda *s: torch.randn(*s, dtype=torch.bfloat16) * 0.4)(S, S)), 'b_sp': _w(1.0 + 0.01 * (lambda *s: torch.randn(*s, dtype=torch.bfloat16) * 0.05)(S)), 'w_out': _w((lambda *s: torch.randn(*s, dtype=torch.bfloat16) * 0.05)(Fh, D))}
    _B_in = _B_setup()
    return {'A_x': _A_in['x'], 'A_wqkv': _A_in['wqkv'], 'A_w_phi': _A_in['w_phi'], 'A_wo': _A_in['wo'], 'B_x': _B_in['x'], 'B_w_in': _B_in['w_in'], 'B_w_sp': _B_in['w_sp'], 'B_b_sp': _B_in['b_sp'], 'B_w_out': _B_in['w_out']}

def reference(A_x, A_wqkv, A_w_phi, A_wo, B_x, B_w_in, B_w_sp, B_b_sp, B_w_out):

    def _A_ref(x, wqkv, w_phi, wo):
        B, S, D = x.shape
        H = 32
        Dh = D // H
        qkv = (lambda x, *d: x.permute(*d))((x @ wqkv).reshape(B, S, 3, H, Dh), 2, 0, 3, 1, 4)
        q, k, v = (qkv[0], qkv[1], qkv[2])
        pq = torch.einsum('bhsd,hdf->bhsf', q, w_phi)
        pk = torch.einsum('bhsd,hdf->bhsf', k, w_phi)
        phi_q = torch.concatenate([_softmax(pq, axis=-1), _softmax(-pq, axis=-1)], axis=-1)
        phi_k = torch.concatenate([_softmax(pk, axis=-1), _softmax(-pk, axis=-1)], axis=-1)
        kv = torch.einsum('bhsf,bhsd->bhfd', phi_k, v)
        z = torch.einsum('bhsf->bhf', phi_k)
        num = torch.einsum('bhqf,bhfd->bhqd', phi_q, kv)
        den = torch.einsum('bhqf,bhf->bhq', phi_q, z)[..., None] + 1e-06
        o = num / den
        return (lambda x, *d: x.permute(*d))(o, 0, 2, 1, 3).reshape(B, S, D) @ wo

    def _B_ref(x, w_in, w_sp, b_sp, w_out):
        B, S, D = x.shape
        F = w_in.shape[-1]
        Fh = F // 2
        z = _gelu(torch.einsum('bsd,df->bsf', x, w_in))
        z1 = z[..., :Fh].clone()
        z2 = _layernorm(z[..., Fh:], axis=-1)
        g = torch.einsum('ts,bsf->btf', w_sp, z2) + b_sp[None, :, None]
        return torch.einsum('bsf,fd->bsd', z1 * g, w_out)
    x = A_x
    x = x + _A_ref(_layernorm(x, axis=-1), A_wqkv, A_w_phi, A_wo)
    x = x + _B_ref(_layernorm(x, axis=-1), B_w_in, B_w_sp, B_b_sp, B_w_out)
    x = x + _A_ref(_layernorm(x, axis=-1), A_wqkv, A_w_phi, A_wo)
    x = x + _B_ref(_layernorm(x, axis=-1), B_w_in, B_w_sp, B_b_sp, B_w_out)
    return x
```

```asm
; @launch kernel=k0_kernel grid=(230,1,1) block=(256,1,1) lds=8192
; @launch kernel=g1a_kernel grid=(240,1,1) block=(512,1,1) lds=131072
; @launch kernel=kva_kernel grid=(256,1,1) block=(512,1,1) lds=65536
; @launch kernel=oa_kernel grid=(256,1,1) block=(512,1,1) lds=11264
; @launch kernel=g2a_kernel grid=(160,1,1) block=(512,1,1) lds=98304
; @launch kernel=g3a_kernel grid=(256,1,1) block=(512,1,1) lds=114688
; @launch kernel=lna_kernel grid=(256,1,1) block=(256,1,1) lds=0
; @launch kernel=g4a_kernel grid=(192,1,1) block=(512,1,1) lds=98304
; @launch kernel=g5a_kernel grid=(160,1,1) block=(512,1,1) lds=98304
; @launch kernel=g1b_kernel grid=(240,1,1) block=(512,1,1) lds=131072
; @launch kernel=kvb_kernel grid=(256,1,1) block=(512,1,1) lds=65536
; @launch kernel=ob_kernel grid=(256,1,1) block=(512,1,1) lds=11264
; @launch kernel=g2b_kernel grid=(160,1,1) block=(512,1,1) lds=98304
; @launch kernel=g3b_kernel grid=(256,1,1) block=(512,1,1) lds=114688
; @launch kernel=lnb_kernel grid=(256,1,1) block=(256,1,1) lds=0
; @launch kernel=g4b_kernel grid=(192,1,1) block=(512,1,1) lds=98304
; @launch kernel=g5b_kernel grid=(160,1,1) block=(512,1,1) lds=98304
.amdgcn_target "amdgcn-amd-amdhsa--gfx950"
.text
.globl k0_kernel
.p2align 8
.type k0_kernel,@function
k0_kernel:
    s_cmp_ge_u32 s2, 230
    s_cbranch_scc1 k0_kernel_end1
    s_load_dwordx16 s[48:63], s[0:1], 0
    s_load_dwordx8 s[64:71], s[0:1], 64
    v_and_b32 v1, 63, v0
    v_lshrrev_b32 v2, 6, v0
    s_nop 0
    v_readfirstlane_b32 s40, v2
    s_waitcnt lgkmcnt(0)
    s_cmp_ge_u32 s2, 198
    s_cbranch_scc1 k0_kernel_z4
    s_cmp_ge_u32 s2, 182
    s_cbranch_scc1 k0_kernel_wf3
    s_cmp_ge_u32 s2, 128
    s_cbranch_scc1 k0_kernel_cs2
    s_mov_b32 s8, s48
    s_mov_b32 s9, s49
    s_mov_b32 s10, 2621440
    s_mov_b32 s11, 0x00020000
    s_add_u32 s12, s70, 30932992
    s_addc_u32 s13, s71, 0
    s_mov_b32 s14, 81920
    s_mov_b32 s15, 0x00020000
    s_lshl_b32 s41, s2, 4
    s_lshl_b32 s42, s40, 2
    s_add_u32 s41, s41, s42
    v_lshlrev_b32 v2, 4, v1
    v_cmp_gt_u32 vcc, 16, v1
    s_mov_b64 s[46:47], vcc
    s_add_u32 s43, s41, 0
    s_mul_i32 s43, s43, 1280
    buffer_load_dwordx4 v[8:11], v2, s[8:11], s43 offen
    s_mov_b64 exec, s[46:47]
    buffer_load_dwordx4 v[12:15], v2, s[8:11], s43 offen offset:1024
    s_mov_b64 exec, -1
    s_add_u32 s43, s41, 1
    s_mul_i32 s43, s43, 1280
    buffer_load_dwordx4 v[16:19], v2, s[8:11], s43 offen
    s_mov_b64 exec, s[46:47]
    buffer_load_dwordx4 v[20:23], v2, s[8:11], s43 offen offset:1024
    s_mov_b64 exec, -1
    s_add_u32 s43, s41, 2
    s_mul_i32 s43, s43, 1280
    buffer_load_dwordx4 v[24:27], v2, s[8:11], s43 offen
    s_mov_b64 exec, s[46:47]
    buffer_load_dwordx4 v[28:31], v2, s[8:11], s43 offen offset:1024
    s_mov_b64 exec, -1
    s_add_u32 s43, s41, 3
    s_mul_i32 s43, s43, 1280
    buffer_load_dwordx4 v[32:35], v2, s[8:11], s43 offen
    s_mov_b64 exec, s[46:47]
    buffer_load_dwordx4 v[36:39], v2, s[8:11], s43 offen offset:1024
    s_mov_b64 exec, -1
    s_waitcnt vmcnt(0)
    v_lshlrev_b32 v40, 16, v8
    v_and_b32 v41, 0xffff0000, v8
    v_lshlrev_b32 v42, 16, v9
    v_and_b32 v43, 0xffff0000, v9
    v_lshlrev_b32 v44, 16, v10
    v_and_b32 v45, 0xffff0000, v10
    v_lshlrev_b32 v46, 16, v11
    v_and_b32 v47, 0xffff0000, v11
    v_add_f32 v48, v40, v41
    v_mul_f32 v49, v40, v40
    v_fmac_f32 v49, v41, v41
    v_add_f32 v48, v48, v42
    v_fmac_f32 v49, v42, v42
    v_add_f32 v48, v48, v43
    v_fmac_f32 v49, v43, v43
    v_add_f32 v48, v48, v44
    v_fmac_f32 v49, v44, v44
    v_add_f32 v48, v48, v45
    v_fmac_f32 v49, v45, v45
    v_add_f32 v48, v48, v46
    v_fmac_f32 v49, v46, v46
    v_add_f32 v48, v48, v47
    v_fmac_f32 v49, v47, v47
    s_nop 1
    v_add_f32_dpp v48, v48, v48 row_ror:8 row_mask:0xf bank_mask:0xf
    v_add_f32_dpp v49, v49, v49 row_ror:8 row_mask:0xf bank_mask:0xf
    s_nop 1
    v_add_f32_dpp v48, v48, v48 row_ror:4 row_mask:0xf bank_mask:0xf
    v_add_f32_dpp v49, v49, v49 row_ror:4 row_mask:0xf bank_mask:0xf
    s_nop 1
    v_add_f32_dpp v48, v48, v48 row_ror:2 row_mask:0xf bank_mask:0xf
    v_add_f32_dpp v49, v49, v49 row_ror:2 row_mask:0xf bank_mask:0xf
    s_nop 1
    v_add_f32_dpp v48, v48, v48 row_ror:1 row_mask:0xf bank_mask:0xf
    v_add_f32_dpp v49, v49, v49 row_ror:1 row_mask:0xf bank_mask:0xf
    v_lshrrev_b32 v50, 4, v1
    s_mov_b32 s44, 2048
    v_mul_u32_u24 v50, s44, v50
    s_add_u32 s43, s41, 0
    v_add_u32 v50, s43, v50
    v_lshlrev_b32 v50, 3, v50
    v_and_b32 v51, 15, v1
    v_cmp_eq_u32 vcc, 0, v51
    s_and_saveexec_b64 s[44:45], vcc
    buffer_store_dwordx2 v[48:49], v50, s[12:15], 0 offen
    s_mov_b64 exec, s[44:45]
    v_lshlrev_b32 v40, 16, v12
    v_and_b32 v41, 0xffff0000, v12
    v_lshlrev_b32 v42, 16, v13
    v_and_b32 v43, 0xffff0000, v13
    v_lshlrev_b32 v44, 16, v14
    v_and_b32 v45, 0xffff0000, v14
    v_lshlrev_b32 v46, 16, v15
    v_and_b32 v47, 0xffff0000, v15
    v_add_f32 v48, v40, v41
    v_mul_f32 v49, v40, v40
    v_fmac_f32 v49, v41, v41
    v_add_f32 v48, v48, v42
    v_fmac_f32 v49, v42, v42
    v_add_f32 v48, v48, v43
    v_fmac_f32 v49, v43, v43
    v_add_f32 v48, v48, v44
    v_fmac_f32 v49, v44, v44
    v_add_f32 v48, v48, v45
    v_fmac_f32 v49, v45, v45
    v_add_f32 v48, v48, v46
    v_fmac_f32 v49, v46, v46
    v_add_f32 v48, v48, v47
    v_fmac_f32 v49, v47, v47
    s_nop 1
    v_add_f32_dpp v48, v48, v48 row_ror:8 row_mask:0xf bank_mask:0xf
    v_add_f32_dpp v49, v49, v49 row_ror:8 row_mask:0xf bank_mask:0xf
    s_nop 1
    v_add_f32_dpp v48, v48, v48 row_ror:4 row_mask:0xf bank_mask:0xf
    v_add_f32_dpp v49, v49, v49 row_ror:4 row_mask:0xf bank_mask:0xf
    s_nop 1
    v_add_f32_dpp v48, v48, v48 row_ror:2 row_mask:0xf bank_mask:0xf
    v_add_f32_dpp v49, v49, v49 row_ror:2 row_mask:0xf bank_mask:0xf
    s_nop 1
    v_add_f32_dpp v48, v48, v48 row_ror:1 row_mask:0xf bank_mask:0xf
    v_add_f32_dpp v49, v49, v49 row_ror:1 row_mask:0xf bank_mask:0xf
    v_lshrrev_b32 v50, 4, v1
    v_mov_b32 v50, 4
    s_mov_b32 s44, 2048
    v_mul_u32_u24 v50, s44, v50
    s_add_u32 s43, s41, 0
    v_add_u32 v50, s43, v50
    v_lshlrev_b32 v50, 3, v50
    v_and_b32 v51, 15, v1
    v_cmp_eq_u32 vcc, 0, v51
    v_cmp_gt_u32 s[44:45], 16, v1
    s_and_b64 vcc, vcc, s[44:45]
    s_and_saveexec_b64 s[44:45], vcc
    buffer_store_dwordx2 v[48:49], v50, s[12:15], 0 offen
    s_mov_b64 exec, s[44:45]
    v_lshlrev_b32 v40, 16, v16
    v_and_b32 v41, 0xffff0000, v16
    v_lshlrev_b32 v42, 16, v17
    v_and_b32 v43, 0xffff0000, v17
    v_lshlrev_b32 v44, 16, v18
    v_and_b32 v45, 0xffff0000, v18
    v_lshlrev_b32 v46, 16, v19
    v_and_b32 v47, 0xffff0000, v19
    v_add_f32 v48, v40, v41
    v_mul_f32 v49, v40, v40
    v_fmac_f32 v49, v41, v41
    v_add_f32 v48, v48, v42
    v_fmac_f32 v49, v42, v42
    v_add_f32 v48, v48, v43
    v_fmac_f32 v49, v43, v43
    v_add_f32 v48, v48, v44
    v_fmac_f32 v49, v44, v44
    v_add_f32 v48, v48, v45
    v_fmac_f32 v49, v45, v45
    v_add_f32 v48, v48, v46
    v_fmac_f32 v49, v46, v46
    v_add_f32 v48, v48, v47
    v_fmac_f32 v49, v47, v47
    s_nop 1
    v_add_f32_dpp v48, v48, v48 row_ror:8 row_mask:0xf bank_mask:0xf
    v_add_f32_dpp v49, v49, v49 row_ror:8 row_mask:0xf bank_mask:0xf
    s_nop 1
    v_add_f32_dpp v48, v48, v48 row_ror:4 row_mask:0xf bank_mask:0xf
    v_add_f32_dpp v49, v49, v49 row_ror:4 row_mask:0xf bank_mask:0xf
    s_nop 1
    v_add_f32_dpp v48, v48, v48 row_ror:2 row_mask:0xf bank_mask:0xf
    v_add_f32_dpp v49, v49, v49 row_ror:2 row_mask:0xf bank_mask:0xf
    s_nop 1
    v_add_f32_dpp v48, v48, v48 row_ror:1 row_mask:0xf bank_mask:0xf
    v_add_f32_dpp v49, v49, v49 row_ror:1 row_mask:0xf bank_mask:0xf
    v_lshrrev_b32 v50, 4, v1
    s_mov_b32 s44, 2048
    v_mul_u32_u24 v50, s44, v50
    s_add_u32 s43, s41, 1
    v_add_u32 v50, s43, v50
    v_lshlrev_b32 v50, 3, v50
    v_and_b32 v51, 15, v1
    v_cmp_eq_u32 vcc, 0, v51
    s_and_saveexec_b64 s[44:45], vcc
    buffer_store_dwordx2 v[48:49], v50, s[12:15], 0 offen
    s_mov_b64 exec, s[44:45]
    v_lshlrev_b32 v40, 16, v20
    v_and_b32 v41, 0xffff0000, v20
    v_lshlrev_b32 v42, 16, v21
    v_and_b32 v43, 0xffff0000, v21
    v_lshlrev_b32 v44, 16, v22
    v_and_b32 v45, 0xffff0000, v22
    v_lshlrev_b32 v46, 16, v23
    v_and_b32 v47, 0xffff0000, v23
    v_add_f32 v48, v40, v41
    v_mul_f32 v49, v40, v40
    v_fmac_f32 v49, v41, v41
    v_add_f32 v48, v48, v42
    v_fmac_f32 v49, v42, v42
    v_add_f32 v48, v48, v43
    v_fmac_f32 v49, v43, v43
    v_add_f32 v48, v48, v44
    v_fmac_f32 v49, v44, v44
    v_add_f32 v48, v48, v45
    v_fmac_f32 v49, v45, v45
    v_add_f32 v48, v48, v46
    v_fmac_f32 v49, v46, v46
    v_add_f32 v48, v48, v47
    v_fmac_f32 v49, v47, v47
    s_nop 1
    v_add_f32_dpp v48, v48, v48 row_ror:8 row_mask:0xf bank_mask:0xf
    v_add_f32_dpp v49, v49, v49 row_ror:8 row_mask:0xf bank_mask:0xf
    s_nop 1
    v_add_f32_dpp v48, v48, v48 row_ror:4 row_mask:0xf bank_mask:0xf
    v_add_f32_dpp v49, v49, v49 row_ror:4 row_mask:0xf bank_mask:0xf
    s_nop 1
    v_add_f32_dpp v48, v48, v48 row_ror:2 row_mask:0xf bank_mask:0xf
    v_add_f32_dpp v49, v49, v49 row_ror:2 row_mask:0xf bank_mask:0xf
    s_nop 1
    v_add_f32_dpp v48, v48, v48 row_ror:1 row_mask:0xf bank_mask:0xf
    v_add_f32_dpp v49, v49, v49 row_ror:1 row_mask:0xf bank_mask:0xf
    v_lshrrev_b32 v50, 4, v1
    v_mov_b32 v50, 4
    s_mov_b32 s44, 2048
    v_mul_u32_u24 v50, s44, v50
    s_add_u32 s43, s41, 1
    v_add_u32 v50, s43, v50
    v_lshlrev_b32 v50, 3, v50
    v_and_b32 v51, 15, v1
    v_cmp_eq_u32 vcc, 0, v51
    v_cmp_gt_u32 s[44:45], 16, v1
    s_and_b64 vcc, vcc, s[44:45]
    s_and_saveexec_b64 s[44:45], vcc
    buffer_store_dwordx2 v[48:49], v50, s[12:15], 0 offen
    s_mov_b64 exec, s[44:45]
    v_lshlrev_b32 v40, 16, v24
    v_and_b32 v41, 0xffff0000, v24
    v_lshlrev_b32 v42, 16, v25
    v_and_b32 v43, 0xffff0000, v25
    v_lshlrev_b32 v44, 16, v26
    v_and_b32 v45, 0xffff0000, v26
    v_lshlrev_b32 v46, 16, v27
    v_and_b32 v47, 0xffff0000, v27
    v_add_f32 v48, v40, v41
    v_mul_f32 v49, v40, v40
    v_fmac_f32 v49, v41, v41
    v_add_f32 v48, v48, v42
    v_fmac_f32 v49, v42, v42
    v_add_f32 v48, v48, v43
    v_fmac_f32 v49, v43, v43
    v_add_f32 v48, v48, v44
    v_fmac_f32 v49, v44, v44
    v_add_f32 v48, v48, v45
    v_fmac_f32 v49, v45, v45
    v_add_f32 v48, v48, v46
    v_fmac_f32 v49, v46, v46
    v_add_f32 v48, v48, v47
    v_fmac_f32 v49, v47, v47
    s_nop 1
    v_add_f32_dpp v48, v48, v48 row_ror:8 row_mask:0xf bank_mask:0xf
    v_add_f32_dpp v49, v49, v49 row_ror:8 row_mask:0xf bank_mask:0xf
    s_nop 1
    v_add_f32_dpp v48, v48, v48 row_ror:4 row_mask:0xf bank_mask:0xf
    v_add_f32_dpp v49, v49, v49 row_ror:4 row_mask:0xf bank_mask:0xf
    s_nop 1
    v_add_f32_dpp v48, v48, v48 row_ror:2 row_mask:0xf bank_mask:0xf
    v_add_f32_dpp v49, v49, v49 row_ror:2 row_mask:0xf bank_mask:0xf
    s_nop 1
    v_add_f32_dpp v48, v48, v48 row_ror:1 row_mask:0xf bank_mask:0xf
    v_add_f32_dpp v49, v49, v49 row_ror:1 row_mask:0xf bank_mask:0xf
    v_lshrrev_b32 v50, 4, v1
    s_mov_b32 s44, 2048
    v_mul_u32_u24 v50, s44, v50
    s_add_u32 s43, s41, 2
    v_add_u32 v50, s43, v50
    v_lshlrev_b32 v50, 3, v50
    v_and_b32 v51, 15, v1
    v_cmp_eq_u32 vcc, 0, v51
    s_and_saveexec_b64 s[44:45], vcc
    buffer_store_dwordx2 v[48:49], v50, s[12:15], 0 offen
    s_mov_b64 exec, s[44:45]
    v_lshlrev_b32 v40, 16, v28
    v_and_b32 v41, 0xffff0000, v28
    v_lshlrev_b32 v42, 16, v29
    v_and_b32 v43, 0xffff0000, v29
    v_lshlrev_b32 v44, 16, v30
    v_and_b32 v45, 0xffff0000, v30
    v_lshlrev_b32 v46, 16, v31
    v_and_b32 v47, 0xffff0000, v31
    v_add_f32 v48, v40, v41
    v_mul_f32 v49, v40, v40
    v_fmac_f32 v49, v41, v41
    v_add_f32 v48, v48, v42
    v_fmac_f32 v49, v42, v42
    v_add_f32 v48, v48, v43
    v_fmac_f32 v49, v43, v43
    v_add_f32 v48, v48, v44
    v_fmac_f32 v49, v44, v44
    v_add_f32 v48, v48, v45
    v_fmac_f32 v49, v45, v45
    v_add_f32 v48, v48, v46
    v_fmac_f32 v49, v46, v46
    v_add_f32 v48, v48, v47
    v_fmac_f32 v49, v47, v47
    s_nop 1
    v_add_f32_dpp v48, v48, v48 row_ror:8 row_mask:0xf bank_mask:0xf
    v_add_f32_dpp v49, v49, v49 row_ror:8 row_mask:0xf bank_mask:0xf
    s_nop 1
    v_add_f32_dpp v48, v48, v48 row_ror:4 row_mask:0xf bank_mask:0xf
    v_add_f32_dpp v49, v49, v49 row_ror:4 row_mask:0xf bank_mask:0xf
    s_nop 1
    v_add_f32_dpp v48, v48, v48 row_ror:2 row_mask:0xf bank_mask:0xf
    v_add_f32_dpp v49, v49, v49 row_ror:2 row_mask:0xf bank_mask:0xf
    s_nop 1
    v_add_f32_dpp v48, v48, v48 row_ror:1 row_mask:0xf bank_mask:0xf
    v_add_f32_dpp v49, v49, v49 row_ror:1 row_mask:0xf bank_mask:0xf
    v_lshrrev_b32 v50, 4, v1
    v_mov_b32 v50, 4
    s_mov_b32 s44, 2048
    v_mul_u32_u24 v50, s44, v50
    s_add_u32 s43, s41, 2
    v_add_u32 v50, s43, v50
    v_lshlrev_b32 v50, 3, v50
    v_and_b32 v51, 15, v1
    v_cmp_eq_u32 vcc, 0, v51
    v_cmp_gt_u32 s[44:45], 16, v1
    s_and_b64 vcc, vcc, s[44:45]
    s_and_saveexec_b64 s[44:45], vcc
    buffer_store_dwordx2 v[48:49], v50, s[12:15], 0 offen
    s_mov_b64 exec, s[44:45]
    v_lshlrev_b32 v40, 16, v32
    v_and_b32 v41, 0xffff0000, v32
    v_lshlrev_b32 v42, 16, v33
    v_and_b32 v43, 0xffff0000, v33
    v_lshlrev_b32 v44, 16, v34
    v_and_b32 v45, 0xffff0000, v34
    v_lshlrev_b32 v46, 16, v35
    v_and_b32 v47, 0xffff0000, v35
    v_add_f32 v48, v40, v41
    v_mul_f32 v49, v40, v40
    v_fmac_f32 v49, v41, v41
    v_add_f32 v48, v48, v42
    v_fmac_f32 v49, v42, v42
    v_add_f32 v48, v48, v43
    v_fmac_f32 v49, v43, v43
    v_add_f32 v48, v48, v44
    v_fmac_f32 v49, v44, v44
    v_add_f32 v48, v48, v45
    v_fmac_f32 v49, v45, v45
    v_add_f32 v48, v48, v46
    v_fmac_f32 v49, v46, v46
    v_add_f32 v48, v48, v47
    v_fmac_f32 v49, v47, v47
    s_nop 1
    v_add_f32_dpp v48, v48, v48 row_ror:8 row_mask:0xf bank_mask:0xf
    v_add_f32_dpp v49, v49, v49 row_ror:8 row_mask:0xf bank_mask:0xf
    s_nop 1
    v_add_f32_dpp v48, v48, v48 row_ror:4 row_mask:0xf bank_mask:0xf
    v_add_f32_dpp v49, v49, v49 row_ror:4 row_mask:0xf bank_mask:0xf
    s_nop 1
    v_add_f32_dpp v48, v48, v48 row_ror:2 row_mask:0xf bank_mask:0xf
    v_add_f32_dpp v49, v49, v49 row_ror:2 row_mask:0xf bank_mask:0xf
    s_nop 1
    v_add_f32_dpp v48, v48, v48 row_ror:1 row_mask:0xf bank_mask:0xf
    v_add_f32_dpp v49, v49, v49 row_ror:1 row_mask:0xf bank_mask:0xf
    v_lshrrev_b32 v50, 4, v1
    s_mov_b32 s44, 2048
    v_mul_u32_u24 v50, s44, v50
    s_add_u32 s43, s41, 3
    v_add_u32 v50, s43, v50
    v_lshlrev_b32 v50, 3, v50
    v_and_b32 v51, 15, v1
    v_cmp_eq_u32 vcc, 0, v51
    s_and_saveexec_b64 s[44:45], vcc
    buffer_store_dwordx2 v[48:49], v50, s[12:15], 0 offen
    s_mov_b64 exec, s[44:45]
    v_lshlrev_b32 v40, 16, v36
    v_and_b32 v41, 0xffff0000, v36
    v_lshlrev_b32 v42, 16, v37
    v_and_b32 v43, 0xffff0000, v37
    v_lshlrev_b32 v44, 16, v38
    v_and_b32 v45, 0xffff0000, v38
    v_lshlrev_b32 v46, 16, v39
    v_and_b32 v47, 0xffff0000, v39
    v_add_f32 v48, v40, v41
    v_mul_f32 v49, v40, v40
    v_fmac_f32 v49, v41, v41
    v_add_f32 v48, v48, v42
    v_fmac_f32 v49, v42, v42
    v_add_f32 v48, v48, v43
    v_fmac_f32 v49, v43, v43
    v_add_f32 v48, v48, v44
    v_fmac_f32 v49, v44, v44
    v_add_f32 v48, v48, v45
    v_fmac_f32 v49, v45, v45
    v_add_f32 v48, v48, v46
    v_fmac_f32 v49, v46, v46
    v_add_f32 v48, v48, v47
    v_fmac_f32 v49, v47, v47
    s_nop 1
    v_add_f32_dpp v48, v48, v48 row_ror:8 row_mask:0xf bank_mask:0xf
    v_add_f32_dpp v49, v49, v49 row_ror:8 row_mask:0xf bank_mask:0xf
    s_nop 1
    v_add_f32_dpp v48, v48, v48 row_ror:4 row_mask:0xf bank_mask:0xf
    v_add_f32_dpp v49, v49, v49 row_ror:4 row_mask:0xf bank_mask:0xf
    s_nop 1
    v_add_f32_dpp v48, v48, v48 row_ror:2 row_mask:0xf bank_mask:0xf
    v_add_f32_dpp v49, v49, v49 row_ror:2 row_mask:0xf bank_mask:0xf
    s_nop 1
    v_add_f32_dpp v48, v48, v48 row_ror:1 row_mask:0xf bank_mask:0xf
    v_add_f32_dpp v49, v49, v49 row_ror:1 row_mask:0xf bank_mask:0xf
    v_lshrrev_b32 v50, 4, v1
    v_mov_b32 v50, 4
    s_mov_b32 s44, 2048
    v_mul_u32_u24 v50, s44, v50
    s_add_u32 s43, s41, 3
    v_add_u32 v50, s43, v50
    v_lshlrev_b32 v50, 3, v50
    v_and_b32 v51, 15, v1
    v_cmp_eq_u32 vcc, 0, v51
    v_cmp_gt_u32 s[44:45], 16, v1
    s_and_b64 vcc, vcc, s[44:45]
    s_and_saveexec_b64 s[44:45], vcc
    buffer_store_dwordx2 v[48:49], v50, s[12:15], 0 offen
    s_mov_b64 exec, s[44:45]
    s_branch k0_kernel_end1
k0_kernel_cs2:
    s_cmp_ge_u32 s2, 158
    s_cbranch_scc1 k0_kernel_csin5
    s_mov_b32 s8, s50
    s_mov_b32 s9, s51
    s_mov_b32 s10, 2457600
    s_mov_b32 s11, 0x00020000
    s_add_u32 s12, s70, 31260672
    s_addc_u32 s13, s71, 0
    s_mov_b32 s14, 7680
    s_mov_b32 s15, 0x00020000
    s_sub_u32 s41, s2, 128
    s_mov_b32 s42, 3840
    s_branch k0_kernel_csgo6
k0_kernel_csin5:
    s_mov_b32 s8, s58
    s_mov_b32 s9, s59
    s_mov_b32 s10, 1966080
    s_mov_b32 s11, 0x00020000
    s_add_u32 s12, s70, 31268864
    s_addc_u32 s13, s71, 0
    s_mov_b32 s14, 6144
    s_mov_b32 s15, 0x00020000
    s_sub_u32 s41, s2, 158
    s_mov_b32 s42, 3072
k0_kernel_csgo6:
    v_and_b32 v3, 7, v0
    v_lshrrev_b32 v4, 3, v0
    s_lshl_b32 s43, s41, 7
    v_mul_u32_u24 v5, 20, v4
    v_mul_lo_u32 v5, v5, s42
    v_lshl_add_u32 v5, v3, 4, v5
    v_mov_b32 v16, 0
    v_mov_b32 v17, 0
    v_mov_b32 v18, 0
    v_mov_b32 v19, 0
    v_mov_b32 v20, 0
    v_mov_b32 v21, 0
    v_mov_b32 v22, 0
    v_mov_b32 v23, 0
    buffer_load_dwordx4 v[24:27], v5, s[8:11], s43 offen
    v_add_u32 v5, s42, v5
    buffer_load_dwordx4 v[28:31], v5, s[8:11], s43 offen
    v_add_u32 v5, s42, v5
    buffer_load_dwordx4 v[32:35], v5, s[8:11], s43 offen
    v_add_u32 v5, s42, v5
    buffer_load_dwordx4 v[36:39], v5, s[8:11], s43 offen
    v_add_u32 v5, s42, v5
    buffer_load_dwordx4 v[40:43], v5, s[8:11], s43 offen
    v_add_u32 v5, s42, v5
    s_waitcnt vmcnt(0)
    v_lshlrev_b32 v44, 16, v24
    v_and_b32 v45, 0xffff0000, v24
    v_add_f32 v16, v16, v44
    v_add_f32 v17, v17, v45
    v_lshlrev_b32 v44, 16, v25
    v_and_b32 v45, 0xffff0000, v25
    v_add_f32 v18, v18, v44
    v_add_f32 v19, v19, v45
    v_lshlrev_b32 v44, 16, v26
    v_and_b32 v45, 0xffff0000, v26
    v_add_f32 v20, v20, v44
    v_add_f32 v21, v21, v45
    v_lshlrev_b32 v44, 16, v27
    v_and_b32 v45, 0xffff0000, v27
    v_add_f32 v22, v22, v44
    v_add_f32 v23, v23, v45
    v_lshlrev_b32 v44, 16, v28
    v_and_b32 v45, 0xffff0000, v28
    v_add_f32 v16, v16, v44
    v_add_f32 v17, v17, v45
    v_lshlrev_b32 v44, 16, v29
    v_and_b32 v45, 0xffff0000, v29
    v_add_f32 v18, v18, v44
    v_add_f32 v19, v19, v45
    v_lshlrev_b32 v44, 16, v30
    v_and_b32 v45, 0xffff0000, v30
    v_add_f32 v20, v20, v44
    v_add_f32 v21, v21, v45
    v_lshlrev_b32 v44, 16, v31
    v_and_b32 v45, 0xffff0000, v31
    v_add_f32 v22, v22, v44
    v_add_f32 v23, v23, v45
    v_lshlrev_b32 v44, 16, v32
    v_and_b32 v45, 0xffff0000, v32
    v_add_f32 v16, v16, v44
    v_add_f32 v17, v17, v45
    v_lshlrev_b32 v44, 16, v33
    v_and_b32 v45, 0xffff0000, v33
    v_add_f32 v18, v18, v44
    v_add_f32 v19, v19, v45
    v_lshlrev_b32 v44, 16, v34
    v_and_b32 v45, 0xffff0000, v34
    v_add_f32 v20, v20, v44
    v_add_f32 v21, v21, v45
    v_lshlrev_b32 v44, 16, v35
    v_and_b32 v45, 0xffff0000, v35
    v_add_f32 v22, v22, v44
    v_add_f32 v23, v23, v45
    v_lshlrev_b32 v44, 16, v36
    v_and_b32 v45, 0xffff0000, v36
    v_add_f32 v16, v16, v44
    v_add_f32 v17, v17, v45
    v_lshlrev_b32 v44, 16, v37
    v_and_b32 v45, 0xffff0000, v37
    v_add_f32 v18, v18, v44
    v_add_f32 v19, v19, v45
    v_lshlrev_b32 v44, 16, v38
    v_and_b32 v45, 0xffff0000, v38
    v_add_f32 v20, v20, v44
    v_add_f32 v21, v21, v45
    v_lshlrev_b32 v44, 16, v39
    v_and_b32 v45, 0xffff0000, v39
    v_add_f32 v22, v22, v44
    v_add_f32 v23, v23, v45
    v_lshlrev_b32 v44, 16, v40
    v_and_b32 v45, 0xffff0000, v40
    v_add_f32 v16, v16, v44
    v_add_f32 v17, v17, v45
    v_lshlrev_b32 v44, 16, v41
    v_and_b32 v45, 0xffff0000, v41
    v_add_f32 v18, v18, v44
    v_add_f32 v19, v19, v45
    v_lshlrev_b32 v44, 16, v42
    v_and_b32 v45, 0xffff0000, v42
    v_add_f32 v20, v20, v44
    v_add_f32 v21, v21, v45
    v_lshlrev_b32 v44, 16, v43
    v_and_b32 v45, 0xffff0000, v43
    v_add_f32 v22, v22, v44
    v_add_f32 v23, v23, v45
    buffer_load_dwordx4 v[24:27], v5, s[8:11], s43 offen
    v_add_u32 v5, s42, v5
    buffer_load_dwordx4 v[28:31], v5, s[8:11], s43 offen
    v_add_u32 v5, s42, v5
    buffer_load_dwordx4 v[32:35], v5, s[8:11], s43 offen
    v_add_u32 v5, s42, v5
    buffer_load_dwordx4 v[36:39], v5, s[8:11], s43 offen
    v_add_u32 v5, s42, v5
    buffer_load_dwordx4 v[40:43], v5, s[8:11], s43 offen
    v_add_u32 v5, s42, v5
    s_waitcnt vmcnt(0)
    v_lshlrev_b32 v44, 16, v24
    v_and_b32 v45, 0xffff0000, v24
    v_add_f32 v16, v16, v44
    v_add_f32 v17, v17, v45
    v_lshlrev_b32 v44, 16, v25
    v_and_b32 v45, 0xffff0000, v25
    v_add_f32 v18, v18, v44
    v_add_f32 v19, v19, v45
    v_lshlrev_b32 v44, 16, v26
    v_and_b32 v45, 0xffff0000, v26
    v_add_f32 v20, v20, v44
    v_add_f32 v21, v21, v45
    v_lshlrev_b32 v44, 16, v27
    v_and_b32 v45, 0xffff0000, v27
    v_add_f32 v22, v22, v44
    v_add_f32 v23, v23, v45
    v_lshlrev_b32 v44, 16, v28
    v_and_b32 v45, 0xffff0000, v28
    v_add_f32 v16, v16, v44
    v_add_f32 v17, v17, v45
    v_lshlrev_b32 v44, 16, v29
    v_and_b32 v45, 0xffff0000, v29
    v_add_f32 v18, v18, v44
    v_add_f32 v19, v19, v45
    v_lshlrev_b32 v44, 16, v30
    v_and_b32 v45, 0xffff0000, v30
    v_add_f32 v20, v20, v44
    v_add_f32 v21, v21, v45
    v_lshlrev_b32 v44, 16, v31
    v_and_b32 v45, 0xffff0000, v31
    v_add_f32 v22, v22, v44
    v_add_f32 v23, v23, v45
    v_lshlrev_b32 v44, 16, v32
    v_and_b32 v45, 0xffff0000, v32
    v_add_f32 v16, v16, v44
    v_add_f32 v17, v17, v45
    v_lshlrev_b32 v44, 16, v33
    v_and_b32 v45, 0xffff0000, v33
    v_add_f32 v18, v18, v44
    v_add_f32 v19, v19, v45
    v_lshlrev_b32 v44, 16, v34
    v_and_b32 v45, 0xffff0000, v34
    v_add_f32 v20, v20, v44
    v_add_f32 v21, v21, v45
    v_lshlrev_b32 v44, 16, v35
    v_and_b32 v45, 0xffff0000, v35
    v_add_f32 v22, v22, v44
    v_add_f32 v23, v23, v45
    v_lshlrev_b32 v44, 16, v36
    v_and_b32 v45, 0xffff0000, v36
    v_add_f32 v16, v16, v44
    v_add_f32 v17, v17, v45
    v_lshlrev_b32 v44, 16, v37
    v_and_b32 v45, 0xffff0000, v37
    v_add_f32 v18, v18, v44
    v_add_f32 v19, v19, v45
    v_lshlrev_b32 v44, 16, v38
    v_and_b32 v45, 0xffff0000, v38
    v_add_f32 v20, v20, v44
    v_add_f32 v21, v21, v45
    v_lshlrev_b32 v44, 16, v39
    v_and_b32 v45, 0xffff0000, v39
    v_add_f32 v22, v22, v44
    v_add_f32 v23, v23, v45
    v_lshlrev_b32 v44, 16, v40
    v_and_b32 v45, 0xffff0000, v40
    v_add_f32 v16, v16, v44
    v_add_f32 v17, v17, v45
    v_lshlrev_b32 v44, 16, v41
    v_and_b32 v45, 0xffff0000, v41
    v_add_f32 v18, v18, v44
    v_add_f32 v19, v19, v45
    v_lshlrev_b32 v44, 16, v42
    v_and_b32 v45, 0xffff0000, v42
    v_add_f32 v20, v20, v44
    v_add_f32 v21, v21, v45
    v_lshlrev_b32 v44, 16, v43
    v_and_b32 v45, 0xffff0000, v43
    v_add_f32 v22, v22, v44
    v_add_f32 v23, v23, v45
    buffer_load_dwordx4 v[24:27], v5, s[8:11], s43 offen
    v_add_u32 v5, s42, v5
    buffer_load_dwordx4 v[28:31], v5, s[8:11], s43 offen
    v_add_u32 v5, s42, v5
    buffer_load_dwordx4 v[32:35], v5, s[8:11], s43 offen
    v_add_u32 v5, s42, v5
    buffer_load_dwordx4 v[36:39], v5, s[8:11], s43 offen
    v_add_u32 v5, s42, v5
    buffer_load_dwordx4 v[40:43], v5, s[8:11], s43 offen
    v_add_u32 v5, s42, v5
    s_waitcnt vmcnt(0)
    v_lshlrev_b32 v44, 16, v24
    v_and_b32 v45, 0xffff0000, v24
    v_add_f32 v16, v16, v44
    v_add_f32 v17, v17, v45
    v_lshlrev_b32 v44, 16, v25
    v_and_b32 v45, 0xffff0000, v25
    v_add_f32 v18, v18, v44
    v_add_f32 v19, v19, v45
    v_lshlrev_b32 v44, 16, v26
    v_and_b32 v45, 0xffff0000, v26
    v_add_f32 v20, v20, v44
    v_add_f32 v21, v21, v45
    v_lshlrev_b32 v44, 16, v27
    v_and_b32 v45, 0xffff0000, v27
    v_add_f32 v22, v22, v44
    v_add_f32 v23, v23, v45
    v_lshlrev_b32 v44, 16, v28
    v_and_b32 v45, 0xffff0000, v28
    v_add_f32 v16, v16, v44
    v_add_f32 v17, v17, v45
    v_lshlrev_b32 v44, 16, v29
    v_and_b32 v45, 0xffff0000, v29
    v_add_f32 v18, v18, v44
    v_add_f32 v19, v19, v45
    v_lshlrev_b32 v44, 16, v30
    v_and_b32 v45, 0xffff0000, v30
    v_add_f32 v20, v20, v44
    v_add_f32 v21, v21, v45
    v_lshlrev_b32 v44, 16, v31
    v_and_b32 v45, 0xffff0000, v31
    v_add_f32 v22, v22, v44
    v_add_f32 v23, v23, v45
    v_lshlrev_b32 v44, 16, v32
    v_and_b32 v45, 0xffff0000, v32
    v_add_f32 v16, v16, v44
    v_add_f32 v17, v17, v45
    v_lshlrev_b32 v44, 16, v33
    v_and_b32 v45, 0xffff0000, v33
    v_add_f32 v18, v18, v44
    v_add_f32 v19, v19, v45
    v_lshlrev_b32 v44, 16, v34
    v_and_b32 v45, 0xffff0000, v34
    v_add_f32 v20, v20, v44
    v_add_f32 v21, v21, v45
    v_lshlrev_b32 v44, 16, v35
    v_and_b32 v45, 0xffff0000, v35
    v_add_f32 v22, v22, v44
    v_add_f32 v23, v23, v45
    v_lshlrev_b32 v44, 16, v36
    v_and_b32 v45, 0xffff0000, v36
    v_add_f32 v16, v16, v44
    v_add_f32 v17, v17, v45
    v_lshlrev_b32 v44, 16, v37
    v_and_b32 v45, 0xffff0000, v37
    v_add_f32 v18, v18, v44
    v_add_f32 v19, v19, v45
    v_lshlrev_b32 v44, 16, v38
    v_and_b32 v45, 0xffff0000, v38
    v_add_f32 v20, v20, v44
    v_add_f32 v21, v21, v45
    v_lshlrev_b32 v44, 16, v39
    v_and_b32 v45, 0xffff0000, v39
    v_add_f32 v22, v22, v44
    v_add_f32 v23, v23, v45
    v_lshlrev_b32 v44, 16, v40
    v_and_b32 v45, 0xffff0000, v40
    v_add_f32 v16, v16, v44
    v_add_f32 v17, v17, v45
    v_lshlrev_b32 v44, 16, v41
    v_and_b32 v45, 0xffff0000, v41
    v_add_f32 v18, v18, v44
    v_add_f32 v19, v19, v45
    v_lshlrev_b32 v44, 16, v42
    v_and_b32 v45, 0xffff0000, v42
    v_add_f32 v20, v20, v44
    v_add_f32 v21, v21, v45
    v_lshlrev_b32 v44, 16, v43
    v_and_b32 v45, 0xffff0000, v43
    v_add_f32 v22, v22, v44
    v_add_f32 v23, v23, v45
    buffer_load_dwordx4 v[24:27], v5, s[8:11], s43 offen
    v_add_u32 v5, s42, v5
    buffer_load_dwordx4 v[28:31], v5, s[8:11], s43 offen
    v_add_u32 v5, s42, v5
    buffer_load_dwordx4 v[32:35], v5, s[8:11], s43 offen
    v_add_u32 v5, s42, v5
    buffer_load_dwordx4 v[36:39], v5, s[8:11], s43 offen
    v_add_u32 v5, s42, v5
    buffer_load_dwordx4 v[40:43], v5, s[8:11], s43 offen
    v_add_u32 v5, s42, v5
    s_waitcnt vmcnt(0)
    v_lshlrev_b32 v44, 16, v24
    v_and_b32 v45, 0xffff0000, v24
    v_add_f32 v16, v16, v44
    v_add_f32 v17, v17, v45
    v_lshlrev_b32 v44, 16, v25
    v_and_b32 v45, 0xffff0000, v25
    v_add_f32 v18, v18, v44
    v_add_f32 v19, v19, v45
    v_lshlrev_b32 v44, 16, v26
    v_and_b32 v45, 0xffff0000, v26
    v_add_f32 v20, v20, v44
    v_add_f32 v21, v21, v45
    v_lshlrev_b32 v44, 16, v27
    v_and_b32 v45, 0xffff0000, v27
    v_add_f32 v22, v22, v44
    v_add_f32 v23, v23, v45
    v_lshlrev_b32 v44, 16, v28
    v_and_b32 v45, 0xffff0000, v28
    v_add_f32 v16, v16, v44
    v_add_f32 v17, v17, v45
    v_lshlrev_b32 v44, 16, v29
    v_and_b32 v45, 0xffff0000, v29
    v_add_f32 v18, v18, v44
    v_add_f32 v19, v19, v45
    v_lshlrev_b32 v44, 16, v30
    v_and_b32 v45, 0xffff0000, v30
    v_add_f32 v20, v20, v44
    v_add_f32 v21, v21, v45
    v_lshlrev_b32 v44, 16, v31
    v_and_b32 v45, 0xffff0000, v31
    v_add_f32 v22, v22, v44
    v_add_f32 v23, v23, v45
    v_lshlrev_b32 v44, 16, v32
    v_and_b32 v45, 0xffff0000, v32
    v_add_f32 v16, v16, v44
    v_add_f32 v17, v17, v45
    v_lshlrev_b32 v44, 16, v33
    v_and_b32 v45, 0xffff0000, v33
    v_add_f32 v18, v18, v44
    v_add_f32 v19, v19, v45
    v_lshlrev_b32 v44, 16, v34
    v_and_b32 v45, 0xffff0000, v34
    v_add_f32 v20, v20, v44
    v_add_f32 v21, v21, v45
    v_lshlrev_b32 v44, 16, v35
    v_and_b32 v45, 0xffff0000, v35
    v_add_f32 v22, v22, v44
    v_add_f32 v23, v23, v45
    v_lshlrev_b32 v44, 16, v36
    v_and_b32 v45, 0xffff0000, v36
    v_add_f32 v16, v16, v44
    v_add_f32 v17, v17, v45
    v_lshlrev_b32 v44, 16, v37
    v_and_b32 v45, 0xffff0000, v37
    v_add_f32 v18, v18, v44
    v_add_f32 v19, v19, v45
    v_lshlrev_b32 v44, 16, v38
    v_and_b32 v45, 0xffff0000, v38
    v_add_f32 v20, v20, v44
    v_add_f32 v21, v21, v45
    v_lshlrev_b32 v44, 16, v39
    v_and_b32 v45, 0xffff0000, v39
    v_add_f32 v22, v22, v44
    v_add_f32 v23, v23, v45
    v_lshlrev_b32 v44, 16, v40
    v_and_b32 v45, 0xffff0000, v40
    v_add_f32 v16, v16, v44
    v_add_f32 v17, v17, v45
    v_lshlrev_b32 v44, 16, v41
    v_and_b32 v45, 0xffff0000, v41
    v_add_f32 v18, v18, v44
    v_add_f32 v19, v19, v45
    v_lshlrev_b32 v44, 16, v42
    v_and_b32 v45, 0xffff0000, v42
    v_add_f32 v20, v20, v44
    v_add_f32 v21, v21, v45
    v_lshlrev_b32 v44, 16, v43
    v_and_b32 v45, 0xffff0000, v43
    v_add_f32 v22, v22, v44
    v_add_f32 v23, v23, v45
    v_lshlrev_b32 v6, 8, v4
    v_lshl_add_u32 v6, v3, 5, v6
    ds_write_b128 v6, v[16:19]
    ds_write_b128 v6, v[20:23] offset:16
    s_waitcnt lgkmcnt(0)
    s_barrier
    v_cmp_gt_u32 vcc, 64, v0
    s_and_saveexec_b64 s[44:45], vcc
    s_cbranch_execz k0_kernel_end1
    v_lshlrev_b32 v6, 2, v0
    ds_read_b32 v16, v6 offset:0
    ds_read_b32 v17, v6 offset:256
    ds_read_b32 v18, v6 offset:512
    ds_read_b32 v19, v6 offset:768
    ds_read_b32 v20, v6 offset:1024
    ds_read_b32 v21, v6 offset:1280
    ds_read_b32 v22, v6 offset:1536
    ds_read_b32 v23, v6 offset:1792
    ds_read_b32 v24, v6 offset:2048
    ds_read_b32 v25, v6 offset:2304
    ds_read_b32 v26, v6 offset:2560
    ds_read_b32 v27, v6 offset:2816
    ds_read_b32 v28, v6 offset:3072
    ds_read_b32 v29, v6 offset:3328
    ds_read_b32 v30, v6 offset:3584
    ds_read_b32 v31, v6 offset:3840
    ds_read_b32 v32, v6 offset:4096
    ds_read_b32 v33, v6 offset:4352
    ds_read_b32 v34, v6 offset:4608
    ds_read_b32 v35, v6 offset:4864
    ds_read_b32 v36, v6 offset:5120
    ds_read_b32 v37, v6 offset:5376
    ds_read_b32 v38, v6 offset:5632
    ds_read_b32 v39, v6 offset:5888
    ds_read_b32 v40, v6 offset:6144
    ds_read_b32 v41, v6 offset:6400
    ds_read_b32 v42, v6 offset:6656
    ds_read_b32 v43, v6 offset:6912
    ds_read_b32 v44, v6 offset:7168
    ds_read_b32 v45, v6 offset:7424
    ds_read_b32 v46, v6 offset:7680
    ds_read_b32 v47, v6 offset:7936
    s_waitcnt lgkmcnt(0)
    v_add_f32 v16, v16, v17
    v_add_f32 v16, v16, v18
    v_add_f32 v16, v16, v19
    v_add_f32 v16, v16, v20
    v_add_f32 v16, v16, v21
    v_add_f32 v16, v16, v22
    v_add_f32 v16, v16, v23
    v_add_f32 v16, v16, v24
    v_add_f32 v16, v16, v25
    v_add_f32 v16, v16, v26
    v_add_f32 v16, v16, v27
    v_add_f32 v16, v16, v28
    v_add_f32 v16, v16, v29
    v_add_f32 v16, v16, v30
    v_add_f32 v16, v16, v31
    v_add_f32 v16, v16, v32
    v_add_f32 v16, v16, v33
    v_add_f32 v16, v16, v34
    v_add_f32 v16, v16, v35
    v_add_f32 v16, v16, v36
    v_add_f32 v16, v16, v37
    v_add_f32 v16, v16, v38
    v_add_f32 v16, v16, v39
    v_add_f32 v16, v16, v40
    v_add_f32 v16, v16, v41
    v_add_f32 v16, v16, v42
    v_add_f32 v16, v16, v43
    v_add_f32 v16, v16, v44
    v_add_f32 v16, v16, v45
    v_add_f32 v16, v16, v46
    v_add_f32 v16, v16, v47
    s_lshl_b32 s43, s41, 8
    buffer_store_dword v16, v6, s[12:15], s43 offen
    s_branch k0_kernel_end1
k0_kernel_wf3:
    s_mov_b32 s8, s52
    s_mov_b32 s9, s53
    s_mov_b32 s10, 25600
    s_mov_b32 s11, 0x00020000
    s_add_u32 s12, s70, 31277056
    s_addc_u32 s13, s71, 0
    s_mov_b32 s14, 65536
    s_mov_b32 s15, 0x00020000
    s_sub_u32 s41, s2, 182
    v_lshrrev_b32 v3, 7, v0
    v_bfe_u32 v4, v0, 6, 1
    v_and_b32 v5, 31, v1
    v_lshrrev_b32 v6, 5, v1
    s_lshl_b32 s42, s41, 1
    v_add_u32 v3, s42, v3
    v_lshlrev_b32 v7, 4, v4
    v_lshl_add_u32 v7, v6, 3, v7
    v_mul_u32_u24 v8, 400, v3
    v_mad_u32_u24 v8, v7, 20, v8
    v_add_u32 v8, v8, v5
    v_lshlrev_b32 v8, 1, v8
    v_cmp_gt_u32 vcc, 20, v5
    v_mov_b32 v9, 0x7ffffff0
    v_cndmask_b32 v8, v9, v8, vcc
    v_add_u32 v10, 0, v7
    v_cmp_gt_u32 vcc, 20, v10
    v_cndmask_b32 v11, v9, v8, vcc
    buffer_load_ushort v24, v11, s[8:11], 0 offen offset:0
    v_add_u32 v10, 1, v7
    v_cmp_gt_u32 vcc, 20, v10
    v_cndmask_b32 v11, v9, v8, vcc
    buffer_load_ushort v25, v11, s[8:11], 0 offen offset:40
    v_add_u32 v10, 2, v7
    v_cmp_gt_u32 vcc, 20, v10
    v_cndmask_b32 v11, v9, v8, vcc
    buffer_load_ushort v26, v11, s[8:11], 0 offen offset:80
    v_add_u32 v10, 3, v7
    v_cmp_gt_u32 vcc, 20, v10
    v_cndmask_b32 v11, v9, v8, vcc
    buffer_load_ushort v27, v11, s[8:11], 0 offen offset:120
    v_add_u32 v10, 4, v7
    v_cmp_gt_u32 vcc, 20, v10
    v_cndmask_b32 v11, v9, v8, vcc
    buffer_load_ushort v28, v11, s[8:11], 0 offen offset:160
    v_add_u32 v10, 5, v7
    v_cmp_gt_u32 vcc, 20, v10
    v_cndmask_b32 v11, v9, v8, vcc
    buffer_load_ushort v29, v11, s[8:11], 0 offen offset:200
    v_add_u32 v10, 6, v7
    v_cmp_gt_u32 vcc, 20, v10
    v_cndmask_b32 v11, v9, v8, vcc
    buffer_load_ushort v30, v11, s[8:11], 0 offen offset:240
    v_add_u32 v10, 7, v7
    v_cmp_gt_u32 vcc, 20, v10
    v_cndmask_b32 v11, v9, v8, vcc
    buffer_load_ushort v31, v11, s[8:11], 0 offen offset:280
    v_lshlrev_b32 v12, 1, v3
    v_add_u32 v12, v12, v4
    v_lshlrev_b32 v12, 6, v12
    v_add_u32 v12, v12, v1
    v_lshlrev_b32 v12, 4, v12
    s_waitcnt vmcnt(0)
    v_lshl_or_b32 v16, v25, 16, v24
    v_lshl_or_b32 v17, v27, 16, v26
    v_lshl_or_b32 v18, v29, 16, v28
    v_lshl_or_b32 v19, v31, 16, v30
    buffer_store_dwordx4 v[16:19], v12, s[12:15], 0 offen
    s_branch k0_kernel_end1
k0_kernel_z4:
    s_add_u32 s12, s70, 31342592
    s_addc_u32 s13, s71, 0
    s_mov_b32 s14, 524288
    s_mov_b32 s15, 0x00020000
    s_sub_u32 s41, s2, 198
    s_lshl_b32 s41, s41, 14
    v_lshlrev_b32 v3, 4, v0
    v_mov_b32 v8, 0
    v_mov_b32 v9, 0
    v_mov_b32 v10, 0
    v_mov_b32 v11, 0
    buffer_store_dwordx4 v[8:11], v3, s[12:15], s41 offen
    s_add_u32 s41, s41, 4096
    buffer_store_dwordx4 v[8:11], v3, s[12:15], s41 offen
    s_add_u32 s41, s41, 4096
    buffer_store_dwordx4 v[8:11], v3, s[12:15], s41 offen
    s_add_u32 s41, s41, 4096
    buffer_store_dwordx4 v[8:11], v3, s[12:15], s41 offen
    s_add_u32 s41, s41, 4096
k0_kernel_end1:
    s_endpgm
.globl g1a_kernel
.p2align 8
.type g1a_kernel,@function
g1a_kernel:
    s_cmp_ge_u32 s2, 240
    s_cbranch_scc1 g1a_kernel_end1
    s_load_dwordx16 s[48:63], s[0:1], 0
    s_load_dwordx8 s[64:71], s[0:1], 64
    v_and_b32 v1, 63, v0
    v_lshrrev_b32 v2, 6, v0
    s_and_b32 s46, s2, 7
    s_lshr_b32 s47, s2, 3
    s_mul_i32 s36, s47, 137
    s_lshr_b32 s36, s36, 11
    s_mul_i32 s3, s36, 15
    s_sub_u32 s37, s47, s3
    s_mul_i32 s46, s46, 2
    s_add_u32 s36, s36, s46
    s_mul_i32 s38, s36, 128
    s_mul_i32 s39, s37, 128
    v_readfirstlane_b32 s40, v2
    s_lshr_b32 s74, s40, 2
    s_and_b32 s40, s40, 3
    s_cmp_eq_u32 s74, 0
    s_cbranch_scc0 g1a_kernel_prod2
    s_branch g1a_kernel_cons3
g1a_kernel_prod2:
    s_mul_i32 s41, s38, 1280
    s_lshl_b32 s42, s39, 1
    s_mul_i32 s43, s40, 4096
    s_mul_i32 s44, s40, 4096
    s_add_u32 s44, s44, 65536
    s_mul_i32 s46, s40, 256
    s_add_u32 s46, s46, 0
    v_add_u32 v2, s46, v1
    v_lshrrev_b32 v3, 3, v2
    v_and_b32 v4, 7, v2
    v_bfe_u32 v5, v3, 1, 3
    v_xor_b32 v4, v4, v5
    v_lshlrev_b32 v4, 4, v4
    s_mov_b32 s47, 1280
    v_mad_u32_u24 v10, v3, s47, v4
    s_mul_i32 s46, s40, 256
    s_add_u32 s46, s46, 64
    v_add_u32 v2, s46, v1
    v_lshrrev_b32 v3, 3, v2
    v_and_b32 v4, 7, v2
    v_bfe_u32 v5, v3, 1, 3
    v_xor_b32 v4, v4, v5
    v_lshlrev_b32 v4, 4, v4
    s_mov_b32 s47, 1280
    v_mad_u32_u24 v11, v3, s47, v4
    s_mul_i32 s46, s40, 256
    s_add_u32 s46, s46, 128
    v_add_u32 v2, s46, v1
    v_lshrrev_b32 v3, 3, v2
    v_and_b32 v4, 7, v2
    v_bfe_u32 v5, v3, 1, 3
    v_xor_b32 v4, v4, v5
    v_lshlrev_b32 v4, 4, v4
    s_mov_b32 s47, 1280
    v_mad_u32_u24 v12, v3, s47, v4
    s_mul_i32 s46, s40, 256
    s_add_u32 s46, s46, 192
    v_add_u32 v2, s46, v1
    v_lshrrev_b32 v3, 3, v2
    v_and_b32 v4, 7, v2
    v_bfe_u32 v5, v3, 1, 3
    v_xor_b32 v4, v4, v5
    v_lshlrev_b32 v4, 4, v4
    s_mov_b32 s47, 1280
    v_mad_u32_u24 v13, v3, s47, v4
    s_mul_i32 s46, s40, 256
    s_add_u32 s46, s46, 0
    v_add_u32 v2, s46, v1
    v_lshrrev_b32 v3, 4, v2
    s_mov_b32 s47, 16
    v_mul_u32_u24 v4, s47, v3
    v_sub_u32 v4, v2, v4
    v_and_b32 v5, 3, v3
    v_lshlrev_b32 v5, 2, v5
    v_xor_b32 v4, v4, v5
    v_lshlrev_b32 v4, 4, v4
    s_mov_b32 s47, 3840
    v_mad_u32_u24 v14, v3, s47, v4
    s_mul_i32 s46, s40, 256
    s_add_u32 s46, s46, 64
    v_add_u32 v2, s46, v1
    v_lshrrev_b32 v3, 4, v2
    s_mov_b32 s47, 16
    v_mul_u32_u24 v4, s47, v3
    v_sub_u32 v4, v2, v4
    v_and_b32 v5, 3, v3
    v_lshlrev_b32 v5, 2, v5
    v_xor_b32 v4, v4, v5
    v_lshlrev_b32 v4, 4, v4
    s_mov_b32 s47, 3840
    v_mad_u32_u24 v15, v3, s47, v4
    s_mul_i32 s46, s40, 256
    s_add_u32 s46, s46, 128
    v_add_u32 v2, s46, v1
    v_lshrrev_b32 v3, 4, v2
    s_mov_b32 s47, 16
    v_mul_u32_u24 v4, s47, v3
    v_sub_u32 v4, v2, v4
    v_and_b32 v5, 3, v3
    v_lshlrev_b32 v5, 2, v5
    v_xor_b32 v4, v4, v5
    v_lshlrev_b32 v4, 4, v4
    s_mov_b32 s47, 3840
    v_mad_u32_u24 v16, v3, s47, v4
    s_mul_i32 s46, s40, 256
    s_add_u32 s46, s46, 192
    v_add_u32 v2, s46, v1
    v_lshrrev_b32 v3, 4, v2
    s_mov_b32 s47, 16
    v_mul_u32_u24 v4, s47, v3
    v_sub_u32 v4, v2, v4
    v_and_b32 v5, 3, v3
    v_lshlrev_b32 v5, 2, v5
    v_xor_b32 v4, v4, v5
    v_lshlrev_b32 v4, 4, v4
    s_mov_b32 s47, 3840
    v_mad_u32_u24 v17, v3, s47, v4
    s_waitcnt lgkmcnt(0)
    s_mov_b32 s8, s48
    s_mov_b32 s9, s49
    s_mov_b32 s10, 2621440
    s_mov_b32 s11, 0x00020000
    s_mov_b32 s12, s50
    s_mov_b32 s13, s51
    s_mov_b32 s14, 2457600
    s_mov_b32 s15, 0x00020000
    s_add_u32 m0, s43, 0
    s_nop 0
    buffer_load_dwordx4 v10, s[8:11], s41 offen lds
    s_add_u32 m0, s43, 1024
    s_nop 0
    buffer_load_dwordx4 v11, s[8:11], s41 offen lds
    s_add_u32 m0, s43, 2048
    s_nop 0
    buffer_load_dwordx4 v12, s[8:11], s41 offen lds
    s_add_u32 m0, s43, 3072
    s_nop 0
    buffer_load_dwordx4 v13, s[8:11], s41 offen lds
    s_add_u32 m0, s44, 0
    s_nop 0
    buffer_load_dwordx4 v14, s[12:15], s42 offen lds
    s_add_u32 m0, s44, 1024
    s_nop 0
    buffer_load_dwordx4 v15, s[12:15], s42 offen lds
    s_add_u32 m0, s44, 2048
    s_nop 0
    buffer_load_dwordx4 v16, s[12:15], s42 offen lds
    s_add_u32 m0, s44, 3072
    s_nop 0
    buffer_load_dwordx4 v17, s[12:15], s42 offen lds
    s_add_u32 s41, s41, 128
    s_add_u32 s42, s42, 245760
    s_add_u32 m0, s43, 16384
    s_nop 0
    buffer_load_dwordx4 v10, s[8:11], s41 offen lds
    s_add_u32 m0, s43, 17408
    s_nop 0
    buffer_load_dwordx4 v11, s[8:11], s41 offen lds
    s_add_u32 m0, s43, 18432
    s_nop 0
    buffer_load_dwordx4 v12, s[8:11], s41 offen lds
    s_add_u32 m0, s43, 19456
    s_nop 0
    buffer_load_dwordx4 v13, s[8:11], s41 offen lds
    s_add_u32 m0, s44, 16384
    s_nop 0
    buffer_load_dwordx4 v14, s[12:15], s42 offen lds
    s_add_u32 m0, s44, 17408
    s_nop 0
    buffer_load_dwordx4 v15, s[12:15], s42 offen lds
    s_add_u32 m0, s44, 18432
    s_nop 0
    buffer_load_dwordx4 v16, s[12:15], s42 offen lds
    s_add_u32 m0, s44, 19456
    s_nop 0
    buffer_load_dwordx4 v17, s[12:15], s42 offen lds
    s_add_u32 s41, s41, 128
    s_add_u32 s42, s42, 245760
    s_add_u32 m0, s43, 32768
    s_nop 0
    buffer_load_dwordx4 v10, s[8:11], s41 offen lds
    s_add_u32 m0, s43, 33792
    s_nop 0
    buffer_load_dwordx4 v11, s[8:11], s41 offen lds
    s_add_u32 m0, s43, 34816
    s_nop 0
    buffer_load_dwordx4 v12, s[8:11], s41 offen lds
    s_add_u32 m0, s43, 35840
    s_nop 0
    buffer_load_dwordx4 v13, s[8:11], s41 offen lds
    s_add_u32 m0, s44, 32768
    s_nop 0
    buffer_load_dwordx4 v14, s[12:15], s42 offen lds
    s_add_u32 m0, s44, 33792
    s_nop 0
    buffer_load_dwordx4 v15, s[12:15], s42 offen lds
    s_add_u32 m0, s44, 34816
    s_nop 0
    buffer_load_dwordx4 v16, s[12:15], s42 offen lds
    s_add_u32 m0, s44, 35840
    s_nop 0
    buffer_load_dwordx4 v17, s[12:15], s42 offen lds
    s_add_u32 s41, s41, 128
    s_add_u32 s42, s42, 245760
    s_waitcnt vmcnt(16)
    s_barrier
    s_add_u32 m0, s43, 49152
    s_nop 0
    buffer_load_dwordx4 v10, s[8:11], s41 offen lds
    s_add_u32 m0, s43, 50176
    s_nop 0
    buffer_load_dwordx4 v11, s[8:11], s41 offen lds
    s_add_u32 m0, s43, 51200
    s_nop 0
    buffer_load_dwordx4 v12, s[8:11], s41 offen lds
    s_add_u32 m0, s43, 52224
    s_nop 0
    buffer_load_dwordx4 v13, s[8:11], s41 offen lds
    s_add_u32 m0, s44, 49152
    s_nop 0
    buffer_load_dwordx4 v14, s[12:15], s42 offen lds
    s_add_u32 m0, s44, 50176
    s_nop 0
    buffer_load_dwordx4 v15, s[12:15], s42 offen lds
    s_add_u32 m0, s44, 51200
    s_nop 0
    buffer_load_dwordx4 v16, s[12:15], s42 offen lds
    s_add_u32 m0, s44, 52224
    s_nop 0
    buffer_load_dwordx4 v17, s[12:15], s42 offen lds
    s_add_u32 s41, s41, 128
    s_add_u32 s42, s42, 245760
    s_waitcnt vmcnt(16)
    s_barrier
    s_add_u32 m0, s43, 0
    s_nop 0
    buffer_load_dwordx4 v10, s[8:11], s41 offen lds
    s_add_u32 m0, s43, 1024
    s_nop 0
    buffer_load_dwordx4 v11, s[8:11], s41 offen lds
    s_add_u32 m0, s43, 2048
    s_nop 0
    buffer_load_dwordx4 v12, s[8:11], s41 offen lds
    s_add_u32 m0, s43, 3072
    s_nop 0
    buffer_load_dwordx4 v13, s[8:11], s41 offen lds
    s_add_u32 m0, s44, 0
    s_nop 0
    buffer_load_dwordx4 v14, s[12:15], s42 offen lds
    s_add_u32 m0, s44, 1024
    s_nop 0
    buffer_load_dwordx4 v15, s[12:15], s42 offen lds
    s_add_u32 m0, s44, 2048
    s_nop 0
    buffer_load_dwordx4 v16, s[12:15], s42 offen lds
    s_add_u32 m0, s44, 3072
    s_nop 0
    buffer_load_dwordx4 v17, s[12:15], s42 offen lds
    s_add_u32 s41, s41, 128
    s_add_u32 s42, s42, 245760
    s_waitcnt vmcnt(16)
    s_barrier
    s_add_u32 m0, s43, 16384
    s_nop 0
    buffer_load_dwordx4 v10, s[8:11], s41 offen lds
    s_add_u32 m0, s43, 17408
    s_nop 0
    buffer_load_dwordx4 v11, s[8:11], s41 offen lds
    s_add_u32 m0, s43, 18432
    s_nop 0
    buffer_load_dwordx4 v12, s[8:11], s41 offen lds
    s_add_u32 m0, s43, 19456
    s_nop 0
    buffer_load_dwordx4 v13, s[8:11], s41 offen lds
    s_add_u32 m0, s44, 16384
    s_nop 0
    buffer_load_dwordx4 v14, s[12:15], s42 offen lds
    s_add_u32 m0, s44, 17408
    s_nop 0
    buffer_load_dwordx4 v15, s[12:15], s42 offen lds
    s_add_u32 m0, s44, 18432
    s_nop 0
    buffer_load_dwordx4 v16, s[12:15], s42 offen lds
    s_add_u32 m0, s44, 19456
    s_nop 0
    buffer_load_dwordx4 v17, s[12:15], s42 offen lds
    s_add_u32 s41, s41, 128
    s_add_u32 s42, s42, 245760
    s_waitcnt vmcnt(16)
    s_barrier
    s_add_u32 m0, s43, 32768
    s_nop 0
    buffer_load_dwordx4 v10, s[8:11], s41 offen lds
    s_add_u32 m0, s43, 33792
    s_nop 0
    buffer_load_dwordx4 v11, s[8:11], s41 offen lds
    s_add_u32 m0, s43, 34816
    s_nop 0
    buffer_load_dwordx4 v12, s[8:11], s41 offen lds
    s_add_u32 m0, s43, 35840
    s_nop 0
    buffer_load_dwordx4 v13, s[8:11], s41 offen lds
    s_add_u32 m0, s44, 32768
    s_nop 0
    buffer_load_dwordx4 v14, s[12:15], s42 offen lds
    s_add_u32 m0, s44, 33792
    s_nop 0
    buffer_load_dwordx4 v15, s[12:15], s42 offen lds
    s_add_u32 m0, s44, 34816
    s_nop 0
    buffer_load_dwordx4 v16, s[12:15], s42 offen lds
    s_add_u32 m0, s44, 35840
    s_nop 0
    buffer_load_dwordx4 v17, s[12:15], s42 offen lds
    s_add_u32 s41, s41, 128
    s_add_u32 s42, s42, 245760
    s_waitcnt vmcnt(16)
    s_barrier
    s_add_u32 m0, s43, 49152
    s_nop 0
    buffer_load_dwordx4 v10, s[8:11], s41 offen lds
    s_add_u32 m0, s43, 50176
    s_nop 0
    buffer_load_dwordx4 v11, s[8:11], s41 offen lds
    s_add_u32 m0, s43, 51200
    s_nop 0
    buffer_load_dwordx4 v12, s[8:11], s41 offen lds
    s_add_u32 m0, s43, 52224
    s_nop 0
    buffer_load_dwordx4 v13, s[8:11], s41 offen lds
    s_add_u32 m0, s44, 49152
    s_nop 0
    buffer_load_dwordx4 v14, s[12:15], s42 offen lds
    s_add_u32 m0, s44, 50176
    s_nop 0
    buffer_load_dwordx4 v15, s[12:15], s42 offen lds
    s_add_u32 m0, s44, 51200
    s_nop 0
    buffer_load_dwordx4 v16, s[12:15], s42 offen lds
    s_add_u32 m0, s44, 52224
    s_nop 0
    buffer_load_dwordx4 v17, s[12:15], s42 offen lds
    s_add_u32 s41, s41, 128
    s_add_u32 s42, s42, 245760
    s_waitcnt vmcnt(16)
    s_barrier
    s_add_u32 m0, s43, 0
    s_nop 0
    buffer_load_dwordx4 v10, s[8:11], s41 offen lds
    s_add_u32 m0, s43, 1024
    s_nop 0
    buffer_load_dwordx4 v11, s[8:11], s41 offen lds
    s_add_u32 m0, s43, 2048
    s_nop 0
    buffer_load_dwordx4 v12, s[8:11], s41 offen lds
    s_add_u32 m0, s43, 3072
    s_nop 0
    buffer_load_dwordx4 v13, s[8:11], s41 offen lds
    s_add_u32 m0, s44, 0
    s_nop 0
    buffer_load_dwordx4 v14, s[12:15], s42 offen lds
    s_add_u32 m0, s44, 1024
    s_nop 0
    buffer_load_dwordx4 v15, s[12:15], s42 offen lds
    s_add_u32 m0, s44, 2048
    s_nop 0
    buffer_load_dwordx4 v16, s[12:15], s42 offen lds
    s_add_u32 m0, s44, 3072
    s_nop 0
    buffer_load_dwordx4 v17, s[12:15], s42 offen lds
    s_add_u32 s41, s41, 128
    s_add_u32 s42, s42, 245760
    s_waitcnt vmcnt(16)
    s_barrier
    s_add_u32 m0, s43, 16384
    s_nop 0
    buffer_load_dwordx4 v10, s[8:11], s41 offen lds
    s_add_u32 m0, s43, 17408
    s_nop 0
    buffer_load_dwordx4 v11, s[8:11], s41 offen lds
    s_add_u32 m0, s43, 18432
    s_nop 0
    buffer_load_dwordx4 v12, s[8:11], s41 offen lds
    s_add_u32 m0, s43, 19456
    s_nop 0
    buffer_load_dwordx4 v13, s[8:11], s41 offen lds
    s_add_u32 m0, s44, 16384
    s_nop 0
    buffer_load_dwordx4 v14, s[12:15], s42 offen lds
    s_add_u32 m0, s44, 17408
    s_nop 0
    buffer_load_dwordx4 v15, s[12:15], s42 offen lds
    s_add_u32 m0, s44, 18432
    s_nop 0
    buffer_load_dwordx4 v16, s[12:15], s42 offen lds
    s_add_u32 m0, s44, 19456
    s_nop 0
    buffer_load_dwordx4 v17, s[12:15], s42 offen lds
    s_add_u32 s41, s41, 128
    s_add_u32 s42, s42, 245760
    s_waitcnt vmcnt(16)
    s_barrier
    s_waitcnt vmcnt(8)
    s_barrier
    s_waitcnt vmcnt(0)
    s_barrier
    s_endpgm
g1a_kernel_cons3:
    s_waitcnt lgkmcnt(0)
    s_mov_b32 s16, s70
    s_mov_b32 s17, s71
    s_mov_b32 s18, 7864320
    s_mov_b32 s19, 0x00020000
    s_lshr_b32 s72, s40, 1
    s_and_b32 s73, s40, 1
    s_mul_i32 s46, s72, 64
    v_and_b32 v2, 31, v1
    v_add_u32 v2, s46, v2
    v_lshrrev_b32 v3, 5, v1
    v_bfe_u32 v4, v2, 1, 3
    v_xor_b32 v3, v3, v4
    v_lshlrev_b32 v3, 4, v3
    v_lshl_add_u32 v18, v2, 7, v3
    v_xor_b32 v19, 32, v18
    v_xor_b32 v20, 64, v18
    v_xor_b32 v21, 96, v18
    s_mul_i32 s46, s73, 8
    s_add_u32 s46, s46, 0
    v_bfe_u32 v2, v1, 4, 1
    v_lshlrev_b32 v2, 1, v2
    v_bfe_u32 v3, v1, 1, 1
    v_add3_u32 v2, v2, v3, s46
    v_bfe_u32 v4, v1, 2, 2
    v_lshlrev_b32 v5, 2, v4
    v_xor_b32 v2, v2, v5
    v_lshlrev_b32 v2, 4, v2
    v_and_b32 v3, 1, v1
    v_lshl_add_u32 v2, v3, 3, v2
    v_lshrrev_b32 v3, 5, v1
    v_lshl_add_u32 v3, v3, 3, v4
    s_mov_b32 s47, 256
    v_mad_u32_u24 v2, v3, s47, v2
    v_add_u32 v22, 65536, v2
    s_mul_i32 s46, s73, 8
    s_add_u32 s46, s46, 4
    v_bfe_u32 v2, v1, 4, 1
    v_lshlrev_b32 v2, 1, v2
    v_bfe_u32 v3, v1, 1, 1
    v_add3_u32 v2, v2, v3, s46
    v_bfe_u32 v4, v1, 2, 2
    v_lshlrev_b32 v5, 2, v4
    v_xor_b32 v2, v2, v5
    v_lshlrev_b32 v2, 4, v2
    v_and_b32 v3, 1, v1
    v_lshl_add_u32 v2, v3, 3, v2
    v_lshrrev_b32 v3, 5, v1
    v_lshl_add_u32 v3, v3, 3, v4
    s_mov_b32 s47, 256
    v_mad_u32_u24 v2, v3, s47, v2
    v_add_u32 v23, 65536, v2
    s_mul_i32 s46, s72, 64
    v_and_b32 v2, 31, v1
    v_add_u32 v2, s46, v2
    s_mov_b32 s47, 272
    v_mul_u32_u24 v2, s47, v2
    s_mul_i32 s46, s73, 128
    v_lshrrev_b32 v3, 5, v1
    v_lshlrev_b32 v3, 3, v3
    v_add3_u32 v40, v2, v3, s46
    v_add_u32 v2, 0, v0
    v_lshrrev_b32 v6, 4, v2
    s_mov_b32 s46, 16
    v_mul_u32_u24 v7, s46, v6
    v_sub_u32 v7, v2, v7
    s_mov_b32 s46, 272
    v_mul_u32_u24 v32, s46, v6
    v_lshl_add_u32 v32, v7, 4, v32
    v_add_u32 v24, s38, v6
    s_mov_b32 s46, 3840
    v_mul_lo_u32 v24, v24, s46
    v_lshl_add_u32 v24, v7, 4, v24
    s_lshl_b32 s46, s39, 1
    v_add_u32 v24, s46, v24
    v_add_u32 v2, 256, v0
    v_lshrrev_b32 v6, 4, v2
    s_mov_b32 s46, 16
    v_mul_u32_u24 v7, s46, v6
    v_sub_u32 v7, v2, v7
    s_mov_b32 s46, 272
    v_mul_u32_u24 v33, s46, v6
    v_lshl_add_u32 v33, v7, 4, v33
    v_add_u32 v25, s38, v6
    s_mov_b32 s46, 3840
    v_mul_lo_u32 v25, v25, s46
    v_lshl_add_u32 v25, v7, 4, v25
    s_lshl_b32 s46, s39, 1
    v_add_u32 v25, s46, v25
    v_add_u32 v2, 512, v0
    v_lshrrev_b32 v6, 4, v2
    s_mov_b32 s46, 16
    v_mul_u32_u24 v7, s46, v6
    v_sub_u32 v7, v2, v7
    s_mov_b32 s46, 272
    v_mul_u32_u24 v34, s46, v6
    v_lshl_add_u32 v34, v7, 4, v34
    v_add_u32 v26, s38, v6
    s_mov_b32 s46, 3840
    v_mul_lo_u32 v26, v26, s46
    v_lshl_add_u32 v26, v7, 4, v26
    s_lshl_b32 s46, s39, 1
    v_add_u32 v26, s46, v26
    v_add_u32 v2, 768, v0
    v_lshrrev_b32 v6, 4, v2
    s_mov_b32 s46, 16
    v_mul_u32_u24 v7, s46, v6
    v_sub_u32 v7, v2, v7
    s_mov_b32 s46, 272
    v_mul_u32_u24 v35, s46, v6
    v_lshl_add_u32 v35, v7, 4, v35
    v_add_u32 v27, s38, v6
    s_mov_b32 s46, 3840
    v_mul_lo_u32 v27, v27, s46
    v_lshl_add_u32 v27, v7, 4, v27
    s_lshl_b32 s46, s39, 1
    v_add_u32 v27, s46, v27
    v_add_u32 v2, 1024, v0
    v_lshrrev_b32 v6, 4, v2
    s_mov_b32 s46, 16
    v_mul_u32_u24 v7, s46, v6
    v_sub_u32 v7, v2, v7
    s_mov_b32 s46, 272
    v_mul_u32_u24 v36, s46, v6
    v_lshl_add_u32 v36, v7, 4, v36
    v_add_u32 v28, s38, v6
    s_mov_b32 s46, 3840
    v_mul_lo_u32 v28, v28, s46
    v_lshl_add_u32 v28, v7, 4, v28
    s_lshl_b32 s46, s39, 1
    v_add_u32 v28, s46, v28
    v_add_u32 v2, 1280, v0
    v_lshrrev_b32 v6, 4, v2
    s_mov_b32 s46, 16
    v_mul_u32_u24 v7, s46, v6
    v_sub_u32 v7, v2, v7
    s_mov_b32 s46, 272
    v_mul_u32_u24 v37, s46, v6
    v_lshl_add_u32 v37, v7, 4, v37
    v_add_u32 v29, s38, v6
    s_mov_b32 s46, 3840
    v_mul_lo_u32 v29, v29, s46
    v_lshl_add_u32 v29, v7, 4, v29
    s_lshl_b32 s46, s39, 1
    v_add_u32 v29, s46, v29
    v_add_u32 v2, 1536, v0
    v_lshrrev_b32 v6, 4, v2
    s_mov_b32 s46, 16
    v_mul_u32_u24 v7, s46, v6
    v_sub_u32 v7, v2, v7
    s_mov_b32 s46, 272
    v_mul_u32_u24 v38, s46, v6
    v_lshl_add_u32 v38, v7, 4, v38
    v_add_u32 v30, s38, v6
    s_mov_b32 s46, 3840
    v_mul_lo_u32 v30, v30, s46
    v_lshl_add_u32 v30, v7, 4, v30
    s_lshl_b32 s46, s39, 1
    v_add_u32 v30, s46, v30
    v_add_u32 v2, 1792, v0
    v_lshrrev_b32 v6, 4, v2
    s_mov_b32 s46, 16
    v_mul_u32_u24 v7, s46, v6
    v_sub_u32 v7, v2, v7
    s_mov_b32 s46, 272
    v_mul_u32_u24 v39, s46, v6
    v_lshl_add_u32 v39, v7, 4, v39
    v_add_u32 v31, s38, v6
    s_mov_b32 s46, 3840
    v_mul_lo_u32 v31, v31, s46
    v_lshl_add_u32 v31, v7, 4, v31
    s_lshl_b32 s46, s39, 1
    v_add_u32 v31, s46, v31
    v_mov_b32 v80, 0
    v_mov_b32 v81, 0
    v_mov_b32 v82, 0
    v_mov_b32 v83, 0
    v_mov_b32 v84, 0
    v_mov_b32 v85, 0
    v_mov_b32 v86, 0
    v_mov_b32 v87, 0
    v_mov_b32 v88, 0
    v_mov_b32 v89, 0
    v_mov_b32 v90, 0
    v_mov_b32 v91, 0
    v_mov_b32 v92, 0
    v_mov_b32 v93, 0
    v_mov_b32 v94, 0
    v_mov_b32 v95, 0
    v_mov_b32 v96, 0
    v_mov_b32 v97, 0
    v_mov_b32 v98, 0
    v_mov_b32 v99, 0
    v_mov_b32 v100, 0
    v_mov_b32 v101, 0
    v_mov_b32 v102, 0
    v_mov_b32 v103, 0
    v_mov_b32 v104, 0
    v_mov_b32 v105, 0
    v_mov_b32 v106, 0
    v_mov_b32 v107, 0
    v_mov_b32 v108, 0
    v_mov_b32 v109, 0
    v_mov_b32 v110, 0
    v_mov_b32 v111, 0
    v_mov_b32 v112, 0
    v_mov_b32 v113, 0
    v_mov_b32 v114, 0
    v_mov_b32 v115, 0
    v_mov_b32 v116, 0
    v_mov_b32 v117, 0
    v_mov_b32 v118, 0
    v_mov_b32 v119, 0
    v_mov_b32 v120, 0
    v_mov_b32 v121, 0
    v_mov_b32 v122, 0
    v_mov_b32 v123, 0
    v_mov_b32 v124, 0
    v_mov_b32 v125, 0
    v_mov_b32 v126, 0
    v_mov_b32 v127, 0
    v_mov_b32 v128, 0
    v_mov_b32 v129, 0
    v_mov_b32 v130, 0
    v_mov_b32 v131, 0
    v_mov_b32 v132, 0
    v_mov_b32 v133, 0
    v_mov_b32 v134, 0
    v_mov_b32 v135, 0
    v_mov_b32 v136, 0
    v_mov_b32 v137, 0
    v_mov_b32 v138, 0
    v_mov_b32 v139, 0
    v_mov_b32 v140, 0
    v_mov_b32 v141, 0
    v_mov_b32 v142, 0
    v_mov_b32 v143, 0
    s_barrier
    ds_read_b128 v[44:47], v18 offset:0
    ds_read_b128 v[48:51], v18 offset:4096
    ds_read_b64_tr_b16 v[52:53], v22 offset:0
    ds_read_b64_tr_b16 v[54:55], v22 offset:1024
    ds_read_b64_tr_b16 v[56:57], v23 offset:0
    ds_read_b64_tr_b16 v[58:59], v23 offset:1024
    ds_read_b128 v[60:63], v19 offset:0
    ds_read_b128 v[64:67], v19 offset:4096
    ds_read_b64_tr_b16 v[68:69], v22 offset:4096
    ds_read_b64_tr_b16 v[70:71], v22 offset:5120
    ds_read_b64_tr_b16 v[72:73], v23 offset:4096
    ds_read_b64_tr_b16 v[74:75], v23 offset:5120
    s_waitcnt lgkmcnt(6)
    v_mfma_f32_32x32x16_bf16 v[80:95], v[52:55], v[44:47], v[80:95]
    v_mfma_f32_32x32x16_bf16 v[96:111], v[52:55], v[48:51], v[96:111]
    v_mfma_f32_32x32x16_bf16 v[112:127], v[56:59], v[44:47], v[112:127]
    v_mfma_f32_32x32x16_bf16 v[128:143], v[56:59], v[48:51], v[128:143]
    ds_read_b128 v[44:47], v20 offset:0
    ds_read_b128 v[48:51], v20 offset:4096
    ds_read_b64_tr_b16 v[52:53], v22 offset:8192
    ds_read_b64_tr_b16 v[54:55], v22 offset:9216
    ds_read_b64_tr_b16 v[56:57], v23 offset:8192
    ds_read_b64_tr_b16 v[58:59], v23 offset:9216
    s_waitcnt lgkmcnt(6)
    v_mfma_f32_32x32x16_bf16 v[80:95], v[68:71], v[60:63], v[80:95]
    v_mfma_f32_32x32x16_bf16 v[96:111], v[68:71], v[64:67], v[96:111]
    v_mfma_f32_32x32x16_bf16 v[112:127], v[72:75], v[60:63], v[112:127]
    v_mfma_f32_32x32x16_bf16 v[128:143], v[72:75], v[64:67], v[128:143]
    ds_read_b128 v[60:63], v21 offset:0
    ds_read_b128 v[64:67], v21 offset:4096
    ds_read_b64_tr_b16 v[68:69], v22 offset:12288
    ds_read_b64_tr_b16 v[70:71], v22 offset:13312
    ds_read_b64_tr_b16 v[72:73], v23 offset:12288
    ds_read_b64_tr_b16 v[74:75], v23 offset:13312
    s_waitcnt lgkmcnt(6)
    v_mfma_f32_32x32x16_bf16 v[80:95], v[52:55], v[44:47], v[80:95]
    v_mfma_f32_32x32x16_bf16 v[96:111], v[52:55], v[48:51], v[96:111]
    v_mfma_f32_32x32x16_bf16 v[112:127], v[56:59], v[44:47], v[112:127]
    v_mfma_f32_32x32x16_bf16 v[128:143], v[56:59], v[48:51], v[128:143]
    s_waitcnt lgkmcnt(0)
    v_mfma_f32_32x32x16_bf16 v[80:95], v[68:71], v[60:63], v[80:95]
    v_mfma_f32_32x32x16_bf16 v[96:111], v[68:71], v[64:67], v[96:111]
    v_mfma_f32_32x32x16_bf16 v[112:127], v[72:75], v[60:63], v[112:127]
    v_mfma_f32_32x32x16_bf16 v[128:143], v[72:75], v[64:67], v[128:143]
    s_barrier
    ds_read_b128 v[44:47], v18 offset:16384
    ds_read_b128 v[48:51], v18 offset:20480
    ds_read_b64_tr_b16 v[52:53], v22 offset:16384
    ds_read_b64_tr_b16 v[54:55], v22 offset:17408
    ds_read_b64_tr_b16 v[56:57], v23 offset:16384
    ds_read_b64_tr_b16 v[58:59], v23 offset:17408
    ds_read_b128 v[60:63], v19 offset:16384
    ds_read_b128 v[64:67], v19 offset:20480
    ds_read_b64_tr_b16 v[68:69], v22 offset:20480
    ds_read_b64_tr_b16 v[70:71], v22 offset:21504
    ds_read_b64_tr_b16 v[72:73], v23 offset:20480
    ds_read_b64_tr_b16 v[74:75], v23 offset:21504
    s_waitcnt lgkmcnt(6)
    v_mfma_f32_32x32x16_bf16 v[80:95], v[52:55], v[44:47], v[80:95]
    v_mfma_f32_32x32x16_bf16 v[96:111], v[52:55], v[48:51], v[96:111]
    v_mfma_f32_32x32x16_bf16 v[112:127], v[56:59], v[44:47], v[112:127]
    v_mfma_f32_32x32x16_bf16 v[128:143], v[56:59], v[48:51], v[128:143]
    ds_read_b128 v[44:47], v20 offset:16384
    ds_read_b128 v[48:51], v20 offset:20480
    ds_read_b64_tr_b16 v[52:53], v22 offset:24576
    ds_read_b64_tr_b16 v[54:55], v22 offset:25600
    ds_read_b64_tr_b16 v[56:57], v23 offset:24576
    ds_read_b64_tr_b16 v[58:59], v23 offset:25600
    s_waitcnt lgkmcnt(6)
    v_mfma_f32_32x32x16_bf16 v[80:95], v[68:71], v[60:63], v[80:95]
    v_mfma_f32_32x32x16_bf16 v[96:111], v[68:71], v[64:67], v[96:111]
    v_mfma_f32_32x32x16_bf16 v[112:127], v[72:75], v[60:63], v[112:127]
    v_mfma_f32_32x32x16_bf16 v[128:143], v[72:75], v[64:67], v[128:143]
    ds_read_b128 v[60:63], v21 offset:16384
    ds_read_b128 v[64:67], v21 offset:20480
    ds_read_b64_tr_b16 v[68:69], v22 offset:28672
    ds_read_b64_tr_b16 v[70:71], v22 offset:29696
    ds_read_b64_tr_b16 v[72:73], v23 offset:28672
    ds_read_b64_tr_b16 v[74:75], v23 offset:29696
    s_waitcnt lgkmcnt(6)
    v_mfma_f32_32x32x16_bf16 v[80:95], v[52:55], v[44:47], v[80:95]
    v_mfma_f32_32x32x16_bf16 v[96:111], v[52:55], v[48:51], v[96:111]
    v_mfma_f32_32x32x16_bf16 v[112:127], v[56:59], v[44:47], v[112:127]
    v_mfma_f32_32x32x16_bf16 v[128:143], v[56:59], v[48:51], v[128:143]
    s_waitcnt lgkmcnt(0)
    v_mfma_f32_32x32x16_bf16 v[80:95], v[68:71], v[60:63], v[80:95]
    v_mfma_f32_32x32x16_bf16 v[96:111], v[68:71], v[64:67], v[96:111]
    v_mfma_f32_32x32x16_bf16 v[112:127], v[72:75], v[60:63], v[112:127]
    v_mfma_f32_32x32x16_bf16 v[128:143], v[72:75], v[64:67], v[128:143]
    s_barrier
    ds_read_b128 v[44:47], v18 offset:32768
    ds_read_b128 v[48:51], v18 offset:36864
    ds_read_b64_tr_b16 v[52:53], v22 offset:32768
    ds_read_b64_tr_b16 v[54:55], v22 offset:33792
    ds_read_b64_tr_b16 v[56:57], v23 offset:32768
    ds_read_b64_tr_b16 v[58:59], v23 offset:33792
    ds_read_b128 v[60:63], v19 offset:32768
    ds_read_b128 v[64:67], v19 offset:36864
    ds_read_b64_tr_b16 v[68:69], v22 offset:36864
    ds_read_b64_tr_b16 v[70:71], v22 offset:37888
    ds_read_b64_tr_b16 v[72:73], v23 offset:36864
    ds_read_b64_tr_b16 v[74:75], v23 offset:37888
    s_waitcnt lgkmcnt(6)
    v_mfma_f32_32x32x16_bf16 v[80:95], v[52:55], v[44:47], v[80:95]
    v_mfma_f32_32x32x16_bf16 v[96:111], v[52:55], v[48:51], v[96:111]
    v_mfma_f32_32x32x16_bf16 v[112:127], v[56:59], v[44:47], v[112:127]
    v_mfma_f32_32x32x16_bf16 v[128:143], v[56:59], v[48:51], v[128:143]
    ds_read_b128 v[44:47], v20 offset:32768
    ds_read_b128 v[48:51], v20 offset:36864
    ds_read_b64_tr_b16 v[52:53], v22 offset:40960
    ds_read_b64_tr_b16 v[54:55], v22 offset:41984
    ds_read_b64_tr_b16 v[56:57], v23 offset:40960
    ds_read_b64_tr_b16 v[58:59], v23 offset:41984
    s_waitcnt lgkmcnt(6)
    v_mfma_f32_32x32x16_bf16 v[80:95], v[68:71], v[60:63], v[80:95]
    v_mfma_f32_32x32x16_bf16 v[96:111], v[68:71], v[64:67], v[96:111]
    v_mfma_f32_32x32x16_bf16 v[112:127], v[72:75], v[60:63], v[112:127]
    v_mfma_f32_32x32x16_bf16 v[128:143], v[72:75], v[64:67], v[128:143]
    ds_read_b128 v[60:63], v21 offset:32768
    ds_read_b128 v[64:67], v21 offset:36864
    ds_read_b64_tr_b16 v[68:69], v22 offset:45056
    ds_read_b64_tr_b16 v[70:71], v22 offset:46080
    ds_read_b64_tr_b16 v[72:73], v23 offset:45056
    ds_read_b64_tr_b16 v[74:75], v23 offset:46080
    s_waitcnt lgkmcnt(6)
    v_mfma_f32_32x32x16_bf16 v[80:95], v[52:55], v[44:47], v[80:95]
    v_mfma_f32_32x32x16_bf16 v[96:111], v[52:55], v[48:51], v[96:111]
    v_mfma_f32_32x32x16_bf16 v[112:127], v[56:59], v[44:47], v[112:127]
    v_mfma_f32_32x32x16_bf16 v[128:143], v[56:59], v[48:51], v[128:143]
    s_waitcnt lgkmcnt(0)
    v_mfma_f32_32x32x16_bf16 v[80:95], v[68:71], v[60:63], v[80:95]
    v_mfma_f32_32x32x16_bf16 v[96:111], v[68:71], v[64:67], v[96:111]
    v_mfma_f32_32x32x16_bf16 v[112:127], v[72:75], v[60:63], v[112:127]
    v_mfma_f32_32x32x16_bf16 v[128:143], v[72:75], v[64:67], v[128:143]
    s_barrier
    ds_read_b128 v[44:47], v18 offset:49152
    ds_read_b128 v[48:51], v18 offset:53248
    ds_read_b64_tr_b16 v[52:53], v22 offset:49152
    ds_read_b64_tr_b16 v[54:55], v22 offset:50176
    ds_read_b64_tr_b16 v[56:57], v23 offset:49152
    ds_read_b64_tr_b16 v[58:59], v23 offset:50176
    ds_read_b128 v[60:63], v19 offset:49152
    ds_read_b128 v[64:67], v19 offset:53248
    ds_read_b64_tr_b16 v[68:69], v22 offset:53248
    ds_read_b64_tr_b16 v[70:71], v22 offset:54272
    ds_read_b64_tr_b16 v[72:73], v23 offset:53248
    ds_read_b64_tr_b16 v[74:75], v23 offset:54272
    s_waitcnt lgkmcnt(6)
    v_mfma_f32_32x32x16_bf16 v[80:95], v[52:55], v[44:47], v[80:95]
    v_mfma_f32_32x32x16_bf16 v[96:111], v[52:55], v[48:51], v[96:111]
    v_mfma_f32_32x32x16_bf16 v[112:127], v[56:59], v[44:47], v[112:127]
    v_mfma_f32_32x32x16_bf16 v[128:143], v[56:59], v[48:51], v[128:143]
    ds_read_b128 v[44:47], v20 offset:49152
    ds_read_b128 v[48:51], v20 offset:53248
    ds_read_b64_tr_b16 v[52:53], v22 offset:57344
    ds_read_b64_tr_b16 v[54:55], v22 offset:58368
    ds_read_b64_tr_b16 v[56:57], v23 offset:57344
    ds_read_b64_tr_b16 v[58:59], v23 offset:58368
    s_waitcnt lgkmcnt(6)
    v_mfma_f32_32x32x16_bf16 v[80:95], v[68:71], v[60:63], v[80:95]
    v_mfma_f32_32x32x16_bf16 v[96:111], v[68:71], v[64:67], v[96:111]
    v_mfma_f32_32x32x16_bf16 v[112:127], v[72:75], v[60:63], v[112:127]
    v_mfma_f32_32x32x16_bf16 v[128:143], v[72:75], v[64:67], v[128:143]
    ds_read_b128 v[60:63], v21 offset:49152
    ds_read_b128 v[64:67], v21 offset:53248
    ds_read_b64_tr_b16 v[68:69], v22 offset:61440
    ds_read_b64_tr_b16 v[70:71], v22 offset:62464
    ds_read_b64_tr_b16 v[72:73], v23 offset:61440
    ds_read_b64_tr_b16 v[74:75], v23 offset:62464
    s_waitcnt lgkmcnt(6)
    v_mfma_f32_32x32x16_bf16 v[80:95], v[52:55], v[44:47], v[80:95]
    v_mfma_f32_32x32x16_bf16 v[96:111], v[52:55], v[48:51], v[96:111]
    v_mfma_f32_32x32x16_bf16 v[112:127], v[56:59], v[44:47], v[112:127]
    v_mfma_f32_32x32x16_bf16 v[128:143], v[56:59], v[48:51], v[128:143]
    s_waitcnt lgkmcnt(0)
    v_mfma_f32_32x32x16_bf16 v[80:95], v[68:71], v[60:63], v[80:95]
    v_mfma_f32_32x32x16_bf16 v[96:111], v[68:71], v[64:67], v[96:111]
    v_mfma_f32_32x32x16_bf16 v[112:127], v[72:75], v[60:63], v[112:127]
    v_mfma_f32_32x32x16_bf16 v[128:143], v[72:75], v[64:67], v[128:143]
    s_barrier
    ds_read_b128 v[44:47], v18 offset:0
    ds_read_b128 v[48:51], v18 offset:4096
    ds_read_b64_tr_b16 v[52:53], v22 offset:0
    ds_read_b64_tr_b16 v[54:55], v22 offset:1024
    ds_read_b64_tr_b16 v[56:57], v23 offset:0
    ds_read_b64_tr_b16 v[58:59], v23 offset:1024
    ds_read_b128 v[60:63], v19 offset:0
    ds_read_b128 v[64:67], v19 offset:4096
    ds_read_b64_tr_b16 v[68:69], v22 offset:4096
    ds_read_b64_tr_b16 v[70:71], v22 offset:5120
    ds_read_b64_tr_b16 v[72:73], v23 offset:4096
    ds_read_b64_tr_b16 v[74:75], v23 offset:5120
    s_waitcnt lgkmcnt(6)
    v_mfma_f32_32x32x16_bf16 v[80:95], v[52:55], v[44:47], v[80:95]
    v_mfma_f32_32x32x16_bf16 v[96:111], v[52:55], v[48:51], v[96:111]
    v_mfma_f32_32x32x16_bf16 v[112:127], v[56:59], v[44:47], v[112:127]
    v_mfma_f32_32x32x16_bf16 v[128:143], v[56:59], v[48:51], v[128:143]
    ds_read_b128 v[44:47], v20 offset:0
    ds_read_b128 v[48:51], v20 offset:4096
    ds_read_b64_tr_b16 v[52:53], v22 offset:8192
    ds_read_b64_tr_b16 v[54:55], v22 offset:9216
    ds_read_b64_tr_b16 v[56:57], v23 offset:8192
    ds_read_b64_tr_b16 v[58:59], v23 offset:9216
    s_waitcnt lgkmcnt(6)
    v_mfma_f32_32x32x16_bf16 v[80:95], v[68:71], v[60:63], v[80:95]
    v_mfma_f32_32x32x16_bf16 v[96:111], v[68:71], v[64:67], v[96:111]
    v_mfma_f32_32x32x16_bf16 v[112:127], v[72:75], v[60:63], v[112:127]
    v_mfma_f32_32x32x16_bf16 v[128:143], v[72:75], v[64:67], v[128:143]
    ds_read_b128 v[60:63], v21 offset:0
    ds_read_b128 v[64:67], v21 offset:4096
    ds_read_b64_tr_b16 v[68:69], v22 offset:12288
    ds_read_b64_tr_b16 v[70:71], v22 offset:13312
    ds_read_b64_tr_b16 v[72:73], v23 offset:12288
    ds_read_b64_tr_b16 v[74:75], v23 offset:13312
    s_waitcnt lgkmcnt(6)
    v_mfma_f32_32x32x16_bf16 v[80:95], v[52:55], v[44:47], v[80:95]
    v_mfma_f32_32x32x16_bf16 v[96:111], v[52:55], v[48:51], v[96:111]
    v_mfma_f32_32x32x16_bf16 v[112:127], v[56:59], v[44:47], v[112:127]
    v_mfma_f32_32x32x16_bf16 v[128:143], v[56:59], v[48:51], v[128:143]
    s_waitcnt lgkmcnt(0)
    v_mfma_f32_32x32x16_bf16 v[80:95], v[68:71], v[60:63], v[80:95]
    v_mfma_f32_32x32x16_bf16 v[96:111], v[68:71], v[64:67], v[96:111]
    v_mfma_f32_32x32x16_bf16 v[112:127], v[72:75], v[60:63], v[112:127]
    v_mfma_f32_32x32x16_bf16 v[128:143], v[72:75], v[64:67], v[128:143]
    s_barrier
    ds_read_b128 v[44:47], v18 offset:16384
    ds_read_b128 v[48:51], v18 offset:20480
    ds_read_b64_tr_b16 v[52:53], v22 offset:16384
    ds_read_b64_tr_b16 v[54:55], v22 offset:17408
    ds_read_b64_tr_b16 v[56:57], v23 offset:16384
    ds_read_b64_tr_b16 v[58:59], v23 offset:17408
    ds_read_b128 v[60:63], v19 offset:16384
    ds_read_b128 v[64:67], v19 offset:20480
    ds_read_b64_tr_b16 v[68:69], v22 offset:20480
    ds_read_b64_tr_b16 v[70:71], v22 offset:21504
    ds_read_b64_tr_b16 v[72:73], v23 offset:20480
    ds_read_b64_tr_b16 v[74:75], v23 offset:21504
    s_waitcnt lgkmcnt(6)
    v_mfma_f32_32x32x16_bf16 v[80:95], v[52:55], v[44:47], v[80:95]
    v_mfma_f32_32x32x16_bf16 v[96:111], v[52:55], v[48:51], v[96:111]
    v_mfma_f32_32x32x16_bf16 v[112:127], v[56:59], v[44:47], v[112:127]
    v_mfma_f32_32x32x16_bf16 v[128:143], v[56:59], v[48:51], v[128:143]
    ds_read_b128 v[44:47], v20 offset:16384
    ds_read_b128 v[48:51], v20 offset:20480
    ds_read_b64_tr_b16 v[52:53], v22 offset:24576
    ds_read_b64_tr_b16 v[54:55], v22 offset:25600
    ds_read_b64_tr_b16 v[56:57], v23 offset:24576
    ds_read_b64_tr_b16 v[58:59], v23 offset:25600
    s_waitcnt lgkmcnt(6)
    v_mfma_f32_32x32x16_bf16 v[80:95], v[68:71], v[60:63], v[80:95]
    v_mfma_f32_32x32x16_bf16 v[96:111], v[68:71], v[64:67], v[96:111]
    v_mfma_f32_32x32x16_bf16 v[112:127], v[72:75], v[60:63], v[112:127]
    v_mfma_f32_32x32x16_bf16 v[128:143], v[72:75], v[64:67], v[128:143]
    ds_read_b128 v[60:63], v21 offset:16384
    ds_read_b128 v[64:67], v21 offset:20480
    ds_read_b64_tr_b16 v[68:69], v22 offset:28672
    ds_read_b64_tr_b16 v[70:71], v22 offset:29696
    ds_read_b64_tr_b16 v[72:73], v23 offset:28672
    ds_read_b64_tr_b16 v[74:75], v23 offset:29696
    s_waitcnt lgkmcnt(6)
    v_mfma_f32_32x32x16_bf16 v[80:95], v[52:55], v[44:47], v[80:95]
    v_mfma_f32_32x32x16_bf16 v[96:111], v[52:55], v[48:51], v[96:111]
    v_mfma_f32_32x32x16_bf16 v[112:127], v[56:59], v[44:47], v[112:127]
    v_mfma_f32_32x32x16_bf16 v[128:143], v[56:59], v[48:51], v[128:143]
    s_waitcnt lgkmcnt(0)
    v_mfma_f32_32x32x16_bf16 v[80:95], v[68:71], v[60:63], v[80:95]
    v_mfma_f32_32x32x16_bf16 v[96:111], v[68:71], v[64:67], v[96:111]
    v_mfma_f32_32x32x16_bf16 v[112:127], v[72:75], v[60:63], v[112:127]
    v_mfma_f32_32x32x16_bf16 v[128:143], v[72:75], v[64:67], v[128:143]
    s_barrier
    ds_read_b128 v[44:47], v18 offset:32768
    ds_read_b128 v[48:51], v18 offset:36864
    ds_read_b64_tr_b16 v[52:53], v22 offset:32768
    ds_read_b64_tr_b16 v[54:55], v22 offset:33792
    ds_read_b64_tr_b16 v[56:57], v23 offset:32768
    ds_read_b64_tr_b16 v[58:59], v23 offset:33792
    ds_read_b128 v[60:63], v19 offset:32768
    ds_read_b128 v[64:67], v19 offset:36864
    ds_read_b64_tr_b16 v[68:69], v22 offset:36864
    ds_read_b64_tr_b16 v[70:71], v22 offset:37888
    ds_read_b64_tr_b16 v[72:73], v23 offset:36864
    ds_read_b64_tr_b16 v[74:75], v23 offset:37888
    s_waitcnt lgkmcnt(6)
    v_mfma_f32_32x32x16_bf16 v[80:95], v[52:55], v[44:47], v[80:95]
    v_mfma_f32_32x32x16_bf16 v[96:111], v[52:55], v[48:51], v[96:111]
    v_mfma_f32_32x32x16_bf16 v[112:127], v[56:59], v[44:47], v[112:127]
    v_mfma_f32_32x32x16_bf16 v[128:143], v[56:59], v[48:51], v[128:143]
    ds_read_b128 v[44:47], v20 offset:32768
    ds_read_b128 v[48:51], v20 offset:36864
    ds_read_b64_tr_b16 v[52:53], v22 offset:40960
    ds_read_b64_tr_b16 v[54:55], v22 offset:41984
    ds_read_b64_tr_b16 v[56:57], v23 offset:40960
    ds_read_b64_tr_b16 v[58:59], v23 offset:41984
    s_waitcnt lgkmcnt(6)
    v_mfma_f32_32x32x16_bf16 v[80:95], v[68:71], v[60:63], v[80:95]
    v_mfma_f32_32x32x16_bf16 v[96:111], v[68:71], v[64:67], v[96:111]
    v_mfma_f32_32x32x16_bf16 v[112:127], v[72:75], v[60:63], v[112:127]
    v_mfma_f32_32x32x16_bf16 v[128:143], v[72:75], v[64:67], v[128:143]
    ds_read_b128 v[60:63], v21 offset:32768
    ds_read_b128 v[64:67], v21 offset:36864
    ds_read_b64_tr_b16 v[68:69], v22 offset:45056
    ds_read_b64_tr_b16 v[70:71], v22 offset:46080
    ds_read_b64_tr_b16 v[72:73], v23 offset:45056
    ds_read_b64_tr_b16 v[74:75], v23 offset:46080
    s_waitcnt lgkmcnt(6)
    v_mfma_f32_32x32x16_bf16 v[80:95], v[52:55], v[44:47], v[80:95]
    v_mfma_f32_32x32x16_bf16 v[96:111], v[52:55], v[48:51], v[96:111]
    v_mfma_f32_32x32x16_bf16 v[112:127], v[56:59], v[44:47], v[112:127]
    v_mfma_f32_32x32x16_bf16 v[128:143], v[56:59], v[48:51], v[128:143]
    s_waitcnt lgkmcnt(0)
    v_mfma_f32_32x32x16_bf16 v[80:95], v[68:71], v[60:63], v[80:95]
    v_mfma_f32_32x32x16_bf16 v[96:111], v[68:71], v[64:67], v[96:111]
    v_mfma_f32_32x32x16_bf16 v[112:127], v[72:75], v[60:63], v[112:127]
    v_mfma_f32_32x32x16_bf16 v[128:143], v[72:75], v[64:67], v[128:143]
    s_add_u32 s28, s70, 30932992
    s_addc_u32 s29, s71, 0
    s_mov_b32 s30, 81920
    s_mov_b32 s31, 0x00020000
    s_add_u32 s32, s70, 31260672
    s_addc_u32 s33, s71, 0
    s_mov_b32 s34, 7680
    s_mov_b32 s35, 0x00020000
    s_mul_i32 s46, s72, 64
    s_add_u32 s46, s46, s38
    v_and_b32 v2, 31, v1
    v_add_u32 v2, s46, v2
    v_lshlrev_b32 v2, 3, v2
    s_mov_b32 s47, 0
    buffer_load_dwordx2 v[148:149], v2, s[28:31], s47 offen offset:0
    s_mov_b32 s47, 16384
    buffer_load_dwordx2 v[150:151], v2, s[28:31], s47 offen offset:0
    s_mov_b32 s47, 32768
    buffer_load_dwordx2 v[152:153], v2, s[28:31], s47 offen offset:0
    s_mov_b32 s47, 49152
    buffer_load_dwordx2 v[154:155], v2, s[28:31], s47 offen offset:0
    s_mov_b32 s47, 65536
    buffer_load_dwordx2 v[156:157], v2, s[28:31], s47 offen offset:0
    s_mov_b32 s47, 0
    buffer_load_dwordx2 v[158:159], v2, s[28:31], s47 offen offset:256
    s_mov_b32 s47, 16384
    buffer_load_dwordx2 v[160:161], v2, s[28:31], s47 offen offset:256
    s_mov_b32 s47, 32768
    buffer_load_dwordx2 v[162:163], v2, s[28:31], s47 offen offset:256
    s_mov_b32 s47, 49152
    buffer_load_dwordx2 v[164:165], v2, s[28:31], s47 offen offset:256
    s_mov_b32 s47, 65536
    buffer_load_dwordx2 v[166:167], v2, s[28:31], s47 offen offset:256
    s_mul_i32 s46, s73, 64
    s_add_u32 s46, s46, s39
    v_lshrrev_b32 v2, 5, v1
    v_lshlrev_b32 v2, 2, v2
    v_add_u32 v2, s46, v2
    v_lshlrev_b32 v2, 2, v2
    buffer_load_dwordx4 v[168:171], v2, s[32:35], 0 offen offset:0
    buffer_load_dwordx4 v[172:175], v2, s[32:35], 0 offen offset:32
    buffer_load_dwordx4 v[176:179], v2, s[32:35], 0 offen offset:64
    buffer_load_dwordx4 v[180:183], v2, s[32:35], 0 offen offset:96
    buffer_load_dwordx4 v[184:187], v2, s[32:35], 0 offen offset:128
    buffer_load_dwordx4 v[188:191], v2, s[32:35], 0 offen offset:160
    buffer_load_dwordx4 v[192:195], v2, s[32:35], 0 offen offset:192
    buffer_load_dwordx4 v[196:199], v2, s[32:35], 0 offen offset:224
    s_barrier
    ds_read_b128 v[44:47], v18 offset:49152
    ds_read_b128 v[48:51], v18 offset:53248
    ds_read_b64_tr_b16 v[52:53], v22 offset:49152
    ds_read_b64_tr_b16 v[54:55], v22 offset:50176
    ds_read_b64_tr_b16 v[56:57], v23 offset:49152
    ds_read_b64_tr_b16 v[58:59], v23 offset:50176
    ds_read_b128 v[60:63], v19 offset:49152
    ds_read_b128 v[64:67], v19 offset:53248
    ds_read_b64_tr_b16 v[68:69], v22 offset:53248
    ds_read_b64_tr_b16 v[70:71], v22 offset:54272
    ds_read_b64_tr_b16 v[72:73], v23 offset:53248
    ds_read_b64_tr_b16 v[74:75], v23 offset:54272
    s_waitcnt lgkmcnt(6)
    v_mfma_f32_32x32x16_bf16 v[80:95], v[52:55], v[44:47], v[80:95]
    v_mfma_f32_32x32x16_bf16 v[96:111], v[52:55], v[48:51], v[96:111]
    v_mfma_f32_32x32x16_bf16 v[112:127], v[56:59], v[44:47], v[112:127]
    v_mfma_f32_32x32x16_bf16 v[128:143], v[56:59], v[48:51], v[128:143]
    ds_read_b128 v[44:47], v20 offset:49152
    ds_read_b128 v[48:51], v20 offset:53248
    ds_read_b64_tr_b16 v[52:53], v22 offset:57344
    ds_read_b64_tr_b16 v[54:55], v22 offset:58368
    ds_read_b64_tr_b16 v[56:57], v23 offset:57344
    ds_read_b64_tr_b16 v[58:59], v23 offset:58368
    s_waitcnt lgkmcnt(6)
    v_mfma_f32_32x32x16_bf16 v[80:95], v[68:71], v[60:63], v[80:95]
    v_mfma_f32_32x32x16_bf16 v[96:111], v[68:71], v[64:67], v[96:111]
    v_mfma_f32_32x32x16_bf16 v[112:127], v[72:75], v[60:63], v[112:127]
    v_mfma_f32_32x32x16_bf16 v[128:143], v[72:75], v[64:67], v[128:143]
    ds_read_b128 v[60:63], v21 offset:49152
    ds_read_b128 v[64:67], v21 offset:53248
    ds_read_b64_tr_b16 v[68:69], v22 offset:61440
    ds_read_b64_tr_b16 v[70:71], v22 offset:62464
    ds_read_b64_tr_b16 v[72:73], v23 offset:61440
    ds_read_b64_tr_b16 v[74:75], v23 offset:62464
    s_waitcnt lgkmcnt(6)
    v_mfma_f32_32x32x16_bf16 v[80:95], v[52:55], v[44:47], v[80:95]
    v_mfma_f32_32x32x16_bf16 v[96:111], v[52:55], v[48:51], v[96:111]
    v_mfma_f32_32x32x16_bf16 v[112:127], v[56:59], v[44:47], v[112:127]
    v_mfma_f32_32x32x16_bf16 v[128:143], v[56:59], v[48:51], v[128:143]
    s_waitcnt lgkmcnt(0)
    v_mfma_f32_32x32x16_bf16 v[80:95], v[68:71], v[60:63], v[80:95]
    v_mfma_f32_32x32x16_bf16 v[96:111], v[68:71], v[64:67], v[96:111]
    v_mfma_f32_32x32x16_bf16 v[112:127], v[72:75], v[60:63], v[112:127]
    v_mfma_f32_32x32x16_bf16 v[128:143], v[72:75], v[64:67], v[128:143]
    s_barrier
    ds_read_b128 v[44:47], v18 offset:0
    ds_read_b128 v[48:51], v18 offset:4096
    ds_read_b64_tr_b16 v[52:53], v22 offset:0
    ds_read_b64_tr_b16 v[54:55], v22 offset:1024
    ds_read_b64_tr_b16 v[56:57], v23 offset:0
    ds_read_b64_tr_b16 v[58:59], v23 offset:1024
    ds_read_b128 v[60:63], v19 offset:0
    ds_read_b128 v[64:67], v19 offset:4096
    ds_read_b64_tr_b16 v[68:69], v22 offset:4096
    ds_read_b64_tr_b16 v[70:71], v22 offset:5120
    ds_read_b64_tr_b16 v[72:73], v23 offset:4096
    ds_read_b64_tr_b16 v[74:75], v23 offset:5120
    s_waitcnt lgkmcnt(6)
    v_mfma_f32_32x32x16_bf16 v[80:95], v[52:55], v[44:47], v[80:95]
    v_mfma_f32_32x32x16_bf16 v[96:111], v[52:55], v[48:51], v[96:111]
    v_mfma_f32_32x32x16_bf16 v[112:127], v[56:59], v[44:47], v[112:127]
    v_mfma_f32_32x32x16_bf16 v[128:143], v[56:59], v[48:51], v[128:143]
    ds_read_b128 v[44:47], v20 offset:0
    ds_read_b128 v[48:51], v20 offset:4096
    ds_read_b64_tr_b16 v[52:53], v22 offset:8192
    ds_read_b64_tr_b16 v[54:55], v22 offset:9216
    ds_read_b64_tr_b16 v[56:57], v23 offset:8192
    ds_read_b64_tr_b16 v[58:59], v23 offset:9216
    s_waitcnt lgkmcnt(6)
    v_mfma_f32_32x32x16_bf16 v[80:95], v[68:71], v[60:63], v[80:95]
    v_mfma_f32_32x32x16_bf16 v[96:111], v[68:71], v[64:67], v[96:111]
    v_mfma_f32_32x32x16_bf16 v[112:127], v[72:75], v[60:63], v[112:127]
    v_mfma_f32_32x32x16_bf16 v[128:143], v[72:75], v[64:67], v[128:143]
    ds_read_b128 v[60:63], v21 offset:0
    ds_read_b128 v[64:67], v21 offset:4096
    ds_read_b64_tr_b16 v[68:69], v22 offset:12288
    ds_read_b64_tr_b16 v[70:71], v22 offset:13312
    ds_read_b64_tr_b16 v[72:73], v23 offset:12288
    ds_read_b64_tr_b16 v[74:75], v23 offset:13312
    s_waitcnt lgkmcnt(6)
    v_mfma_f32_32x32x16_bf16 v[80:95], v[52:55], v[44:47], v[80:95]
    v_mfma_f32_32x32x16_bf16 v[96:111], v[52:55], v[48:51], v[96:111]
    v_mfma_f32_32x32x16_bf16 v[112:127], v[56:59], v[44:47], v[112:127]
    v_mfma_f32_32x32x16_bf16 v[128:143], v[56:59], v[48:51], v[128:143]
    s_waitcnt lgkmcnt(0)
    v_mfma_f32_32x32x16_bf16 v[80:95], v[68:71], v[60:63], v[80:95]
    v_mfma_f32_32x32x16_bf16 v[96:111], v[68:71], v[64:67], v[96:111]
    v_mfma_f32_32x32x16_bf16 v[112:127], v[72:75], v[60:63], v[112:127]
    v_mfma_f32_32x32x16_bf16 v[128:143], v[72:75], v[64:67], v[128:143]
    s_barrier
    ds_read_b128 v[44:47], v18 offset:16384
    ds_read_b128 v[48:51], v18 offset:20480
    ds_read_b64_tr_b16 v[52:53], v22 offset:16384
    ds_read_b64_tr_b16 v[54:55], v22 offset:17408
    ds_read_b64_tr_b16 v[56:57], v23 offset:16384
    ds_read_b64_tr_b16 v[58:59], v23 offset:17408
    ds_read_b128 v[60:63], v19 offset:16384
    ds_read_b128 v[64:67], v19 offset:20480
    ds_read_b64_tr_b16 v[68:69], v22 offset:20480
    ds_read_b64_tr_b16 v[70:71], v22 offset:21504
    ds_read_b64_tr_b16 v[72:73], v23 offset:20480
    ds_read_b64_tr_b16 v[74:75], v23 offset:21504
    s_waitcnt lgkmcnt(6)
    v_mfma_f32_32x32x16_bf16 v[80:95], v[52:55], v[44:47], v[80:95]
    v_mfma_f32_32x32x16_bf16 v[96:111], v[52:55], v[48:51], v[96:111]
    v_mfma_f32_32x32x16_bf16 v[112:127], v[56:59], v[44:47], v[112:127]
    v_mfma_f32_32x32x16_bf16 v[128:143], v[56:59], v[48:51], v[128:143]
    ds_read_b128 v[44:47], v20 offset:16384
    ds_read_b128 v[48:51], v20 offset:20480
    ds_read_b64_tr_b16 v[52:53], v22 offset:24576
    ds_read_b64_tr_b16 v[54:55], v22 offset:25600
    ds_read_b64_tr_b16 v[56:57], v23 offset:24576
    ds_read_b64_tr_b16 v[58:59], v23 offset:25600
    s_waitcnt lgkmcnt(6)
    v_mfma_f32_32x32x16_bf16 v[80:95], v[68:71], v[60:63], v[80:95]
    v_mfma_f32_32x32x16_bf16 v[96:111], v[68:71], v[64:67], v[96:111]
    v_mfma_f32_32x32x16_bf16 v[112:127], v[72:75], v[60:63], v[112:127]
    v_mfma_f32_32x32x16_bf16 v[128:143], v[72:75], v[64:67], v[128:143]
    ds_read_b128 v[60:63], v21 offset:16384
    ds_read_b128 v[64:67], v21 offset:20480
    ds_read_b64_tr_b16 v[68:69], v22 offset:28672
    ds_read_b64_tr_b16 v[70:71], v22 offset:29696
    ds_read_b64_tr_b16 v[72:73], v23 offset:28672
    ds_read_b64_tr_b16 v[74:75], v23 offset:29696
    s_waitcnt lgkmcnt(6)
    v_mfma_f32_32x32x16_bf16 v[80:95], v[52:55], v[44:47], v[80:95]
    v_mfma_f32_32x32x16_bf16 v[96:111], v[52:55], v[48:51], v[96:111]
    v_mfma_f32_32x32x16_bf16 v[112:127], v[56:59], v[44:47], v[112:127]
    v_mfma_f32_32x32x16_bf16 v[128:143], v[56:59], v[48:51], v[128:143]
    s_waitcnt lgkmcnt(0)
    v_mfma_f32_32x32x16_bf16 v[80:95], v[68:71], v[60:63], v[80:95]
    v_mfma_f32_32x32x16_bf16 v[96:111], v[68:71], v[64:67], v[96:111]
    v_mfma_f32_32x32x16_bf16 v[112:127], v[72:75], v[60:63], v[112:127]
    v_mfma_f32_32x32x16_bf16 v[128:143], v[72:75], v[64:67], v[128:143]
    s_barrier
    s_nop 15
    s_waitcnt vmcnt(0)
    v_add_f32 v148, v148, v150
    v_add_f32 v149, v149, v151
    v_add_f32 v148, v148, v152
    v_add_f32 v149, v149, v153
    v_add_f32 v148, v148, v154
    v_add_f32 v149, v149, v155
    v_add_f32 v148, v148, v156
    v_add_f32 v149, v149, v157
    v_mul_f32 v148, 0x3acccccd, v148
    v_mul_f32 v149, 0x3acccccd, v149
    v_fma_f32 v149, -v148, v148, v149
    v_max_f32 v149, 0, v149
    v_cvt_pk_bf16_f32 v2, v149, v149
    v_lshlrev_b32 v149, 16, v2
    v_add_f32 v149, 0x3727c5ac, v149
    v_cvt_pk_bf16_f32 v2, v149, v149
    v_lshlrev_b32 v149, 16, v2
    v_sqrt_f32 v149, v149
    s_nop 0
    v_cvt_pk_bf16_f32 v2, v149, v149
    v_lshlrev_b32 v149, 16, v2
    v_rcp_f32 v146, v149
    v_cvt_pk_bf16_f32 v2, v148, v148
    v_lshlrev_b32 v148, 16, v2
    v_mov_b32 v144, v148
    v_add_f32 v158, v158, v160
    v_add_f32 v159, v159, v161
    v_add_f32 v158, v158, v162
    v_add_f32 v159, v159, v163
    v_add_f32 v158, v158, v164
    v_add_f32 v159, v159, v165
    v_add_f32 v158, v158, v166
    v_add_f32 v159, v159, v167
    v_mul_f32 v158, 0x3acccccd, v158
    v_mul_f32 v159, 0x3acccccd, v159
    v_fma_f32 v159, -v158, v158, v159
    v_max_f32 v159, 0, v159
    v_cvt_pk_bf16_f32 v2, v159, v159
    v_lshlrev_b32 v159, 16, v2
    v_add_f32 v159, 0x3727c5ac, v159
    v_cvt_pk_bf16_f32 v2, v159, v159
    v_lshlrev_b32 v159, 16, v2
    v_sqrt_f32 v159, v159
    s_nop 0
    v_cvt_pk_bf16_f32 v2, v159, v159
    v_lshlrev_b32 v159, 16, v2
    v_rcp_f32 v147, v159
    v_cvt_pk_bf16_f32 v2, v158, v158
    v_lshlrev_b32 v158, 16, v2
    v_mov_b32 v145, v158
    v_fma_f32 v80, -v144, v168, v80
    v_mul_f32 v80, v146, v80
    v_fma_f32 v81, -v144, v169, v81
    v_mul_f32 v81, v146, v81
    v_fma_f32 v82, -v144, v170, v82
    v_mul_f32 v82, v146, v82
    v_fma_f32 v83, -v144, v171, v83
    v_mul_f32 v83, v146, v83
    v_cvt_pk_bf16_f32 v208, v80, v81
    v_cvt_pk_bf16_f32 v209, v82, v83
    ds_write_b64 v40, v[208:209] offset:0
    v_fma_f32 v84, -v144, v172, v84
    v_mul_f32 v84, v146, v84
    v_fma_f32 v85, -v144, v173, v85
    v_mul_f32 v85, v146, v85
    v_fma_f32 v86, -v144, v174, v86
    v_mul_f32 v86, v146, v86
    v_fma_f32 v87, -v144, v175, v87
    v_mul_f32 v87, v146, v87
    v_cvt_pk_bf16_f32 v208, v84, v85
    v_cvt_pk_bf16_f32 v209, v86, v87
    ds_write_b64 v40, v[208:209] offset:16
    v_fma_f32 v88, -v144, v176, v88
    v_mul_f32 v88, v146, v88
    v_fma_f32 v89, -v144, v177, v89
    v_mul_f32 v89, v146, v89
    v_fma_f32 v90, -v144, v178, v90
    v_mul_f32 v90, v146, v90
    v_fma_f32 v91, -v144, v179, v91
    v_mul_f32 v91, v146, v91
    v_cvt_pk_bf16_f32 v208, v88, v89
    v_cvt_pk_bf16_f32 v209, v90, v91
    ds_write_b64 v40, v[208:209] offset:32
    v_fma_f32 v92, -v144, v180, v92
    v_mul_f32 v92, v146, v92
    v_fma_f32 v93, -v144, v181, v93
    v_mul_f32 v93, v146, v93
    v_fma_f32 v94, -v144, v182, v94
    v_mul_f32 v94, v146, v94
    v_fma_f32 v95, -v144, v183, v95
    v_mul_f32 v95, v146, v95
    v_cvt_pk_bf16_f32 v208, v92, v93
    v_cvt_pk_bf16_f32 v209, v94, v95
    ds_write_b64 v40, v[208:209] offset:48
    v_fma_f32 v96, -v145, v168, v96
    v_mul_f32 v96, v147, v96
    v_fma_f32 v97, -v145, v169, v97
    v_mul_f32 v97, v147, v97
    v_fma_f32 v98, -v145, v170, v98
    v_mul_f32 v98, v147, v98
    v_fma_f32 v99, -v145, v171, v99
    v_mul_f32 v99, v147, v99
    v_cvt_pk_bf16_f32 v208, v96, v97
    v_cvt_pk_bf16_f32 v209, v98, v99
    ds_write_b64 v40, v[208:209] offset:8704
    v_fma_f32 v100, -v145, v172, v100
    v_mul_f32 v100, v147, v100
    v_fma_f32 v101, -v145, v173, v101
    v_mul_f32 v101, v147, v101
    v_fma_f32 v102, -v145, v174, v102
    v_mul_f32 v102, v147, v102
    v_fma_f32 v103, -v145, v175, v103
    v_mul_f32 v103, v147, v103
    v_cvt_pk_bf16_f32 v208, v100, v101
    v_cvt_pk_bf16_f32 v209, v102, v103
    ds_write_b64 v40, v[208:209] offset:8720
    v_fma_f32 v104, -v145, v176, v104
    v_mul_f32 v104, v147, v104
    v_fma_f32 v105, -v145, v177, v105
    v_mul_f32 v105, v147, v105
    v_fma_f32 v106, -v145, v178, v106
    v_mul_f32 v106, v147, v106
    v_fma_f32 v107, -v145, v179, v107
    v_mul_f32 v107, v147, v107
    v_cvt_pk_bf16_f32 v208, v104, v105
    v_cvt_pk_bf16_f32 v209, v106, v107
    ds_write_b64 v40, v[208:209] offset:8736
    v_fma_f32 v108, -v145, v180, v108
    v_mul_f32 v108, v147, v108
    v_fma_f32 v109, -v145, v181, v109
    v_mul_f32 v109, v147, v109
    v_fma_f32 v110, -v145, v182, v110
    v_mul_f32 v110, v147, v110
    v_fma_f32 v111, -v145, v183, v111
    v_mul_f32 v111, v147, v111
    v_cvt_pk_bf16_f32 v208, v108, v109
    v_cvt_pk_bf16_f32 v209, v110, v111
    ds_write_b64 v40, v[208:209] offset:8752
    v_fma_f32 v112, -v144, v184, v112
    v_mul_f32 v112, v146, v112
    v_fma_f32 v113, -v144, v185, v113
    v_mul_f32 v113, v146, v113
    v_fma_f32 v114, -v144, v186, v114
    v_mul_f32 v114, v146, v114
    v_fma_f32 v115, -v144, v187, v115
    v_mul_f32 v115, v146, v115
    v_cvt_pk_bf16_f32 v208, v112, v113
    v_cvt_pk_bf16_f32 v209, v114, v115
    ds_write_b64 v40, v[208:209] offset:64
    v_fma_f32 v116, -v144, v188, v116
    v_mul_f32 v116, v146, v116
    v_fma_f32 v117, -v144, v189, v117
    v_mul_f32 v117, v146, v117
    v_fma_f32 v118, -v144, v190, v118
    v_mul_f32 v118, v146, v118
    v_fma_f32 v119, -v144, v191, v119
    v_mul_f32 v119, v146, v119
    v_cvt_pk_bf16_f32 v208, v116, v117
    v_cvt_pk_bf16_f32 v209, v118, v119
    ds_write_b64 v40, v[208:209] offset:80
    v_fma_f32 v120, -v144, v192, v120
    v_mul_f32 v120, v146, v120
    v_fma_f32 v121, -v144, v193, v121
    v_mul_f32 v121, v146, v121
    v_fma_f32 v122, -v144, v194, v122
    v_mul_f32 v122, v146, v122
    v_fma_f32 v123, -v144, v195, v123
    v_mul_f32 v123, v146, v123
    v_cvt_pk_bf16_f32 v208, v120, v121
    v_cvt_pk_bf16_f32 v209, v122, v123
    ds_write_b64 v40, v[208:209] offset:96
    v_fma_f32 v124, -v144, v196, v124
    v_mul_f32 v124, v146, v124
    v_fma_f32 v125, -v144, v197, v125
    v_mul_f32 v125, v146, v125
    v_fma_f32 v126, -v144, v198, v126
    v_mul_f32 v126, v146, v126
    v_fma_f32 v127, -v144, v199, v127
    v_mul_f32 v127, v146, v127
    v_cvt_pk_bf16_f32 v208, v124, v125
    v_cvt_pk_bf16_f32 v209, v126, v127
    ds_write_b64 v40, v[208:209] offset:112
    v_fma_f32 v128, -v145, v184, v128
    v_mul_f32 v128, v147, v128
    v_fma_f32 v129, -v145, v185, v129
    v_mul_f32 v129, v147, v129
    v_fma_f32 v130, -v145, v186, v130
    v_mul_f32 v130, v147, v130
    v_fma_f32 v131, -v145, v187, v131
    v_mul_f32 v131, v147, v131
    v_cvt_pk_bf16_f32 v208, v128, v129
    v_cvt_pk_bf16_f32 v209, v130, v131
    ds_write_b64 v40, v[208:209] offset:8768
    v_fma_f32 v132, -v145, v188, v132
    v_mul_f32 v132, v147, v132
    v_fma_f32 v133, -v145, v189, v133
    v_mul_f32 v133, v147, v133
    v_fma_f32 v134, -v145, v190, v134
    v_mul_f32 v134, v147, v134
    v_fma_f32 v135, -v145, v191, v135
    v_mul_f32 v135, v147, v135
    v_cvt_pk_bf16_f32 v208, v132, v133
    v_cvt_pk_bf16_f32 v209, v134, v135
    ds_write_b64 v40, v[208:209] offset:8784
    v_fma_f32 v136, -v145, v192, v136
    v_mul_f32 v136, v147, v136
    v_fma_f32 v137, -v145, v193, v137
    v_mul_f32 v137, v147, v137
    v_fma_f32 v138, -v145, v194, v138
    v_mul_f32 v138, v147, v138
    v_fma_f32 v139, -v145, v195, v139
    v_mul_f32 v139, v147, v139
    v_cvt_pk_bf16_f32 v208, v136, v137
    v_cvt_pk_bf16_f32 v209, v138, v139
    ds_write_b64 v40, v[208:209] offset:8800
    v_fma_f32 v140, -v145, v196, v140
    v_mul_f32 v140, v147, v140
    v_fma_f32 v141, -v145, v197, v141
    v_mul_f32 v141, v147, v141
    v_fma_f32 v142, -v145, v198, v142
    v_mul_f32 v142, v147, v142
    v_fma_f32 v143, -v145, v199, v143
    v_mul_f32 v143, v147, v143
    v_cvt_pk_bf16_f32 v208, v140, v141
    v_cvt_pk_bf16_f32 v209, v142, v143
    ds_write_b64 v40, v[208:209] offset:8816
    s_waitcnt lgkmcnt(0)
    s_barrier
    ds_read_b128 v[80:83], v32
    ds_read_b128 v[84:87], v33
    ds_read_b128 v[88:91], v34
    ds_read_b128 v[92:95], v35
    ds_read_b128 v[96:99], v36
    ds_read_b128 v[100:103], v37
    ds_read_b128 v[104:107], v38
    ds_read_b128 v[108:111], v39
    s_waitcnt lgkmcnt(7)
    buffer_store_dwordx4 v[80:83], v24, s[16:19], 0 offen
    s_waitcnt lgkmcnt(6)
    buffer_store_dwordx4 v[84:87], v25, s[16:19], 0 offen
    s_waitcnt lgkmcnt(5)
    buffer_store_dwordx4 v[88:91], v26, s[16:19], 0 offen
    s_waitcnt lgkmcnt(4)
    buffer_store_dwordx4 v[92:95], v27, s[16:19], 0 offen
    s_waitcnt lgkmcnt(3)
    buffer_store_dwordx4 v[96:99], v28, s[16:19], 0 offen
    s_waitcnt lgkmcnt(2)
    buffer_store_dwordx4 v[100:103], v29, s[16:19], 0 offen
    s_waitcnt lgkmcnt(1)
    buffer_store_dwordx4 v[104:107], v30, s[16:19], 0 offen
    s_waitcnt lgkmcnt(0)
    buffer_store_dwordx4 v[108:111], v31, s[16:19], 0 offen
g1a_kernel_end1:
    s_endpgm
.globl kva_kernel
.p2align 8
.type kva_kernel,@function
kva_kernel:
    s_cmp_ge_u32 s2, 256
    s_cbranch_scc1 kva_kernel_end1
    s_load_dwordx16 s[48:63], s[0:1], 0
    s_load_dwordx8 s[64:71], s[0:1], 64
    v_and_b32 v1, 63, v0
    v_lshrrev_b32 v2, 6, v0
    s_nop 0
    v_readfirstlane_b32 s40, v2
    v_cmp_lt_u32 vcc, 31, v1
    s_mov_b64 s[46:47], vcc
    s_waitcnt lgkmcnt(0)
    s_mov_b32 s8, s70
    s_mov_b32 s9, s71
    s_mov_b32 s10, 7864320
    s_mov_b32 s11, 0x00020000
    s_add_u32 s12, s70, 31277056
    s_addc_u32 s13, s71, 0
    s_mov_b32 s14, 65536
    s_mov_b32 s15, 0x00020000
    s_add_u32 s16, s70, 31342592
    s_addc_u32 s17, s71, 0
    s_mov_b32 s18, 262144
    s_mov_b32 s19, 0x00020000
    s_and_b32 s41, s2, 7
    s_lshr_b32 s42, s2, 3
    s_lshl_b32 s45, s41, 8
    s_lshl_b32 s48, s40, 5
    s_add_u32 s45, s45, s48
    v_and_b32 v5, 31, v1
    v_add_u32 v7, s45, v5
    s_mov_b32 s48, 3840
    v_mul_lo_u32 v7, v7, s48
    v_lshrrev_b32 v6, 5, v1
    v_lshl_add_u32 v7, v6, 4, v7
    s_mul_i32 s48, s42, 40
    v_add_u32 v120, s48, v7
    buffer_load_dwordx4 v[16:19], v120, s[8:11], 0 offen offset:1280
    buffer_load_dwordx2 v[20:21], v120, s[8:11], 0 offen offset:1312
    buffer_load_dwordx4 v[112:115], v120, s[8:11], 0 offen offset:2560
    buffer_load_dwordx2 v[116:117], v120, s[8:11], 0 offen offset:2592
    s_lshl_b32 s43, s42, 11
    v_lshlrev_b32 v3, 4, v1
    buffer_load_dwordx4 v[24:27], v3, s[12:15], s43 offen
    buffer_load_dwordx4 v[28:31], v3, s[12:15], s43 offen offset:1024
    s_lshl_b32 s44, s40, 13
    v_mov_b32 v32, 0
    v_mov_b32 v33, 0
    v_mov_b32 v34, 0
    v_mov_b32 v35, 0
    v_lshlrev_b32 v4, 4, v1
    v_add_u32 v4, s44, v4
    ds_write_b128 v4, v[32:35] offset:0
    ds_write_b128 v4, v[32:35] offset:1024
    ds_write_b128 v4, v[32:35] offset:2048
    ds_write_b128 v4, v[32:35] offset:3072
    ds_write_b128 v4, v[32:35] offset:4096
    ds_write_b128 v4, v[32:35] offset:5120
    v_lshlrev_b32 v7, 7, v5
    v_lshl_add_u32 v7, v6, 3, v7
    v_add_u32 v121, s44, v7
    v_lshlrev_b32 v7, 6, v5
    v_lshl_add_u32 v7, v6, 4, v7
    v_add_u32 v7, 4096, v7
    v_add_u32 v122, s44, v7
    v_bfe_u32 v8, v1, 2, 2
    v_lshl_add_u32 v8, v6, 3, v8
    v_bfe_u32 v9, v1, 4, 1
    v_and_b32 v10, 3, v1
    v_lshlrev_b32 v10, 3, v10
    v_lshl_add_u32 v10, v9, 5, v10
    v_lshl_add_u32 v11, v8, 7, v10
    v_add_u32 v123, s44, v11
    v_lshl_add_u32 v11, v8, 6, v10
    v_add_u32 v11, 4096, v11
    v_add_u32 v124, s44, v11
    v_mov_b32 v32, 0
    v_mov_b32 v33, 0
    v_mov_b32 v34, 0
    v_mov_b32 v35, 0
    v_mov_b32 v36, 0
    v_mov_b32 v37, 0
    v_mov_b32 v38, 0
    v_mov_b32 v39, 0
    v_mov_b32 v40, 0
    v_mov_b32 v41, 0
    v_mov_b32 v42, 0
    v_mov_b32 v43, 0
    v_mov_b32 v44, 0
    v_mov_b32 v45, 0
    v_mov_b32 v46, 0
    v_mov_b32 v47, 0
    v_mov_b32 v48, 0
    v_mov_b32 v49, 0
    v_mov_b32 v50, 0
    v_mov_b32 v51, 0
    v_mov_b32 v52, 0
    v_mov_b32 v53, 0
    v_mov_b32 v54, 0
    v_mov_b32 v55, 0
    v_mov_b32 v56, 0
    v_mov_b32 v57, 0
    v_mov_b32 v58, 0
    v_mov_b32 v59, 0
    v_mov_b32 v60, 0
    v_mov_b32 v61, 0
    v_mov_b32 v62, 0
    v_mov_b32 v63, 0
    v_mov_b32 v64, 0
    v_mov_b32 v65, 0
    v_mov_b32 v66, 0
    v_mov_b32 v67, 0
    v_mov_b32 v68, 0
    v_mov_b32 v69, 0
    v_mov_b32 v70, 0
    v_mov_b32 v71, 0
    v_mov_b32 v72, 0
    v_mov_b32 v73, 0
    v_mov_b32 v74, 0
    v_mov_b32 v75, 0
    v_mov_b32 v76, 0
    v_mov_b32 v77, 0
    v_mov_b32 v78, 0
    v_mov_b32 v79, 0
    s_waitcnt vmcnt(0) lgkmcnt(0)
    v_cndmask_b32 v20, v20, 0, s[46:47]
    v_cndmask_b32 v21, v21, 0, s[46:47]
    v_mov_b32 v22, 0
    v_mov_b32 v23, 0
    v_mov_b32 v104, 0x3f80
    v_cndmask_b32 v116, v116, v104, s[46:47]
    v_cndmask_b32 v117, v117, 0, s[46:47]
    s_nop 1
    v_mfma_f32_32x32x16_bf16 v[32:47], v[24:27], v[16:19], v[32:47]
    v_mfma_f32_32x32x16_bf16 v[32:47], v[28:31], v[20:23], v[32:47]
    ds_write_b128 v122, v[112:115]
    v_add_u32 v105, 32, v122
    v_lshlrev_b32 v106, 3, v6
    v_sub_u32 v105, v105, v106
    ds_write_b64 v105, v[116:117]
    s_nop 15
    s_nop 3
    v_cvt_pk_bf16_f32 v108, v32, v33
    v_lshlrev_b32 v32, 16, v108
    v_and_b32 v33, 0xffff0000, v108
    v_cvt_pk_bf16_f32 v108, v34, v35
    v_lshlrev_b32 v34, 16, v108
    v_and_b32 v35, 0xffff0000, v108
    v_cvt_pk_bf16_f32 v108, v36, v37
    v_lshlrev_b32 v36, 16, v108
    v_and_b32 v37, 0xffff0000, v108
    v_cvt_pk_bf16_f32 v108, v38, v39
    v_lshlrev_b32 v38, 16, v108
    v_and_b32 v39, 0xffff0000, v108
    v_cvt_pk_bf16_f32 v108, v40, v41
    v_lshlrev_b32 v40, 16, v108
    v_and_b32 v41, 0xffff0000, v108
    v_cvt_pk_bf16_f32 v108, v42, v43
    v_lshlrev_b32 v42, 16, v108
    v_and_b32 v43, 0xffff0000, v108
    v_mov_b32 v110, 0x7f000000
    v_mov_b32 v111, 0xff000000
    v_mov_b32 v80, v32
    v_mov_b32 v92, v32
    v_mov_b32 v81, v33
    v_mov_b32 v93, v33
    v_mov_b32 v82, v34
    v_mov_b32 v94, v34
    v_mov_b32 v83, v35
    v_mov_b32 v95, v35
    v_mov_b32 v84, v36
    v_mov_b32 v96, v36
    v_mov_b32 v85, v37
    v_mov_b32 v97, v37
    v_mov_b32 v86, v38
    v_mov_b32 v98, v38
    v_mov_b32 v87, v39
    v_mov_b32 v99, v39
    v_cndmask_b32 v88, v40, v111, s[46:47]
    v_cndmask_b32 v100, v40, v110, s[46:47]
    v_cndmask_b32 v89, v41, v111, s[46:47]
    v_cndmask_b32 v101, v41, v110, s[46:47]
    v_cndmask_b32 v90, v42, v111, s[46:47]
    v_cndmask_b32 v102, v42, v110, s[46:47]
    v_cndmask_b32 v91, v43, v111, s[46:47]
    v_cndmask_b32 v103, v43, v110, s[46:47]
    v_max_f32 v104, v80, v81
    v_min_f32 v105, v92, v93
    v_max_f32 v104, v104, v82
    v_min_f32 v105, v105, v94
    v_max_f32 v104, v104, v83
    v_min_f32 v105, v105, v95
    v_max_f32 v104, v104, v84
    v_min_f32 v105, v105, v96
    v_max_f32 v104, v104, v85
    v_min_f32 v105, v105, v97
    v_max_f32 v104, v104, v86
    v_min_f32 v105, v105, v98
    v_max_f32 v104, v104, v87
    v_min_f32 v105, v105, v99
    v_max_f32 v104, v104, v88
    v_min_f32 v105, v105, v100
    v_max_f32 v104, v104, v89
    v_min_f32 v105, v105, v101
    v_max_f32 v104, v104, v90
    v_min_f32 v105, v105, v102
    v_max_f32 v104, v104, v91
    v_min_f32 v105, v105, v103
    v_mov_b32 v108, v104
    v_mov_b32 v109, v104
    s_nop 1
    v_permlane32_swap_b32 v108, v109
    s_nop 1
    v_max_f32 v104, v108, v109
    v_mov_b32 v108, v105
    v_mov_b32 v109, v105
    s_nop 1
    v_permlane32_swap_b32 v108, v109
    s_nop 1
    v_min_f32 v105, v108, v109
    v_mov_b32 v108, 0x3fb8aa3b
    v_sub_f32 v80, v80, v104
    v_sub_f32 v92, v105, v92
    v_mul_f32 v80, v108, v80
    v_mul_f32 v92, v108, v92
    v_sub_f32 v81, v81, v104
    v_sub_f32 v93, v105, v93
    v_mul_f32 v81, v108, v81
    v_mul_f32 v93, v108, v93
    v_sub_f32 v82, v82, v104
    v_sub_f32 v94, v105, v94
    v_mul_f32 v82, v108, v82
    v_mul_f32 v94, v108, v94
    v_sub_f32 v83, v83, v104
    v_sub_f32 v95, v105, v95
    v_mul_f32 v83, v108, v83
    v_mul_f32 v95, v108, v95
    v_sub_f32 v84, v84, v104
    v_sub_f32 v96, v105, v96
    v_mul_f32 v84, v108, v84
    v_mul_f32 v96, v108, v96
    v_sub_f32 v85, v85, v104
    v_sub_f32 v97, v105, v97
    v_mul_f32 v85, v108, v85
    v_mul_f32 v97, v108, v97
    v_sub_f32 v86, v86, v104
    v_sub_f32 v98, v105, v98
    v_mul_f32 v86, v108, v86
    v_mul_f32 v98, v108, v98
    v_sub_f32 v87, v87, v104
    v_sub_f32 v99, v105, v99
    v_mul_f32 v87, v108, v87
    v_mul_f32 v99, v108, v99
    v_sub_f32 v88, v88, v104
    v_sub_f32 v100, v105, v100
    v_mul_f32 v88, v108, v88
    v_mul_f32 v100, v108, v100
    v_sub_f32 v89, v89, v104
    v_sub_f32 v101, v105, v101
    v_mul_f32 v89, v108, v89
    v_mul_f32 v101, v108, v101
    v_sub_f32 v90, v90, v104
    v_sub_f32 v102, v105, v102
    v_mul_f32 v90, v108, v90
    v_mul_f32 v102, v108, v102
    v_sub_f32 v91, v91, v104
    v_sub_f32 v103, v105, v103
    v_mul_f32 v91, v108, v91
    v_mul_f32 v103, v108, v103
    v_exp_f32 v80, v80
    v_exp_f32 v92, v92
    v_exp_f32 v81, v81
    v_exp_f32 v93, v93
    v_exp_f32 v82, v82
    v_exp_f32 v94, v94
    v_exp_f32 v83, v83
    v_exp_f32 v95, v95
    v_exp_f32 v84, v84
    v_exp_f32 v96, v96
    v_exp_f32 v85, v85
    v_exp_f32 v97, v97
    v_exp_f32 v86, v86
    v_exp_f32 v98, v98
    v_exp_f32 v87, v87
    v_exp_f32 v99, v99
    v_exp_f32 v88, v88
    v_exp_f32 v100, v100
    v_exp_f32 v89, v89
    v_exp_f32 v101, v101
    v_exp_f32 v90, v90
    v_exp_f32 v102, v102
    v_exp_f32 v91, v91
    v_exp_f32 v103, v103
    v_add_f32 v106, v80, v81
    v_add_f32 v107, v92, v93
    v_add_f32 v106, v106, v82
    v_add_f32 v107, v107, v94
    v_add_f32 v106, v106, v83
    v_add_f32 v107, v107, v95
    v_add_f32 v106, v106, v84
    v_add_f32 v107, v107, v96
    v_add_f32 v106, v106, v85
    v_add_f32 v107, v107, v97
    v_add_f32 v106, v106, v86
    v_add_f32 v107, v107, v98
    v_add_f32 v106, v106, v87
    v_add_f32 v107, v107, v99
    v_add_f32 v106, v106, v88
    v_add_f32 v107, v107, v100
    v_add_f32 v106, v106, v89
    v_add_f32 v107, v107, v101
    v_add_f32 v106, v106, v90
    v_add_f32 v107, v107, v102
    v_add_f32 v106, v106, v91
    v_add_f32 v107, v107, v103
    v_mov_b32 v108, v106
    v_mov_b32 v109, v106
    s_nop 1
    v_permlane32_swap_b32 v108, v109
    s_nop 1
    v_add_f32 v106, v108, v109
    v_mov_b32 v108, v107
    v_mov_b32 v109, v107
    s_nop 1
    v_permlane32_swap_b32 v108, v109
    s_nop 1
    v_add_f32 v107, v108, v109
    v_rcp_f32 v106, v106
    v_rcp_f32 v107, v107
    s_nop 0
    v_mul_f32 v80, v80, v106
    v_mul_f32 v92, v92, v107
    v_mul_f32 v81, v81, v106
    v_mul_f32 v93, v93, v107
    v_mul_f32 v82, v82, v106
    v_mul_f32 v94, v94, v107
    v_mul_f32 v83, v83, v106
    v_mul_f32 v95, v95, v107
    v_mul_f32 v84, v84, v106
    v_mul_f32 v96, v96, v107
    v_mul_f32 v85, v85, v106
    v_mul_f32 v97, v97, v107
    v_mul_f32 v86, v86, v106
    v_mul_f32 v98, v98, v107
    v_mul_f32 v87, v87, v106
    v_mul_f32 v99, v99, v107
    v_mul_f32 v88, v88, v106
    v_mul_f32 v100, v100, v107
    v_mul_f32 v89, v89, v106
    v_mul_f32 v101, v101, v107
    v_mul_f32 v90, v90, v106
    v_mul_f32 v102, v102, v107
    v_mul_f32 v91, v91, v106
    v_mul_f32 v103, v103, v107
    v_cvt_pk_bf16_f32 v104, v80, v81
    v_cvt_pk_bf16_f32 v105, v82, v83
    ds_write_b64 v121, v[104:105] offset:0
    v_cvt_pk_bf16_f32 v104, v84, v85
    v_cvt_pk_bf16_f32 v105, v86, v87
    ds_write_b64 v121, v[104:105] offset:16
    v_cvt_pk_bf16_f32 v104, v88, v89
    v_cvt_pk_bf16_f32 v105, v90, v91
    ds_write_b64 v121, v[104:105] offset:32
    v_cvt_pk_bf16_f32 v104, v92, v93
    v_cvt_pk_bf16_f32 v105, v94, v95
    ds_write_b64 v121, v[104:105] offset:64
    v_cvt_pk_bf16_f32 v104, v96, v97
    v_cvt_pk_bf16_f32 v105, v98, v99
    ds_write_b64 v121, v[104:105] offset:80
    v_cvt_pk_bf16_f32 v104, v100, v101
    v_cvt_pk_bf16_f32 v105, v102, v103
    ds_write_b64 v121, v[104:105] offset:96
    s_waitcnt lgkmcnt(0)
    ds_read_b64_tr_b16 v[16:17], v124 offset:0
    ds_read_b64_tr_b16 v[18:19], v124 offset:256
    ds_read_b64_tr_b16 v[112:113], v123 offset:0
    ds_read_b64_tr_b16 v[114:115], v123 offset:512
    ds_read_b64_tr_b16 v[116:117], v123 offset:64
    ds_read_b64_tr_b16 v[118:119], v123 offset:576
    ds_read_b64_tr_b16 v[20:21], v124 offset:1024
    ds_read_b64_tr_b16 v[22:23], v124 offset:1280
    ds_read_b64_tr_b16 v[32:33], v123 offset:2048
    ds_read_b64_tr_b16 v[34:35], v123 offset:2560
    ds_read_b64_tr_b16 v[36:37], v123 offset:2112
    ds_read_b64_tr_b16 v[38:39], v123 offset:2624
    s_waitcnt lgkmcnt(0)
    v_mfma_f32_32x32x16_bf16 v[48:63], v[112:115], v[16:19], v[48:63]
    v_mfma_f32_32x32x16_bf16 v[64:79], v[116:119], v[16:19], v[64:79]
    v_mfma_f32_32x32x16_bf16 v[48:63], v[32:35], v[20:23], v[48:63]
    v_mfma_f32_32x32x16_bf16 v[64:79], v[36:39], v[20:23], v[64:79]
    s_nop 15
    s_nop 7
    s_barrier
    v_lshlrev_b32 v4, 4, v1
    v_add_u32 v4, s44, v4
    ds_write_b128 v4, v[48:51] offset:0
    ds_write_b128 v4, v[52:55] offset:1024
    ds_write_b128 v4, v[56:59] offset:2048
    ds_write_b128 v4, v[60:63] offset:3072
    ds_write_b128 v4, v[64:67] offset:4096
    ds_write_b128 v4, v[68:71] offset:5120
    ds_write_b128 v4, v[72:75] offset:6144
    ds_write_b128 v4, v[76:79] offset:7168
    s_waitcnt lgkmcnt(0)
    s_barrier
    v_lshlrev_b32 v4, 4, v0
    ds_read_b128 v[48:51], v4 offset:0
    ds_read_b128 v[52:55], v4 offset:8192
    ds_read_b128 v[56:59], v4 offset:16384
    ds_read_b128 v[60:63], v4 offset:24576
    ds_read_b128 v[64:67], v4 offset:32768
    ds_read_b128 v[68:71], v4 offset:40960
    ds_read_b128 v[72:75], v4 offset:49152
    ds_read_b128 v[76:79], v4 offset:57344
    s_waitcnt lgkmcnt(0)
    v_add_f32 v48, v48, v52
    v_add_f32 v49, v49, v53
    v_add_f32 v50, v50, v54
    v_add_f32 v51, v51, v55
    v_add_f32 v48, v48, v56
    v_add_f32 v49, v49, v57
    v_add_f32 v50, v50, v58
    v_add_f32 v51, v51, v59
    v_add_f32 v48, v48, v60
    v_add_f32 v49, v49, v61
    v_add_f32 v50, v50, v62
    v_add_f32 v51, v51, v63
    v_add_f32 v48, v48, v64
    v_add_f32 v49, v49, v65
    v_add_f32 v50, v50, v66
    v_add_f32 v51, v51, v67
    v_add_f32 v48, v48, v68
    v_add_f32 v49, v49, v69
    v_add_f32 v50, v50, v70
    v_add_f32 v51, v51, v71
    v_add_f32 v48, v48, v72
    v_add_f32 v49, v49, v73
    v_add_f32 v50, v50, v74
    v_add_f32 v51, v51, v75
    v_add_f32 v48, v48, v76
    v_add_f32 v49, v49, v77
    v_add_f32 v50, v50, v78
    v_add_f32 v51, v51, v79
    v_lshrrev_b32 v5, 6, v0
    v_lshrrev_b32 v6, 2, v5
    v_and_b32 v7, 3, v5
    v_lshlrev_b32 v7, 3, v7
    v_lshrrev_b32 v8, 5, v1
    v_lshl_add_u32 v7, v8, 2, v7
    v_lshl_add_u32 v7, v6, 5, v7
    v_and_b32 v8, 31, v1
    v_lshl_add_u32 v7, v7, 5, v8
    v_lshlrev_b32 v7, 2, v7
    s_lshl_b32 s48, s42, 13
    buffer_atomic_add_f32 v48, v7, s[16:19], s48 offen offset:0
    buffer_atomic_add_f32 v49, v7, s[16:19], s48 offen offset:128
    buffer_atomic_add_f32 v50, v7, s[16:19], s48 offen offset:256
    buffer_atomic_add_f32 v51, v7, s[16:19], s48 offen offset:384
kva_kernel_end1:
    s_endpgm
.globl oa_kernel
.p2align 8
.type oa_kernel,@function
oa_kernel:
    s_cmp_ge_u32 s2, 256
    s_cbranch_scc1 oa_kernel_end1
    s_load_dwordx16 s[48:63], s[0:1], 0
    s_load_dwordx8 s[64:71], s[0:1], 64
    v_and_b32 v1, 63, v0
    v_lshrrev_b32 v2, 6, v0
    s_nop 0
    v_readfirstlane_b32 s40, v2
    v_cmp_lt_u32 vcc, 31, v1
    s_mov_b64 s[46:47], vcc
    s_waitcnt lgkmcnt(0)
    s_mov_b32 s8, s70
    s_mov_b32 s9, s71
    s_mov_b32 s10, 7864320
    s_mov_b32 s11, 0x00020000
    s_add_u32 s12, s70, 31277056
    s_addc_u32 s13, s71, 0
    s_mov_b32 s14, 65536
    s_mov_b32 s15, 0x00020000
    s_add_u32 s16, s70, 31342592
    s_addc_u32 s17, s71, 0
    s_mov_b32 s18, 262144
    s_mov_b32 s19, 0x00020000
    s_add_u32 s20, s70, 7864320
    s_addc_u32 s21, s71, 0
    s_mov_b32 s22, 2621440
    s_mov_b32 s23, 0x00020000
    s_and_b32 s41, s2, 31
    s_lshr_b32 s42, s2, 5
    s_lshl_b32 s42, s42, 2
    s_and_b32 s43, s40, 3
    s_add_u32 s42, s42, s43
    s_lshr_b32 s49, s40, 2
    v_and_b32 v5, 31, v1
    v_lshrrev_b32 v6, 5, v1
    s_lshl_b32 s45, s41, 6
    s_lshl_b32 s48, s49, 5
    s_add_u32 s50, s45, s48
    v_add_u32 v8, s50, v5
    s_mov_b32 s48, 3840
    v_mul_lo_u32 v8, v8, s48
    v_lshl_add_u32 v8, v6, 4, v8
    s_mul_i32 s48, s42, 40
    v_add_u32 v128, s48, v8
    buffer_load_dwordx4 v[16:19], v128, s[8:11], 0 offen
    buffer_load_dwordx2 v[20:21], v128, s[8:11], 0 offen offset:32
    s_lshl_b32 s43, s42, 11
    v_lshlrev_b32 v3, 4, v1
    buffer_load_dwordx4 v[24:27], v3, s[12:15], s43 offen
    buffer_load_dwordx4 v[28:31], v3, s[12:15], s43 offen offset:1024
    v_lshlrev_b32 v7, 9, v6
    v_lshl_add_u32 v7, v5, 2, v7
    s_lshl_b32 s48, s42, 13
    s_add_u32 s49, s48, 4096
    buffer_load_dword v112, v7, s[16:19], s48 offen offset:0
    buffer_load_dword v113, v7, s[16:19], s48 offen offset:128
    buffer_load_dword v114, v7, s[16:19], s48 offen offset:256
    buffer_load_dword v115, v7, s[16:19], s48 offen offset:384
    buffer_load_dword v116, v7, s[16:19], s48 offen offset:1024
    buffer_load_dword v117, v7, s[16:19], s48 offen offset:1152
    buffer_load_dword v118, v7, s[16:19], s48 offen offset:1280
    buffer_load_dword v119, v7, s[16:19], s48 offen offset:1408
    buffer_load_dword v120, v7, s[16:19], s48 offen offset:2048
    buffer_load_dword v121, v7, s[16:19], s48 offen offset:2176
    buffer_load_dword v122, v7, s[16:19], s48 offen offset:2304
    buffer_load_dword v123, v7, s[16:19], s48 offen offset:2432
    buffer_load_dword v124, v7, s[16:19], s48 offen offset:3072
    buffer_load_dword v125, v7, s[16:19], s48 offen offset:3200
    buffer_load_dword v126, v7, s[16:19], s48 offen offset:3328
    buffer_load_dword v127, v7, s[16:19], s48 offen offset:3456
    buffer_load_dword v64, v7, s[16:19], s49 offen offset:0
    buffer_load_dword v65, v7, s[16:19], s49 offen offset:128
    buffer_load_dword v66, v7, s[16:19], s49 offen offset:256
    buffer_load_dword v67, v7, s[16:19], s49 offen offset:384
    buffer_load_dword v68, v7, s[16:19], s49 offen offset:1024
    buffer_load_dword v69, v7, s[16:19], s49 offen offset:1152
    buffer_load_dword v70, v7, s[16:19], s49 offen offset:1280
    buffer_load_dword v71, v7, s[16:19], s49 offen offset:1408
    buffer_load_dword v72, v7, s[16:19], s49 offen offset:2048
    buffer_load_dword v73, v7, s[16:19], s49 offen offset:2176
    buffer_load_dword v74, v7, s[16:19], s49 offen offset:2304
    buffer_load_dword v75, v7, s[16:19], s49 offen offset:2432
    buffer_load_dword v76, v7, s[16:19], s49 offen offset:3072
    buffer_load_dword v77, v7, s[16:19], s49 offen offset:3200
    buffer_load_dword v78, v7, s[16:19], s49 offen offset:3328
    buffer_load_dword v79, v7, s[16:19], s49 offen offset:3456
    s_lshr_b32 s48, s40, 2
    s_mul_i32 s48, s48, 5632
    v_mul_u32_u24 v8, 176, v5
    v_lshl_add_u32 v8, v6, 3, v8
    v_add_u32 v8, s48, v8
    s_and_b32 s48, s40, 3
    s_mul_i32 s48, s48, 40
    v_add_u32 v129, s48, v8
    v_mov_b32 v102, 0
    v_mov_b32 v103, 0
    v_mov_b32 v110, 0
    v_mov_b32 v111, 0
    v_mov_b32 v32, 0
    v_mov_b32 v33, 0
    v_mov_b32 v34, 0
    v_mov_b32 v35, 0
    v_mov_b32 v36, 0
    v_mov_b32 v37, 0
    v_mov_b32 v38, 0
    v_mov_b32 v39, 0
    v_mov_b32 v40, 0
    v_mov_b32 v41, 0
    v_mov_b32 v42, 0
    v_mov_b32 v43, 0
    v_mov_b32 v44, 0
    v_mov_b32 v45, 0
    v_mov_b32 v46, 0
    v_mov_b32 v47, 0
    s_waitcnt vmcnt(32)
    v_cndmask_b32 v20, v20, 0, s[46:47]
    v_cndmask_b32 v21, v21, 0, s[46:47]
    v_mov_b32 v22, 0
    v_mov_b32 v23, 0
    s_nop 1
    v_mfma_f32_32x32x16_bf16 v[32:47], v[24:27], v[16:19], v[32:47]
    v_mfma_f32_32x32x16_bf16 v[32:47], v[28:31], v[20:23], v[32:47]
    s_waitcnt vmcnt(0)
    v_cvt_pk_bf16_f32 v48, v112, v113
    v_cvt_pk_bf16_f32 v49, v114, v115
    v_cvt_pk_bf16_f32 v50, v116, v117
    v_cvt_pk_bf16_f32 v51, v118, v119
    v_cvt_pk_bf16_f32 v52, v120, v121
    v_cvt_pk_bf16_f32 v53, v122, v123
    v_cvt_pk_bf16_f32 v54, v124, v125
    v_cvt_pk_bf16_f32 v55, v126, v127
    v_cvt_pk_bf16_f32 v56, v64, v65
    v_cvt_pk_bf16_f32 v57, v66, v67
    v_cvt_pk_bf16_f32 v58, v68, v69
    v_cvt_pk_bf16_f32 v59, v70, v71
    v_cvt_pk_bf16_f32 v60, v72, v73
    v_cvt_pk_bf16_f32 v61, v74, v75
    v_cvt_pk_bf16_f32 v62, v76, v77
    v_cvt_pk_bf16_f32 v63, v78, v79
    s_nop 3
    v_cvt_pk_bf16_f32 v92, v32, v33
    v_lshlrev_b32 v32, 16, v92
    v_and_b32 v33, 0xffff0000, v92
    v_cvt_pk_bf16_f32 v92, v34, v35
    v_lshlrev_b32 v34, 16, v92
    v_and_b32 v35, 0xffff0000, v92
    v_cvt_pk_bf16_f32 v92, v36, v37
    v_lshlrev_b32 v36, 16, v92
    v_and_b32 v37, 0xffff0000, v92
    v_cvt_pk_bf16_f32 v92, v38, v39
    v_lshlrev_b32 v38, 16, v92
    v_and_b32 v39, 0xffff0000, v92
    v_cvt_pk_bf16_f32 v92, v40, v41
    v_lshlrev_b32 v40, 16, v92
    v_and_b32 v41, 0xffff0000, v92
    v_cvt_pk_bf16_f32 v92, v42, v43
    v_lshlrev_b32 v42, 16, v92
    v_and_b32 v43, 0xffff0000, v92
    v_mov_b32 v94, 0x7f000000
    v_mov_b32 v95, 0xff000000
    v_mov_b32 v64, v32
    v_mov_b32 v76, v32
    v_mov_b32 v65, v33
    v_mov_b32 v77, v33
    v_mov_b32 v66, v34
    v_mov_b32 v78, v34
    v_mov_b32 v67, v35
    v_mov_b32 v79, v35
    v_mov_b32 v68, v36
    v_mov_b32 v80, v36
    v_mov_b32 v69, v37
    v_mov_b32 v81, v37
    v_mov_b32 v70, v38
    v_mov_b32 v82, v38
    v_mov_b32 v71, v39
    v_mov_b32 v83, v39
    v_cndmask_b32 v72, v40, v95, s[46:47]
    v_cndmask_b32 v84, v40, v94, s[46:47]
    v_cndmask_b32 v73, v41, v95, s[46:47]
    v_cndmask_b32 v85, v41, v94, s[46:47]
    v_cndmask_b32 v74, v42, v95, s[46:47]
    v_cndmask_b32 v86, v42, v94, s[46:47]
    v_cndmask_b32 v75, v43, v95, s[46:47]
    v_cndmask_b32 v87, v43, v94, s[46:47]
    v_max_f32 v88, v64, v65
    v_min_f32 v89, v76, v77
    v_max_f32 v88, v88, v66
    v_min_f32 v89, v89, v78
    v_max_f32 v88, v88, v67
    v_min_f32 v89, v89, v79
    v_max_f32 v88, v88, v68
    v_min_f32 v89, v89, v80
    v_max_f32 v88, v88, v69
    v_min_f32 v89, v89, v81
    v_max_f32 v88, v88, v70
    v_min_f32 v89, v89, v82
    v_max_f32 v88, v88, v71
    v_min_f32 v89, v89, v83
    v_max_f32 v88, v88, v72
    v_min_f32 v89, v89, v84
    v_max_f32 v88, v88, v73
    v_min_f32 v89, v89, v85
    v_max_f32 v88, v88, v74
    v_min_f32 v89, v89, v86
    v_max_f32 v88, v88, v75
    v_min_f32 v89, v89, v87
    v_mov_b32 v92, v88
    v_mov_b32 v93, v88
    s_nop 1
    v_permlane32_swap_b32 v92, v93
    s_nop 1
    v_max_f32 v88, v92, v93
    v_mov_b32 v92, v89
    v_mov_b32 v93, v89
    s_nop 1
    v_permlane32_swap_b32 v92, v93
    s_nop 1
    v_min_f32 v89, v92, v93
    v_mov_b32 v92, 0x3fb8aa3b
    v_sub_f32 v64, v64, v88
    v_sub_f32 v76, v89, v76
    v_mul_f32 v64, v92, v64
    v_mul_f32 v76, v92, v76
    v_sub_f32 v65, v65, v88
    v_sub_f32 v77, v89, v77
    v_mul_f32 v65, v92, v65
    v_mul_f32 v77, v92, v77
    v_sub_f32 v66, v66, v88
    v_sub_f32 v78, v89, v78
    v_mul_f32 v66, v92, v66
    v_mul_f32 v78, v92, v78
    v_sub_f32 v67, v67, v88
    v_sub_f32 v79, v89, v79
    v_mul_f32 v67, v92, v67
    v_mul_f32 v79, v92, v79
    v_sub_f32 v68, v68, v88
    v_sub_f32 v80, v89, v80
    v_mul_f32 v68, v92, v68
    v_mul_f32 v80, v92, v80
    v_sub_f32 v69, v69, v88
    v_sub_f32 v81, v89, v81
    v_mul_f32 v69, v92, v69
    v_mul_f32 v81, v92, v81
    v_sub_f32 v70, v70, v88
    v_sub_f32 v82, v89, v82
    v_mul_f32 v70, v92, v70
    v_mul_f32 v82, v92, v82
    v_sub_f32 v71, v71, v88
    v_sub_f32 v83, v89, v83
    v_mul_f32 v71, v92, v71
    v_mul_f32 v83, v92, v83
    v_sub_f32 v72, v72, v88
    v_sub_f32 v84, v89, v84
    v_mul_f32 v72, v92, v72
    v_mul_f32 v84, v92, v84
    v_sub_f32 v73, v73, v88
    v_sub_f32 v85, v89, v85
    v_mul_f32 v73, v92, v73
    v_mul_f32 v85, v92, v85
    v_sub_f32 v74, v74, v88
    v_sub_f32 v86, v89, v86
    v_mul_f32 v74, v92, v74
    v_mul_f32 v86, v92, v86
    v_sub_f32 v75, v75, v88
    v_sub_f32 v87, v89, v87
    v_mul_f32 v75, v92, v75
    v_mul_f32 v87, v92, v87
    v_exp_f32 v64, v64
    v_exp_f32 v76, v76
    v_exp_f32 v65, v65
    v_exp_f32 v77, v77
    v_exp_f32 v66, v66
    v_exp_f32 v78, v78
    v_exp_f32 v67, v67
    v_exp_f32 v79, v79
    v_exp_f32 v68, v68
    v_exp_f32 v80, v80
    v_exp_f32 v69, v69
    v_exp_f32 v81, v81
    v_exp_f32 v70, v70
    v_exp_f32 v82, v82
    v_exp_f32 v71, v71
    v_exp_f32 v83, v83
    v_exp_f32 v72, v72
    v_exp_f32 v84, v84
    v_exp_f32 v73, v73
    v_exp_f32 v85, v85
    v_exp_f32 v74, v74
    v_exp_f32 v86, v86
    v_exp_f32 v75, v75
    v_exp_f32 v87, v87
    v_add_f32 v90, v64, v65
    v_add_f32 v91, v76, v77
    v_add_f32 v90, v90, v66
    v_add_f32 v91, v91, v78
    v_add_f32 v90, v90, v67
    v_add_f32 v91, v91, v79
    v_add_f32 v90, v90, v68
    v_add_f32 v91, v91, v80
    v_add_f32 v90, v90, v69
    v_add_f32 v91, v91, v81
    v_add_f32 v90, v90, v70
    v_add_f32 v91, v91, v82
    v_add_f32 v90, v90, v71
    v_add_f32 v91, v91, v83
    v_add_f32 v90, v90, v72
    v_add_f32 v91, v91, v84
    v_add_f32 v90, v90, v73
    v_add_f32 v91, v91, v85
    v_add_f32 v90, v90, v74
    v_add_f32 v91, v91, v86
    v_add_f32 v90, v90, v75
    v_add_f32 v91, v91, v87
    v_mov_b32 v92, v90
    v_mov_b32 v93, v90
    s_nop 1
    v_permlane32_swap_b32 v92, v93
    s_nop 1
    v_add_f32 v90, v92, v93
    v_mov_b32 v92, v91
    v_mov_b32 v93, v91
    s_nop 1
    v_permlane32_swap_b32 v92, v93
    s_nop 1
    v_add_f32 v91, v92, v93
    v_rcp_f32 v90, v90
    v_rcp_f32 v91, v91
    s_nop 0
    v_mul_f32 v64, v64, v90
    v_mul_f32 v76, v76, v91
    v_mul_f32 v65, v65, v90
    v_mul_f32 v77, v77, v91
    v_mul_f32 v66, v66, v90
    v_mul_f32 v78, v78, v91
    v_mul_f32 v67, v67, v90
    v_mul_f32 v79, v79, v91
    v_mul_f32 v68, v68, v90
    v_mul_f32 v80, v80, v91
    v_mul_f32 v69, v69, v90
    v_mul_f32 v81, v81, v91
    v_mul_f32 v70, v70, v90
    v_mul_f32 v82, v82, v91
    v_mul_f32 v71, v71, v90
    v_mul_f32 v83, v83, v91
    v_mul_f32 v72, v72, v90
    v_mul_f32 v84, v84, v91
    v_mul_f32 v73, v73, v90
    v_mul_f32 v85, v85, v91
    v_mul_f32 v74, v74, v90
    v_mul_f32 v86, v86, v91
    v_mul_f32 v75, v75, v90
    v_mul_f32 v87, v87, v91
    v_cvt_pk_bf16_f32 v96, v64, v65
    v_cvt_pk_bf16_f32 v97, v66, v67
    v_cvt_pk_bf16_f32 v98, v68, v69
    v_cvt_pk_bf16_f32 v99, v70, v71
    v_cvt_pk_bf16_f32 v100, v72, v73
    v_cvt_pk_bf16_f32 v101, v74, v75
    v_cvt_pk_bf16_f32 v104, v76, v77
    v_cvt_pk_bf16_f32 v105, v78, v79
    v_cvt_pk_bf16_f32 v106, v80, v81
    v_cvt_pk_bf16_f32 v107, v82, v83
    v_cvt_pk_bf16_f32 v108, v84, v85
    v_cvt_pk_bf16_f32 v109, v86, v87
    v_mov_b32 v112, 0
    v_mov_b32 v113, 0
    v_mov_b32 v114, 0
    v_mov_b32 v115, 0
    v_mov_b32 v116, 0
    v_mov_b32 v117, 0
    v_mov_b32 v118, 0
    v_mov_b32 v119, 0
    v_mov_b32 v120, 0
    v_mov_b32 v121, 0
    v_mov_b32 v122, 0
    v_mov_b32 v123, 0
    v_mov_b32 v124, 0
    v_mov_b32 v125, 0
    v_mov_b32 v126, 0
    v_mov_b32 v127, 0
    s_nop 1
    v_mfma_f32_32x32x16_bf16 v[112:127], v[48:51], v[96:99], v[112:127]
    v_mfma_f32_32x32x16_bf16 v[112:127], v[52:55], v[100:103], v[112:127]
    v_mfma_f32_32x32x16_bf16 v[112:127], v[56:59], v[104:107], v[112:127]
    v_mfma_f32_32x32x16_bf16 v[112:127], v[60:63], v[108:111], v[112:127]
    s_nop 15
    s_nop 3
    v_mov_b32 v88, v120
    v_mov_b32 v89, v120
    s_nop 1
    v_permlane32_swap_b32 v89, v88
    s_nop 1
    v_cvt_pk_bf16_f32 v90, v88, v88
    v_lshlrev_b32 v88, 16, v90
    v_add_f32 v88, 0x358637bd, v88
    v_cvt_pk_bf16_f32 v90, v88, v88
    v_lshlrev_b32 v88, 16, v90
    v_rcp_f32 v88, v88
    s_nop 0
    v_cvt_pk_bf16_f32 v90, v112, v113
    v_cvt_pk_bf16_f32 v91, v114, v115
    v_lshlrev_b32 v112, 16, v90
    v_and_b32 v113, 0xffff0000, v90
    v_lshlrev_b32 v114, 16, v91
    v_and_b32 v115, 0xffff0000, v91
    v_mul_f32 v112, v112, v88
    v_mul_f32 v113, v113, v88
    v_mul_f32 v114, v114, v88
    v_mul_f32 v115, v115, v88
    v_cvt_pk_bf16_f32 v90, v112, v113
    v_cvt_pk_bf16_f32 v91, v114, v115
    ds_write_b64 v129, v[90:91] offset:0
    v_cvt_pk_bf16_f32 v90, v116, v117
    v_cvt_pk_bf16_f32 v91, v118, v119
    v_lshlrev_b32 v116, 16, v90
    v_and_b32 v117, 0xffff0000, v90
    v_lshlrev_b32 v118, 16, v91
    v_and_b32 v119, 0xffff0000, v91
    v_mul_f32 v116, v116, v88
    v_mul_f32 v117, v117, v88
    v_mul_f32 v118, v118, v88
    v_mul_f32 v119, v119, v88
    v_cvt_pk_bf16_f32 v90, v116, v117
    v_cvt_pk_bf16_f32 v91, v118, v119
    ds_write_b64 v129, v[90:91] offset:16
    v_cvt_pk_bf16_f32 v90, v120, v121
    v_cvt_pk_bf16_f32 v91, v122, v123
    v_lshlrev_b32 v120, 16, v90
    v_and_b32 v121, 0xffff0000, v90
    v_lshlrev_b32 v122, 16, v91
    v_and_b32 v123, 0xffff0000, v91
    v_mul_f32 v120, v120, v88
    v_mul_f32 v121, v121, v88
    v_mul_f32 v122, v122, v88
    v_mul_f32 v123, v123, v88
    v_cvt_pk_bf16_f32 v90, v120, v121
    v_cvt_pk_bf16_f32 v91, v122, v123
    s_mov_b64 s[50:51], exec
    s_andn2_b64 exec, exec, s[46:47]
    ds_write_b64 v129, v[90:91] offset:32
    s_mov_b64 exec, s[50:51]
    s_waitcnt lgkmcnt(0)
    s_barrier
    v_add_u32 v4, 0, v0
    s_mov_b32 s48, 205
    v_mul_u32_u24 v5, s48, v4
    v_lshrrev_b32 v5, 11, v5
    v_mul_u32_u24 v6, 10, v5
    v_sub_u32 v6, v4, v6
    v_mul_u32_u24 v7, 176, v5
    v_lshl_add_u32 v7, v6, 4, v7
    ds_read_b128 v[32:35], v7
    v_add_u32 v8, s45, v5
    s_mov_b32 s48, 1280
    v_mul_lo_u32 v8, v8, s48
    v_lshl_add_u32 v8, v6, 4, v8
    s_lshr_b32 s48, s2, 5
    s_mul_i32 s48, s48, 160
    s_waitcnt lgkmcnt(0)
    buffer_store_dwordx4 v[32:35], v8, s[20:23], s48 offen
    v_add_u32 v4, 512, v0
    s_mov_b32 s48, 205
    v_mul_u32_u24 v5, s48, v4
    v_lshrrev_b32 v5, 11, v5
    v_mul_u32_u24 v6, 10, v5
    v_sub_u32 v6, v4, v6
    v_mul_u32_u24 v7, 176, v5
    v_lshl_add_u32 v7, v6, 4, v7
    v_cmp_gt_u32 vcc, 640, v4
    s_and_saveexec_b64 s[50:51], vcc
    s_cbranch_execz oa_kernel_end1
    ds_read_b128 v[32:35], v7
    v_add_u32 v8, s45, v5
    s_mov_b32 s48, 1280
    v_mul_lo_u32 v8, v8, s48
    v_lshl_add_u32 v8, v6, 4, v8
    s_lshr_b32 s48, s2, 5
    s_mul_i32 s48, s48, 160
    s_waitcnt lgkmcnt(0)
    buffer_store_dwordx4 v[32:35], v8, s[20:23], s48 offen
oa_kernel_end1:
    s_endpgm
.globl g2a_kernel
.p2align 8
.type g2a_kernel,@function
g2a_kernel:
    s_cmp_ge_u32 s2, 160
    s_cbranch_scc1 g2a_kernel_end1
    s_load_dwordx16 s[48:63], s[0:1], 0
    s_load_dwordx8 s[64:71], s[0:1], 64
    v_and_b32 v1, 63, v0
    v_lshrrev_b32 v2, 6, v0
    s_and_b32 s46, s2, 7
    s_lshr_b32 s47, s2, 3
    s_mul_i32 s36, s47, 103
    s_lshr_b32 s36, s36, 9
    s_mul_i32 s3, s36, 5
    s_sub_u32 s37, s47, s3
    s_mul_i32 s46, s46, 4
    s_add_u32 s36, s36, s46
    s_mul_i32 s38, s36, 64
    s_mul_i32 s39, s37, 128
    v_readfirstlane_b32 s40, v2
    s_lshr_b32 s74, s40, 2
    s_and_b32 s40, s40, 3
    s_cmp_eq_u32 s74, 0
    s_cbranch_scc0 g2a_kernel_prod2
    s_branch g2a_kernel_cons3
g2a_kernel_prod2:
    s_mul_i32 s41, s38, 1280
    s_lshl_b32 s42, s39, 1
    s_mul_i32 s43, s40, 2048
    s_mul_i32 s44, s40, 4096
    s_add_u32 s44, s44, 32768
    s_mul_i32 s46, s40, 128
    s_add_u32 s46, s46, 0
    v_add_u32 v2, s46, v1
    v_lshrrev_b32 v3, 3, v2
    v_and_b32 v4, 7, v2
    v_bfe_u32 v5, v3, 1, 3
    v_xor_b32 v4, v4, v5
    v_lshlrev_b32 v4, 4, v4
    s_mov_b32 s47, 1280
    v_mad_u32_u24 v10, v3, s47, v4
    s_mul_i32 s46, s40, 128
    s_add_u32 s46, s46, 64
    v_add_u32 v2, s46, v1
    v_lshrrev_b32 v3, 3, v2
    v_and_b32 v4, 7, v2
    v_bfe_u32 v5, v3, 1, 3
    v_xor_b32 v4, v4, v5
    v_lshlrev_b32 v4, 4, v4
    s_mov_b32 s47, 1280
    v_mad_u32_u24 v11, v3, s47, v4
    s_mul_i32 s46, s40, 256
    s_add_u32 s46, s46, 0
    v_add_u32 v2, s46, v1
    v_lshrrev_b32 v3, 4, v2
    s_mov_b32 s47, 16
    v_mul_u32_u24 v4, s47, v3
    v_sub_u32 v4, v2, v4
    v_and_b32 v5, 3, v3
    v_lshlrev_b32 v5, 2, v5
    v_xor_b32 v4, v4, v5
    v_lshlrev_b32 v4, 4, v4
    s_mov_b32 s47, 1280
    v_mad_u32_u24 v12, v3, s47, v4
    s_mul_i32 s46, s40, 256
    s_add_u32 s46, s46, 64
    v_add_u32 v2, s46, v1
    v_lshrrev_b32 v3, 4, v2
    s_mov_b32 s47, 16
    v_mul_u32_u24 v4, s47, v3
    v_sub_u32 v4, v2, v4
    v_and_b32 v5, 3, v3
    v_lshlrev_b32 v5, 2, v5
    v_xor_b32 v4, v4, v5
    v_lshlrev_b32 v4, 4, v4
    s_mov_b32 s47, 1280
    v_mad_u32_u24 v13, v3, s47, v4
    s_mul_i32 s46, s40, 256
    s_add_u32 s46, s46, 128
    v_add_u32 v2, s46, v1
    v_lshrrev_b32 v3, 4, v2
    s_mov_b32 s47, 16
    v_mul_u32_u24 v4, s47, v3
    v_sub_u32 v4, v2, v4
    v_and_b32 v5, 3, v3
    v_lshlrev_b32 v5, 2, v5
    v_xor_b32 v4, v4, v5
    v_lshlrev_b32 v4, 4, v4
    s_mov_b32 s47, 1280
    v_mad_u32_u24 v14, v3, s47, v4
    s_mul_i32 s46, s40, 256
    s_add_u32 s46, s46, 192
    v_add_u32 v2, s46, v1
    v_lshrrev_b32 v3, 4, v2
    s_mov_b32 s47, 16
    v_mul_u32_u24 v4, s47, v3
    v_sub_u32 v4, v2, v4
    v_and_b32 v5, 3, v3
    v_lshlrev_b32 v5, 2, v5
    v_xor_b32 v4, v4, v5
    v_lshlrev_b32 v4, 4, v4
    s_mov_b32 s47, 1280
    v_mad_u32_u24 v15, v3, s47, v4
    s_waitcnt lgkmcnt(0)
    s_add_u32 s8, s70, 7864320
    s_addc_u32 s9, s71, 0
    s_mov_b32 s10, 2621440
    s_mov_b32 s11, 0x00020000
    s_mov_b32 s12, s54
    s_mov_b32 s13, s55
    s_mov_b32 s14, 819200
    s_mov_b32 s15, 0x00020000
    s_add_u32 m0, s43, 0
    s_nop 0
    buffer_load_dwordx4 v10, s[8:11], s41 offen lds
    s_add_u32 m0, s43, 1024
    s_nop 0
    buffer_load_dwordx4 v11, s[8:11], s41 offen lds
    s_add_u32 m0, s44, 0
    s_nop 0
    buffer_load_dwordx4 v12, s[12:15], s42 offen lds
    s_add_u32 m0, s44, 1024
    s_nop 0
    buffer_load_dwordx4 v13, s[12:15], s42 offen lds
    s_add_u32 m0, s44, 2048
    s_nop 0
    buffer_load_dwordx4 v14, s[12:15], s42 offen lds
    s_add_u32 m0, s44, 3072
    s_nop 0
    buffer_load_dwordx4 v15, s[12:15], s42 offen lds
    s_add_u32 s41, s41, 128
    s_add_u32 s42, s42, 81920
    s_add_u32 m0, s43, 8192
    s_nop 0
    buffer_load_dwordx4 v10, s[8:11], s41 offen lds
    s_add_u32 m0, s43, 9216
    s_nop 0
    buffer_load_dwordx4 v11, s[8:11], s41 offen lds
    s_add_u32 m0, s44, 16384
    s_nop 0
    buffer_load_dwordx4 v12, s[12:15], s42 offen lds
    s_add_u32 m0, s44, 17408
    s_nop 0
    buffer_load_dwordx4 v13, s[12:15], s42 offen lds
    s_add_u32 m0, s44, 18432
    s_nop 0
    buffer_load_dwordx4 v14, s[12:15], s42 offen lds
    s_add_u32 m0, s44, 19456
    s_nop 0
    buffer_load_dwordx4 v15, s[12:15], s42 offen lds
    s_add_u32 s41, s41, 128
    s_add_u32 s42, s42, 81920
    s_add_u32 m0, s43, 16384
    s_nop 0
    buffer_load_dwordx4 v10, s[8:11], s41 offen lds
    s_add_u32 m0, s43, 17408
    s_nop 0
    buffer_load_dwordx4 v11, s[8:11], s41 offen lds
    s_add_u32 m0, s44, 32768
    s_nop 0
    buffer_load_dwordx4 v12, s[12:15], s42 offen lds
    s_add_u32 m0, s44, 33792
    s_nop 0
    buffer_load_dwordx4 v13, s[12:15], s42 offen lds
    s_add_u32 m0, s44, 34816
    s_nop 0
    buffer_load_dwordx4 v14, s[12:15], s42 offen lds
    s_add_u32 m0, s44, 35840
    s_nop 0
    buffer_load_dwordx4 v15, s[12:15], s42 offen lds
    s_add_u32 s41, s41, 128
    s_add_u32 s42, s42, 81920
    s_waitcnt vmcnt(12)
    s_barrier
    s_add_u32 m0, s43, 24576
    s_nop 0
    buffer_load_dwordx4 v10, s[8:11], s41 offen lds
    s_add_u32 m0, s43, 25600
    s_nop 0
    buffer_load_dwordx4 v11, s[8:11], s41 offen lds
    s_add_u32 m0, s44, 49152
    s_nop 0
    buffer_load_dwordx4 v12, s[12:15], s42 offen lds
    s_add_u32 m0, s44, 50176
    s_nop 0
    buffer_load_dwordx4 v13, s[12:15], s42 offen lds
    s_add_u32 m0, s44, 51200
    s_nop 0
    buffer_load_dwordx4 v14, s[12:15], s42 offen lds
    s_add_u32 m0, s44, 52224
    s_nop 0
    buffer_load_dwordx4 v15, s[12:15], s42 offen lds
    s_add_u32 s41, s41, 128
    s_add_u32 s42, s42, 81920
    s_waitcnt vmcnt(12)
    s_barrier
    s_add_u32 m0, s43, 0
    s_nop 0
    buffer_load_dwordx4 v10, s[8:11], s41 offen lds
    s_add_u32 m0, s43, 1024
    s_nop 0
    buffer_load_dwordx4 v11, s[8:11], s41 offen lds
    s_add_u32 m0, s44, 0
    s_nop 0
    buffer_load_dwordx4 v12, s[12:15], s42 offen lds
    s_add_u32 m0, s44, 1024
    s_nop 0
    buffer_load_dwordx4 v13, s[12:15], s42 offen lds
    s_add_u32 m0, s44, 2048
    s_nop 0
    buffer_load_dwordx4 v14, s[12:15], s42 offen lds
    s_add_u32 m0, s44, 3072
    s_nop 0
    buffer_load_dwordx4 v15, s[12:15], s42 offen lds
    s_add_u32 s41, s41, 128
    s_add_u32 s42, s42, 81920
    s_waitcnt vmcnt(12)
    s_barrier
    s_add_u32 m0, s43, 8192
    s_nop 0
    buffer_load_dwordx4 v10, s[8:11], s41 offen lds
    s_add_u32 m0, s43, 9216
    s_nop 0
    buffer_load_dwordx4 v11, s[8:11], s41 offen lds
    s_add_u32 m0, s44, 16384
    s_nop 0
    buffer_load_dwordx4 v12, s[12:15], s42 offen lds
    s_add_u32 m0, s44, 17408
    s_nop 0
    buffer_load_dwordx4 v13, s[12:15], s42 offen lds
    s_add_u32 m0, s44, 18432
    s_nop 0
    buffer_load_dwordx4 v14, s[12:15], s42 offen lds
    s_add_u32 m0, s44, 19456
    s_nop 0
    buffer_load_dwordx4 v15, s[12:15], s42 offen lds
    s_add_u32 s41, s41, 128
    s_add_u32 s42, s42, 81920
    s_waitcnt vmcnt(12)
    s_barrier
    s_add_u32 m0, s43, 16384
    s_nop 0
    buffer_load_dwordx4 v10, s[8:11], s41 offen lds
    s_add_u32 m0, s43, 17408
    s_nop 0
    buffer_load_dwordx4 v11, s[8:11], s41 offen lds
    s_add_u32 m0, s44, 32768
    s_nop 0
    buffer_load_dwordx4 v12, s[12:15], s42 offen lds
    s_add_u32 m0, s44, 33792
    s_nop 0
    buffer_load_dwordx4 v13, s[12:15], s42 offen lds
    s_add_u32 m0, s44, 34816
    s_nop 0
    buffer_load_dwordx4 v14, s[12:15], s42 offen lds
    s_add_u32 m0, s44, 35840
    s_nop 0
    buffer_load_dwordx4 v15, s[12:15], s42 offen lds
    s_add_u32 s41, s41, 128
    s_add_u32 s42, s42, 81920
    s_waitcnt vmcnt(12)
    s_barrier
    s_add_u32 m0, s43, 24576
    s_nop 0
    buffer_load_dwordx4 v10, s[8:11], s41 offen lds
    s_add_u32 m0, s43, 25600
    s_nop 0
    buffer_load_dwordx4 v11, s[8:11], s41 offen lds
    s_add_u32 m0, s44, 49152
    s_nop 0
    buffer_load_dwordx4 v12, s[12:15], s42 offen lds
    s_add_u32 m0, s44, 50176
    s_nop 0
    buffer_load_dwordx4 v13, s[12:15], s42 offen lds
    s_add_u32 m0, s44, 51200
    s_nop 0
    buffer_load_dwordx4 v14, s[12:15], s42 offen lds
    s_add_u32 m0, s44, 52224
    s_nop 0
    buffer_load_dwordx4 v15, s[12:15], s42 offen lds
    s_add_u32 s41, s41, 128
    s_add_u32 s42, s42, 81920
    s_waitcnt vmcnt(12)
    s_barrier
    s_add_u32 m0, s43, 0
    s_nop 0
    buffer_load_dwordx4 v10, s[8:11], s41 offen lds
    s_add_u32 m0, s43, 1024
    s_nop 0
    buffer_load_dwordx4 v11, s[8:11], s41 offen lds
    s_add_u32 m0, s44, 0
    s_nop 0
    buffer_load_dwordx4 v12, s[12:15], s42 offen lds
    s_add_u32 m0, s44, 1024
    s_nop 0
    buffer_load_dwordx4 v13, s[12:15], s42 offen lds
    s_add_u32 m0, s44, 2048
    s_nop 0
    buffer_load_dwordx4 v14, s[12:15], s42 offen lds
    s_add_u32 m0, s44, 3072
    s_nop 0
    buffer_load_dwordx4 v15, s[12:15], s42 offen lds
    s_add_u32 s41, s41, 128
    s_add_u32 s42, s42, 81920
    s_waitcnt vmcnt(12)
    s_barrier
    s_add_u32 m0, s43, 8192
    s_nop 0
    buffer_load_dwordx4 v10, s[8:11], s41 offen lds
    s_add_u32 m0, s43, 9216
    s_nop 0
    buffer_load_dwordx4 v11, s[8:11], s41 offen lds
    s_add_u32 m0, s44, 16384
    s_nop 0
    buffer_load_dwordx4 v12, s[12:15], s42 offen lds
    s_add_u32 m0, s44, 17408
    s_nop 0
    buffer_load_dwordx4 v13, s[12:15], s42 offen lds
    s_add_u32 m0, s44, 18432
    s_nop 0
    buffer_load_dwordx4 v14, s[12:15], s42 offen lds
    s_add_u32 m0, s44, 19456
    s_nop 0
    buffer_load_dwordx4 v15, s[12:15], s42 offen lds
    s_add_u32 s41, s41, 128
    s_add_u32 s42, s42, 81920
    s_waitcnt vmcnt(12)
    s_barrier
    s_waitcnt vmcnt(6)
    s_barrier
    s_waitcnt vmcnt(0)
    s_barrier
    s_endpgm
g2a_kernel_cons3:
    s_waitcnt lgkmcnt(0)
    s_add_u32 s16, s70, 10485760
    s_addc_u32 s17, s71, 0
    s_mov_b32 s18, 2621440
    s_mov_b32 s19, 0x00020000
    s_lshr_b32 s72, s40, 1
    s_and_b32 s73, s40, 1
    s_mul_i32 s46, s72, 32
    v_and_b32 v2, 31, v1
    v_add_u32 v2, s46, v2
    v_lshrrev_b32 v3, 5, v1
    v_bfe_u32 v4, v2, 1, 3
    v_xor_b32 v3, v3, v4
    v_lshlrev_b32 v3, 4, v3
    v_lshl_add_u32 v16, v2, 7, v3
    v_xor_b32 v17, 32, v16
    v_xor_b32 v18, 64, v16
    v_xor_b32 v19, 96, v16
    s_mul_i32 s46, s73, 8
    s_add_u32 s46, s46, 0
    v_bfe_u32 v2, v1, 4, 1
    v_lshlrev_b32 v2, 1, v2
    v_bfe_u32 v3, v1, 1, 1
    v_add3_u32 v2, v2, v3, s46
    v_bfe_u32 v4, v1, 2, 2
    v_lshlrev_b32 v5, 2, v4
    v_xor_b32 v2, v2, v5
    v_lshlrev_b32 v2, 4, v2
    v_and_b32 v3, 1, v1
    v_lshl_add_u32 v2, v3, 3, v2
    v_lshrrev_b32 v3, 5, v1
    v_lshl_add_u32 v3, v3, 3, v4
    s_mov_b32 s47, 256
    v_mad_u32_u24 v2, v3, s47, v2
    v_add_u32 v20, 32768, v2
    s_mul_i32 s46, s73, 8
    s_add_u32 s46, s46, 4
    v_bfe_u32 v2, v1, 4, 1
    v_lshlrev_b32 v2, 1, v2
    v_bfe_u32 v3, v1, 1, 1
    v_add3_u32 v2, v2, v3, s46
    v_bfe_u32 v4, v1, 2, 2
    v_lshlrev_b32 v5, 2, v4
    v_xor_b32 v2, v2, v5
    v_lshlrev_b32 v2, 4, v2
    v_and_b32 v3, 1, v1
    v_lshl_add_u32 v2, v3, 3, v2
    v_lshrrev_b32 v3, 5, v1
    v_lshl_add_u32 v3, v3, 3, v4
    s_mov_b32 s47, 256
    v_mad_u32_u24 v2, v3, s47, v2
    v_add_u32 v21, 32768, v2
    s_mul_i32 s46, s72, 32
    v_and_b32 v2, 31, v1
    v_add_u32 v2, s46, v2
    s_mov_b32 s47, 272
    v_mul_u32_u24 v2, s47, v2
    s_mul_i32 s46, s73, 128
    v_lshrrev_b32 v3, 5, v1
    v_lshlrev_b32 v3, 3, v3
    v_add3_u32 v30, v2, v3, s46
    v_add_u32 v2, 0, v0
    v_lshrrev_b32 v6, 4, v2
    s_mov_b32 s46, 16
    v_mul_u32_u24 v7, s46, v6
    v_sub_u32 v7, v2, v7
    s_mov_b32 s46, 272
    v_mul_u32_u24 v26, s46, v6
    v_lshl_add_u32 v26, v7, 4, v26
    v_add_u32 v22, s38, v6
    s_mov_b32 s46, 1280
    v_mul_lo_u32 v22, v22, s46
    v_lshl_add_u32 v22, v7, 4, v22
    s_lshl_b32 s46, s39, 1
    v_add_u32 v22, s46, v22
    v_add_u32 v2, 256, v0
    v_lshrrev_b32 v6, 4, v2
    s_mov_b32 s46, 16
    v_mul_u32_u24 v7, s46, v6
    v_sub_u32 v7, v2, v7
    s_mov_b32 s46, 272
    v_mul_u32_u24 v27, s46, v6
    v_lshl_add_u32 v27, v7, 4, v27
    v_add_u32 v23, s38, v6
    s_mov_b32 s46, 1280
    v_mul_lo_u32 v23, v23, s46
    v_lshl_add_u32 v23, v7, 4, v23
    s_lshl_b32 s46, s39, 1
    v_add_u32 v23, s46, v23
    v_add_u32 v2, 512, v0
    v_lshrrev_b32 v6, 4, v2
    s_mov_b32 s46, 16
    v_mul_u32_u24 v7, s46, v6
    v_sub_u32 v7, v2, v7
    s_mov_b32 s46, 272
    v_mul_u32_u24 v28, s46, v6
    v_lshl_add_u32 v28, v7, 4, v28
    v_add_u32 v24, s38, v6
    s_mov_b32 s46, 1280
    v_mul_lo_u32 v24, v24, s46
    v_lshl_add_u32 v24, v7, 4, v24
    s_lshl_b32 s46, s39, 1
    v_add_u32 v24, s46, v24
    v_add_u32 v2, 768, v0
    v_lshrrev_b32 v6, 4, v2
    s_mov_b32 s46, 16
    v_mul_u32_u24 v7, s46, v6
    v_sub_u32 v7, v2, v7
    s_mov_b32 s46, 272
    v_mul_u32_u24 v29, s46, v6
    v_lshl_add_u32 v29, v7, 4, v29
    v_add_u32 v25, s38, v6
    s_mov_b32 s46, 1280
    v_mul_lo_u32 v25, v25, s46
    v_lshl_add_u32 v25, v7, 4, v25
    s_lshl_b32 s46, s39, 1
    v_add_u32 v25, s46, v25
    v_mov_b32 v64, 0
    v_mov_b32 v65, 0
    v_mov_b32 v66, 0
    v_mov_b32 v67, 0
    v_mov_b32 v68, 0
    v_mov_b32 v69, 0
    v_mov_b32 v70, 0
    v_mov_b32 v71, 0
    v_mov_b32 v72, 0
    v_mov_b32 v73, 0
    v_mov_b32 v74, 0
    v_mov_b32 v75, 0
    v_mov_b32 v76, 0
    v_mov_b32 v77, 0
    v_mov_b32 v78, 0
    v_mov_b32 v79, 0
    v_mov_b32 v80, 0
    v_mov_b32 v81, 0
    v_mov_b32 v82, 0
    v_mov_b32 v83, 0
    v_mov_b32 v84, 0
    v_mov_b32 v85, 0
    v_mov_b32 v86, 0
    v_mov_b32 v87, 0
    v_mov_b32 v88, 0
    v_mov_b32 v89, 0
    v_mov_b32 v90, 0
    v_mov_b32 v91, 0
    v_mov_b32 v92, 0
    v_mov_b32 v93, 0
    v_mov_b32 v94, 0
    v_mov_b32 v95, 0
    s_barrier
    ds_read_b128 v[32:35], v16 offset:0
    ds_read_b64_tr_b16 v[36:37], v20 offset:0
    ds_read_b64_tr_b16 v[38:39], v20 offset:1024
    ds_read_b64_tr_b16 v[40:41], v21 offset:0
    ds_read_b64_tr_b16 v[42:43], v21 offset:1024
    ds_read_b128 v[44:47], v17 offset:0
    ds_read_b64_tr_b16 v[48:49], v20 offset:4096
    ds_read_b64_tr_b16 v[50:51], v20 offset:5120
    ds_read_b64_tr_b16 v[52:53], v21 offset:4096
    ds_read_b64_tr_b16 v[54:55], v21 offset:5120
    s_waitcnt lgkmcnt(5)
    v_mfma_f32_32x32x16_bf16 v[64:79], v[36:39], v[32:35], v[64:79]
    v_mfma_f32_32x32x16_bf16 v[80:95], v[40:43], v[32:35], v[80:95]
    ds_read_b128 v[32:35], v18 offset:0
    ds_read_b64_tr_b16 v[36:37], v20 offset:8192
    ds_read_b64_tr_b16 v[38:39], v20 offset:9216
    ds_read_b64_tr_b16 v[40:41], v21 offset:8192
    ds_read_b64_tr_b16 v[42:43], v21 offset:9216
    s_waitcnt lgkmcnt(5)
    v_mfma_f32_32x32x16_bf16 v[64:79], v[48:51], v[44:47], v[64:79]
    v_mfma_f32_32x32x16_bf16 v[80:95], v[52:55], v[44:47], v[80:95]
    ds_read_b128 v[44:47], v19 offset:0
    ds_read_b64_tr_b16 v[48:49], v20 offset:12288
    ds_read_b64_tr_b16 v[50:51], v20 offset:13312
    ds_read_b64_tr_b16 v[52:53], v21 offset:12288
    ds_read_b64_tr_b16 v[54:55], v21 offset:13312
    s_waitcnt lgkmcnt(5)
    v_mfma_f32_32x32x16_bf16 v[64:79], v[36:39], v[32:35], v[64:79]
    v_mfma_f32_32x32x16_bf16 v[80:95], v[40:43], v[32:35], v[80:95]
    s_waitcnt lgkmcnt(0)
    v_mfma_f32_32x32x16_bf16 v[64:79], v[48:51], v[44:47], v[64:79]
    v_mfma_f32_32x32x16_bf16 v[80:95], v[52:55], v[44:47], v[80:95]
    s_barrier
    ds_read_b128 v[32:35], v16 offset:8192
    ds_read_b64_tr_b16 v[36:37], v20 offset:16384
    ds_read_b64_tr_b16 v[38:39], v20 offset:17408
    ds_read_b64_tr_b16 v[40:41], v21 offset:16384
    ds_read_b64_tr_b16 v[42:43], v21 offset:17408
    ds_read_b128 v[44:47], v17 offset:8192
    ds_read_b64_tr_b16 v[48:49], v20 offset:20480
    ds_read_b64_tr_b16 v[50:51], v20 offset:21504
    ds_read_b64_tr_b16 v[52:53], v21 offset:20480
    ds_read_b64_tr_b16 v[54:55], v21 offset:21504
    s_waitcnt lgkmcnt(5)
    v_mfma_f32_32x32x16_bf16 v[64:79], v[36:39], v[32:35], v[64:79]
    v_mfma_f32_32x32x16_bf16 v[80:95], v[40:43], v[32:35], v[80:95]
    ds_read_b128 v[32:35], v18 offset:8192
    ds_read_b64_tr_b16 v[36:37], v20 offset:24576
    ds_read_b64_tr_b16 v[38:39], v20 offset:25600
    ds_read_b64_tr_b16 v[40:41], v21 offset:24576
    ds_read_b64_tr_b16 v[42:43], v21 offset:25600
    s_waitcnt lgkmcnt(5)
    v_mfma_f32_32x32x16_bf16 v[64:79], v[48:51], v[44:47], v[64:79]
    v_mfma_f32_32x32x16_bf16 v[80:95], v[52:55], v[44:47], v[80:95]
    ds_read_b128 v[44:47], v19 offset:8192
    ds_read_b64_tr_b16 v[48:49], v20 offset:28672
    ds_read_b64_tr_b16 v[50:51], v20 offset:29696
    ds_read_b64_tr_b16 v[52:53], v21 offset:28672
    ds_read_b64_tr_b16 v[54:55], v21 offset:29696
    s_waitcnt lgkmcnt(5)
    v_mfma_f32_32x32x16_bf16 v[64:79], v[36:39], v[32:35], v[64:79]
    v_mfma_f32_32x32x16_bf16 v[80:95], v[40:43], v[32:35], v[80:95]
    s_waitcnt lgkmcnt(0)
    v_mfma_f32_32x32x16_bf16 v[64:79], v[48:51], v[44:47], v[64:79]
    v_mfma_f32_32x32x16_bf16 v[80:95], v[52:55], v[44:47], v[80:95]
    s_barrier
    ds_read_b128 v[32:35], v16 offset:16384
    ds_read_b64_tr_b16 v[36:37], v20 offset:32768
    ds_read_b64_tr_b16 v[38:39], v20 offset:33792
    ds_read_b64_tr_b16 v[40:41], v21 offset:32768
    ds_read_b64_tr_b16 v[42:43], v21 offset:33792
    ds_read_b128 v[44:47], v17 offset:16384
    ds_read_b64_tr_b16 v[48:49], v20 offset:36864
    ds_read_b64_tr_b16 v[50:51], v20 offset:37888
    ds_read_b64_tr_b16 v[52:53], v21 offset:36864
    ds_read_b64_tr_b16 v[54:55], v21 offset:37888
    s_waitcnt lgkmcnt(5)
    v_mfma_f32_32x32x16_bf16 v[64:79], v[36:39], v[32:35], v[64:79]
    v_mfma_f32_32x32x16_bf16 v[80:95], v[40:43], v[32:35], v[80:95]
    ds_read_b128 v[32:35], v18 offset:16384
    ds_read_b64_tr_b16 v[36:37], v20 offset:40960
    ds_read_b64_tr_b16 v[38:39], v20 offset:41984
    ds_read_b64_tr_b16 v[40:41], v21 offset:40960
    ds_read_b64_tr_b16 v[42:43], v21 offset:41984
    s_waitcnt lgkmcnt(5)
    v_mfma_f32_32x32x16_bf16 v[64:79], v[48:51], v[44:47], v[64:79]
    v_mfma_f32_32x32x16_bf16 v[80:95], v[52:55], v[44:47], v[80:95]
    ds_read_b128 v[44:47], v19 offset:16384
    ds_read_b64_tr_b16 v[48:49], v20 offset:45056
    ds_read_b64_tr_b16 v[50:51], v20 offset:46080
    ds_read_b64_tr_b16 v[52:53], v21 offset:45056
    ds_read_b64_tr_b16 v[54:55], v21 offset:46080
    s_waitcnt lgkmcnt(5)
    v_mfma_f32_32x32x16_bf16 v[64:79], v[36:39], v[32:35], v[64:79]
    v_mfma_f32_32x32x16_bf16 v[80:95], v[40:43], v[32:35], v[80:95]
    s_waitcnt lgkmcnt(0)
    v_mfma_f32_32x32x16_bf16 v[64:79], v[48:51], v[44:47], v[64:79]
    v_mfma_f32_32x32x16_bf16 v[80:95], v[52:55], v[44:47], v[80:95]
    s_barrier
    ds_read_b128 v[32:35], v16 offset:24576
    ds_read_b64_tr_b16 v[36:37], v20 offset:49152
    ds_read_b64_tr_b16 v[38:39], v20 offset:50176
    ds_read_b64_tr_b16 v[40:41], v21 offset:49152
    ds_read_b64_tr_b16 v[42:43], v21 offset:50176
    ds_read_b128 v[44:47], v17 offset:24576
    ds_read_b64_tr_b16 v[48:49], v20 offset:53248
    ds_read_b64_tr_b16 v[50:51], v20 offset:54272
    ds_read_b64_tr_b16 v[52:53], v21 offset:53248
    ds_read_b64_tr_b16 v[54:55], v21 offset:54272
    s_waitcnt lgkmcnt(5)
    v_mfma_f32_32x32x16_bf16 v[64:79], v[36:39], v[32:35], v[64:79]
    v_mfma_f32_32x32x16_bf16 v[80:95], v[40:43], v[32:35], v[80:95]
    ds_read_b128 v[32:35], v18 offset:24576
    ds_read_b64_tr_b16 v[36:37], v20 offset:57344
    ds_read_b64_tr_b16 v[38:39], v20 offset:58368
    ds_read_b64_tr_b16 v[40:41], v21 offset:57344
    ds_read_b64_tr_b16 v[42:43], v21 offset:58368
    s_waitcnt lgkmcnt(5)
    v_mfma_f32_32x32x16_bf16 v[64:79], v[48:51], v[44:47], v[64:79]
    v_mfma_f32_32x32x16_bf16 v[80:95], v[52:55], v[44:47], v[80:95]
    ds_read_b128 v[44:47], v19 offset:24576
    ds_read_b64_tr_b16 v[48:49], v20 offset:61440
    ds_read_b64_tr_b16 v[50:51], v20 offset:62464
    ds_read_b64_tr_b16 v[52:53], v21 offset:61440
    ds_read_b64_tr_b16 v[54:55], v21 offset:62464
    s_waitcnt lgkmcnt(5)
    v_mfma_f32_32x32x16_bf16 v[64:79], v[36:39], v[32:35], v[64:79]
    v_mfma_f32_32x32x16_bf16 v[80:95], v[40:43], v[32:35], v[80:95]
    s_waitcnt lgkmcnt(0)
    v_mfma_f32_32x32x16_bf16 v[64:79], v[48:51], v[44:47], v[64:79]
    v_mfma_f32_32x32x16_bf16 v[80:95], v[52:55], v[44:47], v[80:95]
    s_barrier
    ds_read_b128 v[32:35], v16 offset:0
    ds_read_b64_tr_b16 v[36:37], v20 offset:0
    ds_read_b64_tr_b16 v[38:39], v20 offset:1024
    ds_read_b64_tr_b16 v[40:41], v21 offset:0
    ds_read_b64_tr_b16 v[42:43], v21 offset:1024
    ds_read_b128 v[44:47], v17 offset:0
    ds_read_b64_tr_b16 v[48:49], v20 offset:4096
    ds_read_b64_tr_b16 v[50:51], v20 offset:5120
    ds_read_b64_tr_b16 v[52:53], v21 offset:4096
    ds_read_b64_tr_b16 v[54:55], v21 offset:5120
    s_waitcnt lgkmcnt(5)
    v_mfma_f32_32x32x16_bf16 v[64:79], v[36:39], v[32:35], v[64:79]
    v_mfma_f32_32x32x16_bf16 v[80:95], v[40:43], v[32:35], v[80:95]
    ds_read_b128 v[32:35], v18 offset:0
    ds_read_b64_tr_b16 v[36:37], v20 offset:8192
    ds_read_b64_tr_b16 v[38:39], v20 offset:9216
    ds_read_b64_tr_b16 v[40:41], v21 offset:8192
    ds_read_b64_tr_b16 v[42:43], v21 offset:9216
    s_waitcnt lgkmcnt(5)
    v_mfma_f32_32x32x16_bf16 v[64:79], v[48:51], v[44:47], v[64:79]
    v_mfma_f32_32x32x16_bf16 v[80:95], v[52:55], v[44:47], v[80:95]
    ds_read_b128 v[44:47], v19 offset:0
    ds_read_b64_tr_b16 v[48:49], v20 offset:12288
    ds_read_b64_tr_b16 v[50:51], v20 offset:13312
    ds_read_b64_tr_b16 v[52:53], v21 offset:12288
    ds_read_b64_tr_b16 v[54:55], v21 offset:13312
    s_waitcnt lgkmcnt(5)
    v_mfma_f32_32x32x16_bf16 v[64:79], v[36:39], v[32:35], v[64:79]
    v_mfma_f32_32x32x16_bf16 v[80:95], v[40:43], v[32:35], v[80:95]
    s_waitcnt lgkmcnt(0)
    v_mfma_f32_32x32x16_bf16 v[64:79], v[48:51], v[44:47], v[64:79]
    v_mfma_f32_32x32x16_bf16 v[80:95], v[52:55], v[44:47], v[80:95]
    s_barrier
    ds_read_b128 v[32:35], v16 offset:8192
    ds_read_b64_tr_b16 v[36:37], v20 offset:16384
    ds_read_b64_tr_b16 v[38:39], v20 offset:17408
    ds_read_b64_tr_b16 v[40:41], v21 offset:16384
    ds_read_b64_tr_b16 v[42:43], v21 offset:17408
    ds_read_b128 v[44:47], v17 offset:8192
    ds_read_b64_tr_b16 v[48:49], v20 offset:20480
    ds_read_b64_tr_b16 v[50:51], v20 offset:21504
    ds_read_b64_tr_b16 v[52:53], v21 offset:20480
    ds_read_b64_tr_b16 v[54:55], v21 offset:21504
    s_waitcnt lgkmcnt(5)
    v_mfma_f32_32x32x16_bf16 v[64:79], v[36:39], v[32:35], v[64:79]
    v_mfma_f32_32x32x16_bf16 v[80:95], v[40:43], v[32:35], v[80:95]
    ds_read_b128 v[32:35], v18 offset:8192
    ds_read_b64_tr_b16 v[36:37], v20 offset:24576
    ds_read_b64_tr_b16 v[38:39], v20 offset:25600
    ds_read_b64_tr_b16 v[40:41], v21 offset:24576
    ds_read_b64_tr_b16 v[42:43], v21 offset:25600
    s_waitcnt lgkmcnt(5)
    v_mfma_f32_32x32x16_bf16 v[64:79], v[48:51], v[44:47], v[64:79]
    v_mfma_f32_32x32x16_bf16 v[80:95], v[52:55], v[44:47], v[80:95]
    ds_read_b128 v[44:47], v19 offset:8192
    ds_read_b64_tr_b16 v[48:49], v20 offset:28672
    ds_read_b64_tr_b16 v[50:51], v20 offset:29696
    ds_read_b64_tr_b16 v[52:53], v21 offset:28672
    ds_read_b64_tr_b16 v[54:55], v21 offset:29696
    s_waitcnt lgkmcnt(5)
    v_mfma_f32_32x32x16_bf16 v[64:79], v[36:39], v[32:35], v[64:79]
    v_mfma_f32_32x32x16_bf16 v[80:95], v[40:43], v[32:35], v[80:95]
    s_waitcnt lgkmcnt(0)
    v_mfma_f32_32x32x16_bf16 v[64:79], v[48:51], v[44:47], v[64:79]
    v_mfma_f32_32x32x16_bf16 v[80:95], v[52:55], v[44:47], v[80:95]
    s_barrier
    ds_read_b128 v[32:35], v16 offset:16384
    ds_read_b64_tr_b16 v[36:37], v20 offset:32768
    ds_read_b64_tr_b16 v[38:39], v20 offset:33792
    ds_read_b64_tr_b16 v[40:41], v21 offset:32768
    ds_read_b64_tr_b16 v[42:43], v21 offset:33792
    ds_read_b128 v[44:47], v17 offset:16384
    ds_read_b64_tr_b16 v[48:49], v20 offset:36864
    ds_read_b64_tr_b16 v[50:51], v20 offset:37888
    ds_read_b64_tr_b16 v[52:53], v21 offset:36864
    ds_read_b64_tr_b16 v[54:55], v21 offset:37888
    s_waitcnt lgkmcnt(5)
    v_mfma_f32_32x32x16_bf16 v[64:79], v[36:39], v[32:35], v[64:79]
    v_mfma_f32_32x32x16_bf16 v[80:95], v[40:43], v[32:35], v[80:95]
    ds_read_b128 v[32:35], v18 offset:16384
    ds_read_b64_tr_b16 v[36:37], v20 offset:40960
    ds_read_b64_tr_b16 v[38:39], v20 offset:41984
    ds_read_b64_tr_b16 v[40:41], v21 offset:40960
    ds_read_b64_tr_b16 v[42:43], v21 offset:41984
    s_waitcnt lgkmcnt(5)
    v_mfma_f32_32x32x16_bf16 v[64:79], v[48:51], v[44:47], v[64:79]
    v_mfma_f32_32x32x16_bf16 v[80:95], v[52:55], v[44:47], v[80:95]
    ds_read_b128 v[44:47], v19 offset:16384
    ds_read_b64_tr_b16 v[48:49], v20 offset:45056
    ds_read_b64_tr_b16 v[50:51], v20 offset:46080
    ds_read_b64_tr_b16 v[52:53], v21 offset:45056
    ds_read_b64_tr_b16 v[54:55], v21 offset:46080
    s_waitcnt lgkmcnt(5)
    v_mfma_f32_32x32x16_bf16 v[64:79], v[36:39], v[32:35], v[64:79]
    v_mfma_f32_32x32x16_bf16 v[80:95], v[40:43], v[32:35], v[80:95]
    s_waitcnt lgkmcnt(0)
    v_mfma_f32_32x32x16_bf16 v[64:79], v[48:51], v[44:47], v[64:79]
    v_mfma_f32_32x32x16_bf16 v[80:95], v[52:55], v[44:47], v[80:95]
    s_mov_b32 s20, s48
    s_mov_b32 s21, s49
    s_mov_b32 s22, 2621440
    s_mov_b32 s23, 0x00020000
    buffer_load_dwordx4 v[100:103], v22, s[20:23], 0 offen
    buffer_load_dwordx4 v[104:107], v23, s[20:23], 0 offen
    buffer_load_dwordx4 v[108:111], v24, s[20:23], 0 offen
    buffer_load_dwordx4 v[112:115], v25, s[20:23], 0 offen
    s_barrier
    ds_read_b128 v[32:35], v16 offset:24576
    ds_read_b64_tr_b16 v[36:37], v20 offset:49152
    ds_read_b64_tr_b16 v[38:39], v20 offset:50176
    ds_read_b64_tr_b16 v[40:41], v21 offset:49152
    ds_read_b64_tr_b16 v[42:43], v21 offset:50176
    ds_read_b128 v[44:47], v17 offset:24576
    ds_read_b64_tr_b16 v[48:49], v20 offset:53248
    ds_read_b64_tr_b16 v[50:51], v20 offset:54272
    ds_read_b64_tr_b16 v[52:53], v21 offset:53248
    ds_read_b64_tr_b16 v[54:55], v21 offset:54272
    s_waitcnt lgkmcnt(5)
    v_mfma_f32_32x32x16_bf16 v[64:79], v[36:39], v[32:35], v[64:79]
    v_mfma_f32_32x32x16_bf16 v[80:95], v[40:43], v[32:35], v[80:95]
    ds_read_b128 v[32:35], v18 offset:24576
    ds_read_b64_tr_b16 v[36:37], v20 offset:57344
    ds_read_b64_tr_b16 v[38:39], v20 offset:58368
    ds_read_b64_tr_b16 v[40:41], v21 offset:57344
    ds_read_b64_tr_b16 v[42:43], v21 offset:58368
    s_waitcnt lgkmcnt(5)
    v_mfma_f32_32x32x16_bf16 v[64:79], v[48:51], v[44:47], v[64:79]
    v_mfma_f32_32x32x16_bf16 v[80:95], v[52:55], v[44:47], v[80:95]
    ds_read_b128 v[44:47], v19 offset:24576
    ds_read_b64_tr_b16 v[48:49], v20 offset:61440
    ds_read_b64_tr_b16 v[50:51], v20 offset:62464
    ds_read_b64_tr_b16 v[52:53], v21 offset:61440
    ds_read_b64_tr_b16 v[54:55], v21 offset:62464
    s_waitcnt lgkmcnt(5)
    v_mfma_f32_32x32x16_bf16 v[64:79], v[36:39], v[32:35], v[64:79]
    v_mfma_f32_32x32x16_bf16 v[80:95], v[40:43], v[32:35], v[80:95]
    s_waitcnt lgkmcnt(0)
    v_mfma_f32_32x32x16_bf16 v[64:79], v[48:51], v[44:47], v[64:79]
    v_mfma_f32_32x32x16_bf16 v[80:95], v[52:55], v[44:47], v[80:95]
    s_barrier
    ds_read_b128 v[32:35], v16 offset:0
    ds_read_b64_tr_b16 v[36:37], v20 offset:0
    ds_read_b64_tr_b16 v[38:39], v20 offset:1024
    ds_read_b64_tr_b16 v[40:41], v21 offset:0
    ds_read_b64_tr_b16 v[42:43], v21 offset:1024
    ds_read_b128 v[44:47], v17 offset:0
    ds_read_b64_tr_b16 v[48:49], v20 offset:4096
    ds_read_b64_tr_b16 v[50:51], v20 offset:5120
    ds_read_b64_tr_b16 v[52:53], v21 offset:4096
    ds_read_b64_tr_b16 v[54:55], v21 offset:5120
    s_waitcnt lgkmcnt(5)
    v_mfma_f32_32x32x16_bf16 v[64:79], v[36:39], v[32:35], v[64:79]
    v_mfma_f32_32x32x16_bf16 v[80:95], v[40:43], v[32:35], v[80:95]
    ds_read_b128 v[32:35], v18 offset:0
    ds_read_b64_tr_b16 v[36:37], v20 offset:8192
    ds_read_b64_tr_b16 v[38:39], v20 offset:9216
    ds_read_b64_tr_b16 v[40:41], v21 offset:8192
    ds_read_b64_tr_b16 v[42:43], v21 offset:9216
    s_waitcnt lgkmcnt(5)
    v_mfma_f32_32x32x16_bf16 v[64:79], v[48:51], v[44:47], v[64:79]
    v_mfma_f32_32x32x16_bf16 v[80:95], v[52:55], v[44:47], v[80:95]
    ds_read_b128 v[44:47], v19 offset:0
    ds_read_b64_tr_b16 v[48:49], v20 offset:12288
    ds_read_b64_tr_b16 v[50:51], v20 offset:13312
    ds_read_b64_tr_b16 v[52:53], v21 offset:12288
    ds_read_b64_tr_b16 v[54:55], v21 offset:13312
    s_waitcnt lgkmcnt(5)
    v_mfma_f32_32x32x16_bf16 v[64:79], v[36:39], v[32:35], v[64:79]
    v_mfma_f32_32x32x16_bf16 v[80:95], v[40:43], v[32:35], v[80:95]
    s_waitcnt lgkmcnt(0)
    v_mfma_f32_32x32x16_bf16 v[64:79], v[48:51], v[44:47], v[64:79]
    v_mfma_f32_32x32x16_bf16 v[80:95], v[52:55], v[44:47], v[80:95]
    s_barrier
    ds_read_b128 v[32:35], v16 offset:8192
    ds_read_b64_tr_b16 v[36:37], v20 offset:16384
    ds_read_b64_tr_b16 v[38:39], v20 offset:17408
    ds_read_b64_tr_b16 v[40:41], v21 offset:16384
    ds_read_b64_tr_b16 v[42:43], v21 offset:17408
    ds_read_b128 v[44:47], v17 offset:8192
    ds_read_b64_tr_b16 v[48:49], v20 offset:20480
    ds_read_b64_tr_b16 v[50:51], v20 offset:21504
    ds_read_b64_tr_b16 v[52:53], v21 offset:20480
    ds_read_b64_tr_b16 v[54:55], v21 offset:21504
    s_waitcnt lgkmcnt(5)
    v_mfma_f32_32x32x16_bf16 v[64:79], v[36:39], v[32:35], v[64:79]
    v_mfma_f32_32x32x16_bf16 v[80:95], v[40:43], v[32:35], v[80:95]
    ds_read_b128 v[32:35], v18 offset:8192
    ds_read_b64_tr_b16 v[36:37], v20 offset:24576
    ds_read_b64_tr_b16 v[38:39], v20 offset:25600
    ds_read_b64_tr_b16 v[40:41], v21 offset:24576
    ds_read_b64_tr_b16 v[42:43], v21 offset:25600
    s_waitcnt lgkmcnt(5)
    v_mfma_f32_32x32x16_bf16 v[64:79], v[48:51], v[44:47], v[64:79]
    v_mfma_f32_32x32x16_bf16 v[80:95], v[52:55], v[44:47], v[80:95]
    ds_read_b128 v[44:47], v19 offset:8192
    ds_read_b64_tr_b16 v[48:49], v20 offset:28672
    ds_read_b64_tr_b16 v[50:51], v20 offset:29696
    ds_read_b64_tr_b16 v[52:53], v21 offset:28672
    ds_read_b64_tr_b16 v[54:55], v21 offset:29696
    s_waitcnt lgkmcnt(5)
    v_mfma_f32_32x32x16_bf16 v[64:79], v[36:39], v[32:35], v[64:79]
    v_mfma_f32_32x32x16_bf16 v[80:95], v[40:43], v[32:35], v[80:95]
    s_waitcnt lgkmcnt(0)
    v_mfma_f32_32x32x16_bf16 v[64:79], v[48:51], v[44:47], v[64:79]
    v_mfma_f32_32x32x16_bf16 v[80:95], v[52:55], v[44:47], v[80:95]
    s_barrier
    s_nop 15
    v_cvt_pk_bf16_f32 v124, v64, v65
    v_cvt_pk_bf16_f32 v125, v66, v67
    ds_write_b64 v30, v[124:125] offset:0
    v_cvt_pk_bf16_f32 v124, v68, v69
    v_cvt_pk_bf16_f32 v125, v70, v71
    ds_write_b64 v30, v[124:125] offset:16
    v_cvt_pk_bf16_f32 v124, v72, v73
    v_cvt_pk_bf16_f32 v125, v74, v75
    ds_write_b64 v30, v[124:125] offset:32
    v_cvt_pk_bf16_f32 v124, v76, v77
    v_cvt_pk_bf16_f32 v125, v78, v79
    ds_write_b64 v30, v[124:125] offset:48
    v_cvt_pk_bf16_f32 v124, v80, v81
    v_cvt_pk_bf16_f32 v125, v82, v83
    ds_write_b64 v30, v[124:125] offset:64
    v_cvt_pk_bf16_f32 v124, v84, v85
    v_cvt_pk_bf16_f32 v125, v86, v87
    ds_write_b64 v30, v[124:125] offset:80
    v_cvt_pk_bf16_f32 v124, v88, v89
    v_cvt_pk_bf16_f32 v125, v90, v91
    ds_write_b64 v30, v[124:125] offset:96
    v_cvt_pk_bf16_f32 v124, v92, v93
    v_cvt_pk_bf16_f32 v125, v94, v95
    ds_write_b64 v30, v[124:125] offset:112
    s_waitcnt lgkmcnt(0)
    s_barrier
    ds_read_b128 v[64:67], v26
    ds_read_b128 v[68:71], v27
    ds_read_b128 v[72:75], v28
    ds_read_b128 v[76:79], v29
    s_add_u32 s28, s70, 31014912
    s_addc_u32 s29, s71, 0
    s_mov_b32 s30, 81920
    s_mov_b32 s31, 0x00020000
    s_waitcnt vmcnt(0)
    s_waitcnt lgkmcnt(3)
    v_lshlrev_b32 v116, 16, v64
    v_and_b32 v117, 0xffff0000, v64
    v_lshlrev_b32 v124, 16, v100
    v_and_b32 v125, 0xffff0000, v100
    v_lshlrev_b32 v118, 16, v65
    v_and_b32 v119, 0xffff0000, v65
    v_lshlrev_b32 v126, 16, v101
    v_and_b32 v127, 0xffff0000, v101
    v_lshlrev_b32 v120, 16, v66
    v_and_b32 v121, 0xffff0000, v66
    v_lshlrev_b32 v128, 16, v102
    v_and_b32 v129, 0xffff0000, v102
    v_lshlrev_b32 v122, 16, v67
    v_and_b32 v123, 0xffff0000, v67
    v_lshlrev_b32 v130, 16, v103
    v_and_b32 v131, 0xffff0000, v103
    v_add_f32 v116, v116, v124
    v_add_f32 v117, v117, v125
    v_add_f32 v118, v118, v126
    v_add_f32 v119, v119, v127
    v_add_f32 v120, v120, v128
    v_add_f32 v121, v121, v129
    v_add_f32 v122, v122, v130
    v_add_f32 v123, v123, v131
    v_cvt_pk_bf16_f32 v64, v116, v117
    v_cvt_pk_bf16_f32 v65, v118, v119
    v_cvt_pk_bf16_f32 v66, v120, v121
    v_cvt_pk_bf16_f32 v67, v122, v123
    buffer_store_dwordx4 v[64:67], v22, s[16:19], 0 offen
    v_lshlrev_b32 v116, 16, v64
    v_and_b32 v117, 0xffff0000, v64
    v_lshlrev_b32 v118, 16, v65
    v_and_b32 v119, 0xffff0000, v65
    v_lshlrev_b32 v120, 16, v66
    v_and_b32 v121, 0xffff0000, v66
    v_lshlrev_b32 v122, 16, v67
    v_and_b32 v123, 0xffff0000, v67
    v_add_f32 v100, v116, v117
    v_mul_f32 v101, v116, v116
    v_fmac_f32 v101, v117, v117
    v_add_f32 v100, v100, v118
    v_fmac_f32 v101, v118, v118
    v_add_f32 v100, v100, v119
    v_fmac_f32 v101, v119, v119
    v_add_f32 v100, v100, v120
    v_fmac_f32 v101, v120, v120
    v_add_f32 v100, v100, v121
    v_fmac_f32 v101, v121, v121
    v_add_f32 v100, v100, v122
    v_fmac_f32 v101, v122, v122
    v_add_f32 v100, v100, v123
    v_fmac_f32 v101, v123, v123
    s_waitcnt lgkmcnt(2)
    v_lshlrev_b32 v116, 16, v68
    v_and_b32 v117, 0xffff0000, v68
    v_lshlrev_b32 v124, 16, v104
    v_and_b32 v125, 0xffff0000, v104
    v_lshlrev_b32 v118, 16, v69
    v_and_b32 v119, 0xffff0000, v69
    v_lshlrev_b32 v126, 16, v105
    v_and_b32 v127, 0xffff0000, v105
    v_lshlrev_b32 v120, 16, v70
    v_and_b32 v121, 0xffff0000, v70
    v_lshlrev_b32 v128, 16, v106
    v_and_b32 v129, 0xffff0000, v106
    v_lshlrev_b32 v122, 16, v71
    v_and_b32 v123, 0xffff0000, v71
    v_lshlrev_b32 v130, 16, v107
    v_and_b32 v131, 0xffff0000, v107
    v_add_f32 v116, v116, v124
    v_add_f32 v117, v117, v125
    v_add_f32 v118, v118, v126
    v_add_f32 v119, v119, v127
    v_add_f32 v120, v120, v128
    v_add_f32 v121, v121, v129
    v_add_f32 v122, v122, v130
    v_add_f32 v123, v123, v131
    v_cvt_pk_bf16_f32 v68, v116, v117
    v_cvt_pk_bf16_f32 v69, v118, v119
    v_cvt_pk_bf16_f32 v70, v120, v121
    v_cvt_pk_bf16_f32 v71, v122, v123
    buffer_store_dwordx4 v[68:71], v23, s[16:19], 0 offen
    v_lshlrev_b32 v116, 16, v68
    v_and_b32 v117, 0xffff0000, v68
    v_lshlrev_b32 v118, 16, v69
    v_and_b32 v119, 0xffff0000, v69
    v_lshlrev_b32 v120, 16, v70
    v_and_b32 v121, 0xffff0000, v70
    v_lshlrev_b32 v122, 16, v71
    v_and_b32 v123, 0xffff0000, v71
    v_add_f32 v104, v116, v117
    v_mul_f32 v105, v116, v116
    v_fmac_f32 v105, v117, v117
    v_add_f32 v104, v104, v118
    v_fmac_f32 v105, v118, v118
    v_add_f32 v104, v104, v119
    v_fmac_f32 v105, v119, v119
    v_add_f32 v104, v104, v120
    v_fmac_f32 v105, v120, v120
    v_add_f32 v104, v104, v121
    v_fmac_f32 v105, v121, v121
    v_add_f32 v104, v104, v122
    v_fmac_f32 v105, v122, v122
    v_add_f32 v104, v104, v123
    v_fmac_f32 v105, v123, v123
    s_waitcnt lgkmcnt(1)
    v_lshlrev_b32 v116, 16, v72
    v_and_b32 v117, 0xffff0000, v72
    v_lshlrev_b32 v124, 16, v108
    v_and_b32 v125, 0xffff0000, v108
    v_lshlrev_b32 v118, 16, v73
    v_and_b32 v119, 0xffff0000, v73
    v_lshlrev_b32 v126, 16, v109
    v_and_b32 v127, 0xffff0000, v109
    v_lshlrev_b32 v120, 16, v74
    v_and_b32 v121, 0xffff0000, v74
    v_lshlrev_b32 v128, 16, v110
    v_and_b32 v129, 0xffff0000, v110
    v_lshlrev_b32 v122, 16, v75
    v_and_b32 v123, 0xffff0000, v75
    v_lshlrev_b32 v130, 16, v111
    v_and_b32 v131, 0xffff0000, v111
    v_add_f32 v116, v116, v124
    v_add_f32 v117, v117, v125
    v_add_f32 v118, v118, v126
    v_add_f32 v119, v119, v127
    v_add_f32 v120, v120, v128
    v_add_f32 v121, v121, v129
    v_add_f32 v122, v122, v130
    v_add_f32 v123, v123, v131
    v_cvt_pk_bf16_f32 v72, v116, v117
    v_cvt_pk_bf16_f32 v73, v118, v119
    v_cvt_pk_bf16_f32 v74, v120, v121
    v_cvt_pk_bf16_f32 v75, v122, v123
    buffer_store_dwordx4 v[72:75], v24, s[16:19], 0 offen
    v_lshlrev_b32 v116, 16, v72
    v_and_b32 v117, 0xffff0000, v72
    v_lshlrev_b32 v118, 16, v73
    v_and_b32 v119, 0xffff0000, v73
    v_lshlrev_b32 v120, 16, v74
    v_and_b32 v121, 0xffff0000, v74
    v_lshlrev_b32 v122, 16, v75
    v_and_b32 v123, 0xffff0000, v75
    v_add_f32 v108, v116, v117
    v_mul_f32 v109, v116, v116
    v_fmac_f32 v109, v117, v117
    v_add_f32 v108, v108, v118
    v_fmac_f32 v109, v118, v118
    v_add_f32 v108, v108, v119
    v_fmac_f32 v109, v119, v119
    v_add_f32 v108, v108, v120
    v_fmac_f32 v109, v120, v120
    v_add_f32 v108, v108, v121
    v_fmac_f32 v109, v121, v121
    v_add_f32 v108, v108, v122
    v_fmac_f32 v109, v122, v122
    v_add_f32 v108, v108, v123
    v_fmac_f32 v109, v123, v123
    s_waitcnt lgkmcnt(0)
    v_lshlrev_b32 v116, 16, v76
    v_and_b32 v117, 0xffff0000, v76
    v_lshlrev_b32 v124, 16, v112
    v_and_b32 v125, 0xffff0000, v112
    v_lshlrev_b32 v118, 16, v77
    v_and_b32 v119, 0xffff0000, v77
    v_lshlrev_b32 v126, 16, v113
    v_and_b32 v127, 0xffff0000, v113
    v_lshlrev_b32 v120, 16, v78
    v_and_b32 v121, 0xffff0000, v78
    v_lshlrev_b32 v128, 16, v114
    v_and_b32 v129, 0xffff0000, v114
    v_lshlrev_b32 v122, 16, v79
    v_and_b32 v123, 0xffff0000, v79
    v_lshlrev_b32 v130, 16, v115
    v_and_b32 v131, 0xffff0000, v115
    v_add_f32 v116, v116, v124
    v_add_f32 v117, v117, v125
    v_add_f32 v118, v118, v126
    v_add_f32 v119, v119, v127
    v_add_f32 v120, v120, v128
    v_add_f32 v121, v121, v129
    v_add_f32 v122, v122, v130
    v_add_f32 v123, v123, v131
    v_cvt_pk_bf16_f32 v76, v116, v117
    v_cvt_pk_bf16_f32 v77, v118, v119
    v_cvt_pk_bf16_f32 v78, v120, v121
    v_cvt_pk_bf16_f32 v79, v122, v123
    buffer_store_dwordx4 v[76:79], v25, s[16:19], 0 offen
    v_lshlrev_b32 v116, 16, v76
    v_and_b32 v117, 0xffff0000, v76
    v_lshlrev_b32 v118, 16, v77
    v_and_b32 v119, 0xffff0000, v77
    v_lshlrev_b32 v120, 16, v78
    v_and_b32 v121, 0xffff0000, v78
    v_lshlrev_b32 v122, 16, v79
    v_and_b32 v123, 0xffff0000, v79
    v_add_f32 v112, v116, v117
    v_mul_f32 v113, v116, v116
    v_fmac_f32 v113, v117, v117
    v_add_f32 v112, v112, v118
    v_fmac_f32 v113, v118, v118
    v_add_f32 v112, v112, v119
    v_fmac_f32 v113, v119, v119
    v_add_f32 v112, v112, v120
    v_fmac_f32 v113, v120, v120
    v_add_f32 v112, v112, v121
    v_fmac_f32 v113, v121, v121
    v_add_f32 v112, v112, v122
    v_fmac_f32 v113, v122, v122
    v_add_f32 v112, v112, v123
    v_fmac_f32 v113, v123, v123
    s_nop 1
    v_add_f32_dpp v100, v100, v100 row_ror:8 row_mask:0xf bank_mask:0xf
    v_add_f32_dpp v101, v101, v101 row_ror:8 row_mask:0xf bank_mask:0xf
    v_add_f32_dpp v104, v104, v104 row_ror:8 row_mask:0xf bank_mask:0xf
    v_add_f32_dpp v105, v105, v105 row_ror:8 row_mask:0xf bank_mask:0xf
    v_add_f32_dpp v108, v108, v108 row_ror:8 row_mask:0xf bank_mask:0xf
    v_add_f32_dpp v109, v109, v109 row_ror:8 row_mask:0xf bank_mask:0xf
    v_add_f32_dpp v112, v112, v112 row_ror:8 row_mask:0xf bank_mask:0xf
    v_add_f32_dpp v113, v113, v113 row_ror:8 row_mask:0xf bank_mask:0xf
    s_nop 1
    v_add_f32_dpp v100, v100, v100 row_ror:4 row_mask:0xf bank_mask:0xf
    v_add_f32_dpp v101, v101, v101 row_ror:4 row_mask:0xf bank_mask:0xf
    v_add_f32_dpp v104, v104, v104 row_ror:4 row_mask:0xf bank_mask:0xf
    v_add_f32_dpp v105, v105, v105 row_ror:4 row_mask:0xf bank_mask:0xf
    v_add_f32_dpp v108, v108, v108 row_ror:4 row_mask:0xf bank_mask:0xf
    v_add_f32_dpp v109, v109, v109 row_ror:4 row_mask:0xf bank_mask:0xf
    v_add_f32_dpp v112, v112, v112 row_ror:4 row_mask:0xf bank_mask:0xf
    v_add_f32_dpp v113, v113, v113 row_ror:4 row_mask:0xf bank_mask:0xf
    s_nop 1
    v_add_f32_dpp v100, v100, v100 row_ror:2 row_mask:0xf bank_mask:0xf
    v_add_f32_dpp v101, v101, v101 row_ror:2 row_mask:0xf bank_mask:0xf
    v_add_f32_dpp v104, v104, v104 row_ror:2 row_mask:0xf bank_mask:0xf
    v_add_f32_dpp v105, v105, v105 row_ror:2 row_mask:0xf bank_mask:0xf
    v_add_f32_dpp v108, v108, v108 row_ror:2 row_mask:0xf bank_mask:0xf
    v_add_f32_dpp v109, v109, v109 row_ror:2 row_mask:0xf bank_mask:0xf
    v_add_f32_dpp v112, v112, v112 row_ror:2 row_mask:0xf bank_mask:0xf
    v_add_f32_dpp v113, v113, v113 row_ror:2 row_mask:0xf bank_mask:0xf
    s_nop 1
    v_add_f32_dpp v100, v100, v100 row_ror:1 row_mask:0xf bank_mask:0xf
    v_add_f32_dpp v101, v101, v101 row_ror:1 row_mask:0xf bank_mask:0xf
    v_add_f32_dpp v104, v104, v104 row_ror:1 row_mask:0xf bank_mask:0xf
    v_add_f32_dpp v105, v105, v105 row_ror:1 row_mask:0xf bank_mask:0xf
    v_add_f32_dpp v108, v108, v108 row_ror:1 row_mask:0xf bank_mask:0xf
    v_add_f32_dpp v109, v109, v109 row_ror:1 row_mask:0xf bank_mask:0xf
    v_add_f32_dpp v112, v112, v112 row_ror:1 row_mask:0xf bank_mask:0xf
    v_add_f32_dpp v113, v113, v113 row_ror:1 row_mask:0xf bank_mask:0xf
    v_lshrrev_b32 v2, 4, v0
    v_add_u32 v2, s38, v2
    s_mul_i32 s46, s37, 2048
    v_add_u32 v2, s46, v2
    v_lshlrev_b32 v2, 3, v2
    v_and_b32 v3, 15, v0
    v_cmp_eq_u32 vcc, 0, v3
    s_and_saveexec_b64 s[46:47], vcc
    buffer_store_dwordx2 v[100:101], v2, s[28:31], 0 offen offset:0
    buffer_store_dwordx2 v[104:105], v2, s[28:31], 0 offen offset:128
    buffer_store_dwordx2 v[108:109], v2, s[28:31], 0 offen offset:256
    buffer_store_dwordx2 v[112:113], v2, s[28:31], 0 offen offset:384
    s_mov_b64 exec, s[46:47]
g2a_kernel_end1:
    s_endpgm
.globl g3a_kernel
.p2align 8
.type g3a_kernel,@function
g3a_kernel:
    s_cmp_ge_u32 s2, 256
    s_cbranch_scc1 g3a_kernel_end1
    s_load_dwordx16 s[48:63], s[0:1], 0
    s_load_dwordx8 s[64:71], s[0:1], 64
    v_and_b32 v1, 63, v0
    v_lshrrev_b32 v2, 6, v0
    s_and_b32 s46, s2, 7
    s_lshr_b32 s47, s2, 3
    s_mul_i32 s36, s47, 257
    s_lshr_b32 s36, s36, 12
    s_mul_i32 s3, s36, 16
    s_sub_u32 s37, s47, s3
    s_mul_i32 s46, s46, 2
    s_add_u32 s36, s36, s46
    s_mul_i32 s38, s36, 128
    s_mul_i32 s39, s37, 96
    v_readfirstlane_b32 s40, v2
    s_lshr_b32 s74, s40, 2
    s_and_b32 s40, s40, 3
    s_cmp_eq_u32 s74, 0
    s_cbranch_scc0 g3a_kernel_prod2
    s_branch g3a_kernel_cons3
g3a_kernel_prod2:
    s_mul_i32 s41, s38, 1280
    s_lshl_b32 s42, s39, 1
    s_mul_i32 s43, s40, 4096
    s_mul_i32 s44, s40, 3072
    s_add_u32 s44, s44, 65536
    s_mul_i32 s46, s40, 256
    s_add_u32 s46, s46, 0
    v_add_u32 v2, s46, v1
    v_lshrrev_b32 v3, 3, v2
    v_and_b32 v4, 7, v2
    v_bfe_u32 v5, v3, 1, 3
    v_xor_b32 v4, v4, v5
    v_lshlrev_b32 v4, 4, v4
    s_mov_b32 s47, 1280
    v_mad_u32_u24 v10, v3, s47, v4
    s_mul_i32 s46, s40, 256
    s_add_u32 s46, s46, 64
    v_add_u32 v2, s46, v1
    v_lshrrev_b32 v3, 3, v2
    v_and_b32 v4, 7, v2
    v_bfe_u32 v5, v3, 1, 3
    v_xor_b32 v4, v4, v5
    v_lshlrev_b32 v4, 4, v4
    s_mov_b32 s47, 1280
    v_mad_u32_u24 v11, v3, s47, v4
    s_mul_i32 s46, s40, 256
    s_add_u32 s46, s46, 128
    v_add_u32 v2, s46, v1
    v_lshrrev_b32 v3, 3, v2
    v_and_b32 v4, 7, v2
    v_bfe_u32 v5, v3, 1, 3
    v_xor_b32 v4, v4, v5
    v_lshlrev_b32 v4, 4, v4
    s_mov_b32 s47, 1280
    v_mad_u32_u24 v12, v3, s47, v4
    s_mul_i32 s46, s40, 256
    s_add_u32 s46, s46, 192
    v_add_u32 v2, s46, v1
    v_lshrrev_b32 v3, 3, v2
    v_and_b32 v4, 7, v2
    v_bfe_u32 v5, v3, 1, 3
    v_xor_b32 v4, v4, v5
    v_lshlrev_b32 v4, 4, v4
    s_mov_b32 s47, 1280
    v_mad_u32_u24 v13, v3, s47, v4
    s_mul_i32 s46, s40, 192
    s_add_u32 s46, s46, 0
    v_add_u32 v2, s46, v1
    s_mov_b32 s47, 683
    v_mul_u32_u24 v3, s47, v2
    v_lshrrev_b32 v3, 13, v3
    s_mov_b32 s47, 12
    v_mul_u32_u24 v4, s47, v3
    v_sub_u32 v4, v2, v4
    v_lshlrev_b32 v4, 4, v4
    s_mov_b32 s47, 3072
    v_mad_u32_u24 v14, v3, s47, v4
    s_mul_i32 s46, s40, 192
    s_add_u32 s46, s46, 64
    v_add_u32 v2, s46, v1
    s_mov_b32 s47, 683
    v_mul_u32_u24 v3, s47, v2
    v_lshrrev_b32 v3, 13, v3
    s_mov_b32 s47, 12
    v_mul_u32_u24 v4, s47, v3
    v_sub_u32 v4, v2, v4
    v_lshlrev_b32 v4, 4, v4
    s_mov_b32 s47, 3072
    v_mad_u32_u24 v15, v3, s47, v4
    s_mul_i32 s46, s40, 192
    s_add_u32 s46, s46, 128
    v_add_u32 v2, s46, v1
    s_mov_b32 s47, 683
    v_mul_u32_u24 v3, s47, v2
    v_lshrrev_b32 v3, 13, v3
    s_mov_b32 s47, 12
    v_mul_u32_u24 v4, s47, v3
    v_sub_u32 v4, v2, v4
    v_lshlrev_b32 v4, 4, v4
    s_mov_b32 s47, 3072
    v_mad_u32_u24 v16, v3, s47, v4
    s_waitcnt lgkmcnt(0)
    s_add_u32 s8, s70, 10485760
    s_addc_u32 s9, s71, 0
    s_mov_b32 s10, 2621440
    s_mov_b32 s11, 0x00020000
    s_mov_b32 s12, s58
    s_mov_b32 s13, s59
    s_mov_b32 s14, 1966080
    s_mov_b32 s15, 0x00020000
    s_add_u32 m0, s43, 0
    s_nop 0
    buffer_load_dwordx4 v10, s[8:11], s41 offen lds
    s_add_u32 m0, s43, 1024
    s_nop 0
    buffer_load_dwordx4 v11, s[8:11], s41 offen lds
    s_add_u32 m0, s43, 2048
    s_nop 0
    buffer_load_dwordx4 v12, s[8:11], s41 offen lds
    s_add_u32 m0, s43, 3072
    s_nop 0
    buffer_load_dwordx4 v13, s[8:11], s41 offen lds
    s_add_u32 m0, s44, 0
    s_nop 0
    buffer_load_dwordx4 v14, s[12:15], s42 offen lds
    s_add_u32 m0, s44, 1024
    s_nop 0
    buffer_load_dwordx4 v15, s[12:15], s42 offen lds
    s_add_u32 m0, s44, 2048
    s_nop 0
    buffer_load_dwordx4 v16, s[12:15], s42 offen lds
    s_add_u32 s41, s41, 128
    s_add_u32 s42, s42, 196608
    s_add_u32 m0, s43, 16384
    s_nop 0
    buffer_load_dwordx4 v10, s[8:11], s41 offen lds
    s_add_u32 m0, s43, 17408
    s_nop 0
    buffer_load_dwordx4 v11, s[8:11], s41 offen lds
    s_add_u32 m0, s43, 18432
    s_nop 0
    buffer_load_dwordx4 v12, s[8:11], s41 offen lds
    s_add_u32 m0, s43, 19456
    s_nop 0
    buffer_load_dwordx4 v13, s[8:11], s41 offen lds
    s_add_u32 m0, s44, 12288
    s_nop 0
    buffer_load_dwordx4 v14, s[12:15], s42 offen lds
    s_add_u32 m0, s44, 13312
    s_nop 0
    buffer_load_dwordx4 v15, s[12:15], s42 offen lds
    s_add_u32 m0, s44, 14336
    s_nop 0
    buffer_load_dwordx4 v16, s[12:15], s42 offen lds
    s_add_u32 s41, s41, 128
    s_add_u32 s42, s42, 196608
    s_add_u32 m0, s43, 32768
    s_nop 0
    buffer_load_dwordx4 v10, s[8:11], s41 offen lds
    s_add_u32 m0, s43, 33792
    s_nop 0
    buffer_load_dwordx4 v11, s[8:11], s41 offen lds
    s_add_u32 m0, s43, 34816
    s_nop 0
    buffer_load_dwordx4 v12, s[8:11], s41 offen lds
    s_add_u32 m0, s43, 35840
    s_nop 0
    buffer_load_dwordx4 v13, s[8:11], s41 offen lds
    s_add_u32 m0, s44, 24576
    s_nop 0
    buffer_load_dwordx4 v14, s[12:15], s42 offen lds
    s_add_u32 m0, s44, 25600
    s_nop 0
    buffer_load_dwordx4 v15, s[12:15], s42 offen lds
    s_add_u32 m0, s44, 26624
    s_nop 0
    buffer_load_dwordx4 v16, s[12:15], s42 offen lds
    s_add_u32 s41, s41, 128
    s_add_u32 s42, s42, 196608
    s_waitcnt vmcnt(14)
    s_barrier
    s_add_u32 m0, s43, 49152
    s_nop 0
    buffer_load_dwordx4 v10, s[8:11], s41 offen lds
    s_add_u32 m0, s43, 50176
    s_nop 0
    buffer_load_dwordx4 v11, s[8:11], s41 offen lds
    s_add_u32 m0, s43, 51200
    s_nop 0
    buffer_load_dwordx4 v12, s[8:11], s41 offen lds
    s_add_u32 m0, s43, 52224
    s_nop 0
    buffer_load_dwordx4 v13, s[8:11], s41 offen lds
    s_add_u32 m0, s44, 36864
    s_nop 0
    buffer_load_dwordx4 v14, s[12:15], s42 offen lds
    s_add_u32 m0, s44, 37888
    s_nop 0
    buffer_load_dwordx4 v15, s[12:15], s42 offen lds
    s_add_u32 m0, s44, 38912
    s_nop 0
    buffer_load_dwordx4 v16, s[12:15], s42 offen lds
    s_add_u32 s41, s41, 128
    s_add_u32 s42, s42, 196608
    s_waitcnt vmcnt(14)
    s_barrier
    s_add_u32 m0, s43, 0
    s_nop 0
    buffer_load_dwordx4 v10, s[8:11], s41 offen lds
    s_add_u32 m0, s43, 1024
    s_nop 0
    buffer_load_dwordx4 v11, s[8:11], s41 offen lds
    s_add_u32 m0, s43, 2048
    s_nop 0
    buffer_load_dwordx4 v12, s[8:11], s41 offen lds
    s_add_u32 m0, s43, 3072
    s_nop 0
    buffer_load_dwordx4 v13, s[8:11], s41 offen lds
    s_add_u32 m0, s44, 0
    s_nop 0
    buffer_load_dwordx4 v14, s[12:15], s42 offen lds
    s_add_u32 m0, s44, 1024
    s_nop 0
    buffer_load_dwordx4 v15, s[12:15], s42 offen lds
    s_add_u32 m0, s44, 2048
    s_nop 0
    buffer_load_dwordx4 v16, s[12:15], s42 offen lds
    s_add_u32 s41, s41, 128
    s_add_u32 s42, s42, 196608
    s_waitcnt vmcnt(14)
    s_barrier
    s_add_u32 m0, s43, 16384
    s_nop 0
    buffer_load_dwordx4 v10, s[8:11], s41 offen lds
    s_add_u32 m0, s43, 17408
    s_nop 0
    buffer_load_dwordx4 v11, s[8:11], s41 offen lds
    s_add_u32 m0, s43, 18432
    s_nop 0
    buffer_load_dwordx4 v12, s[8:11], s41 offen lds
    s_add_u32 m0, s43, 19456
    s_nop 0
    buffer_load_dwordx4 v13, s[8:11], s41 offen lds
    s_add_u32 m0, s44, 12288
    s_nop 0
    buffer_load_dwordx4 v14, s[12:15], s42 offen lds
    s_add_u32 m0, s44, 13312
    s_nop 0
    buffer_load_dwordx4 v15, s[12:15], s42 offen lds
    s_add_u32 m0, s44, 14336
    s_nop 0
    buffer_load_dwordx4 v16, s[12:15], s42 offen lds
    s_add_u32 s41, s41, 128
    s_add_u32 s42, s42, 196608
    s_waitcnt vmcnt(14)
    s_barrier
    s_add_u32 m0, s43, 32768
    s_nop 0
    buffer_load_dwordx4 v10, s[8:11], s41 offen lds
    s_add_u32 m0, s43, 33792
    s_nop 0
    buffer_load_dwordx4 v11, s[8:11], s41 offen lds
    s_add_u32 m0, s43, 34816
    s_nop 0
    buffer_load_dwordx4 v12, s[8:11], s41 offen lds
    s_add_u32 m0, s43, 35840
    s_nop 0
    buffer_load_dwordx4 v13, s[8:11], s41 offen lds
    s_add_u32 m0, s44, 24576
    s_nop 0
    buffer_load_dwordx4 v14, s[12:15], s42 offen lds
    s_add_u32 m0, s44, 25600
    s_nop 0
    buffer_load_dwordx4 v15, s[12:15], s42 offen lds
    s_add_u32 m0, s44, 26624
    s_nop 0
    buffer_load_dwordx4 v16, s[12:15], s42 offen lds
    s_add_u32 s41, s41, 128
    s_add_u32 s42, s42, 196608
    s_waitcnt vmcnt(14)
    s_barrier
    s_add_u32 m0, s43, 49152
    s_nop 0
    buffer_load_dwordx4 v10, s[8:11], s41 offen lds
    s_add_u32 m0, s43, 50176
    s_nop 0
    buffer_load_dwordx4 v11, s[8:11], s41 offen lds
    s_add_u32 m0, s43, 51200
    s_nop 0
    buffer_load_dwordx4 v12, s[8:11], s41 offen lds
    s_add_u32 m0, s43, 52224
    s_nop 0
    buffer_load_dwordx4 v13, s[8:11], s41 offen lds
    s_add_u32 m0, s44, 36864
    s_nop 0
    buffer_load_dwordx4 v14, s[12:15], s42 offen lds
    s_add_u32 m0, s44, 37888
    s_nop 0
    buffer_load_dwordx4 v15, s[12:15], s42 offen lds
    s_add_u32 m0, s44, 38912
    s_nop 0
    buffer_load_dwordx4 v16, s[12:15], s42 offen lds
    s_add_u32 s41, s41, 128
    s_add_u32 s42, s42, 196608
    s_waitcnt vmcnt(14)
    s_barrier
    s_add_u32 m0, s43, 0
    s_nop 0
    buffer_load_dwordx4 v10, s[8:11], s41 offen lds
    s_add_u32 m0, s43, 1024
    s_nop 0
    buffer_load_dwordx4 v11, s[8:11], s41 offen lds
    s_add_u32 m0, s43, 2048
    s_nop 0
    buffer_load_dwordx4 v12, s[8:11], s41 offen lds
    s_add_u32 m0, s43, 3072
    s_nop 0
    buffer_load_dwordx4 v13, s[8:11], s41 offen lds
    s_add_u32 m0, s44, 0
    s_nop 0
    buffer_load_dwordx4 v14, s[12:15], s42 offen lds
    s_add_u32 m0, s44, 1024
    s_nop 0
    buffer_load_dwordx4 v15, s[12:15], s42 offen lds
    s_add_u32 m0, s44, 2048
    s_nop 0
    buffer_load_dwordx4 v16, s[12:15], s42 offen lds
    s_add_u32 s41, s41, 128
    s_add_u32 s42, s42, 196608
    s_waitcnt vmcnt(14)
    s_barrier
    s_add_u32 m0, s43, 16384
    s_nop 0
    buffer_load_dwordx4 v10, s[8:11], s41 offen lds
    s_add_u32 m0, s43, 17408
    s_nop 0
    buffer_load_dwordx4 v11, s[8:11], s41 offen lds
    s_add_u32 m0, s43, 18432
    s_nop 0
    buffer_load_dwordx4 v12, s[8:11], s41 offen lds
    s_add_u32 m0, s43, 19456
    s_nop 0
    buffer_load_dwordx4 v13, s[8:11], s41 offen lds
    s_add_u32 m0, s44, 12288
    s_nop 0
    buffer_load_dwordx4 v14, s[12:15], s42 offen lds
    s_add_u32 m0, s44, 13312
    s_nop 0
    buffer_load_dwordx4 v15, s[12:15], s42 offen lds
    s_add_u32 m0, s44, 14336
    s_nop 0
    buffer_load_dwordx4 v16, s[12:15], s42 offen lds
    s_add_u32 s41, s41, 128
    s_add_u32 s42, s42, 196608
    s_waitcnt vmcnt(14)
    s_barrier
    s_waitcnt vmcnt(7)
    s_barrier
    s_waitcnt vmcnt(0)
    s_barrier
    s_endpgm
g3a_kernel_cons3:
    s_waitcnt lgkmcnt(0)
    s_add_u32 s16, s70, 18350080
    s_addc_u32 s17, s71, 0
    s_mov_b32 s18, 6291456
    s_mov_b32 s19, 0x00020000
    s_lshr_b32 s72, s40, 0
    s_and_b32 s73, s40, 0
    s_mul_i32 s46, s72, 32
    v_and_b32 v2, 31, v1
    v_add_u32 v2, s46, v2
    v_lshrrev_b32 v3, 5, v1
    v_bfe_u32 v4, v2, 1, 3
    v_xor_b32 v3, v3, v4
    v_lshlrev_b32 v3, 4, v3
    v_lshl_add_u32 v17, v2, 7, v3
    v_xor_b32 v18, 32, v17
    v_xor_b32 v19, 64, v17
    v_xor_b32 v20, 96, v17
    s_mul_i32 s46, s73, 12
    s_add_u32 s46, s46, 0
    v_bfe_u32 v2, v1, 4, 1
    v_lshlrev_b32 v2, 1, v2
    v_bfe_u32 v3, v1, 1, 1
    v_add3_u32 v2, v2, v3, s46
    v_bfe_u32 v4, v1, 2, 2
    v_lshlrev_b32 v2, 4, v2
    v_and_b32 v3, 1, v1
    v_lshl_add_u32 v2, v3, 3, v2
    v_lshrrev_b32 v3, 5, v1
    v_lshl_add_u32 v3, v3, 3, v4
    s_mov_b32 s47, 192
    v_mad_u32_u24 v2, v3, s47, v2
    v_add_u32 v21, 65536, v2
    s_mul_i32 s46, s73, 12
    s_add_u32 s46, s46, 4
    v_bfe_u32 v2, v1, 4, 1
    v_lshlrev_b32 v2, 1, v2
    v_bfe_u32 v3, v1, 1, 1
    v_add3_u32 v2, v2, v3, s46
    v_bfe_u32 v4, v1, 2, 2
    v_lshlrev_b32 v2, 4, v2
    v_and_b32 v3, 1, v1
    v_lshl_add_u32 v2, v3, 3, v2
    v_lshrrev_b32 v3, 5, v1
    v_lshl_add_u32 v3, v3, 3, v4
    s_mov_b32 s47, 192
    v_mad_u32_u24 v2, v3, s47, v2
    v_add_u32 v22, 65536, v2
    s_mul_i32 s46, s73, 12
    s_add_u32 s46, s46, 8
    v_bfe_u32 v2, v1, 4, 1
    v_lshlrev_b32 v2, 1, v2
    v_bfe_u32 v3, v1, 1, 1
    v_add3_u32 v2, v2, v3, s46
    v_bfe_u32 v4, v1, 2, 2
    v_lshlrev_b32 v2, 4, v2
    v_and_b32 v3, 1, v1
    v_lshl_add_u32 v2, v3, 3, v2
    v_lshrrev_b32 v3, 5, v1
    v_lshl_add_u32 v3, v3, 3, v4
    s_mov_b32 s47, 192
    v_mad_u32_u24 v2, v3, s47, v2
    v_add_u32 v23, 65536, v2
    s_mul_i32 s46, s72, 32
    v_and_b32 v2, 31, v1
    v_add_u32 v2, s46, v2
    s_mov_b32 s47, 208
    v_mul_u32_u24 v2, s47, v2
    s_mul_i32 s46, s73, 192
    v_lshrrev_b32 v3, 5, v1
    v_lshlrev_b32 v3, 3, v3
    v_add3_u32 v36, v2, v3, s46
    v_add_u32 v2, 0, v0
    s_mov_b32 s46, 683
    v_mul_u32_u24 v6, s46, v2
    v_lshrrev_b32 v6, 13, v6
    s_mov_b32 s46, 12
    v_mul_u32_u24 v7, s46, v6
    v_sub_u32 v7, v2, v7
    s_mov_b32 s46, 208
    v_mul_u32_u24 v30, s46, v6
    v_lshl_add_u32 v30, v7, 4, v30
    v_add_u32 v24, s38, v6
    s_mov_b32 s46, 3072
    v_mul_lo_u32 v24, v24, s46
    v_lshl_add_u32 v24, v7, 4, v24
    s_lshl_b32 s46, s39, 1
    v_add_u32 v24, s46, v24
    v_add_u32 v2, 256, v0
    s_mov_b32 s46, 683
    v_mul_u32_u24 v6, s46, v2
    v_lshrrev_b32 v6, 13, v6
    s_mov_b32 s46, 12
    v_mul_u32_u24 v7, s46, v6
    v_sub_u32 v7, v2, v7
    s_mov_b32 s46, 208
    v_mul_u32_u24 v31, s46, v6
    v_lshl_add_u32 v31, v7, 4, v31
    v_add_u32 v25, s38, v6
    s_mov_b32 s46, 3072
    v_mul_lo_u32 v25, v25, s46
    v_lshl_add_u32 v25, v7, 4, v25
    s_lshl_b32 s46, s39, 1
    v_add_u32 v25, s46, v25
    v_add_u32 v2, 512, v0
    s_mov_b32 s46, 683
    v_mul_u32_u24 v6, s46, v2
    v_lshrrev_b32 v6, 13, v6
    s_mov_b32 s46, 12
    v_mul_u32_u24 v7, s46, v6
    v_sub_u32 v7, v2, v7
    s_mov_b32 s46, 208
    v_mul_u32_u24 v32, s46, v6
    v_lshl_add_u32 v32, v7, 4, v32
    v_add_u32 v26, s38, v6
    s_mov_b32 s46, 3072
    v_mul_lo_u32 v26, v26, s46
    v_lshl_add_u32 v26, v7, 4, v26
    s_lshl_b32 s46, s39, 1
    v_add_u32 v26, s46, v26
    v_add_u32 v2, 768, v0
    s_mov_b32 s46, 683
    v_mul_u32_u24 v6, s46, v2
    v_lshrrev_b32 v6, 13, v6
    s_mov_b32 s46, 12
    v_mul_u32_u24 v7, s46, v6
    v_sub_u32 v7, v2, v7
    s_mov_b32 s46, 208
    v_mul_u32_u24 v33, s46, v6
    v_lshl_add_u32 v33, v7, 4, v33
    v_add_u32 v27, s38, v6
    s_mov_b32 s46, 3072
    v_mul_lo_u32 v27, v27, s46
    v_lshl_add_u32 v27, v7, 4, v27
    s_lshl_b32 s46, s39, 1
    v_add_u32 v27, s46, v27
    v_add_u32 v2, 1024, v0
    s_mov_b32 s46, 683
    v_mul_u32_u24 v6, s46, v2
    v_lshrrev_b32 v6, 13, v6
    s_mov_b32 s46, 12
    v_mul_u32_u24 v7, s46, v6
    v_sub_u32 v7, v2, v7
    s_mov_b32 s46, 208
    v_mul_u32_u24 v34, s46, v6
    v_lshl_add_u32 v34, v7, 4, v34
    v_add_u32 v28, s38, v6
    s_mov_b32 s46, 3072
    v_mul_lo_u32 v28, v28, s46
    v_lshl_add_u32 v28, v7, 4, v28
    s_lshl_b32 s46, s39, 1
    v_add_u32 v28, s46, v28
    v_add_u32 v2, 1280, v0
    s_mov_b32 s46, 683
    v_mul_u32_u24 v6, s46, v2
    v_lshrrev_b32 v6, 13, v6
    s_mov_b32 s46, 12
    v_mul_u32_u24 v7, s46, v6
    v_sub_u32 v7, v2, v7
    s_mov_b32 s46, 208
    v_mul_u32_u24 v35, s46, v6
    v_lshl_add_u32 v35, v7, 4, v35
    v_add_u32 v29, s38, v6
    s_mov_b32 s46, 3072
    v_mul_lo_u32 v29, v29, s46
    v_lshl_add_u32 v29, v7, 4, v29
    s_lshl_b32 s46, s39, 1
    v_add_u32 v29, s46, v29
    v_mov_b32 v80, 0
    v_mov_b32 v81, 0
    v_mov_b32 v82, 0
    v_mov_b32 v83, 0
    v_mov_b32 v84, 0
    v_mov_b32 v85, 0
    v_mov_b32 v86, 0
    v_mov_b32 v87, 0
    v_mov_b32 v88, 0
    v_mov_b32 v89, 0
    v_mov_b32 v90, 0
    v_mov_b32 v91, 0
    v_mov_b32 v92, 0
    v_mov_b32 v93, 0
    v_mov_b32 v94, 0
    v_mov_b32 v95, 0
    v_mov_b32 v96, 0
    v_mov_b32 v97, 0
    v_mov_b32 v98, 0
    v_mov_b32 v99, 0
    v_mov_b32 v100, 0
    v_mov_b32 v101, 0
    v_mov_b32 v102, 0
    v_mov_b32 v103, 0
    v_mov_b32 v104, 0
    v_mov_b32 v105, 0
    v_mov_b32 v106, 0
    v_mov_b32 v107, 0
    v_mov_b32 v108, 0
    v_mov_b32 v109, 0
    v_mov_b32 v110, 0
    v_mov_b32 v111, 0
    v_mov_b32 v112, 0
    v_mov_b32 v113, 0
    v_mov_b32 v114, 0
    v_mov_b32 v115, 0
    v_mov_b32 v116, 0
    v_mov_b32 v117, 0
    v_mov_b32 v118, 0
    v_mov_b32 v119, 0
    v_mov_b32 v120, 0
    v_mov_b32 v121, 0
    v_mov_b32 v122, 0
    v_mov_b32 v123, 0
    v_mov_b32 v124, 0
    v_mov_b32 v125, 0
    v_mov_b32 v126, 0
    v_mov_b32 v127, 0
    s_barrier
    ds_read_b128 v[40:43], v17 offset:0
    ds_read_b64_tr_b16 v[44:45], v21 offset:0
    ds_read_b64_tr_b16 v[46:47], v21 offset:768
    ds_read_b64_tr_b16 v[48:49], v22 offset:0
    ds_read_b64_tr_b16 v[50:51], v22 offset:768
    ds_read_b64_tr_b16 v[52:53], v23 offset:0
    ds_read_b64_tr_b16 v[54:55], v23 offset:768
    ds_read_b128 v[56:59], v18 offset:0
    ds_read_b64_tr_b16 v[60:61], v21 offset:3072
    ds_read_b64_tr_b16 v[62:63], v21 offset:3840
    ds_read_b64_tr_b16 v[64:65], v22 offset:3072
    ds_read_b64_tr_b16 v[66:67], v22 offset:3840
    ds_read_b64_tr_b16 v[68:69], v23 offset:3072
    ds_read_b64_tr_b16 v[70:71], v23 offset:3840
    s_waitcnt lgkmcnt(7)
    v_mfma_f32_32x32x16_bf16 v[80:95], v[44:47], v[40:43], v[80:95]
    v_mfma_f32_32x32x16_bf16 v[96:111], v[48:51], v[40:43], v[96:111]
    v_mfma_f32_32x32x16_bf16 v[112:127], v[52:55], v[40:43], v[112:127]
    ds_read_b128 v[40:43], v19 offset:0
    ds_read_b64_tr_b16 v[44:45], v21 offset:6144
    ds_read_b64_tr_b16 v[46:47], v21 offset:6912
    ds_read_b64_tr_b16 v[48:49], v22 offset:6144
    ds_read_b64_tr_b16 v[50:51], v22 offset:6912
    ds_read_b64_tr_b16 v[52:53], v23 offset:6144
    ds_read_b64_tr_b16 v[54:55], v23 offset:6912
    s_waitcnt lgkmcnt(7)
    v_mfma_f32_32x32x16_bf16 v[80:95], v[60:63], v[56:59], v[80:95]
    v_mfma_f32_32x32x16_bf16 v[96:111], v[64:67], v[56:59], v[96:111]
    v_mfma_f32_32x32x16_bf16 v[112:127], v[68:71], v[56:59], v[112:127]
    ds_read_b128 v[56:59], v20 offset:0
    ds_read_b64_tr_b16 v[60:61], v21 offset:9216
    ds_read_b64_tr_b16 v[62:63], v21 offset:9984
    ds_read_b64_tr_b16 v[64:65], v22 offset:9216
    ds_read_b64_tr_b16 v[66:67], v22 offset:9984
    ds_read_b64_tr_b16 v[68:69], v23 offset:9216
    ds_read_b64_tr_b16 v[70:71], v23 offset:9984
    s_waitcnt lgkmcnt(7)
    v_mfma_f32_32x32x16_bf16 v[80:95], v[44:47], v[40:43], v[80:95]
    v_mfma_f32_32x32x16_bf16 v[96:111], v[48:51], v[40:43], v[96:111]
    v_mfma_f32_32x32x16_bf16 v[112:127], v[52:55], v[40:43], v[112:127]
    s_waitcnt lgkmcnt(0)
    v_mfma_f32_32x32x16_bf16 v[80:95], v[60:63], v[56:59], v[80:95]
    v_mfma_f32_32x32x16_bf16 v[96:111], v[64:67], v[56:59], v[96:111]
    v_mfma_f32_32x32x16_bf16 v[112:127], v[68:71], v[56:59], v[112:127]
    s_barrier
    ds_read_b128 v[40:43], v17 offset:16384
    ds_read_b64_tr_b16 v[44:45], v21 offset:12288
    ds_read_b64_tr_b16 v[46:47], v21 offset:13056
    ds_read_b64_tr_b16 v[48:49], v22 offset:12288
    ds_read_b64_tr_b16 v[50:51], v22 offset:13056
    ds_read_b64_tr_b16 v[52:53], v23 offset:12288
    ds_read_b64_tr_b16 v[54:55], v23 offset:13056
    ds_read_b128 v[56:59], v18 offset:16384
    ds_read_b64_tr_b16 v[60:61], v21 offset:15360
    ds_read_b64_tr_b16 v[62:63], v21 offset:16128
    ds_read_b64_tr_b16 v[64:65], v22 offset:15360
    ds_read_b64_tr_b16 v[66:67], v22 offset:16128
    ds_read_b64_tr_b16 v[68:69], v23 offset:15360
    ds_read_b64_tr_b16 v[70:71], v23 offset:16128
    s_waitcnt lgkmcnt(7)
    v_mfma_f32_32x32x16_bf16 v[80:95], v[44:47], v[40:43], v[80:95]
    v_mfma_f32_32x32x16_bf16 v[96:111], v[48:51], v[40:43], v[96:111]
    v_mfma_f32_32x32x16_bf16 v[112:127], v[52:55], v[40:43], v[112:127]
    ds_read_b128 v[40:43], v19 offset:16384
    ds_read_b64_tr_b16 v[44:45], v21 offset:18432
    ds_read_b64_tr_b16 v[46:47], v21 offset:19200
    ds_read_b64_tr_b16 v[48:49], v22 offset:18432
    ds_read_b64_tr_b16 v[50:51], v22 offset:19200
    ds_read_b64_tr_b16 v[52:53], v23 offset:18432
    ds_read_b64_tr_b16 v[54:55], v23 offset:19200
    s_waitcnt lgkmcnt(7)
    v_mfma_f32_32x32x16_bf16 v[80:95], v[60:63], v[56:59], v[80:95]
    v_mfma_f32_32x32x16_bf16 v[96:111], v[64:67], v[56:59], v[96:111]
    v_mfma_f32_32x32x16_bf16 v[112:127], v[68:71], v[56:59], v[112:127]
    ds_read_b128 v[56:59], v20 offset:16384
    ds_read_b64_tr_b16 v[60:61], v21 offset:21504
    ds_read_b64_tr_b16 v[62:63], v21 offset:22272
    ds_read_b64_tr_b16 v[64:65], v22 offset:21504
    ds_read_b64_tr_b16 v[66:67], v22 offset:22272
    ds_read_b64_tr_b16 v[68:69], v23 offset:21504
    ds_read_b64_tr_b16 v[70:71], v23 offset:22272
    s_waitcnt lgkmcnt(7)
    v_mfma_f32_32x32x16_bf16 v[80:95], v[44:47], v[40:43], v[80:95]
    v_mfma_f32_32x32x16_bf16 v[96:111], v[48:51], v[40:43], v[96:111]
    v_mfma_f32_32x32x16_bf16 v[112:127], v[52:55], v[40:43], v[112:127]
    s_waitcnt lgkmcnt(0)
    v_mfma_f32_32x32x16_bf16 v[80:95], v[60:63], v[56:59], v[80:95]
    v_mfma_f32_32x32x16_bf16 v[96:111], v[64:67], v[56:59], v[96:111]
    v_mfma_f32_32x32x16_bf16 v[112:127], v[68:71], v[56:59], v[112:127]
    s_barrier
    ds_read_b128 v[40:43], v17 offset:32768
    ds_read_b64_tr_b16 v[44:45], v21 offset:24576
    ds_read_b64_tr_b16 v[46:47], v21 offset:25344
    ds_read_b64_tr_b16 v[48:49], v22 offset:24576
    ds_read_b64_tr_b16 v[50:51], v22 offset:25344
    ds_read_b64_tr_b16 v[52:53], v23 offset:24576
    ds_read_b64_tr_b16 v[54:55], v23 offset:25344
    ds_read_b128 v[56:59], v18 offset:32768
    ds_read_b64_tr_b16 v[60:61], v21 offset:27648
    ds_read_b64_tr_b16 v[62:63], v21 offset:28416
    ds_read_b64_tr_b16 v[64:65], v22 offset:27648
    ds_read_b64_tr_b16 v[66:67], v22 offset:28416
    ds_read_b64_tr_b16 v[68:69], v23 offset:27648
    ds_read_b64_tr_b16 v[70:71], v23 offset:28416
    s_waitcnt lgkmcnt(7)
    v_mfma_f32_32x32x16_bf16 v[80:95], v[44:47], v[40:43], v[80:95]
    v_mfma_f32_32x32x16_bf16 v[96:111], v[48:51], v[40:43], v[96:111]
    v_mfma_f32_32x32x16_bf16 v[112:127], v[52:55], v[40:43], v[112:127]
    ds_read_b128 v[40:43], v19 offset:32768
    ds_read_b64_tr_b16 v[44:45], v21 offset:30720
    ds_read_b64_tr_b16 v[46:47], v21 offset:31488
    ds_read_b64_tr_b16 v[48:49], v22 offset:30720
    ds_read_b64_tr_b16 v[50:51], v22 offset:31488
    ds_read_b64_tr_b16 v[52:53], v23 offset:30720
    ds_read_b64_tr_b16 v[54:55], v23 offset:31488
    s_waitcnt lgkmcnt(7)
    v_mfma_f32_32x32x16_bf16 v[80:95], v[60:63], v[56:59], v[80:95]
    v_mfma_f32_32x32x16_bf16 v[96:111], v[64:67], v[56:59], v[96:111]
    v_mfma_f32_32x32x16_bf16 v[112:127], v[68:71], v[56:59], v[112:127]
    ds_read_b128 v[56:59], v20 offset:32768
    ds_read_b64_tr_b16 v[60:61], v21 offset:33792
    ds_read_b64_tr_b16 v[62:63], v21 offset:34560
    ds_read_b64_tr_b16 v[64:65], v22 offset:33792
    ds_read_b64_tr_b16 v[66:67], v22 offset:34560
    ds_read_b64_tr_b16 v[68:69], v23 offset:33792
    ds_read_b64_tr_b16 v[70:71], v23 offset:34560
    s_waitcnt lgkmcnt(7)
    v_mfma_f32_32x32x16_bf16 v[80:95], v[44:47], v[40:43], v[80:95]
    v_mfma_f32_32x32x16_bf16 v[96:111], v[48:51], v[40:43], v[96:111]
    v_mfma_f32_32x32x16_bf16 v[112:127], v[52:55], v[40:43], v[112:127]
    s_waitcnt lgkmcnt(0)
    v_mfma_f32_32x32x16_bf16 v[80:95], v[60:63], v[56:59], v[80:95]
    v_mfma_f32_32x32x16_bf16 v[96:111], v[64:67], v[56:59], v[96:111]
    v_mfma_f32_32x32x16_bf16 v[112:127], v[68:71], v[56:59], v[112:127]
    s_barrier
    ds_read_b128 v[40:43], v17 offset:49152
    ds_read_b64_tr_b16 v[44:45], v21 offset:36864
    ds_read_b64_tr_b16 v[46:47], v21 offset:37632
    ds_read_b64_tr_b16 v[48:49], v22 offset:36864
    ds_read_b64_tr_b16 v[50:51], v22 offset:37632
    ds_read_b64_tr_b16 v[52:53], v23 offset:36864
    ds_read_b64_tr_b16 v[54:55], v23 offset:37632
    ds_read_b128 v[56:59], v18 offset:49152
    ds_read_b64_tr_b16 v[60:61], v21 offset:39936
    ds_read_b64_tr_b16 v[62:63], v21 offset:40704
    ds_read_b64_tr_b16 v[64:65], v22 offset:39936
    ds_read_b64_tr_b16 v[66:67], v22 offset:40704
    ds_read_b64_tr_b16 v[68:69], v23 offset:39936
    ds_read_b64_tr_b16 v[70:71], v23 offset:40704
    s_waitcnt lgkmcnt(7)
    v_mfma_f32_32x32x16_bf16 v[80:95], v[44:47], v[40:43], v[80:95]
    v_mfma_f32_32x32x16_bf16 v[96:111], v[48:51], v[40:43], v[96:111]
    v_mfma_f32_32x32x16_bf16 v[112:127], v[52:55], v[40:43], v[112:127]
    ds_read_b128 v[40:43], v19 offset:49152
    ds_read_b64_tr_b16 v[44:45], v21 offset:43008
    ds_read_b64_tr_b16 v[46:47], v21 offset:43776
    ds_read_b64_tr_b16 v[48:49], v22 offset:43008
    ds_read_b64_tr_b16 v[50:51], v22 offset:43776
    ds_read_b64_tr_b16 v[52:53], v23 offset:43008
    ds_read_b64_tr_b16 v[54:55], v23 offset:43776
    s_waitcnt lgkmcnt(7)
    v_mfma_f32_32x32x16_bf16 v[80:95], v[60:63], v[56:59], v[80:95]
    v_mfma_f32_32x32x16_bf16 v[96:111], v[64:67], v[56:59], v[96:111]
    v_mfma_f32_32x32x16_bf16 v[112:127], v[68:71], v[56:59], v[112:127]
    ds_read_b128 v[56:59], v20 offset:49152
    ds_read_b64_tr_b16 v[60:61], v21 offset:46080
    ds_read_b64_tr_b16 v[62:63], v21 offset:46848
    ds_read_b64_tr_b16 v[64:65], v22 offset:46080
    ds_read_b64_tr_b16 v[66:67], v22 offset:46848
    ds_read_b64_tr_b16 v[68:69], v23 offset:46080
    ds_read_b64_tr_b16 v[70:71], v23 offset:46848
    s_waitcnt lgkmcnt(7)
    v_mfma_f32_32x32x16_bf16 v[80:95], v[44:47], v[40:43], v[80:95]
    v_mfma_f32_32x32x16_bf16 v[96:111], v[48:51], v[40:43], v[96:111]
    v_mfma_f32_32x32x16_bf16 v[112:127], v[52:55], v[40:43], v[112:127]
    s_waitcnt lgkmcnt(0)
    v_mfma_f32_32x32x16_bf16 v[80:95], v[60:63], v[56:59], v[80:95]
    v_mfma_f32_32x32x16_bf16 v[96:111], v[64:67], v[56:59], v[96:111]
    v_mfma_f32_32x32x16_bf16 v[112:127], v[68:71], v[56:59], v[112:127]
    s_barrier
    ds_read_b128 v[40:43], v17 offset:0
    ds_read_b64_tr_b16 v[44:45], v21 offset:0
    ds_read_b64_tr_b16 v[46:47], v21 offset:768
    ds_read_b64_tr_b16 v[48:49], v22 offset:0
    ds_read_b64_tr_b16 v[50:51], v22 offset:768
    ds_read_b64_tr_b16 v[52:53], v23 offset:0
    ds_read_b64_tr_b16 v[54:55], v23 offset:768
    ds_read_b128 v[56:59], v18 offset:0
    ds_read_b64_tr_b16 v[60:61], v21 offset:3072
    ds_read_b64_tr_b16 v[62:63], v21 offset:3840
    ds_read_b64_tr_b16 v[64:65], v22 offset:3072
    ds_read_b64_tr_b16 v[66:67], v22 offset:3840
    ds_read_b64_tr_b16 v[68:69], v23 offset:3072
    ds_read_b64_tr_b16 v[70:71], v23 offset:3840
    s_waitcnt lgkmcnt(7)
    v_mfma_f32_32x32x16_bf16 v[80:95], v[44:47], v[40:43], v[80:95]
    v_mfma_f32_32x32x16_bf16 v[96:111], v[48:51], v[40:43], v[96:111]
    v_mfma_f32_32x32x16_bf16 v[112:127], v[52:55], v[40:43], v[112:127]
    ds_read_b128 v[40:43], v19 offset:0
    ds_read_b64_tr_b16 v[44:45], v21 offset:6144
    ds_read_b64_tr_b16 v[46:47], v21 offset:6912
    ds_read_b64_tr_b16 v[48:49], v22 offset:6144
    ds_read_b64_tr_b16 v[50:51], v22 offset:6912
    ds_read_b64_tr_b16 v[52:53], v23 offset:6144
    ds_read_b64_tr_b16 v[54:55], v23 offset:6912
    s_waitcnt lgkmcnt(7)
    v_mfma_f32_32x32x16_bf16 v[80:95], v[60:63], v[56:59], v[80:95]
    v_mfma_f32_32x32x16_bf16 v[96:111], v[64:67], v[56:59], v[96:111]
    v_mfma_f32_32x32x16_bf16 v[112:127], v[68:71], v[56:59], v[112:127]
    ds_read_b128 v[56:59], v20 offset:0
    ds_read_b64_tr_b16 v[60:61], v21 offset:9216
    ds_read_b64_tr_b16 v[62:63], v21 offset:9984
    ds_read_b64_tr_b16 v[64:65], v22 offset:9216
    ds_read_b64_tr_b16 v[66:67], v22 offset:9984
    ds_read_b64_tr_b16 v[68:69], v23 offset:9216
    ds_read_b64_tr_b16 v[70:71], v23 offset:9984
    s_waitcnt lgkmcnt(7)
    v_mfma_f32_32x32x16_bf16 v[80:95], v[44:47], v[40:43], v[80:95]
    v_mfma_f32_32x32x16_bf16 v[96:111], v[48:51], v[40:43], v[96:111]
    v_mfma_f32_32x32x16_bf16 v[112:127], v[52:55], v[40:43], v[112:127]
    s_waitcnt lgkmcnt(0)
    v_mfma_f32_32x32x16_bf16 v[80:95], v[60:63], v[56:59], v[80:95]
    v_mfma_f32_32x32x16_bf16 v[96:111], v[64:67], v[56:59], v[96:111]
    v_mfma_f32_32x32x16_bf16 v[112:127], v[68:71], v[56:59], v[112:127]
    s_barrier
    ds_read_b128 v[40:43], v17 offset:16384
    ds_read_b64_tr_b16 v[44:45], v21 offset:12288
    ds_read_b64_tr_b16 v[46:47], v21 offset:13056
    ds_read_b64_tr_b16 v[48:49], v22 offset:12288
    ds_read_b64_tr_b16 v[50:51], v22 offset:13056
    ds_read_b64_tr_b16 v[52:53], v23 offset:12288
    ds_read_b64_tr_b16 v[54:55], v23 offset:13056
    ds_read_b128 v[56:59], v18 offset:16384
    ds_read_b64_tr_b16 v[60:61], v21 offset:15360
    ds_read_b64_tr_b16 v[62:63], v21 offset:16128
    ds_read_b64_tr_b16 v[64:65], v22 offset:15360
    ds_read_b64_tr_b16 v[66:67], v22 offset:16128
    ds_read_b64_tr_b16 v[68:69], v23 offset:15360
    ds_read_b64_tr_b16 v[70:71], v23 offset:16128
    s_waitcnt lgkmcnt(7)
    v_mfma_f32_32x32x16_bf16 v[80:95], v[44:47], v[40:43], v[80:95]
    v_mfma_f32_32x32x16_bf16 v[96:111], v[48:51], v[40:43], v[96:111]
    v_mfma_f32_32x32x16_bf16 v[112:127], v[52:55], v[40:43], v[112:127]
    ds_read_b128 v[40:43], v19 offset:16384
    ds_read_b64_tr_b16 v[44:45], v21 offset:18432
    ds_read_b64_tr_b16 v[46:47], v21 offset:19200
    ds_read_b64_tr_b16 v[48:49], v22 offset:18432
    ds_read_b64_tr_b16 v[50:51], v22 offset:19200
    ds_read_b64_tr_b16 v[52:53], v23 offset:18432
    ds_read_b64_tr_b16 v[54:55], v23 offset:19200
    s_waitcnt lgkmcnt(7)
    v_mfma_f32_32x32x16_bf16 v[80:95], v[60:63], v[56:59], v[80:95]
    v_mfma_f32_32x32x16_bf16 v[96:111], v[64:67], v[56:59], v[96:111]
    v_mfma_f32_32x32x16_bf16 v[112:127], v[68:71], v[56:59], v[112:127]
    ds_read_b128 v[56:59], v20 offset:16384
    ds_read_b64_tr_b16 v[60:61], v21 offset:21504
    ds_read_b64_tr_b16 v[62:63], v21 offset:22272
    ds_read_b64_tr_b16 v[64:65], v22 offset:21504
    ds_read_b64_tr_b16 v[66:67], v22 offset:22272
    ds_read_b64_tr_b16 v[68:69], v23 offset:21504
    ds_read_b64_tr_b16 v[70:71], v23 offset:22272
    s_waitcnt lgkmcnt(7)
    v_mfma_f32_32x32x16_bf16 v[80:95], v[44:47], v[40:43], v[80:95]
    v_mfma_f32_32x32x16_bf16 v[96:111], v[48:51], v[40:43], v[96:111]
    v_mfma_f32_32x32x16_bf16 v[112:127], v[52:55], v[40:43], v[112:127]
    s_waitcnt lgkmcnt(0)
    v_mfma_f32_32x32x16_bf16 v[80:95], v[60:63], v[56:59], v[80:95]
    v_mfma_f32_32x32x16_bf16 v[96:111], v[64:67], v[56:59], v[96:111]
    v_mfma_f32_32x32x16_bf16 v[112:127], v[68:71], v[56:59], v[112:127]
    s_barrier
    ds_read_b128 v[40:43], v17 offset:32768
    ds_read_b64_tr_b16 v[44:45], v21 offset:24576
    ds_read_b64_tr_b16 v[46:47], v21 offset:25344
    ds_read_b64_tr_b16 v[48:49], v22 offset:24576
    ds_read_b64_tr_b16 v[50:51], v22 offset:25344
    ds_read_b64_tr_b16 v[52:53], v23 offset:24576
    ds_read_b64_tr_b16 v[54:55], v23 offset:25344
    ds_read_b128 v[56:59], v18 offset:32768
    ds_read_b64_tr_b16 v[60:61], v21 offset:27648
    ds_read_b64_tr_b16 v[62:63], v21 offset:28416
    ds_read_b64_tr_b16 v[64:65], v22 offset:27648
    ds_read_b64_tr_b16 v[66:67], v22 offset:28416
    ds_read_b64_tr_b16 v[68:69], v23 offset:27648
    ds_read_b64_tr_b16 v[70:71], v23 offset:28416
    s_waitcnt lgkmcnt(7)
    v_mfma_f32_32x32x16_bf16 v[80:95], v[44:47], v[40:43], v[80:95]
    v_mfma_f32_32x32x16_bf16 v[96:111], v[48:51], v[40:43], v[96:111]
    v_mfma_f32_32x32x16_bf16 v[112:127], v[52:55], v[40:43], v[112:127]
    ds_read_b128 v[40:43], v19 offset:32768
    ds_read_b64_tr_b16 v[44:45], v21 offset:30720
    ds_read_b64_tr_b16 v[46:47], v21 offset:31488
    ds_read_b64_tr_b16 v[48:49], v22 offset:30720
    ds_read_b64_tr_b16 v[50:51], v22 offset:31488
    ds_read_b64_tr_b16 v[52:53], v23 offset:30720
    ds_read_b64_tr_b16 v[54:55], v23 offset:31488
    s_waitcnt lgkmcnt(7)
    v_mfma_f32_32x32x16_bf16 v[80:95], v[60:63], v[56:59], v[80:95]
    v_mfma_f32_32x32x16_bf16 v[96:111], v[64:67], v[56:59], v[96:111]
    v_mfma_f32_32x32x16_bf16 v[112:127], v[68:71], v[56:59], v[112:127]
    ds_read_b128 v[56:59], v20 offset:32768
    ds_read_b64_tr_b16 v[60:61], v21 offset:33792
    ds_read_b64_tr_b16 v[62:63], v21 offset:34560
    ds_read_b64_tr_b16 v[64:65], v22 offset:33792
    ds_read_b64_tr_b16 v[66:67], v22 offset:34560
    ds_read_b64_tr_b16 v[68:69], v23 offset:33792
    ds_read_b64_tr_b16 v[70:71], v23 offset:34560
    s_waitcnt lgkmcnt(7)
    v_mfma_f32_32x32x16_bf16 v[80:95], v[44:47], v[40:43], v[80:95]
    v_mfma_f32_32x32x16_bf16 v[96:111], v[48:51], v[40:43], v[96:111]
    v_mfma_f32_32x32x16_bf16 v[112:127], v[52:55], v[40:43], v[112:127]
    s_waitcnt lgkmcnt(0)
    v_mfma_f32_32x32x16_bf16 v[80:95], v[60:63], v[56:59], v[80:95]
    v_mfma_f32_32x32x16_bf16 v[96:111], v[64:67], v[56:59], v[96:111]
    v_mfma_f32_32x32x16_bf16 v[112:127], v[68:71], v[56:59], v[112:127]
    s_add_u32 s28, s70, 31014912
    s_addc_u32 s29, s71, 0
    s_mov_b32 s30, 81920
    s_mov_b32 s31, 0x00020000
    s_add_u32 s32, s70, 31268864
    s_addc_u32 s33, s71, 0
    s_mov_b32 s34, 6144
    s_mov_b32 s35, 0x00020000
    s_mul_i32 s46, s72, 32
    s_add_u32 s46, s46, s38
    v_and_b32 v2, 31, v1
    v_add_u32 v2, s46, v2
    v_lshlrev_b32 v2, 3, v2
    s_mov_b32 s47, 0
    buffer_load_dwordx2 v[130:131], v2, s[28:31], s47 offen offset:0
    s_mov_b32 s47, 16384
    buffer_load_dwordx2 v[132:133], v2, s[28:31], s47 offen offset:0
    s_mov_b32 s47, 32768
    buffer_load_dwordx2 v[134:135], v2, s[28:31], s47 offen offset:0
    s_mov_b32 s47, 49152
    buffer_load_dwordx2 v[136:137], v2, s[28:31], s47 offen offset:0
    s_mov_b32 s47, 65536
    buffer_load_dwordx2 v[138:139], v2, s[28:31], s47 offen offset:0
    s_mul_i32 s46, s73, 96
    s_add_u32 s46, s46, s39
    v_lshrrev_b32 v2, 5, v1
    v_lshlrev_b32 v2, 2, v2
    v_add_u32 v2, s46, v2
    v_lshlrev_b32 v2, 2, v2
    buffer_load_dwordx4 v[140:143], v2, s[32:35], 0 offen offset:0
    buffer_load_dwordx4 v[144:147], v2, s[32:35], 0 offen offset:32
    buffer_load_dwordx4 v[148:151], v2, s[32:35], 0 offen offset:64
    buffer_load_dwordx4 v[152:155], v2, s[32:35], 0 offen offset:96
    buffer_load_dwordx4 v[156:159], v2, s[32:35], 0 offen offset:128
    buffer_load_dwordx4 v[160:163], v2, s[32:35], 0 offen offset:160
    buffer_load_dwordx4 v[164:167], v2, s[32:35], 0 offen offset:192
    buffer_load_dwordx4 v[168:171], v2, s[32:35], 0 offen offset:224
    buffer_load_dwordx4 v[172:175], v2, s[32:35], 0 offen offset:256
    buffer_load_dwordx4 v[176:179], v2, s[32:35], 0 offen offset:288
    buffer_load_dwordx4 v[180:183], v2, s[32:35], 0 offen offset:320
    buffer_load_dwordx4 v[184:187], v2, s[32:35], 0 offen offset:352
    s_barrier
    ds_read_b128 v[40:43], v17 offset:49152
    ds_read_b64_tr_b16 v[44:45], v21 offset:36864
    ds_read_b64_tr_b16 v[46:47], v21 offset:37632
    ds_read_b64_tr_b16 v[48:49], v22 offset:36864
    ds_read_b64_tr_b16 v[50:51], v22 offset:37632
    ds_read_b64_tr_b16 v[52:53], v23 offset:36864
    ds_read_b64_tr_b16 v[54:55], v23 offset:37632
    ds_read_b128 v[56:59], v18 offset:49152
    ds_read_b64_tr_b16 v[60:61], v21 offset:39936
    ds_read_b64_tr_b16 v[62:63], v21 offset:40704
    ds_read_b64_tr_b16 v[64:65], v22 offset:39936
    ds_read_b64_tr_b16 v[66:67], v22 offset:40704
    ds_read_b64_tr_b16 v[68:69], v23 offset:39936
    ds_read_b64_tr_b16 v[70:71], v23 offset:40704
    s_waitcnt lgkmcnt(7)
    v_mfma_f32_32x32x16_bf16 v[80:95], v[44:47], v[40:43], v[80:95]
    v_mfma_f32_32x32x16_bf16 v[96:111], v[48:51], v[40:43], v[96:111]
    v_mfma_f32_32x32x16_bf16 v[112:127], v[52:55], v[40:43], v[112:127]
    ds_read_b128 v[40:43], v19 offset:49152
    ds_read_b64_tr_b16 v[44:45], v21 offset:43008
    ds_read_b64_tr_b16 v[46:47], v21 offset:43776
    ds_read_b64_tr_b16 v[48:49], v22 offset:43008
    ds_read_b64_tr_b16 v[50:51], v22 offset:43776
    ds_read_b64_tr_b16 v[52:53], v23 offset:43008
    ds_read_b64_tr_b16 v[54:55], v23 offset:43776
    s_waitcnt lgkmcnt(7)
    v_mfma_f32_32x32x16_bf16 v[80:95], v[60:63], v[56:59], v[80:95]
    v_mfma_f32_32x32x16_bf16 v[96:111], v[64:67], v[56:59], v[96:111]
    v_mfma_f32_32x32x16_bf16 v[112:127], v[68:71], v[56:59], v[112:127]
    ds_read_b128 v[56:59], v20 offset:49152
    ds_read_b64_tr_b16 v[60:61], v21 offset:46080
    ds_read_b64_tr_b16 v[62:63], v21 offset:46848
    ds_read_b64_tr_b16 v[64:65], v22 offset:46080
    ds_read_b64_tr_b16 v[66:67], v22 offset:46848
    ds_read_b64_tr_b16 v[68:69], v23 offset:46080
    ds_read_b64_tr_b16 v[70:71], v23 offset:46848
    s_waitcnt lgkmcnt(7)
    v_mfma_f32_32x32x16_bf16 v[80:95], v[44:47], v[40:43], v[80:95]
    v_mfma_f32_32x32x16_bf16 v[96:111], v[48:51], v[40:43], v[96:111]
    v_mfma_f32_32x32x16_bf16 v[112:127], v[52:55], v[40:43], v[112:127]
    s_waitcnt lgkmcnt(0)
    v_mfma_f32_32x32x16_bf16 v[80:95], v[60:63], v[56:59], v[80:95]
    v_mfma_f32_32x32x16_bf16 v[96:111], v[64:67], v[56:59], v[96:111]
    v_mfma_f32_32x32x16_bf16 v[112:127], v[68:71], v[56:59], v[112:127]
    s_barrier
    ds_read_b128 v[40:43], v17 offset:0
    ds_read_b64_tr_b16 v[44:45], v21 offset:0
    ds_read_b64_tr_b16 v[46:47], v21 offset:768
    ds_read_b64_tr_b16 v[48:49], v22 offset:0
    ds_read_b64_tr_b16 v[50:51], v22 offset:768
    ds_read_b64_tr_b16 v[52:53], v23 offset:0
    ds_read_b64_tr_b16 v[54:55], v23 offset:768
    ds_read_b128 v[56:59], v18 offset:0
    ds_read_b64_tr_b16 v[60:61], v21 offset:3072
    ds_read_b64_tr_b16 v[62:63], v21 offset:3840
    ds_read_b64_tr_b16 v[64:65], v22 offset:3072
    ds_read_b64_tr_b16 v[66:67], v22 offset:3840
    ds_read_b64_tr_b16 v[68:69], v23 offset:3072
    ds_read_b64_tr_b16 v[70:71], v23 offset:3840
    s_waitcnt lgkmcnt(7)
    v_mfma_f32_32x32x16_bf16 v[80:95], v[44:47], v[40:43], v[80:95]
    v_mfma_f32_32x32x16_bf16 v[96:111], v[48:51], v[40:43], v[96:111]
    v_mfma_f32_32x32x16_bf16 v[112:127], v[52:55], v[40:43], v[112:127]
    ds_read_b128 v[40:43], v19 offset:0
    ds_read_b64_tr_b16 v[44:45], v21 offset:6144
    ds_read_b64_tr_b16 v[46:47], v21 offset:6912
    ds_read_b64_tr_b16 v[48:49], v22 offset:6144
    ds_read_b64_tr_b16 v[50:51], v22 offset:6912
    ds_read_b64_tr_b16 v[52:53], v23 offset:6144
    ds_read_b64_tr_b16 v[54:55], v23 offset:6912
    s_waitcnt lgkmcnt(7)
    v_mfma_f32_32x32x16_bf16 v[80:95], v[60:63], v[56:59], v[80:95]
    v_mfma_f32_32x32x16_bf16 v[96:111], v[64:67], v[56:59], v[96:111]
    v_mfma_f32_32x32x16_bf16 v[112:127], v[68:71], v[56:59], v[112:127]
    ds_read_b128 v[56:59], v20 offset:0
    ds_read_b64_tr_b16 v[60:61], v21 offset:9216
    ds_read_b64_tr_b16 v[62:63], v21 offset:9984
    ds_read_b64_tr_b16 v[64:65], v22 offset:9216
    ds_read_b64_tr_b16 v[66:67], v22 offset:9984
    ds_read_b64_tr_b16 v[68:69], v23 offset:9216
    ds_read_b64_tr_b16 v[70:71], v23 offset:9984
    s_waitcnt lgkmcnt(7)
    v_mfma_f32_32x32x16_bf16 v[80:95], v[44:47], v[40:43], v[80:95]
    v_mfma_f32_32x32x16_bf16 v[96:111], v[48:51], v[40:43], v[96:111]
    v_mfma_f32_32x32x16_bf16 v[112:127], v[52:55], v[40:43], v[112:127]
    s_waitcnt lgkmcnt(0)
    v_mfma_f32_32x32x16_bf16 v[80:95], v[60:63], v[56:59], v[80:95]
    v_mfma_f32_32x32x16_bf16 v[96:111], v[64:67], v[56:59], v[96:111]
    v_mfma_f32_32x32x16_bf16 v[112:127], v[68:71], v[56:59], v[112:127]
    s_barrier
    ds_read_b128 v[40:43], v17 offset:16384
    ds_read_b64_tr_b16 v[44:45], v21 offset:12288
    ds_read_b64_tr_b16 v[46:47], v21 offset:13056
    ds_read_b64_tr_b16 v[48:49], v22 offset:12288
    ds_read_b64_tr_b16 v[50:51], v22 offset:13056
    ds_read_b64_tr_b16 v[52:53], v23 offset:12288
    ds_read_b64_tr_b16 v[54:55], v23 offset:13056
    ds_read_b128 v[56:59], v18 offset:16384
    ds_read_b64_tr_b16 v[60:61], v21 offset:15360
    ds_read_b64_tr_b16 v[62:63], v21 offset:16128
    ds_read_b64_tr_b16 v[64:65], v22 offset:15360
    ds_read_b64_tr_b16 v[66:67], v22 offset:16128
    ds_read_b64_tr_b16 v[68:69], v23 offset:15360
    ds_read_b64_tr_b16 v[70:71], v23 offset:16128
    s_waitcnt lgkmcnt(7)
    v_mfma_f32_32x32x16_bf16 v[80:95], v[44:47], v[40:43], v[80:95]
    v_mfma_f32_32x32x16_bf16 v[96:111], v[48:51], v[40:43], v[96:111]
    v_mfma_f32_32x32x16_bf16 v[112:127], v[52:55], v[40:43], v[112:127]
    ds_read_b128 v[40:43], v19 offset:16384
    ds_read_b64_tr_b16 v[44:45], v21 offset:18432
    ds_read_b64_tr_b16 v[46:47], v21 offset:19200
    ds_read_b64_tr_b16 v[48:49], v22 offset:18432
    ds_read_b64_tr_b16 v[50:51], v22 offset:19200
    ds_read_b64_tr_b16 v[52:53], v23 offset:18432
    ds_read_b64_tr_b16 v[54:55], v23 offset:19200
    s_waitcnt lgkmcnt(7)
    v_mfma_f32_32x32x16_bf16 v[80:95], v[60:63], v[56:59], v[80:95]
    v_mfma_f32_32x32x16_bf16 v[96:111], v[64:67], v[56:59], v[96:111]
    v_mfma_f32_32x32x16_bf16 v[112:127], v[68:71], v[56:59], v[112:127]
    ds_read_b128 v[56:59], v20 offset:16384
    ds_read_b64_tr_b16 v[60:61], v21 offset:21504
    ds_read_b64_tr_b16 v[62:63], v21 offset:22272
    ds_read_b64_tr_b16 v[64:65], v22 offset:21504
    ds_read_b64_tr_b16 v[66:67], v22 offset:22272
    ds_read_b64_tr_b16 v[68:69], v23 offset:21504
    ds_read_b64_tr_b16 v[70:71], v23 offset:22272
    s_waitcnt lgkmcnt(7)
    v_mfma_f32_32x32x16_bf16 v[80:95], v[44:47], v[40:43], v[80:95]
    v_mfma_f32_32x32x16_bf16 v[96:111], v[48:51], v[40:43], v[96:111]
    v_mfma_f32_32x32x16_bf16 v[112:127], v[52:55], v[40:43], v[112:127]
    s_waitcnt lgkmcnt(0)
    v_mfma_f32_32x32x16_bf16 v[80:95], v[60:63], v[56:59], v[80:95]
    v_mfma_f32_32x32x16_bf16 v[96:111], v[64:67], v[56:59], v[96:111]
    v_mfma_f32_32x32x16_bf16 v[112:127], v[68:71], v[56:59], v[112:127]
    s_barrier
    s_nop 15
    s_waitcnt vmcnt(0)
    v_add_f32 v130, v130, v132
    v_add_f32 v131, v131, v133
    v_add_f32 v130, v130, v134
    v_add_f32 v131, v131, v135
    v_add_f32 v130, v130, v136
    v_add_f32 v131, v131, v137
    v_add_f32 v130, v130, v138
    v_add_f32 v131, v131, v139
    v_mul_f32 v130, 0x3acccccd, v130
    v_mul_f32 v131, 0x3acccccd, v131
    v_fma_f32 v131, -v130, v130, v131
    v_max_f32 v131, 0, v131
    v_cvt_pk_bf16_f32 v2, v131, v131
    v_lshlrev_b32 v131, 16, v2
    v_add_f32 v131, 0x3727c5ac, v131
    v_cvt_pk_bf16_f32 v2, v131, v131
    v_lshlrev_b32 v131, 16, v2
    v_sqrt_f32 v131, v131
    s_nop 0
    v_cvt_pk_bf16_f32 v2, v131, v131
    v_lshlrev_b32 v131, 16, v2
    v_rcp_f32 v129, v131
    v_cvt_pk_bf16_f32 v2, v130, v130
    v_lshlrev_b32 v130, 16, v2
    v_mov_b32 v128, v130
    v_mov_b32 v198, 0xc0135761
    v_mov_b32 v199, 0xbdd2d3e8
    v_fma_f32 v80, -v128, v140, v80
    v_mul_f32 v80, v129, v80
    v_fma_f32 v81, -v128, v141, v81
    v_mul_f32 v81, v129, v81
    v_fma_f32 v82, -v128, v142, v82
    v_mul_f32 v82, v129, v82
    v_fma_f32 v83, -v128, v143, v83
    v_mul_f32 v83, v129, v83
    v_cvt_pk_bf16_f32 v188, v80, v81
    v_cvt_pk_bf16_f32 v189, v82, v83
    v_lshlrev_b32 v80, 16, v188
    v_and_b32 v81, 0xffff0000, v188
    v_lshlrev_b32 v82, 16, v189
    v_and_b32 v83, 0xffff0000, v189
    v_mul_f32 v190, v80, v80
    v_fma_f32 v190, v190, v199, v198
    v_mul_f32 v190, v190, v80
    v_exp_f32 v190, v190
    v_mul_f32 v191, v81, v81
    v_fma_f32 v191, v191, v199, v198
    v_mul_f32 v191, v191, v81
    v_exp_f32 v191, v191
    v_mul_f32 v192, v82, v82
    v_fma_f32 v192, v192, v199, v198
    v_mul_f32 v192, v192, v82
    v_exp_f32 v192, v192
    v_mul_f32 v193, v83, v83
    v_fma_f32 v193, v193, v199, v198
    v_mul_f32 v193, v193, v83
    v_exp_f32 v193, v193
    v_add_f32 v190, 1.0, v190
    v_rcp_f32 v190, v190
    v_add_f32 v191, 1.0, v191
    v_rcp_f32 v191, v191
    v_add_f32 v192, 1.0, v192
    v_rcp_f32 v192, v192
    v_add_f32 v193, 1.0, v193
    v_rcp_f32 v193, v193
    v_mul_f32 v80, v80, v190
    v_mul_f32 v81, v81, v191
    v_mul_f32 v82, v82, v192
    v_mul_f32 v83, v83, v193
    v_cvt_pk_bf16_f32 v196, v80, v81
    v_cvt_pk_bf16_f32 v197, v82, v83
    ds_write_b64 v36, v[196:197] offset:0
    v_fma_f32 v84, -v128, v144, v84
    v_mul_f32 v84, v129, v84
    v_fma_f32 v85, -v128, v145, v85
    v_mul_f32 v85, v129, v85
    v_fma_f32 v86, -v128, v146, v86
    v_mul_f32 v86, v129, v86
    v_fma_f32 v87, -v128, v147, v87
    v_mul_f32 v87, v129, v87
    v_cvt_pk_bf16_f32 v188, v84, v85
    v_cvt_pk_bf16_f32 v189, v86, v87
    v_lshlrev_b32 v84, 16, v188
    v_and_b32 v85, 0xffff0000, v188
    v_lshlrev_b32 v86, 16, v189
    v_and_b32 v87, 0xffff0000, v189
    v_mul_f32 v190, v84, v84
    v_fma_f32 v190, v190, v199, v198
    v_mul_f32 v190, v190, v84
    v_exp_f32 v190, v190
    v_mul_f32 v191, v85, v85
    v_fma_f32 v191, v191, v199, v198
    v_mul_f32 v191, v191, v85
    v_exp_f32 v191, v191
    v_mul_f32 v192, v86, v86
    v_fma_f32 v192, v192, v199, v198
    v_mul_f32 v192, v192, v86
    v_exp_f32 v192, v192
    v_mul_f32 v193, v87, v87
    v_fma_f32 v193, v193, v199, v198
    v_mul_f32 v193, v193, v87
    v_exp_f32 v193, v193
    v_add_f32 v190, 1.0, v190
    v_rcp_f32 v190, v190
    v_add_f32 v191, 1.0, v191
    v_rcp_f32 v191, v191
    v_add_f32 v192, 1.0, v192
    v_rcp_f32 v192, v192
    v_add_f32 v193, 1.0, v193
    v_rcp_f32 v193, v193
    v_mul_f32 v84, v84, v190
    v_mul_f32 v85, v85, v191
    v_mul_f32 v86, v86, v192
    v_mul_f32 v87, v87, v193
    v_cvt_pk_bf16_f32 v196, v84, v85
    v_cvt_pk_bf16_f32 v197, v86, v87
    ds_write_b64 v36, v[196:197] offset:16
    v_fma_f32 v88, -v128, v148, v88
    v_mul_f32 v88, v129, v88
    v_fma_f32 v89, -v128, v149, v89
    v_mul_f32 v89, v129, v89
    v_fma_f32 v90, -v128, v150, v90
    v_mul_f32 v90, v129, v90
    v_fma_f32 v91, -v128, v151, v91
    v_mul_f32 v91, v129, v91
    v_cvt_pk_bf16_f32 v188, v88, v89
    v_cvt_pk_bf16_f32 v189, v90, v91
    v_lshlrev_b32 v88, 16, v188
    v_and_b32 v89, 0xffff0000, v188
    v_lshlrev_b32 v90, 16, v189
    v_and_b32 v91, 0xffff0000, v189
    v_mul_f32 v190, v88, v88
    v_fma_f32 v190, v190, v199, v198
    v_mul_f32 v190, v190, v88
    v_exp_f32 v190, v190
    v_mul_f32 v191, v89, v89
    v_fma_f32 v191, v191, v199, v198
    v_mul_f32 v191, v191, v89
    v_exp_f32 v191, v191
    v_mul_f32 v192, v90, v90
    v_fma_f32 v192, v192, v199, v198
    v_mul_f32 v192, v192, v90
    v_exp_f32 v192, v192
    v_mul_f32 v193, v91, v91
    v_fma_f32 v193, v193, v199, v198
    v_mul_f32 v193, v193, v91
    v_exp_f32 v193, v193
    v_add_f32 v190, 1.0, v190
    v_rcp_f32 v190, v190
    v_add_f32 v191, 1.0, v191
    v_rcp_f32 v191, v191
    v_add_f32 v192, 1.0, v192
    v_rcp_f32 v192, v192
    v_add_f32 v193, 1.0, v193
    v_rcp_f32 v193, v193
    v_mul_f32 v88, v88, v190
    v_mul_f32 v89, v89, v191
    v_mul_f32 v90, v90, v192
    v_mul_f32 v91, v91, v193
    v_cvt_pk_bf16_f32 v196, v88, v89
    v_cvt_pk_bf16_f32 v197, v90, v91
    ds_write_b64 v36, v[196:197] offset:32
    v_fma_f32 v92, -v128, v152, v92
    v_mul_f32 v92, v129, v92
    v_fma_f32 v93, -v128, v153, v93
    v_mul_f32 v93, v129, v93
    v_fma_f32 v94, -v128, v154, v94
    v_mul_f32 v94, v129, v94
    v_fma_f32 v95, -v128, v155, v95
    v_mul_f32 v95, v129, v95
    v_cvt_pk_bf16_f32 v188, v92, v93
    v_cvt_pk_bf16_f32 v189, v94, v95
    v_lshlrev_b32 v92, 16, v188
    v_and_b32 v93, 0xffff0000, v188
    v_lshlrev_b32 v94, 16, v189
    v_and_b32 v95, 0xffff0000, v189
    v_mul_f32 v190, v92, v92
    v_fma_f32 v190, v190, v199, v198
    v_mul_f32 v190, v190, v92
    v_exp_f32 v190, v190
    v_mul_f32 v191, v93, v93
    v_fma_f32 v191, v191, v199, v198
    v_mul_f32 v191, v191, v93
    v_exp_f32 v191, v191
    v_mul_f32 v192, v94, v94
    v_fma_f32 v192, v192, v199, v198
    v_mul_f32 v192, v192, v94
    v_exp_f32 v192, v192
    v_mul_f32 v193, v95, v95
    v_fma_f32 v193, v193, v199, v198
    v_mul_f32 v193, v193, v95
    v_exp_f32 v193, v193
    v_add_f32 v190, 1.0, v190
    v_rcp_f32 v190, v190
    v_add_f32 v191, 1.0, v191
    v_rcp_f32 v191, v191
    v_add_f32 v192, 1.0, v192
    v_rcp_f32 v192, v192
    v_add_f32 v193, 1.0, v193
    v_rcp_f32 v193, v193
    v_mul_f32 v92, v92, v190
    v_mul_f32 v93, v93, v191
    v_mul_f32 v94, v94, v192
    v_mul_f32 v95, v95, v193
    v_cvt_pk_bf16_f32 v196, v92, v93
    v_cvt_pk_bf16_f32 v197, v94, v95
    ds_write_b64 v36, v[196:197] offset:48
    v_fma_f32 v96, -v128, v156, v96
    v_mul_f32 v96, v129, v96
    v_fma_f32 v97, -v128, v157, v97
    v_mul_f32 v97, v129, v97
    v_fma_f32 v98, -v128, v158, v98
    v_mul_f32 v98, v129, v98
    v_fma_f32 v99, -v128, v159, v99
    v_mul_f32 v99, v129, v99
    v_cvt_pk_bf16_f32 v188, v96, v97
    v_cvt_pk_bf16_f32 v189, v98, v99
    v_lshlrev_b32 v96, 16, v188
    v_and_b32 v97, 0xffff0000, v188
    v_lshlrev_b32 v98, 16, v189
    v_and_b32 v99, 0xffff0000, v189
    v_mul_f32 v190, v96, v96
    v_fma_f32 v190, v190, v199, v198
    v_mul_f32 v190, v190, v96
    v_exp_f32 v190, v190
    v_mul_f32 v191, v97, v97
    v_fma_f32 v191, v191, v199, v198
    v_mul_f32 v191, v191, v97
    v_exp_f32 v191, v191
    v_mul_f32 v192, v98, v98
    v_fma_f32 v192, v192, v199, v198
    v_mul_f32 v192, v192, v98
    v_exp_f32 v192, v192
    v_mul_f32 v193, v99, v99
    v_fma_f32 v193, v193, v199, v198
    v_mul_f32 v193, v193, v99
    v_exp_f32 v193, v193
    v_add_f32 v190, 1.0, v190
    v_rcp_f32 v190, v190
    v_add_f32 v191, 1.0, v191
    v_rcp_f32 v191, v191
    v_add_f32 v192, 1.0, v192
    v_rcp_f32 v192, v192
    v_add_f32 v193, 1.0, v193
    v_rcp_f32 v193, v193
    v_mul_f32 v96, v96, v190
    v_mul_f32 v97, v97, v191
    v_mul_f32 v98, v98, v192
    v_mul_f32 v99, v99, v193
    v_cvt_pk_bf16_f32 v196, v96, v97
    v_cvt_pk_bf16_f32 v197, v98, v99
    ds_write_b64 v36, v[196:197] offset:64
    v_fma_f32 v100, -v128, v160, v100
    v_mul_f32 v100, v129, v100
    v_fma_f32 v101, -v128, v161, v101
    v_mul_f32 v101, v129, v101
    v_fma_f32 v102, -v128, v162, v102
    v_mul_f32 v102, v129, v102
    v_fma_f32 v103, -v128, v163, v103
    v_mul_f32 v103, v129, v103
    v_cvt_pk_bf16_f32 v188, v100, v101
    v_cvt_pk_bf16_f32 v189, v102, v103
    v_lshlrev_b32 v100, 16, v188
    v_and_b32 v101, 0xffff0000, v188
    v_lshlrev_b32 v102, 16, v189
    v_and_b32 v103, 0xffff0000, v189
    v_mul_f32 v190, v100, v100
    v_fma_f32 v190, v190, v199, v198
    v_mul_f32 v190, v190, v100
    v_exp_f32 v190, v190
    v_mul_f32 v191, v101, v101
    v_fma_f32 v191, v191, v199, v198
    v_mul_f32 v191, v191, v101
    v_exp_f32 v191, v191
    v_mul_f32 v192, v102, v102
    v_fma_f32 v192, v192, v199, v198
    v_mul_f32 v192, v192, v102
    v_exp_f32 v192, v192
    v_mul_f32 v193, v103, v103
    v_fma_f32 v193, v193, v199, v198
    v_mul_f32 v193, v193, v103
    v_exp_f32 v193, v193
    v_add_f32 v190, 1.0, v190
    v_rcp_f32 v190, v190
    v_add_f32 v191, 1.0, v191
    v_rcp_f32 v191, v191
    v_add_f32 v192, 1.0, v192
    v_rcp_f32 v192, v192
    v_add_f32 v193, 1.0, v193
    v_rcp_f32 v193, v193
    v_mul_f32 v100, v100, v190
    v_mul_f32 v101, v101, v191
    v_mul_f32 v102, v102, v192
    v_mul_f32 v103, v103, v193
    v_cvt_pk_bf16_f32 v196, v100, v101
    v_cvt_pk_bf16_f32 v197, v102, v103
    ds_write_b64 v36, v[196:197] offset:80
    v_fma_f32 v104, -v128, v164, v104
    v_mul_f32 v104, v129, v104
    v_fma_f32 v105, -v128, v165, v105
    v_mul_f32 v105, v129, v105
    v_fma_f32 v106, -v128, v166, v106
    v_mul_f32 v106, v129, v106
    v_fma_f32 v107, -v128, v167, v107
    v_mul_f32 v107, v129, v107
    v_cvt_pk_bf16_f32 v188, v104, v105
    v_cvt_pk_bf16_f32 v189, v106, v107
    v_lshlrev_b32 v104, 16, v188
    v_and_b32 v105, 0xffff0000, v188
    v_lshlrev_b32 v106, 16, v189
    v_and_b32 v107, 0xffff0000, v189
    v_mul_f32 v190, v104, v104
    v_fma_f32 v190, v190, v199, v198
    v_mul_f32 v190, v190, v104
    v_exp_f32 v190, v190
    v_mul_f32 v191, v105, v105
    v_fma_f32 v191, v191, v199, v198
    v_mul_f32 v191, v191, v105
    v_exp_f32 v191, v191
    v_mul_f32 v192, v106, v106
    v_fma_f32 v192, v192, v199, v198
    v_mul_f32 v192, v192, v106
    v_exp_f32 v192, v192
    v_mul_f32 v193, v107, v107
    v_fma_f32 v193, v193, v199, v198
    v_mul_f32 v193, v193, v107
    v_exp_f32 v193, v193
    v_add_f32 v190, 1.0, v190
    v_rcp_f32 v190, v190
    v_add_f32 v191, 1.0, v191
    v_rcp_f32 v191, v191
    v_add_f32 v192, 1.0, v192
    v_rcp_f32 v192, v192
    v_add_f32 v193, 1.0, v193
    v_rcp_f32 v193, v193
    v_mul_f32 v104, v104, v190
    v_mul_f32 v105, v105, v191
    v_mul_f32 v106, v106, v192
    v_mul_f32 v107, v107, v193
    v_cvt_pk_bf16_f32 v196, v104, v105
    v_cvt_pk_bf16_f32 v197, v106, v107
    ds_write_b64 v36, v[196:197] offset:96
    v_fma_f32 v108, -v128, v168, v108
    v_mul_f32 v108, v129, v108
    v_fma_f32 v109, -v128, v169, v109
    v_mul_f32 v109, v129, v109
    v_fma_f32 v110, -v128, v170, v110
    v_mul_f32 v110, v129, v110
    v_fma_f32 v111, -v128, v171, v111
    v_mul_f32 v111, v129, v111
    v_cvt_pk_bf16_f32 v188, v108, v109
    v_cvt_pk_bf16_f32 v189, v110, v111
    v_lshlrev_b32 v108, 16, v188
    v_and_b32 v109, 0xffff0000, v188
    v_lshlrev_b32 v110, 16, v189
    v_and_b32 v111, 0xffff0000, v189
    v_mul_f32 v190, v108, v108
    v_fma_f32 v190, v190, v199, v198
    v_mul_f32 v190, v190, v108
    v_exp_f32 v190, v190
    v_mul_f32 v191, v109, v109
    v_fma_f32 v191, v191, v199, v198
    v_mul_f32 v191, v191, v109
    v_exp_f32 v191, v191
    v_mul_f32 v192, v110, v110
    v_fma_f32 v192, v192, v199, v198
    v_mul_f32 v192, v192, v110
    v_exp_f32 v192, v192
    v_mul_f32 v193, v111, v111
    v_fma_f32 v193, v193, v199, v198
    v_mul_f32 v193, v193, v111
    v_exp_f32 v193, v193
    v_add_f32 v190, 1.0, v190
    v_rcp_f32 v190, v190
    v_add_f32 v191, 1.0, v191
    v_rcp_f32 v191, v191
    v_add_f32 v192, 1.0, v192
    v_rcp_f32 v192, v192
    v_add_f32 v193, 1.0, v193
    v_rcp_f32 v193, v193
    v_mul_f32 v108, v108, v190
    v_mul_f32 v109, v109, v191
    v_mul_f32 v110, v110, v192
    v_mul_f32 v111, v111, v193
    v_cvt_pk_bf16_f32 v196, v108, v109
    v_cvt_pk_bf16_f32 v197, v110, v111
    ds_write_b64 v36, v[196:197] offset:112
    v_fma_f32 v112, -v128, v172, v112
    v_mul_f32 v112, v129, v112
    v_fma_f32 v113, -v128, v173, v113
    v_mul_f32 v113, v129, v113
    v_fma_f32 v114, -v128, v174, v114
    v_mul_f32 v114, v129, v114
    v_fma_f32 v115, -v128, v175, v115
    v_mul_f32 v115, v129, v115
    v_cvt_pk_bf16_f32 v188, v112, v113
    v_cvt_pk_bf16_f32 v189, v114, v115
    v_lshlrev_b32 v112, 16, v188
    v_and_b32 v113, 0xffff0000, v188
    v_lshlrev_b32 v114, 16, v189
    v_and_b32 v115, 0xffff0000, v189
    v_mul_f32 v190, v112, v112
    v_fma_f32 v190, v190, v199, v198
    v_mul_f32 v190, v190, v112
    v_exp_f32 v190, v190
    v_mul_f32 v191, v113, v113
    v_fma_f32 v191, v191, v199, v198
    v_mul_f32 v191, v191, v113
    v_exp_f32 v191, v191
    v_mul_f32 v192, v114, v114
    v_fma_f32 v192, v192, v199, v198
    v_mul_f32 v192, v192, v114
    v_exp_f32 v192, v192
    v_mul_f32 v193, v115, v115
    v_fma_f32 v193, v193, v199, v198
    v_mul_f32 v193, v193, v115
    v_exp_f32 v193, v193
    v_add_f32 v190, 1.0, v190
    v_rcp_f32 v190, v190
    v_add_f32 v191, 1.0, v191
    v_rcp_f32 v191, v191
    v_add_f32 v192, 1.0, v192
    v_rcp_f32 v192, v192
    v_add_f32 v193, 1.0, v193
    v_rcp_f32 v193, v193
    v_mul_f32 v112, v112, v190
    v_mul_f32 v113, v113, v191
    v_mul_f32 v114, v114, v192
    v_mul_f32 v115, v115, v193
    v_cvt_pk_bf16_f32 v196, v112, v113
    v_cvt_pk_bf16_f32 v197, v114, v115
    ds_write_b64 v36, v[196:197] offset:128
    v_fma_f32 v116, -v128, v176, v116
    v_mul_f32 v116, v129, v116
    v_fma_f32 v117, -v128, v177, v117
    v_mul_f32 v117, v129, v117
    v_fma_f32 v118, -v128, v178, v118
    v_mul_f32 v118, v129, v118
    v_fma_f32 v119, -v128, v179, v119
    v_mul_f32 v119, v129, v119
    v_cvt_pk_bf16_f32 v188, v116, v117
    v_cvt_pk_bf16_f32 v189, v118, v119
    v_lshlrev_b32 v116, 16, v188
    v_and_b32 v117, 0xffff0000, v188
    v_lshlrev_b32 v118, 16, v189
    v_and_b32 v119, 0xffff0000, v189
    v_mul_f32 v190, v116, v116
    v_fma_f32 v190, v190, v199, v198
    v_mul_f32 v190, v190, v116
    v_exp_f32 v190, v190
    v_mul_f32 v191, v117, v117
    v_fma_f32 v191, v191, v199, v198
    v_mul_f32 v191, v191, v117
    v_exp_f32 v191, v191
    v_mul_f32 v192, v118, v118
    v_fma_f32 v192, v192, v199, v198
    v_mul_f32 v192, v192, v118
    v_exp_f32 v192, v192
    v_mul_f32 v193, v119, v119
    v_fma_f32 v193, v193, v199, v198
    v_mul_f32 v193, v193, v119
    v_exp_f32 v193, v193
    v_add_f32 v190, 1.0, v190
    v_rcp_f32 v190, v190
    v_add_f32 v191, 1.0, v191
    v_rcp_f32 v191, v191
    v_add_f32 v192, 1.0, v192
    v_rcp_f32 v192, v192
    v_add_f32 v193, 1.0, v193
    v_rcp_f32 v193, v193
    v_mul_f32 v116, v116, v190
    v_mul_f32 v117, v117, v191
    v_mul_f32 v118, v118, v192
    v_mul_f32 v119, v119, v193
    v_cvt_pk_bf16_f32 v196, v116, v117
    v_cvt_pk_bf16_f32 v197, v118, v119
    ds_write_b64 v36, v[196:197] offset:144
    v_fma_f32 v120, -v128, v180, v120
    v_mul_f32 v120, v129, v120
    v_fma_f32 v121, -v128, v181, v121
    v_mul_f32 v121, v129, v121
    v_fma_f32 v122, -v128, v182, v122
    v_mul_f32 v122, v129, v122
    v_fma_f32 v123, -v128, v183, v123
    v_mul_f32 v123, v129, v123
    v_cvt_pk_bf16_f32 v188, v120, v121
    v_cvt_pk_bf16_f32 v189, v122, v123
    v_lshlrev_b32 v120, 16, v188
    v_and_b32 v121, 0xffff0000, v188
    v_lshlrev_b32 v122, 16, v189
    v_and_b32 v123, 0xffff0000, v189
    v_mul_f32 v190, v120, v120
    v_fma_f32 v190, v190, v199, v198
    v_mul_f32 v190, v190, v120
    v_exp_f32 v190, v190
    v_mul_f32 v191, v121, v121
    v_fma_f32 v191, v191, v199, v198
    v_mul_f32 v191, v191, v121
    v_exp_f32 v191, v191
    v_mul_f32 v192, v122, v122
    v_fma_f32 v192, v192, v199, v198
    v_mul_f32 v192, v192, v122
    v_exp_f32 v192, v192
    v_mul_f32 v193, v123, v123
    v_fma_f32 v193, v193, v199, v198
    v_mul_f32 v193, v193, v123
    v_exp_f32 v193, v193
    v_add_f32 v190, 1.0, v190
    v_rcp_f32 v190, v190
    v_add_f32 v191, 1.0, v191
    v_rcp_f32 v191, v191
    v_add_f32 v192, 1.0, v192
    v_rcp_f32 v192, v192
    v_add_f32 v193, 1.0, v193
    v_rcp_f32 v193, v193
    v_mul_f32 v120, v120, v190
    v_mul_f32 v121, v121, v191
    v_mul_f32 v122, v122, v192
    v_mul_f32 v123, v123, v193
    v_cvt_pk_bf16_f32 v196, v120, v121
    v_cvt_pk_bf16_f32 v197, v122, v123
    ds_write_b64 v36, v[196:197] offset:160
    v_fma_f32 v124, -v128, v184, v124
    v_mul_f32 v124, v129, v124
    v_fma_f32 v125, -v128, v185, v125
    v_mul_f32 v125, v129, v125
    v_fma_f32 v126, -v128, v186, v126
    v_mul_f32 v126, v129, v126
    v_fma_f32 v127, -v128, v187, v127
    v_mul_f32 v127, v129, v127
    v_cvt_pk_bf16_f32 v188, v124, v125
    v_cvt_pk_bf16_f32 v189, v126, v127
    v_lshlrev_b32 v124, 16, v188
    v_and_b32 v125, 0xffff0000, v188
    v_lshlrev_b32 v126, 16, v189
    v_and_b32 v127, 0xffff0000, v189
    v_mul_f32 v190, v124, v124
    v_fma_f32 v190, v190, v199, v198
    v_mul_f32 v190, v190, v124
    v_exp_f32 v190, v190
    v_mul_f32 v191, v125, v125
    v_fma_f32 v191, v191, v199, v198
    v_mul_f32 v191, v191, v125
    v_exp_f32 v191, v191
    v_mul_f32 v192, v126, v126
    v_fma_f32 v192, v192, v199, v198
    v_mul_f32 v192, v192, v126
    v_exp_f32 v192, v192
    v_mul_f32 v193, v127, v127
    v_fma_f32 v193, v193, v199, v198
    v_mul_f32 v193, v193, v127
    v_exp_f32 v193, v193
    v_add_f32 v190, 1.0, v190
    v_rcp_f32 v190, v190
    v_add_f32 v191, 1.0, v191
    v_rcp_f32 v191, v191
    v_add_f32 v192, 1.0, v192
    v_rcp_f32 v192, v192
    v_add_f32 v193, 1.0, v193
    v_rcp_f32 v193, v193
    v_mul_f32 v124, v124, v190
    v_mul_f32 v125, v125, v191
    v_mul_f32 v126, v126, v192
    v_mul_f32 v127, v127, v193
    v_cvt_pk_bf16_f32 v196, v124, v125
    v_cvt_pk_bf16_f32 v197, v126, v127
    ds_write_b64 v36, v[196:197] offset:176
    s_waitcnt lgkmcnt(0)
    s_barrier
    ds_read_b128 v[80:83], v30
    ds_read_b128 v[84:87], v31
    ds_read_b128 v[88:91], v32
    ds_read_b128 v[92:95], v33
    ds_read_b128 v[96:99], v34
    ds_read_b128 v[100:103], v35
    s_waitcnt lgkmcnt(5)
    buffer_store_dwordx4 v[80:83], v24, s[16:19], 0 offen
    s_waitcnt lgkmcnt(4)
    buffer_store_dwordx4 v[84:87], v25, s[16:19], 0 offen
    s_waitcnt lgkmcnt(3)
    buffer_store_dwordx4 v[88:91], v26, s[16:19], 0 offen
    s_waitcnt lgkmcnt(2)
    buffer_store_dwordx4 v[92:95], v27, s[16:19], 0 offen
    s_waitcnt lgkmcnt(1)
    buffer_store_dwordx4 v[96:99], v28, s[16:19], 0 offen
    s_waitcnt lgkmcnt(0)
    buffer_store_dwordx4 v[100:103], v29, s[16:19], 0 offen
g3a_kernel_end1:
    s_endpgm
.globl lna_kernel
.p2align 8
.type lna_kernel,@function
lna_kernel:
    s_cmp_ge_u32 s2, 256
    s_cbranch_scc1 lna_kernel_end1
    s_load_dwordx16 s[48:63], s[0:1], 0
    s_load_dwordx8 s[64:71], s[0:1], 64
    v_and_b32 v1, 63, v0
    v_lshrrev_b32 v2, 6, v0
    s_nop 0
    v_readfirstlane_b32 s40, v2
    s_waitcnt lgkmcnt(0)
    s_add_u32 s8, s70, 18350080
    s_addc_u32 s9, s71, 0
    s_mov_b32 s10, 6291456
    s_mov_b32 s11, 0x00020000
    s_add_u32 s12, s70, 24641536
    s_addc_u32 s13, s71, 0
    s_mov_b32 s14, 3145728
    s_mov_b32 s15, 0x00020000
    s_lshl_b32 s41, s2, 3
    s_lshl_b32 s42, s40, 1
    s_add_u32 s41, s41, s42
    s_mul_i32 s43, s41, 3072
    s_mul_i32 s44, s41, 1536
    v_lshlrev_b32 v2, 4, v1
    v_cmp_gt_u32 vcc, 32, v1
    s_mov_b64 s[46:47], vcc
    s_add_u32 s45, s43, 1536
    buffer_load_dwordx4 v[8:11], v2, s[8:11], s45 offen
    s_mov_b64 exec, s[46:47]
    buffer_load_dwordx4 v[12:15], v2, s[8:11], s45 offen offset:1024
    s_mov_b64 exec, -1
    s_add_u32 s45, s43, 4608
    buffer_load_dwordx4 v[16:19], v2, s[8:11], s45 offen
    s_mov_b64 exec, s[46:47]
    buffer_load_dwordx4 v[20:23], v2, s[8:11], s45 offen offset:1024
    s_mov_b64 exec, -1
    s_waitcnt vmcnt(0)
    v_cndmask_b32 v12, 0, v12, s[46:47]
    v_cndmask_b32 v13, 0, v13, s[46:47]
    v_cndmask_b32 v14, 0, v14, s[46:47]
    v_cndmask_b32 v15, 0, v15, s[46:47]
    v_lshlrev_b32 v24, 16, v8
    v_and_b32 v25, 0xffff0000, v8
    v_lshlrev_b32 v26, 16, v9
    v_and_b32 v27, 0xffff0000, v9
    v_lshlrev_b32 v28, 16, v10
    v_and_b32 v29, 0xffff0000, v10
    v_lshlrev_b32 v30, 16, v11
    v_and_b32 v31, 0xffff0000, v11
    v_lshlrev_b32 v32, 16, v12
    v_and_b32 v33, 0xffff0000, v12
    v_lshlrev_b32 v34, 16, v13
    v_and_b32 v35, 0xffff0000, v13
    v_lshlrev_b32 v36, 16, v14
    v_and_b32 v37, 0xffff0000, v14
    v_lshlrev_b32 v38, 16, v15
    v_and_b32 v39, 0xffff0000, v15
    v_add_f32 v40, v24, v25
    v_add_f32 v40, v40, v26
    v_add_f32 v40, v40, v27
    v_add_f32 v40, v40, v28
    v_add_f32 v40, v40, v29
    v_add_f32 v40, v40, v30
    v_add_f32 v40, v40, v31
    v_add_f32 v40, v40, v32
    v_add_f32 v40, v40, v33
    v_add_f32 v40, v40, v34
    v_add_f32 v40, v40, v35
    v_add_f32 v40, v40, v36
    v_add_f32 v40, v40, v37
    v_add_f32 v40, v40, v38
    v_add_f32 v40, v40, v39
    s_nop 1
    v_add_f32_dpp v40, v40, v40 row_ror:8 row_mask:0xf bank_mask:0xf
    s_nop 1
    v_add_f32_dpp v40, v40, v40 row_ror:4 row_mask:0xf bank_mask:0xf
    s_nop 1
    v_add_f32_dpp v40, v40, v40 row_ror:2 row_mask:0xf bank_mask:0xf
    s_nop 1
    v_add_f32_dpp v40, v40, v40 row_ror:1 row_mask:0xf bank_mask:0xf
    s_nop 1
    v_readlane_b32 s48, v40, 0
    v_readlane_b32 s49, v40, 16
    v_readlane_b32 s50, v40, 32
    v_readlane_b32 s51, v40, 48
    s_nop 1
    v_mov_b32 v40, s48
    v_add_f32 v40, s49, v40
    v_add_f32 v40, s50, v40
    v_add_f32 v40, s51, v40
    v_mul_f32 v40, 0x3aaaaaab, v40
    v_mov_b32 v41, 0
    v_sub_f32 v42, v24, v40
    v_fmac_f32 v41, v42, v42
    v_sub_f32 v42, v25, v40
    v_fmac_f32 v41, v42, v42
    v_sub_f32 v42, v26, v40
    v_fmac_f32 v41, v42, v42
    v_sub_f32 v42, v27, v40
    v_fmac_f32 v41, v42, v42
    v_sub_f32 v42, v28, v40
    v_fmac_f32 v41, v42, v42
    v_sub_f32 v42, v29, v40
    v_fmac_f32 v41, v42, v42
    v_sub_f32 v42, v30, v40
    v_fmac_f32 v41, v42, v42
    v_sub_f32 v42, v31, v40
    v_fmac_f32 v41, v42, v42
    v_sub_f32 v42, v32, v40
    v_cndmask_b32 v42, 0, v42, s[46:47]
    v_fmac_f32 v41, v42, v42
    v_sub_f32 v42, v33, v40
    v_cndmask_b32 v42, 0, v42, s[46:47]
    v_fmac_f32 v41, v42, v42
    v_sub_f32 v42, v34, v40
    v_cndmask_b32 v42, 0, v42, s[46:47]
    v_fmac_f32 v41, v42, v42
    v_sub_f32 v42, v35, v40
    v_cndmask_b32 v42, 0, v42, s[46:47]
    v_fmac_f32 v41, v42, v42
    v_sub_f32 v42, v36, v40
    v_cndmask_b32 v42, 0, v42, s[46:47]
    v_fmac_f32 v41, v42, v42
    v_sub_f32 v42, v37, v40
    v_cndmask_b32 v42, 0, v42, s[46:47]
    v_fmac_f32 v41, v42, v42
    v_sub_f32 v42, v38, v40
    v_cndmask_b32 v42, 0, v42, s[46:47]
    v_fmac_f32 v41, v42, v42
    v_sub_f32 v42, v39, v40
    v_cndmask_b32 v42, 0, v42, s[46:47]
    v_fmac_f32 v41, v42, v42
    s_nop 1
    v_add_f32_dpp v41, v41, v41 row_ror:8 row_mask:0xf bank_mask:0xf
    s_nop 1
    v_add_f32_dpp v41, v41, v41 row_ror:4 row_mask:0xf bank_mask:0xf
    s_nop 1
    v_add_f32_dpp v41, v41, v41 row_ror:2 row_mask:0xf bank_mask:0xf
    s_nop 1
    v_add_f32_dpp v41, v41, v41 row_ror:1 row_mask:0xf bank_mask:0xf
    s_nop 1
    v_readlane_b32 s48, v41, 0
    v_readlane_b32 s49, v41, 16
    v_readlane_b32 s50, v41, 32
    v_readlane_b32 s51, v41, 48
    s_nop 1
    v_mov_b32 v41, s48
    v_add_f32 v41, s49, v41
    v_add_f32 v41, s50, v41
    v_add_f32 v41, s51, v41
    v_mul_f32 v41, 0x3aaaaaab, v41
    v_cvt_pk_bf16_f32 v42, v41, v41
    v_lshlrev_b32 v41, 16, v42
    v_add_f32 v41, 0x3727c5ac, v41
    v_cvt_pk_bf16_f32 v42, v41, v41
    v_lshlrev_b32 v41, 16, v42
    v_sqrt_f32 v41, v41
    s_nop 0
    v_cvt_pk_bf16_f32 v42, v41, v41
    v_lshlrev_b32 v41, 16, v42
    v_rcp_f32 v41, v41
    v_cvt_pk_bf16_f32 v42, v40, v40
    v_lshlrev_b32 v40, 16, v42
    v_sub_f32 v24, v24, v40
    v_sub_f32 v25, v25, v40
    v_cvt_pk_bf16_f32 v42, v24, v25
    v_lshlrev_b32 v24, 16, v42
    v_and_b32 v25, 0xffff0000, v42
    v_mul_f32 v24, v24, v41
    v_mul_f32 v25, v25, v41
    v_cvt_pk_bf16_f32 v8, v24, v25
    v_sub_f32 v26, v26, v40
    v_sub_f32 v27, v27, v40
    v_cvt_pk_bf16_f32 v42, v26, v27
    v_lshlrev_b32 v26, 16, v42
    v_and_b32 v27, 0xffff0000, v42
    v_mul_f32 v26, v26, v41
    v_mul_f32 v27, v27, v41
    v_cvt_pk_bf16_f32 v9, v26, v27
    v_sub_f32 v28, v28, v40
    v_sub_f32 v29, v29, v40
    v_cvt_pk_bf16_f32 v42, v28, v29
    v_lshlrev_b32 v28, 16, v42
    v_and_b32 v29, 0xffff0000, v42
    v_mul_f32 v28, v28, v41
    v_mul_f32 v29, v29, v41
    v_cvt_pk_bf16_f32 v10, v28, v29
    v_sub_f32 v30, v30, v40
    v_sub_f32 v31, v31, v40
    v_cvt_pk_bf16_f32 v42, v30, v31
    v_lshlrev_b32 v30, 16, v42
    v_and_b32 v31, 0xffff0000, v42
    v_mul_f32 v30, v30, v41
    v_mul_f32 v31, v31, v41
    v_cvt_pk_bf16_f32 v11, v30, v31
    v_sub_f32 v32, v32, v40
    v_sub_f32 v33, v33, v40
    v_cvt_pk_bf16_f32 v42, v32, v33
    v_lshlrev_b32 v32, 16, v42
    v_and_b32 v33, 0xffff0000, v42
    v_mul_f32 v32, v32, v41
    v_mul_f32 v33, v33, v41
    v_cvt_pk_bf16_f32 v12, v32, v33
    v_sub_f32 v34, v34, v40
    v_sub_f32 v35, v35, v40
    v_cvt_pk_bf16_f32 v42, v34, v35
    v_lshlrev_b32 v34, 16, v42
    v_and_b32 v35, 0xffff0000, v42
    v_mul_f32 v34, v34, v41
    v_mul_f32 v35, v35, v41
    v_cvt_pk_bf16_f32 v13, v34, v35
    v_sub_f32 v36, v36, v40
    v_sub_f32 v37, v37, v40
    v_cvt_pk_bf16_f32 v42, v36, v37
    v_lshlrev_b32 v36, 16, v42
    v_and_b32 v37, 0xffff0000, v42
    v_mul_f32 v36, v36, v41
    v_mul_f32 v37, v37, v41
    v_cvt_pk_bf16_f32 v14, v36, v37
    v_sub_f32 v38, v38, v40
    v_sub_f32 v39, v39, v40
    v_cvt_pk_bf16_f32 v42, v38, v39
    v_lshlrev_b32 v38, 16, v42
    v_and_b32 v39, 0xffff0000, v42
    v_mul_f32 v38, v38, v41
    v_mul_f32 v39, v39, v41
    v_cvt_pk_bf16_f32 v15, v38, v39
    s_add_u32 s45, s44, 0
    buffer_store_dwordx4 v[8:11], v2, s[12:15], s45 offen
    s_mov_b64 exec, s[46:47]
    buffer_store_dwordx4 v[12:15], v2, s[12:15], s45 offen offset:1024
    s_mov_b64 exec, -1
    v_cndmask_b32 v20, 0, v20, s[46:47]
    v_cndmask_b32 v21, 0, v21, s[46:47]
    v_cndmask_b32 v22, 0, v22, s[46:47]
    v_cndmask_b32 v23, 0, v23, s[46:47]
    v_lshlrev_b32 v24, 16, v16
    v_and_b32 v25, 0xffff0000, v16
    v_lshlrev_b32 v26, 16, v17
    v_and_b32 v27, 0xffff0000, v17
    v_lshlrev_b32 v28, 16, v18
    v_and_b32 v29, 0xffff0000, v18
    v_lshlrev_b32 v30, 16, v19
    v_and_b32 v31, 0xffff0000, v19
    v_lshlrev_b32 v32, 16, v20
    v_and_b32 v33, 0xffff0000, v20
    v_lshlrev_b32 v34, 16, v21
    v_and_b32 v35, 0xffff0000, v21
    v_lshlrev_b32 v36, 16, v22
    v_and_b32 v37, 0xffff0000, v22
    v_lshlrev_b32 v38, 16, v23
    v_and_b32 v39, 0xffff0000, v23
    v_add_f32 v40, v24, v25
    v_add_f32 v40, v40, v26
    v_add_f32 v40, v40, v27
    v_add_f32 v40, v40, v28
    v_add_f32 v40, v40, v29
    v_add_f32 v40, v40, v30
    v_add_f32 v40, v40, v31
    v_add_f32 v40, v40, v32
    v_add_f32 v40, v40, v33
    v_add_f32 v40, v40, v34
    v_add_f32 v40, v40, v35
    v_add_f32 v40, v40, v36
    v_add_f32 v40, v40, v37
    v_add_f32 v40, v40, v38
    v_add_f32 v40, v40, v39
    s_nop 1
    v_add_f32_dpp v40, v40, v40 row_ror:8 row_mask:0xf bank_mask:0xf
    s_nop 1
    v_add_f32_dpp v40, v40, v40 row_ror:4 row_mask:0xf bank_mask:0xf
    s_nop 1
    v_add_f32_dpp v40, v40, v40 row_ror:2 row_mask:0xf bank_mask:0xf
    s_nop 1
    v_add_f32_dpp v40, v40, v40 row_ror:1 row_mask:0xf bank_mask:0xf
    s_nop 1
    v_readlane_b32 s48, v40, 0
    v_readlane_b32 s49, v40, 16
    v_readlane_b32 s50, v40, 32
    v_readlane_b32 s51, v40, 48
    s_nop 1
    v_mov_b32 v40, s48
    v_add_f32 v40, s49, v40
    v_add_f32 v40, s50, v40
    v_add_f32 v40, s51, v40
    v_mul_f32 v40, 0x3aaaaaab, v40
    v_mov_b32 v41, 0
    v_sub_f32 v42, v24, v40
    v_fmac_f32 v41, v42, v42
    v_sub_f32 v42, v25, v40
    v_fmac_f32 v41, v42, v42
    v_sub_f32 v42, v26, v40
    v_fmac_f32 v41, v42, v42
    v_sub_f32 v42, v27, v40
    v_fmac_f32 v41, v42, v42
    v_sub_f32 v42, v28, v40
    v_fmac_f32 v41, v42, v42
    v_sub_f32 v42, v29, v40
    v_fmac_f32 v41, v42, v42
    v_sub_f32 v42, v30, v40
    v_fmac_f32 v41, v42, v42
    v_sub_f32 v42, v31, v40
    v_fmac_f32 v41, v42, v42
    v_sub_f32 v42, v32, v40
    v_cndmask_b32 v42, 0, v42, s[46:47]
    v_fmac_f32 v41, v42, v42
    v_sub_f32 v42, v33, v40
    v_cndmask_b32 v42, 0, v42, s[46:47]
    v_fmac_f32 v41, v42, v42
    v_sub_f32 v42, v34, v40
    v_cndmask_b32 v42, 0, v42, s[46:47]
    v_fmac_f32 v41, v42, v42
    v_sub_f32 v42, v35, v40
    v_cndmask_b32 v42, 0, v42, s[46:47]
    v_fmac_f32 v41, v42, v42
    v_sub_f32 v42, v36, v40
    v_cndmask_b32 v42, 0, v42, s[46:47]
    v_fmac_f32 v41, v42, v42
    v_sub_f32 v42, v37, v40
    v_cndmask_b32 v42, 0, v42, s[46:47]
    v_fmac_f32 v41, v42, v42
    v_sub_f32 v42, v38, v40
    v_cndmask_b32 v42, 0, v42, s[46:47]
    v_fmac_f32 v41, v42, v42
    v_sub_f32 v42, v39, v40
    v_cndmask_b32 v42, 0, v42, s[46:47]
    v_fmac_f32 v41, v42, v42
    s_nop 1
    v_add_f32_dpp v41, v41, v41 row_ror:8 row_mask:0xf bank_mask:0xf
    s_nop 1
    v_add_f32_dpp v41, v41, v41 row_ror:4 row_mask:0xf bank_mask:0xf
    s_nop 1
    v_add_f32_dpp v41, v41, v41 row_ror:2 row_mask:0xf bank_mask:0xf
    s_nop 1
    v_add_f32_dpp v41, v41, v41 row_ror:1 row_mask:0xf bank_mask:0xf
    s_nop 1
    v_readlane_b32 s48, v41, 0
    v_readlane_b32 s49, v41, 16
    v_readlane_b32 s50, v41, 32
    v_readlane_b32 s51, v41, 48
    s_nop 1
    v_mov_b32 v41, s48
    v_add_f32 v41, s49, v41
    v_add_f32 v41, s50, v41
    v_add_f32 v41, s51, v41
    v_mul_f32 v41, 0x3aaaaaab, v41
    v_cvt_pk_bf16_f32 v42, v41, v41
    v_lshlrev_b32 v41, 16, v42
    v_add_f32 v41, 0x3727c5ac, v41
    v_cvt_pk_bf16_f32 v42, v41, v41
    v_lshlrev_b32 v41, 16, v42
    v_sqrt_f32 v41, v41
    s_nop 0
    v_cvt_pk_bf16_f32 v42, v41, v41
    v_lshlrev_b32 v41, 16, v42
    v_rcp_f32 v41, v41
    v_cvt_pk_bf16_f32 v42, v40, v40
    v_lshlrev_b32 v40, 16, v42
    v_sub_f32 v24, v24, v40
    v_sub_f32 v25, v25, v40
    v_cvt_pk_bf16_f32 v42, v24, v25
    v_lshlrev_b32 v24, 16, v42
    v_and_b32 v25, 0xffff0000, v42
    v_mul_f32 v24, v24, v41
    v_mul_f32 v25, v25, v41
    v_cvt_pk_bf16_f32 v16, v24, v25
    v_sub_f32 v26, v26, v40
    v_sub_f32 v27, v27, v40
    v_cvt_pk_bf16_f32 v42, v26, v27
    v_lshlrev_b32 v26, 16, v42
    v_and_b32 v27, 0xffff0000, v42
    v_mul_f32 v26, v26, v41
    v_mul_f32 v27, v27, v41
    v_cvt_pk_bf16_f32 v17, v26, v27
    v_sub_f32 v28, v28, v40
    v_sub_f32 v29, v29, v40
    v_cvt_pk_bf16_f32 v42, v28, v29
    v_lshlrev_b32 v28, 16, v42
    v_and_b32 v29, 0xffff0000, v42
    v_mul_f32 v28, v28, v41
    v_mul_f32 v29, v29, v41
    v_cvt_pk_bf16_f32 v18, v28, v29
    v_sub_f32 v30, v30, v40
    v_sub_f32 v31, v31, v40
    v_cvt_pk_bf16_f32 v42, v30, v31
    v_lshlrev_b32 v30, 16, v42
    v_and_b32 v31, 0xffff0000, v42
    v_mul_f32 v30, v30, v41
    v_mul_f32 v31, v31, v41
    v_cvt_pk_bf16_f32 v19, v30, v31
    v_sub_f32 v32, v32, v40
    v_sub_f32 v33, v33, v40
    v_cvt_pk_bf16_f32 v42, v32, v33
    v_lshlrev_b32 v32, 16, v42
    v_and_b32 v33, 0xffff0000, v42
    v_mul_f32 v32, v32, v41
    v_mul_f32 v33, v33, v41
    v_cvt_pk_bf16_f32 v20, v32, v33
    v_sub_f32 v34, v34, v40
    v_sub_f32 v35, v35, v40
    v_cvt_pk_bf16_f32 v42, v34, v35
    v_lshlrev_b32 v34, 16, v42
    v_and_b32 v35, 0xffff0000, v42
    v_mul_f32 v34, v34, v41
    v_mul_f32 v35, v35, v41
    v_cvt_pk_bf16_f32 v21, v34, v35
    v_sub_f32 v36, v36, v40
    v_sub_f32 v37, v37, v40
    v_cvt_pk_bf16_f32 v42, v36, v37
    v_lshlrev_b32 v36, 16, v42
    v_and_b32 v37, 0xffff0000, v42
    v_mul_f32 v36, v36, v41
    v_mul_f32 v37, v37, v41
    v_cvt_pk_bf16_f32 v22, v36, v37
    v_sub_f32 v38, v38, v40
    v_sub_f32 v39, v39, v40
    v_cvt_pk_bf16_f32 v42, v38, v39
    v_lshlrev_b32 v38, 16, v42
    v_and_b32 v39, 0xffff0000, v42
    v_mul_f32 v38, v38, v41
    v_mul_f32 v39, v39, v41
    v_cvt_pk_bf16_f32 v23, v38, v39
    s_add_u32 s45, s44, 1536
    buffer_store_dwordx4 v[16:19], v2, s[12:15], s45 offen
    s_mov_b64 exec, s[46:47]
    buffer_store_dwordx4 v[20:23], v2, s[12:15], s45 offen offset:1024
    s_mov_b64 exec, -1
lna_kernel_end1:
    s_endpgm
.globl g4a_kernel
.p2align 8
.type g4a_kernel,@function
g4a_kernel:
    s_cmp_ge_u32 s2, 192
    s_cbranch_scc1 g4a_kernel_end1
    s_load_dwordx16 s[48:63], s[0:1], 0
    s_load_dwordx8 s[64:71], s[0:1], 64
    v_and_b32 v1, 63, v0
    v_lshrrev_b32 v2, 6, v0
    s_and_b32 s46, s2, 7
    s_lshr_b32 s47, s2, 3
    s_mul_i32 s36, s47, 171
    s_lshr_b32 s36, s36, 11
    s_mul_i32 s3, s36, 12
    s_sub_u32 s37, s47, s3
    s_mul_i32 s46, s46, 2
    s_add_u32 s36, s36, s46
    s_mul_i32 s38, s36, 128
    s_mul_i32 s39, s37, 64
    v_readfirstlane_b32 s40, v2
    s_lshr_b32 s74, s40, 2
    s_and_b32 s40, s40, 3
    s_cmp_eq_u32 s74, 0
    s_cbranch_scc0 g4a_kernel_prod2
    s_branch g4a_kernel_cons3
g4a_kernel_prod2:
    s_mul_i32 s41, s38, 4096
    s_lshl_b32 s42, s39, 1
    s_mul_i32 s43, s40, 4096
    s_mul_i32 s44, s40, 2048
    s_add_u32 s44, s44, 65536
    s_mul_i32 s46, s40, 256
    s_add_u32 s46, s46, 0
    v_add_u32 v2, s46, v1
    v_lshrrev_b32 v3, 3, v2
    v_and_b32 v4, 7, v2
    v_bfe_u32 v5, v3, 1, 3
    v_xor_b32 v4, v4, v5
    v_lshlrev_b32 v4, 4, v4
    s_mov_b32 s47, 4096
    v_mad_u32_u24 v10, v3, s47, v4
    s_mul_i32 s46, s40, 256
    s_add_u32 s46, s46, 64
    v_add_u32 v2, s46, v1
    v_lshrrev_b32 v3, 3, v2
    v_and_b32 v4, 7, v2
    v_bfe_u32 v5, v3, 1, 3
    v_xor_b32 v4, v4, v5
    v_lshlrev_b32 v4, 4, v4
    s_mov_b32 s47, 4096
    v_mad_u32_u24 v11, v3, s47, v4
    s_mul_i32 s46, s40, 256
    s_add_u32 s46, s46, 128
    v_add_u32 v2, s46, v1
    v_lshrrev_b32 v3, 3, v2
    v_and_b32 v4, 7, v2
    v_bfe_u32 v5, v3, 1, 3
    v_xor_b32 v4, v4, v5
    v_lshlrev_b32 v4, 4, v4
    s_mov_b32 s47, 4096
    v_mad_u32_u24 v12, v3, s47, v4
    s_mul_i32 s46, s40, 256
    s_add_u32 s46, s46, 192
    v_add_u32 v2, s46, v1
    v_lshrrev_b32 v3, 3, v2
    v_and_b32 v4, 7, v2
    v_bfe_u32 v5, v3, 1, 3
    v_xor_b32 v4, v4, v5
    v_lshlrev_b32 v4, 4, v4
    s_mov_b32 s47, 4096
    v_mad_u32_u24 v13, v3, s47, v4
    s_mul_i32 s46, s40, 128
    s_add_u32 s46, s46, 0
    v_add_u32 v2, s46, v1
    v_lshrrev_b32 v3, 3, v2
    s_mov_b32 s47, 8
    v_mul_u32_u24 v4, s47, v3
    v_sub_u32 v4, v2, v4
    v_bfe_u32 v5, v3, 1, 1
    v_lshlrev_b32 v5, 2, v5
    v_xor_b32 v4, v4, v5
    v_lshlrev_b32 v4, 4, v4
    s_mov_b32 s47, 1536
    v_mad_u32_u24 v14, v3, s47, v4
    s_mul_i32 s46, s40, 128
    s_add_u32 s46, s46, 64
    v_add_u32 v2, s46, v1
    v_lshrrev_b32 v3, 3, v2
    s_mov_b32 s47, 8
    v_mul_u32_u24 v4, s47, v3
    v_sub_u32 v4, v2, v4
    v_bfe_u32 v5, v3, 1, 1
    v_lshlrev_b32 v5, 2, v5
    v_xor_b32 v4, v4, v5
    v_lshlrev_b32 v4, 4, v4
    s_mov_b32 s47, 1536
    v_mad_u32_u24 v15, v3, s47, v4
    s_waitcnt lgkmcnt(0)
    s_mov_b32 s8, s60
    s_mov_b32 s9, s61
    s_mov_b32 s10, 8388608
    s_mov_b32 s11, 0x00020000
    s_add_u32 s12, s70, 24641536
    s_addc_u32 s13, s71, 0
    s_mov_b32 s14, 3145728
    s_mov_b32 s15, 0x00020000
    s_add_u32 m0, s43, 0
    s_nop 0
    buffer_load_dwordx4 v10, s[8:11], s41 offen lds
    s_add_u32 m0, s43, 1024
    s_nop 0
    buffer_load_dwordx4 v11, s[8:11], s41 offen lds
    s_add_u32 m0, s43, 2048
    s_nop 0
    buffer_load_dwordx4 v12, s[8:11], s41 offen lds
    s_add_u32 m0, s43, 3072
    s_nop 0
    buffer_load_dwordx4 v13, s[8:11], s41 offen lds
    s_add_u32 m0, s44, 0
    s_nop 0
    buffer_load_dwordx4 v14, s[12:15], s42 offen lds
    s_add_u32 m0, s44, 1024
    s_nop 0
    buffer_load_dwordx4 v15, s[12:15], s42 offen lds
    s_add_u32 s41, s41, 128
    s_add_u32 s42, s42, 98304
    s_add_u32 m0, s43, 16384
    s_nop 0
    buffer_load_dwordx4 v10, s[8:11], s41 offen lds
    s_add_u32 m0, s43, 17408
    s_nop 0
    buffer_load_dwordx4 v11, s[8:11], s41 offen lds
    s_add_u32 m0, s43, 18432
    s_nop 0
    buffer_load_dwordx4 v12, s[8:11], s41 offen lds
    s_add_u32 m0, s43, 19456
    s_nop 0
    buffer_load_dwordx4 v13, s[8:11], s41 offen lds
    s_add_u32 m0, s44, 8192
    s_nop 0
    buffer_load_dwordx4 v14, s[12:15], s42 offen lds
    s_add_u32 m0, s44, 9216
    s_nop 0
    buffer_load_dwordx4 v15, s[12:15], s42 offen lds
    s_add_u32 s41, s41, 128
    s_add_u32 s42, s42, 98304
    s_add_u32 m0, s43, 32768
    s_nop 0
    buffer_load_dwordx4 v10, s[8:11], s41 offen lds
    s_add_u32 m0, s43, 33792
    s_nop 0
    buffer_load_dwordx4 v11, s[8:11], s41 offen lds
    s_add_u32 m0, s43, 34816
    s_nop 0
    buffer_load_dwordx4 v12, s[8:11], s41 offen lds
    s_add_u32 m0, s43, 35840
    s_nop 0
    buffer_load_dwordx4 v13, s[8:11], s41 offen lds
    s_add_u32 m0, s44, 16384
    s_nop 0
    buffer_load_dwordx4 v14, s[12:15], s42 offen lds
    s_add_u32 m0, s44, 17408
    s_nop 0
    buffer_load_dwordx4 v15, s[12:15], s42 offen lds
    s_add_u32 s41, s41, 128
    s_add_u32 s42, s42, 98304
    s_mov_b32 s45, 7
g4a_kernel_ploop4:
    s_waitcnt vmcnt(12)
    s_barrier
    s_add_u32 m0, s43, 49152
    s_nop 0
    buffer_load_dwordx4 v10, s[8:11], s41 offen lds
    s_add_u32 m0, s43, 50176
    s_nop 0
    buffer_load_dwordx4 v11, s[8:11], s41 offen lds
    s_add_u32 m0, s43, 51200
    s_nop 0
    buffer_load_dwordx4 v12, s[8:11], s41 offen lds
    s_add_u32 m0, s43, 52224
    s_nop 0
    buffer_load_dwordx4 v13, s[8:11], s41 offen lds
    s_add_u32 m0, s44, 24576
    s_nop 0
    buffer_load_dwordx4 v14, s[12:15], s42 offen lds
    s_add_u32 m0, s44, 25600
    s_nop 0
    buffer_load_dwordx4 v15, s[12:15], s42 offen lds
    s_add_u32 s41, s41, 128
    s_add_u32 s42, s42, 98304
    s_waitcnt vmcnt(12)
    s_barrier
    s_add_u32 m0, s43, 0
    s_nop 0
    buffer_load_dwordx4 v10, s[8:11], s41 offen lds
    s_add_u32 m0, s43, 1024
    s_nop 0
    buffer_load_dwordx4 v11, s[8:11], s41 offen lds
    s_add_u32 m0, s43, 2048
    s_nop 0
    buffer_load_dwordx4 v12, s[8:11], s41 offen lds
    s_add_u32 m0, s43, 3072
    s_nop 0
    buffer_load_dwordx4 v13, s[8:11], s41 offen lds
    s_add_u32 m0, s44, 0
    s_nop 0
    buffer_load_dwordx4 v14, s[12:15], s42 offen lds
    s_add_u32 m0, s44, 1024
    s_nop 0
    buffer_load_dwordx4 v15, s[12:15], s42 offen lds
    s_add_u32 s41, s41, 128
    s_add_u32 s42, s42, 98304
    s_waitcnt vmcnt(12)
    s_barrier
    s_add_u32 m0, s43, 16384
    s_nop 0
    buffer_load_dwordx4 v10, s[8:11], s41 offen lds
    s_add_u32 m0, s43, 17408
    s_nop 0
    buffer_load_dwordx4 v11, s[8:11], s41 offen lds
    s_add_u32 m0, s43, 18432
    s_nop 0
    buffer_load_dwordx4 v12, s[8:11], s41 offen lds
    s_add_u32 m0, s43, 19456
    s_nop 0
    buffer_load_dwordx4 v13, s[8:11], s41 offen lds
    s_add_u32 m0, s44, 8192
    s_nop 0
    buffer_load_dwordx4 v14, s[12:15], s42 offen lds
    s_add_u32 m0, s44, 9216
    s_nop 0
    buffer_load_dwordx4 v15, s[12:15], s42 offen lds
    s_add_u32 s41, s41, 128
    s_add_u32 s42, s42, 98304
    s_waitcnt vmcnt(12)
    s_barrier
    s_add_u32 m0, s43, 32768
    s_nop 0
    buffer_load_dwordx4 v10, s[8:11], s41 offen lds
    s_add_u32 m0, s43, 33792
    s_nop 0
    buffer_load_dwordx4 v11, s[8:11], s41 offen lds
    s_add_u32 m0, s43, 34816
    s_nop 0
    buffer_load_dwordx4 v12, s[8:11], s41 offen lds
    s_add_u32 m0, s43, 35840
    s_nop 0
    buffer_load_dwordx4 v13, s[8:11], s41 offen lds
    s_add_u32 m0, s44, 16384
    s_nop 0
    buffer_load_dwordx4 v14, s[12:15], s42 offen lds
    s_add_u32 m0, s44, 17408
    s_nop 0
    buffer_load_dwordx4 v15, s[12:15], s42 offen lds
    s_add_u32 s41, s41, 128
    s_add_u32 s42, s42, 98304
    s_sub_u32 s45, s45, 1
    s_cmp_lg_u32 s45, 0
    s_cbranch_scc1 g4a_kernel_ploop4
    s_waitcnt vmcnt(12)
    s_barrier
    s_add_u32 m0, s43, 49152
    s_nop 0
    buffer_load_dwordx4 v10, s[8:11], s41 offen lds
    s_add_u32 m0, s43, 50176
    s_nop 0
    buffer_load_dwordx4 v11, s[8:11], s41 offen lds
    s_add_u32 m0, s43, 51200
    s_nop 0
    buffer_load_dwordx4 v12, s[8:11], s41 offen lds
    s_add_u32 m0, s43, 52224
    s_nop 0
    buffer_load_dwordx4 v13, s[8:11], s41 offen lds
    s_add_u32 m0, s44, 24576
    s_nop 0
    buffer_load_dwordx4 v14, s[12:15], s42 offen lds
    s_add_u32 m0, s44, 25600
    s_nop 0
    buffer_load_dwordx4 v15, s[12:15], s42 offen lds
    s_add_u32 s41, s41, 128
    s_add_u32 s42, s42, 98304
    s_waitcnt vmcnt(12)
    s_barrier
    s_waitcnt vmcnt(6)
    s_barrier
    s_waitcnt vmcnt(0)
    s_barrier
    s_endpgm
g4a_kernel_cons3:
    s_waitcnt lgkmcnt(0)
    s_add_u32 s16, s70, 27787264
    s_addc_u32 s17, s71, 0
    s_mov_b32 s18, 3145728
    s_mov_b32 s19, 0x00020000
    s_lshr_b32 s72, s40, 1
    s_and_b32 s73, s40, 1
    s_mul_i32 s46, s72, 64
    v_and_b32 v2, 31, v1
    v_add_u32 v2, s46, v2
    v_lshrrev_b32 v3, 5, v1
    v_bfe_u32 v4, v2, 1, 3
    v_xor_b32 v3, v3, v4
    v_lshlrev_b32 v3, 4, v3
    v_lshl_add_u32 v16, v2, 7, v3
    v_xor_b32 v17, 32, v16
    v_xor_b32 v18, 64, v16
    v_xor_b32 v19, 96, v16
    s_mul_i32 s46, s73, 4
    s_add_u32 s46, s46, 0
    v_bfe_u32 v2, v1, 4, 1
    v_lshlrev_b32 v2, 1, v2
    v_bfe_u32 v3, v1, 1, 1
    v_add3_u32 v2, v2, v3, s46
    v_bfe_u32 v4, v1, 2, 2
    v_bfe_u32 v5, v4, 1, 1
    v_lshlrev_b32 v5, 2, v5
    v_xor_b32 v2, v2, v5
    v_lshlrev_b32 v2, 4, v2
    v_and_b32 v3, 1, v1
    v_lshl_add_u32 v2, v3, 3, v2
    v_lshrrev_b32 v3, 5, v1
    v_lshl_add_u32 v3, v3, 3, v4
    s_mov_b32 s47, 128
    v_mad_u32_u24 v2, v3, s47, v2
    v_add_u32 v20, 65536, v2
    s_mul_i32 s46, s72, 64
    v_and_b32 v2, 31, v1
    v_add_u32 v2, s46, v2
    s_mov_b32 s47, 144
    v_mul_u32_u24 v2, s47, v2
    s_mul_i32 s46, s73, 64
    v_lshrrev_b32 v3, 5, v1
    v_lshlrev_b32 v3, 3, v3
    v_add3_u32 v29, v2, v3, s46
    v_add_u32 v2, 0, v0
    v_lshrrev_b32 v6, 3, v2
    s_mov_b32 s46, 8
    v_mul_u32_u24 v7, s46, v6
    v_sub_u32 v7, v2, v7
    s_mov_b32 s46, 144
    v_mul_u32_u24 v25, s46, v6
    v_lshl_add_u32 v25, v7, 4, v25
    v_add_u32 v21, s38, v6
    s_mov_b32 s46, 1536
    v_mul_lo_u32 v21, v21, s46
    v_lshl_add_u32 v21, v7, 4, v21
    s_lshl_b32 s46, s39, 1
    v_add_u32 v21, s46, v21
    v_add_u32 v2, 256, v0
    v_lshrrev_b32 v6, 3, v2
    s_mov_b32 s46, 8
    v_mul_u32_u24 v7, s46, v6
    v_sub_u32 v7, v2, v7
    s_mov_b32 s46, 144
    v_mul_u32_u24 v26, s46, v6
    v_lshl_add_u32 v26, v7, 4, v26
    v_add_u32 v22, s38, v6
    s_mov_b32 s46, 1536
    v_mul_lo_u32 v22, v22, s46
    v_lshl_add_u32 v22, v7, 4, v22
    s_lshl_b32 s46, s39, 1
    v_add_u32 v22, s46, v22
    v_add_u32 v2, 512, v0
    v_lshrrev_b32 v6, 3, v2
    s_mov_b32 s46, 8
    v_mul_u32_u24 v7, s46, v6
    v_sub_u32 v7, v2, v7
    s_mov_b32 s46, 144
    v_mul_u32_u24 v27, s46, v6
    v_lshl_add_u32 v27, v7, 4, v27
    v_add_u32 v23, s38, v6
    s_mov_b32 s46, 1536
    v_mul_lo_u32 v23, v23, s46
    v_lshl_add_u32 v23, v7, 4, v23
    s_lshl_b32 s46, s39, 1
    v_add_u32 v23, s46, v23
    v_add_u32 v2, 768, v0
    v_lshrrev_b32 v6, 3, v2
    s_mov_b32 s46, 8
    v_mul_u32_u24 v7, s46, v6
    v_sub_u32 v7, v2, v7
    s_mov_b32 s46, 144
    v_mul_u32_u24 v28, s46, v6
    v_lshl_add_u32 v28, v7, 4, v28
    v_add_u32 v24, s38, v6
    s_mov_b32 s46, 1536
    v_mul_lo_u32 v24, v24, s46
    v_lshl_add_u32 v24, v7, 4, v24
    s_lshl_b32 s46, s39, 1
    v_add_u32 v24, s46, v24
    v_mov_b32 v64, 0
    v_mov_b32 v65, 0
    v_mov_b32 v66, 0
    v_mov_b32 v67, 0
    v_mov_b32 v68, 0
    v_mov_b32 v69, 0
    v_mov_b32 v70, 0
    v_mov_b32 v71, 0
    v_mov_b32 v72, 0
    v_mov_b32 v73, 0
    v_mov_b32 v74, 0
    v_mov_b32 v75, 0
    v_mov_b32 v76, 0
    v_mov_b32 v77, 0
    v_mov_b32 v78, 0
    v_mov_b32 v79, 0
    v_mov_b32 v80, 0
    v_mov_b32 v81, 0
    v_mov_b32 v82, 0
    v_mov_b32 v83, 0
    v_mov_b32 v84, 0
    v_mov_b32 v85, 0
    v_mov_b32 v86, 0
    v_mov_b32 v87, 0
    v_mov_b32 v88, 0
    v_mov_b32 v89, 0
    v_mov_b32 v90, 0
    v_mov_b32 v91, 0
    v_mov_b32 v92, 0
    v_mov_b32 v93, 0
    v_mov_b32 v94, 0
    v_mov_b32 v95, 0
    s_mov_b32 s45, 7
g4a_kernel_loop5:
    s_barrier
    ds_read_b128 v[32:35], v16 offset:0
    ds_read_b128 v[36:39], v16 offset:4096
    ds_read_b64_tr_b16 v[40:41], v20 offset:0
    ds_read_b64_tr_b16 v[42:43], v20 offset:512
    ds_read_b128 v[44:47], v17 offset:0
    ds_read_b128 v[48:51], v17 offset:4096
    ds_read_b64_tr_b16 v[52:53], v20 offset:2048
    ds_read_b64_tr_b16 v[54:55], v20 offset:2560
    s_waitcnt lgkmcnt(4)
    v_mfma_f32_32x32x16_bf16 v[64:79], v[40:43], v[32:35], v[64:79]
    v_mfma_f32_32x32x16_bf16 v[80:95], v[40:43], v[36:39], v[80:95]
    ds_read_b128 v[32:35], v18 offset:0
    ds_read_b128 v[36:39], v18 offset:4096
    ds_read_b64_tr_b16 v[40:41], v20 offset:4096
    ds_read_b64_tr_b16 v[42:43], v20 offset:4608
    s_waitcnt lgkmcnt(4)
    v_mfma_f32_32x32x16_bf16 v[64:79], v[52:55], v[44:47], v[64:79]
    v_mfma_f32_32x32x16_bf16 v[80:95], v[52:55], v[48:51], v[80:95]
    ds_read_b128 v[44:47], v19 offset:0
    ds_read_b128 v[48:51], v19 offset:4096
    ds_read_b64_tr_b16 v[52:53], v20 offset:6144
    ds_read_b64_tr_b16 v[54:55], v20 offset:6656
    s_waitcnt lgkmcnt(4)
    v_mfma_f32_32x32x16_bf16 v[64:79], v[40:43], v[32:35], v[64:79]
    v_mfma_f32_32x32x16_bf16 v[80:95], v[40:43], v[36:39], v[80:95]
    s_waitcnt lgkmcnt(0)
    v_mfma_f32_32x32x16_bf16 v[64:79], v[52:55], v[44:47], v[64:79]
    v_mfma_f32_32x32x16_bf16 v[80:95], v[52:55], v[48:51], v[80:95]
    s_barrier
    ds_read_b128 v[32:35], v16 offset:16384
    ds_read_b128 v[36:39], v16 offset:20480
    ds_read_b64_tr_b16 v[40:41], v20 offset:8192
    ds_read_b64_tr_b16 v[42:43], v20 offset:8704
    ds_read_b128 v[44:47], v17 offset:16384
    ds_read_b128 v[48:51], v17 offset:20480
    ds_read_b64_tr_b16 v[52:53], v20 offset:10240
    ds_read_b64_tr_b16 v[54:55], v20 offset:10752
    s_waitcnt lgkmcnt(4)
    v_mfma_f32_32x32x16_bf16 v[64:79], v[40:43], v[32:35], v[64:79]
    v_mfma_f32_32x32x16_bf16 v[80:95], v[40:43], v[36:39], v[80:95]
    ds_read_b128 v[32:35], v18 offset:16384
    ds_read_b128 v[36:39], v18 offset:20480
    ds_read_b64_tr_b16 v[40:41], v20 offset:12288
    ds_read_b64_tr_b16 v[42:43], v20 offset:12800
    s_waitcnt lgkmcnt(4)
    v_mfma_f32_32x32x16_bf16 v[64:79], v[52:55], v[44:47], v[64:79]
    v_mfma_f32_32x32x16_bf16 v[80:95], v[52:55], v[48:51], v[80:95]
    ds_read_b128 v[44:47], v19 offset:16384
    ds_read_b128 v[48:51], v19 offset:20480
    ds_read_b64_tr_b16 v[52:53], v20 offset:14336
    ds_read_b64_tr_b16 v[54:55], v20 offset:14848
    s_waitcnt lgkmcnt(4)
    v_mfma_f32_32x32x16_bf16 v[64:79], v[40:43], v[32:35], v[64:79]
    v_mfma_f32_32x32x16_bf16 v[80:95], v[40:43], v[36:39], v[80:95]
    s_waitcnt lgkmcnt(0)
    v_mfma_f32_32x32x16_bf16 v[64:79], v[52:55], v[44:47], v[64:79]
    v_mfma_f32_32x32x16_bf16 v[80:95], v[52:55], v[48:51], v[80:95]
    s_barrier
    ds_read_b128 v[32:35], v16 offset:32768
    ds_read_b128 v[36:39], v16 offset:36864
    ds_read_b64_tr_b16 v[40:41], v20 offset:16384
    ds_read_b64_tr_b16 v[42:43], v20 offset:16896
    ds_read_b128 v[44:47], v17 offset:32768
    ds_read_b128 v[48:51], v17 offset:36864
    ds_read_b64_tr_b16 v[52:53], v20 offset:18432
    ds_read_b64_tr_b16 v[54:55], v20 offset:18944
    s_waitcnt lgkmcnt(4)
    v_mfma_f32_32x32x16_bf16 v[64:79], v[40:43], v[32:35], v[64:79]
    v_mfma_f32_32x32x16_bf16 v[80:95], v[40:43], v[36:39], v[80:95]
    ds_read_b128 v[32:35], v18 offset:32768
    ds_read_b128 v[36:39], v18 offset:36864
    ds_read_b64_tr_b16 v[40:41], v20 offset:20480
    ds_read_b64_tr_b16 v[42:43], v20 offset:20992
    s_waitcnt lgkmcnt(4)
    v_mfma_f32_32x32x16_bf16 v[64:79], v[52:55], v[44:47], v[64:79]
    v_mfma_f32_32x32x16_bf16 v[80:95], v[52:55], v[48:51], v[80:95]
    ds_read_b128 v[44:47], v19 offset:32768
    ds_read_b128 v[48:51], v19 offset:36864
    ds_read_b64_tr_b16 v[52:53], v20 offset:22528
    ds_read_b64_tr_b16 v[54:55], v20 offset:23040
    s_waitcnt lgkmcnt(4)
    v_mfma_f32_32x32x16_bf16 v[64:79], v[40:43], v[32:35], v[64:79]
    v_mfma_f32_32x32x16_bf16 v[80:95], v[40:43], v[36:39], v[80:95]
    s_waitcnt lgkmcnt(0)
    v_mfma_f32_32x32x16_bf16 v[64:79], v[52:55], v[44:47], v[64:79]
    v_mfma_f32_32x32x16_bf16 v[80:95], v[52:55], v[48:51], v[80:95]
    s_barrier
    ds_read_b128 v[32:35], v16 offset:49152
    ds_read_b128 v[36:39], v16 offset:53248
    ds_read_b64_tr_b16 v[40:41], v20 offset:24576
    ds_read_b64_tr_b16 v[42:43], v20 offset:25088
    ds_read_b128 v[44:47], v17 offset:49152
    ds_read_b128 v[48:51], v17 offset:53248
    ds_read_b64_tr_b16 v[52:53], v20 offset:26624
    ds_read_b64_tr_b16 v[54:55], v20 offset:27136
    s_waitcnt lgkmcnt(4)
    v_mfma_f32_32x32x16_bf16 v[64:79], v[40:43], v[32:35], v[64:79]
    v_mfma_f32_32x32x16_bf16 v[80:95], v[40:43], v[36:39], v[80:95]
    ds_read_b128 v[32:35], v18 offset:49152
    ds_read_b128 v[36:39], v18 offset:53248
    ds_read_b64_tr_b16 v[40:41], v20 offset:28672
    ds_read_b64_tr_b16 v[42:43], v20 offset:29184
    s_waitcnt lgkmcnt(4)
    v_mfma_f32_32x32x16_bf16 v[64:79], v[52:55], v[44:47], v[64:79]
    v_mfma_f32_32x32x16_bf16 v[80:95], v[52:55], v[48:51], v[80:95]
    ds_read_b128 v[44:47], v19 offset:49152
    ds_read_b128 v[48:51], v19 offset:53248
    ds_read_b64_tr_b16 v[52:53], v20 offset:30720
    ds_read_b64_tr_b16 v[54:55], v20 offset:31232
    s_waitcnt lgkmcnt(4)
    v_mfma_f32_32x32x16_bf16 v[64:79], v[40:43], v[32:35], v[64:79]
    v_mfma_f32_32x32x16_bf16 v[80:95], v[40:43], v[36:39], v[80:95]
    s_waitcnt lgkmcnt(0)
    v_mfma_f32_32x32x16_bf16 v[64:79], v[52:55], v[44:47], v[64:79]
    v_mfma_f32_32x32x16_bf16 v[80:95], v[52:55], v[48:51], v[80:95]
    s_sub_u32 s45, s45, 1
    s_cmp_lg_u32 s45, 0
    s_cbranch_scc1 g4a_kernel_loop5
    s_barrier
    ds_read_b128 v[32:35], v16 offset:0
    ds_read_b128 v[36:39], v16 offset:4096
    ds_read_b64_tr_b16 v[40:41], v20 offset:0
    ds_read_b64_tr_b16 v[42:43], v20 offset:512
    ds_read_b128 v[44:47], v17 offset:0
    ds_read_b128 v[48:51], v17 offset:4096
    ds_read_b64_tr_b16 v[52:53], v20 offset:2048
    ds_read_b64_tr_b16 v[54:55], v20 offset:2560
    s_waitcnt lgkmcnt(4)
    v_mfma_f32_32x32x16_bf16 v[64:79], v[40:43], v[32:35], v[64:79]
    v_mfma_f32_32x32x16_bf16 v[80:95], v[40:43], v[36:39], v[80:95]
    ds_read_b128 v[32:35], v18 offset:0
    ds_read_b128 v[36:39], v18 offset:4096
    ds_read_b64_tr_b16 v[40:41], v20 offset:4096
    ds_read_b64_tr_b16 v[42:43], v20 offset:4608
    s_waitcnt lgkmcnt(4)
    v_mfma_f32_32x32x16_bf16 v[64:79], v[52:55], v[44:47], v[64:79]
    v_mfma_f32_32x32x16_bf16 v[80:95], v[52:55], v[48:51], v[80:95]
    ds_read_b128 v[44:47], v19 offset:0
    ds_read_b128 v[48:51], v19 offset:4096
    ds_read_b64_tr_b16 v[52:53], v20 offset:6144
    ds_read_b64_tr_b16 v[54:55], v20 offset:6656
    s_waitcnt lgkmcnt(4)
    v_mfma_f32_32x32x16_bf16 v[64:79], v[40:43], v[32:35], v[64:79]
    v_mfma_f32_32x32x16_bf16 v[80:95], v[40:43], v[36:39], v[80:95]
    s_waitcnt lgkmcnt(0)
    v_mfma_f32_32x32x16_bf16 v[64:79], v[52:55], v[44:47], v[64:79]
    v_mfma_f32_32x32x16_bf16 v[80:95], v[52:55], v[48:51], v[80:95]
    s_mov_b32 s28, s62
    s_mov_b32 s29, s63
    s_mov_b32 s30, 4096
    s_mov_b32 s31, 0x00020000
    s_mul_i32 s46, s72, 64
    s_add_u32 s46, s46, s38
    v_and_b32 v2, 31, v1
    v_add_u32 v2, s46, v2
    v_lshlrev_b32 v2, 1, v2
    buffer_load_ushort v96, v2, s[28:31], 0 offen offset:0
    buffer_load_ushort v97, v2, s[28:31], 0 offen offset:64
    s_add_u32 s20, s70, 18350080
    s_addc_u32 s21, s71, 0
    s_mov_b32 s22, 6291456
    s_mov_b32 s23, 0x00020000
    v_add_u32 v2, 0, v0
    v_lshrrev_b32 v6, 3, v2
    s_mov_b32 s46, 8
    v_mul_u32_u24 v7, s46, v6
    v_sub_u32 v7, v2, v7
    v_add_u32 v3, s38, v6
    s_mov_b32 s46, 3072
    v_mul_lo_u32 v3, v3, s46
    v_lshl_add_u32 v3, v7, 4, v3
    s_lshl_b32 s46, s39, 1
    v_add_u32 v3, s46, v3
    buffer_load_dwordx4 v[100:103], v3, s[20:23], 0 offen
    v_add_u32 v2, 256, v0
    v_lshrrev_b32 v6, 3, v2
    s_mov_b32 s46, 8
    v_mul_u32_u24 v7, s46, v6
    v_sub_u32 v7, v2, v7
    v_add_u32 v3, s38, v6
    s_mov_b32 s46, 3072
    v_mul_lo_u32 v3, v3, s46
    v_lshl_add_u32 v3, v7, 4, v3
    s_lshl_b32 s46, s39, 1
    v_add_u32 v3, s46, v3
    buffer_load_dwordx4 v[104:107], v3, s[20:23], 0 offen
    v_add_u32 v2, 512, v0
    v_lshrrev_b32 v6, 3, v2
    s_mov_b32 s46, 8
    v_mul_u32_u24 v7, s46, v6
    v_sub_u32 v7, v2, v7
    v_add_u32 v3, s38, v6
    s_mov_b32 s46, 3072
    v_mul_lo_u32 v3, v3, s46
    v_lshl_add_u32 v3, v7, 4, v3
    s_lshl_b32 s46, s39, 1
    v_add_u32 v3, s46, v3
    buffer_load_dwordx4 v[108:111], v3, s[20:23], 0 offen
    v_add_u32 v2, 768, v0
    v_lshrrev_b32 v6, 3, v2
    s_mov_b32 s46, 8
    v_mul_u32_u24 v7, s46, v6
    v_sub_u32 v7, v2, v7
    v_add_u32 v3, s38, v6
    s_mov_b32 s46, 3072
    v_mul_lo_u32 v3, v3, s46
    v_lshl_add_u32 v3, v7, 4, v3
    s_lshl_b32 s46, s39, 1
    v_add_u32 v3, s46, v3
    buffer_load_dwordx4 v[112:115], v3, s[20:23], 0 offen
    s_barrier
    ds_read_b128 v[32:35], v16 offset:16384
    ds_read_b128 v[36:39], v16 offset:20480
    ds_read_b64_tr_b16 v[40:41], v20 offset:8192
    ds_read_b64_tr_b16 v[42:43], v20 offset:8704
    ds_read_b128 v[44:47], v17 offset:16384
    ds_read_b128 v[48:51], v17 offset:20480
    ds_read_b64_tr_b16 v[52:53], v20 offset:10240
    ds_read_b64_tr_b16 v[54:55], v20 offset:10752
    s_waitcnt lgkmcnt(4)
    v_mfma_f32_32x32x16_bf16 v[64:79], v[40:43], v[32:35], v[64:79]
    v_mfma_f32_32x32x16_bf16 v[80:95], v[40:43], v[36:39], v[80:95]
    ds_read_b128 v[32:35], v18 offset:16384
    ds_read_b128 v[36:39], v18 offset:20480
    ds_read_b64_tr_b16 v[40:41], v20 offset:12288
    ds_read_b64_tr_b16 v[42:43], v20 offset:12800
    s_waitcnt lgkmcnt(4)
    v_mfma_f32_32x32x16_bf16 v[64:79], v[52:55], v[44:47], v[64:79]
    v_mfma_f32_32x32x16_bf16 v[80:95], v[52:55], v[48:51], v[80:95]
    ds_read_b128 v[44:47], v19 offset:16384
    ds_read_b128 v[48:51], v19 offset:20480
    ds_read_b64_tr_b16 v[52:53], v20 offset:14336
    ds_read_b64_tr_b16 v[54:55], v20 offset:14848
    s_waitcnt lgkmcnt(4)
    v_mfma_f32_32x32x16_bf16 v[64:79], v[40:43], v[32:35], v[64:79]
    v_mfma_f32_32x32x16_bf16 v[80:95], v[40:43], v[36:39], v[80:95]
    s_waitcnt lgkmcnt(0)
    v_mfma_f32_32x32x16_bf16 v[64:79], v[52:55], v[44:47], v[64:79]
    v_mfma_f32_32x32x16_bf16 v[80:95], v[52:55], v[48:51], v[80:95]
    s_barrier
    ds_read_b128 v[32:35], v16 offset:32768
    ds_read_b128 v[36:39], v16 offset:36864
    ds_read_b64_tr_b16 v[40:41], v20 offset:16384
    ds_read_b64_tr_b16 v[42:43], v20 offset:16896
    ds_read_b128 v[44:47], v17 offset:32768
    ds_read_b128 v[48:51], v17 offset:36864
    ds_read_b64_tr_b16 v[52:53], v20 offset:18432
    ds_read_b64_tr_b16 v[54:55], v20 offset:18944
    s_waitcnt lgkmcnt(4)
    v_mfma_f32_32x32x16_bf16 v[64:79], v[40:43], v[32:35], v[64:79]
    v_mfma_f32_32x32x16_bf16 v[80:95], v[40:43], v[36:39], v[80:95]
    ds_read_b128 v[32:35], v18 offset:32768
    ds_read_b128 v[36:39], v18 offset:36864
    ds_read_b64_tr_b16 v[40:41], v20 offset:20480
    ds_read_b64_tr_b16 v[42:43], v20 offset:20992
    s_waitcnt lgkmcnt(4)
    v_mfma_f32_32x32x16_bf16 v[64:79], v[52:55], v[44:47], v[64:79]
    v_mfma_f32_32x32x16_bf16 v[80:95], v[52:55], v[48:51], v[80:95]
    ds_read_b128 v[44:47], v19 offset:32768
    ds_read_b128 v[48:51], v19 offset:36864
    ds_read_b64_tr_b16 v[52:53], v20 offset:22528
    ds_read_b64_tr_b16 v[54:55], v20 offset:23040
    s_waitcnt lgkmcnt(4)
    v_mfma_f32_32x32x16_bf16 v[64:79], v[40:43], v[32:35], v[64:79]
    v_mfma_f32_32x32x16_bf16 v[80:95], v[40:43], v[36:39], v[80:95]
    s_waitcnt lgkmcnt(0)
    v_mfma_f32_32x32x16_bf16 v[64:79], v[52:55], v[44:47], v[64:79]
    v_mfma_f32_32x32x16_bf16 v[80:95], v[52:55], v[48:51], v[80:95]
    s_barrier
    ds_read_b128 v[32:35], v16 offset:49152
    ds_read_b128 v[36:39], v16 offset:53248
    ds_read_b64_tr_b16 v[40:41], v20 offset:24576
    ds_read_b64_tr_b16 v[42:43], v20 offset:25088
    ds_read_b128 v[44:47], v17 offset:49152
    ds_read_b128 v[48:51], v17 offset:53248
    ds_read_b64_tr_b16 v[52:53], v20 offset:26624
    ds_read_b64_tr_b16 v[54:55], v20 offset:27136
    s_waitcnt lgkmcnt(4)
    v_mfma_f32_32x32x16_bf16 v[64:79], v[40:43], v[32:35], v[64:79]
    v_mfma_f32_32x32x16_bf16 v[80:95], v[40:43], v[36:39], v[80:95]
    ds_read_b128 v[32:35], v18 offset:49152
    ds_read_b128 v[36:39], v18 offset:53248
    ds_read_b64_tr_b16 v[40:41], v20 offset:28672
    ds_read_b64_tr_b16 v[42:43], v20 offset:29184
    s_waitcnt lgkmcnt(4)
    v_mfma_f32_32x32x16_bf16 v[64:79], v[52:55], v[44:47], v[64:79]
    v_mfma_f32_32x32x16_bf16 v[80:95], v[52:55], v[48:51], v[80:95]
    ds_read_b128 v[44:47], v19 offset:49152
    ds_read_b128 v[48:51], v19 offset:53248
    ds_read_b64_tr_b16 v[52:53], v20 offset:30720
    ds_read_b64_tr_b16 v[54:55], v20 offset:31232
    s_waitcnt lgkmcnt(4)
    v_mfma_f32_32x32x16_bf16 v[64:79], v[40:43], v[32:35], v[64:79]
    v_mfma_f32_32x32x16_bf16 v[80:95], v[40:43], v[36:39], v[80:95]
    s_waitcnt lgkmcnt(0)
    v_mfma_f32_32x32x16_bf16 v[64:79], v[52:55], v[44:47], v[64:79]
    v_mfma_f32_32x32x16_bf16 v[80:95], v[52:55], v[48:51], v[80:95]
    s_barrier
    s_nop 15
    s_waitcnt vmcnt(0)
    v_lshlrev_b32 v96, 16, v96
    v_lshlrev_b32 v97, 16, v97
    v_cvt_pk_bf16_f32 v116, v64, v65
    v_cvt_pk_bf16_f32 v117, v66, v67
    v_lshlrev_b32 v64, 16, v116
    v_and_b32 v65, 0xffff0000, v116
    v_lshlrev_b32 v66, 16, v117
    v_and_b32 v67, 0xffff0000, v117
    v_add_f32 v64, v96, v64
    v_add_f32 v65, v96, v65
    v_add_f32 v66, v96, v66
    v_add_f32 v67, v96, v67
    v_cvt_pk_bf16_f32 v124, v64, v65
    v_cvt_pk_bf16_f32 v125, v66, v67
    ds_write_b64 v29, v[124:125] offset:0
    v_cvt_pk_bf16_f32 v116, v68, v69
    v_cvt_pk_bf16_f32 v117, v70, v71
    v_lshlrev_b32 v68, 16, v116
    v_and_b32 v69, 0xffff0000, v116
    v_lshlrev_b32 v70, 16, v117
    v_and_b32 v71, 0xffff0000, v117
    v_add_f32 v68, v96, v68
    v_add_f32 v69, v96, v69
    v_add_f32 v70, v96, v70
    v_add_f32 v71, v96, v71
    v_cvt_pk_bf16_f32 v124, v68, v69
    v_cvt_pk_bf16_f32 v125, v70, v71
    ds_write_b64 v29, v[124:125] offset:16
    v_cvt_pk_bf16_f32 v116, v72, v73
    v_cvt_pk_bf16_f32 v117, v74, v75
    v_lshlrev_b32 v72, 16, v116
    v_and_b32 v73, 0xffff0000, v116
    v_lshlrev_b32 v74, 16, v117
    v_and_b32 v75, 0xffff0000, v117
    v_add_f32 v72, v96, v72
    v_add_f32 v73, v96, v73
    v_add_f32 v74, v96, v74
    v_add_f32 v75, v96, v75
    v_cvt_pk_bf16_f32 v124, v72, v73
    v_cvt_pk_bf16_f32 v125, v74, v75
    ds_write_b64 v29, v[124:125] offset:32
    v_cvt_pk_bf16_f32 v116, v76, v77
    v_cvt_pk_bf16_f32 v117, v78, v79
    v_lshlrev_b32 v76, 16, v116
    v_and_b32 v77, 0xffff0000, v116
    v_lshlrev_b32 v78, 16, v117
    v_and_b32 v79, 0xffff0000, v117
    v_add_f32 v76, v96, v76
    v_add_f32 v77, v96, v77
    v_add_f32 v78, v96, v78
    v_add_f32 v79, v96, v79
    v_cvt_pk_bf16_f32 v124, v76, v77
    v_cvt_pk_bf16_f32 v125, v78, v79
    ds_write_b64 v29, v[124:125] offset:48
    v_cvt_pk_bf16_f32 v116, v80, v81
    v_cvt_pk_bf16_f32 v117, v82, v83
    v_lshlrev_b32 v80, 16, v116
    v_and_b32 v81, 0xffff0000, v116
    v_lshlrev_b32 v82, 16, v117
    v_and_b32 v83, 0xffff0000, v117
    v_add_f32 v80, v97, v80
    v_add_f32 v81, v97, v81
    v_add_f32 v82, v97, v82
    v_add_f32 v83, v97, v83
    v_cvt_pk_bf16_f32 v124, v80, v81
    v_cvt_pk_bf16_f32 v125, v82, v83
    ds_write_b64 v29, v[124:125] offset:4608
    v_cvt_pk_bf16_f32 v116, v84, v85
    v_cvt_pk_bf16_f32 v117, v86, v87
    v_lshlrev_b32 v84, 16, v116
    v_and_b32 v85, 0xffff0000, v116
    v_lshlrev_b32 v86, 16, v117
    v_and_b32 v87, 0xffff0000, v117
    v_add_f32 v84, v97, v84
    v_add_f32 v85, v97, v85
    v_add_f32 v86, v97, v86
    v_add_f32 v87, v97, v87
    v_cvt_pk_bf16_f32 v124, v84, v85
    v_cvt_pk_bf16_f32 v125, v86, v87
    ds_write_b64 v29, v[124:125] offset:4624
    v_cvt_pk_bf16_f32 v116, v88, v89
    v_cvt_pk_bf16_f32 v117, v90, v91
    v_lshlrev_b32 v88, 16, v116
    v_and_b32 v89, 0xffff0000, v116
    v_lshlrev_b32 v90, 16, v117
    v_and_b32 v91, 0xffff0000, v117
    v_add_f32 v88, v97, v88
    v_add_f32 v89, v97, v89
    v_add_f32 v90, v97, v90
    v_add_f32 v91, v97, v91
    v_cvt_pk_bf16_f32 v124, v88, v89
    v_cvt_pk_bf16_f32 v125, v90, v91
    ds_write_b64 v29, v[124:125] offset:4640
    v_cvt_pk_bf16_f32 v116, v92, v93
    v_cvt_pk_bf16_f32 v117, v94, v95
    v_lshlrev_b32 v92, 16, v116
    v_and_b32 v93, 0xffff0000, v116
    v_lshlrev_b32 v94, 16, v117
    v_and_b32 v95, 0xffff0000, v117
    v_add_f32 v92, v97, v92
    v_add_f32 v93, v97, v93
    v_add_f32 v94, v97, v94
    v_add_f32 v95, v97, v95
    v_cvt_pk_bf16_f32 v124, v92, v93
    v_cvt_pk_bf16_f32 v125, v94, v95
    ds_write_b64 v29, v[124:125] offset:4656
    s_waitcnt lgkmcnt(0)
    s_barrier
    ds_read_b128 v[64:67], v25
    ds_read_b128 v[68:71], v26
    ds_read_b128 v[72:75], v27
    ds_read_b128 v[76:79], v28
    s_waitcnt vmcnt(0)
    s_waitcnt lgkmcnt(3)
    v_lshlrev_b32 v116, 16, v64
    v_and_b32 v117, 0xffff0000, v64
    v_lshlrev_b32 v124, 16, v100
    v_and_b32 v125, 0xffff0000, v100
    v_lshlrev_b32 v118, 16, v65
    v_and_b32 v119, 0xffff0000, v65
    v_lshlrev_b32 v126, 16, v101
    v_and_b32 v127, 0xffff0000, v101
    v_lshlrev_b32 v120, 16, v66
    v_and_b32 v121, 0xffff0000, v66
    v_lshlrev_b32 v128, 16, v102
    v_and_b32 v129, 0xffff0000, v102
    v_lshlrev_b32 v122, 16, v67
    v_and_b32 v123, 0xffff0000, v67
    v_lshlrev_b32 v130, 16, v103
    v_and_b32 v131, 0xffff0000, v103
    v_mul_f32 v116, v116, v124
    v_mul_f32 v117, v117, v125
    v_mul_f32 v118, v118, v126
    v_mul_f32 v119, v119, v127
    v_mul_f32 v120, v120, v128
    v_mul_f32 v121, v121, v129
    v_mul_f32 v122, v122, v130
    v_mul_f32 v123, v123, v131
    v_cvt_pk_bf16_f32 v64, v116, v117
    v_cvt_pk_bf16_f32 v65, v118, v119
    v_cvt_pk_bf16_f32 v66, v120, v121
    v_cvt_pk_bf16_f32 v67, v122, v123
    buffer_store_dwordx4 v[64:67], v21, s[16:19], 0 offen
    s_waitcnt lgkmcnt(2)
    v_lshlrev_b32 v116, 16, v68
    v_and_b32 v117, 0xffff0000, v68
    v_lshlrev_b32 v124, 16, v104
    v_and_b32 v125, 0xffff0000, v104
    v_lshlrev_b32 v118, 16, v69
    v_and_b32 v119, 0xffff0000, v69
    v_lshlrev_b32 v126, 16, v105
    v_and_b32 v127, 0xffff0000, v105
    v_lshlrev_b32 v120, 16, v70
    v_and_b32 v121, 0xffff0000, v70
    v_lshlrev_b32 v128, 16, v106
    v_and_b32 v129, 0xffff0000, v106
    v_lshlrev_b32 v122, 16, v71
    v_and_b32 v123, 0xffff0000, v71
    v_lshlrev_b32 v130, 16, v107
    v_and_b32 v131, 0xffff0000, v107
    v_mul_f32 v116, v116, v124
    v_mul_f32 v117, v117, v125
    v_mul_f32 v118, v118, v126
    v_mul_f32 v119, v119, v127
    v_mul_f32 v120, v120, v128
    v_mul_f32 v121, v121, v129
    v_mul_f32 v122, v122, v130
    v_mul_f32 v123, v123, v131
    v_cvt_pk_bf16_f32 v68, v116, v117
    v_cvt_pk_bf16_f32 v69, v118, v119
    v_cvt_pk_bf16_f32 v70, v120, v121
    v_cvt_pk_bf16_f32 v71, v122, v123
    buffer_store_dwordx4 v[68:71], v22, s[16:19], 0 offen
    s_waitcnt lgkmcnt(1)
    v_lshlrev_b32 v116, 16, v72
    v_and_b32 v117, 0xffff0000, v72
    v_lshlrev_b32 v124, 16, v108
    v_and_b32 v125, 0xffff0000, v108
    v_lshlrev_b32 v118, 16, v73
    v_and_b32 v119, 0xffff0000, v73
    v_lshlrev_b32 v126, 16, v109
    v_and_b32 v127, 0xffff0000, v109
    v_lshlrev_b32 v120, 16, v74
    v_and_b32 v121, 0xffff0000, v74
    v_lshlrev_b32 v128, 16, v110
    v_and_b32 v129, 0xffff0000, v110
    v_lshlrev_b32 v122, 16, v75
    v_and_b32 v123, 0xffff0000, v75
    v_lshlrev_b32 v130, 16, v111
    v_and_b32 v131, 0xffff0000, v111
    v_mul_f32 v116, v116, v124
    v_mul_f32 v117, v117, v125
    v_mul_f32 v118, v118, v126
    v_mul_f32 v119, v119, v127
    v_mul_f32 v120, v120, v128
    v_mul_f32 v121, v121, v129
    v_mul_f32 v122, v122, v130
    v_mul_f32 v123, v123, v131
    v_cvt_pk_bf16_f32 v72, v116, v117
    v_cvt_pk_bf16_f32 v73, v118, v119
    v_cvt_pk_bf16_f32 v74, v120, v121
    v_cvt_pk_bf16_f32 v75, v122, v123
    buffer_store_dwordx4 v[72:75], v23, s[16:19], 0 offen
    s_waitcnt lgkmcnt(0)
    v_lshlrev_b32 v116, 16, v76
    v_and_b32 v117, 0xffff0000, v76
    v_lshlrev_b32 v124, 16, v112
    v_and_b32 v125, 0xffff0000, v112
    v_lshlrev_b32 v118, 16, v77
    v_and_b32 v119, 0xffff0000, v77
    v_lshlrev_b32 v126, 16, v113
    v_and_b32 v127, 0xffff0000, v113
    v_lshlrev_b32 v120, 16, v78
    v_and_b32 v121, 0xffff0000, v78
    v_lshlrev_b32 v128, 16, v114
    v_and_b32 v129, 0xffff0000, v114
    v_lshlrev_b32 v122, 16, v79
    v_and_b32 v123, 0xffff0000, v79
    v_lshlrev_b32 v130, 16, v115
    v_and_b32 v131, 0xffff0000, v115
    v_mul_f32 v116, v116, v124
    v_mul_f32 v117, v117, v125
    v_mul_f32 v118, v118, v126
    v_mul_f32 v119, v119, v127
    v_mul_f32 v120, v120, v128
    v_mul_f32 v121, v121, v129
    v_mul_f32 v122, v122, v130
    v_mul_f32 v123, v123, v131
    v_cvt_pk_bf16_f32 v76, v116, v117
    v_cvt_pk_bf16_f32 v77, v118, v119
    v_cvt_pk_bf16_f32 v78, v120, v121
    v_cvt_pk_bf16_f32 v79, v122, v123
    buffer_store_dwordx4 v[76:79], v24, s[16:19], 0 offen
g4a_kernel_end1:
    s_endpgm
.globl g5a_kernel
.p2align 8
.type g5a_kernel,@function
g5a_kernel:
    s_cmp_ge_u32 s2, 160
    s_cbranch_scc1 g5a_kernel_end1
    s_load_dwordx16 s[48:63], s[0:1], 0
    s_load_dwordx8 s[64:71], s[0:1], 64
    v_and_b32 v1, 63, v0
    v_lshrrev_b32 v2, 6, v0
    s_and_b32 s46, s2, 7
    s_lshr_b32 s47, s2, 3
    s_mul_i32 s36, s47, 103
    s_lshr_b32 s36, s36, 9
    s_mul_i32 s3, s36, 5
    s_sub_u32 s37, s47, s3
    s_mul_i32 s46, s46, 4
    s_add_u32 s36, s36, s46
    s_mul_i32 s38, s36, 64
    s_mul_i32 s39, s37, 128
    v_readfirstlane_b32 s40, v2
    s_lshr_b32 s74, s40, 2
    s_and_b32 s40, s40, 3
    s_cmp_eq_u32 s74, 0
    s_cbranch_scc0 g5a_kernel_prod2
    s_branch g5a_kernel_cons3
g5a_kernel_prod2:
    s_mul_i32 s41, s38, 1536
    s_lshl_b32 s42, s39, 1
    s_mul_i32 s43, s40, 2048
    s_mul_i32 s44, s40, 4096
    s_add_u32 s44, s44, 32768
    s_mul_i32 s46, s40, 128
    s_add_u32 s46, s46, 0
    v_add_u32 v2, s46, v1
    v_lshrrev_b32 v3, 3, v2
    v_and_b32 v4, 7, v2
    v_bfe_u32 v5, v3, 1, 3
    v_xor_b32 v4, v4, v5
    v_lshlrev_b32 v4, 4, v4
    s_mov_b32 s47, 1536
    v_mad_u32_u24 v10, v3, s47, v4
    s_mul_i32 s46, s40, 128
    s_add_u32 s46, s46, 64
    v_add_u32 v2, s46, v1
    v_lshrrev_b32 v3, 3, v2
    v_and_b32 v4, 7, v2
    v_bfe_u32 v5, v3, 1, 3
    v_xor_b32 v4, v4, v5
    v_lshlrev_b32 v4, 4, v4
    s_mov_b32 s47, 1536
    v_mad_u32_u24 v11, v3, s47, v4
    s_mul_i32 s46, s40, 256
    s_add_u32 s46, s46, 0
    v_add_u32 v2, s46, v1
    v_lshrrev_b32 v3, 4, v2
    s_mov_b32 s47, 16
    v_mul_u32_u24 v4, s47, v3
    v_sub_u32 v4, v2, v4
    v_and_b32 v5, 3, v3
    v_lshlrev_b32 v5, 2, v5
    v_xor_b32 v4, v4, v5
    v_lshlrev_b32 v4, 4, v4
    s_mov_b32 s47, 1280
    v_mad_u32_u24 v12, v3, s47, v4
    s_mul_i32 s46, s40, 256
    s_add_u32 s46, s46, 64
    v_add_u32 v2, s46, v1
    v_lshrrev_b32 v3, 4, v2
    s_mov_b32 s47, 16
    v_mul_u32_u24 v4, s47, v3
    v_sub_u32 v4, v2, v4
    v_and_b32 v5, 3, v3
    v_lshlrev_b32 v5, 2, v5
    v_xor_b32 v4, v4, v5
    v_lshlrev_b32 v4, 4, v4
    s_mov_b32 s47, 1280
    v_mad_u32_u24 v13, v3, s47, v4
    s_mul_i32 s46, s40, 256
    s_add_u32 s46, s46, 128
    v_add_u32 v2, s46, v1
    v_lshrrev_b32 v3, 4, v2
    s_mov_b32 s47, 16
    v_mul_u32_u24 v4, s47, v3
    v_sub_u32 v4, v2, v4
    v_and_b32 v5, 3, v3
    v_lshlrev_b32 v5, 2, v5
    v_xor_b32 v4, v4, v5
    v_lshlrev_b32 v4, 4, v4
    s_mov_b32 s47, 1280
    v_mad_u32_u24 v14, v3, s47, v4
    s_mul_i32 s46, s40, 256
    s_add_u32 s46, s46, 192
    v_add_u32 v2, s46, v1
    v_lshrrev_b32 v3, 4, v2
    s_mov_b32 s47, 16
    v_mul_u32_u24 v4, s47, v3
    v_sub_u32 v4, v2, v4
    v_and_b32 v5, 3, v3
    v_lshlrev_b32 v5, 2, v5
    v_xor_b32 v4, v4, v5
    v_lshlrev_b32 v4, 4, v4
    s_mov_b32 s47, 1280
    v_mad_u32_u24 v15, v3, s47, v4
    s_waitcnt lgkmcnt(0)
    s_add_u32 s8, s70, 27787264
    s_addc_u32 s9, s71, 0
    s_mov_b32 s10, 3145728
    s_mov_b32 s11, 0x00020000
    s_mov_b32 s12, s64
    s_mov_b32 s13, s65
    s_mov_b32 s14, 983040
    s_mov_b32 s15, 0x00020000
    s_add_u32 m0, s43, 0
    s_nop 0
    buffer_load_dwordx4 v10, s[8:11], s41 offen lds
    s_add_u32 m0, s43, 1024
    s_nop 0
    buffer_load_dwordx4 v11, s[8:11], s41 offen lds
    s_add_u32 m0, s44, 0
    s_nop 0
    buffer_load_dwordx4 v12, s[12:15], s42 offen lds
    s_add_u32 m0, s44, 1024
    s_nop 0
    buffer_load_dwordx4 v13, s[12:15], s42 offen lds
    s_add_u32 m0, s44, 2048
    s_nop 0
    buffer_load_dwordx4 v14, s[12:15], s42 offen lds
    s_add_u32 m0, s44, 3072
    s_nop 0
    buffer_load_dwordx4 v15, s[12:15], s42 offen lds
    s_add_u32 s41, s41, 128
    s_add_u32 s42, s42, 81920
    s_add_u32 m0, s43, 8192
    s_nop 0
    buffer_load_dwordx4 v10, s[8:11], s41 offen lds
    s_add_u32 m0, s43, 9216
    s_nop 0
    buffer_load_dwordx4 v11, s[8:11], s41 offen lds
    s_add_u32 m0, s44, 16384
    s_nop 0
    buffer_load_dwordx4 v12, s[12:15], s42 offen lds
    s_add_u32 m0, s44, 17408
    s_nop 0
    buffer_load_dwordx4 v13, s[12:15], s42 offen lds
    s_add_u32 m0, s44, 18432
    s_nop 0
    buffer_load_dwordx4 v14, s[12:15], s42 offen lds
    s_add_u32 m0, s44, 19456
    s_nop 0
    buffer_load_dwordx4 v15, s[12:15], s42 offen lds
    s_add_u32 s41, s41, 128
    s_add_u32 s42, s42, 81920
    s_add_u32 m0, s43, 16384
    s_nop 0
    buffer_load_dwordx4 v10, s[8:11], s41 offen lds
    s_add_u32 m0, s43, 17408
    s_nop 0
    buffer_load_dwordx4 v11, s[8:11], s41 offen lds
    s_add_u32 m0, s44, 32768
    s_nop 0
    buffer_load_dwordx4 v12, s[12:15], s42 offen lds
    s_add_u32 m0, s44, 33792
    s_nop 0
    buffer_load_dwordx4 v13, s[12:15], s42 offen lds
    s_add_u32 m0, s44, 34816
    s_nop 0
    buffer_load_dwordx4 v14, s[12:15], s42 offen lds
    s_add_u32 m0, s44, 35840
    s_nop 0
    buffer_load_dwordx4 v15, s[12:15], s42 offen lds
    s_add_u32 s41, s41, 128
    s_add_u32 s42, s42, 81920
    s_mov_b32 s45, 2
g5a_kernel_ploop4:
    s_waitcnt vmcnt(12)
    s_barrier
    s_add_u32 m0, s43, 24576
    s_nop 0
    buffer_load_dwordx4 v10, s[8:11], s41 offen lds
    s_add_u32 m0, s43, 25600
    s_nop 0
    buffer_load_dwordx4 v11, s[8:11], s41 offen lds
    s_add_u32 m0, s44, 49152
    s_nop 0
    buffer_load_dwordx4 v12, s[12:15], s42 offen lds
    s_add_u32 m0, s44, 50176
    s_nop 0
    buffer_load_dwordx4 v13, s[12:15], s42 offen lds
    s_add_u32 m0, s44, 51200
    s_nop 0
    buffer_load_dwordx4 v14, s[12:15], s42 offen lds
    s_add_u32 m0, s44, 52224
    s_nop 0
    buffer_load_dwordx4 v15, s[12:15], s42 offen lds
    s_add_u32 s41, s41, 128
    s_add_u32 s42, s42, 81920
    s_waitcnt vmcnt(12)
    s_barrier
    s_add_u32 m0, s43, 0
    s_nop 0
    buffer_load_dwordx4 v10, s[8:11], s41 offen lds
    s_add_u32 m0, s43, 1024
    s_nop 0
    buffer_load_dwordx4 v11, s[8:11], s41 offen lds
    s_add_u32 m0, s44, 0
    s_nop 0
    buffer_load_dwordx4 v12, s[12:15], s42 offen lds
    s_add_u32 m0, s44, 1024
    s_nop 0
    buffer_load_dwordx4 v13, s[12:15], s42 offen lds
    s_add_u32 m0, s44, 2048
    s_nop 0
    buffer_load_dwordx4 v14, s[12:15], s42 offen lds
    s_add_u32 m0, s44, 3072
    s_nop 0
    buffer_load_dwordx4 v15, s[12:15], s42 offen lds
    s_add_u32 s41, s41, 128
    s_add_u32 s42, s42, 81920
    s_waitcnt vmcnt(12)
    s_barrier
    s_add_u32 m0, s43, 8192
    s_nop 0
    buffer_load_dwordx4 v10, s[8:11], s41 offen lds
    s_add_u32 m0, s43, 9216
    s_nop 0
    buffer_load_dwordx4 v11, s[8:11], s41 offen lds
    s_add_u32 m0, s44, 16384
    s_nop 0
    buffer_load_dwordx4 v12, s[12:15], s42 offen lds
    s_add_u32 m0, s44, 17408
    s_nop 0
    buffer_load_dwordx4 v13, s[12:15], s42 offen lds
    s_add_u32 m0, s44, 18432
    s_nop 0
    buffer_load_dwordx4 v14, s[12:15], s42 offen lds
    s_add_u32 m0, s44, 19456
    s_nop 0
    buffer_load_dwordx4 v15, s[12:15], s42 offen lds
    s_add_u32 s41, s41, 128
    s_add_u32 s42, s42, 81920
    s_waitcnt vmcnt(12)
    s_barrier
    s_add_u32 m0, s43, 16384
    s_nop 0
    buffer_load_dwordx4 v10, s[8:11], s41 offen lds
    s_add_u32 m0, s43, 17408
    s_nop 0
    buffer_load_dwordx4 v11, s[8:11], s41 offen lds
    s_add_u32 m0, s44, 32768
    s_nop 0
    buffer_load_dwordx4 v12, s[12:15], s42 offen lds
    s_add_u32 m0, s44, 33792
    s_nop 0
    buffer_load_dwordx4 v13, s[12:15], s42 offen lds
    s_add_u32 m0, s44, 34816
    s_nop 0
    buffer_load_dwordx4 v14, s[12:15], s42 offen lds
    s_add_u32 m0, s44, 35840
    s_nop 0
    buffer_load_dwordx4 v15, s[12:15], s42 offen lds
    s_add_u32 s41, s41, 128
    s_add_u32 s42, s42, 81920
    s_sub_u32 s45, s45, 1
    s_cmp_lg_u32 s45, 0
    s_cbranch_scc1 g5a_kernel_ploop4
    s_waitcnt vmcnt(12)
    s_barrier
    s_add_u32 m0, s43, 24576
    s_nop 0
    buffer_load_dwordx4 v10, s[8:11], s41 offen lds
    s_add_u32 m0, s43, 25600
    s_nop 0
    buffer_load_dwordx4 v11, s[8:11], s41 offen lds
    s_add_u32 m0, s44, 49152
    s_nop 0
    buffer_load_dwordx4 v12, s[12:15], s42 offen lds
    s_add_u32 m0, s44, 50176
    s_nop 0
    buffer_load_dwordx4 v13, s[12:15], s42 offen lds
    s_add_u32 m0, s44, 51200
    s_nop 0
    buffer_load_dwordx4 v14, s[12:15], s42 offen lds
    s_add_u32 m0, s44, 52224
    s_nop 0
    buffer_load_dwordx4 v15, s[12:15], s42 offen lds
    s_add_u32 s41, s41, 128
    s_add_u32 s42, s42, 81920
    s_waitcnt vmcnt(12)
    s_barrier
    s_waitcnt vmcnt(6)
    s_barrier
    s_waitcnt vmcnt(0)
    s_barrier
    s_endpgm
g5a_kernel_cons3:
    s_waitcnt lgkmcnt(0)
    s_add_u32 s16, s70, 13107200
    s_addc_u32 s17, s71, 0
    s_mov_b32 s18, 2621440
    s_mov_b32 s19, 0x00020000
    s_lshr_b32 s72, s40, 1
    s_and_b32 s73, s40, 1
    s_mul_i32 s46, s72, 32
    v_and_b32 v2, 31, v1
    v_add_u32 v2, s46, v2
    v_lshrrev_b32 v3, 5, v1
    v_bfe_u32 v4, v2, 1, 3
    v_xor_b32 v3, v3, v4
    v_lshlrev_b32 v3, 4, v3
    v_lshl_add_u32 v16, v2, 7, v3
    v_xor_b32 v17, 32, v16
    v_xor_b32 v18, 64, v16
    v_xor_b32 v19, 96, v16
    s_mul_i32 s46, s73, 8
    s_add_u32 s46, s46, 0
    v_bfe_u32 v2, v1, 4, 1
    v_lshlrev_b32 v2, 1, v2
    v_bfe_u32 v3, v1, 1, 1
    v_add3_u32 v2, v2, v3, s46
    v_bfe_u32 v4, v1, 2, 2
    v_lshlrev_b32 v5, 2, v4
    v_xor_b32 v2, v2, v5
    v_lshlrev_b32 v2, 4, v2
    v_and_b32 v3, 1, v1
    v_lshl_add_u32 v2, v3, 3, v2
    v_lshrrev_b32 v3, 5, v1
    v_lshl_add_u32 v3, v3, 3, v4
    s_mov_b32 s47, 256
    v_mad_u32_u24 v2, v3, s47, v2
    v_add_u32 v20, 32768, v2
    s_mul_i32 s46, s73, 8
    s_add_u32 s46, s46, 4
    v_bfe_u32 v2, v1, 4, 1
    v_lshlrev_b32 v2, 1, v2
    v_bfe_u32 v3, v1, 1, 1
    v_add3_u32 v2, v2, v3, s46
    v_bfe_u32 v4, v1, 2, 2
    v_lshlrev_b32 v5, 2, v4
    v_xor_b32 v2, v2, v5
    v_lshlrev_b32 v2, 4, v2
    v_and_b32 v3, 1, v1
    v_lshl_add_u32 v2, v3, 3, v2
    v_lshrrev_b32 v3, 5, v1
    v_lshl_add_u32 v3, v3, 3, v4
    s_mov_b32 s47, 256
    v_mad_u32_u24 v2, v3, s47, v2
    v_add_u32 v21, 32768, v2
    s_mul_i32 s46, s72, 32
    v_and_b32 v2, 31, v1
    v_add_u32 v2, s46, v2
    s_mov_b32 s47, 272
    v_mul_u32_u24 v2, s47, v2
    s_mul_i32 s46, s73, 128
    v_lshrrev_b32 v3, 5, v1
    v_lshlrev_b32 v3, 3, v3
    v_add3_u32 v30, v2, v3, s46
    v_add_u32 v2, 0, v0
    v_lshrrev_b32 v6, 4, v2
    s_mov_b32 s46, 16
    v_mul_u32_u24 v7, s46, v6
    v_sub_u32 v7, v2, v7
    s_mov_b32 s46, 272
    v_mul_u32_u24 v26, s46, v6
    v_lshl_add_u32 v26, v7, 4, v26
    v_add_u32 v22, s38, v6
    s_mov_b32 s46, 1280
    v_mul_lo_u32 v22, v22, s46
    v_lshl_add_u32 v22, v7, 4, v22
    s_lshl_b32 s46, s39, 1
    v_add_u32 v22, s46, v22
    v_add_u32 v2, 256, v0
    v_lshrrev_b32 v6, 4, v2
    s_mov_b32 s46, 16
    v_mul_u32_u24 v7, s46, v6
    v_sub_u32 v7, v2, v7
    s_mov_b32 s46, 272
    v_mul_u32_u24 v27, s46, v6
    v_lshl_add_u32 v27, v7, 4, v27
    v_add_u32 v23, s38, v6
    s_mov_b32 s46, 1280
    v_mul_lo_u32 v23, v23, s46
    v_lshl_add_u32 v23, v7, 4, v23
    s_lshl_b32 s46, s39, 1
    v_add_u32 v23, s46, v23
    v_add_u32 v2, 512, v0
    v_lshrrev_b32 v6, 4, v2
    s_mov_b32 s46, 16
    v_mul_u32_u24 v7, s46, v6
    v_sub_u32 v7, v2, v7
    s_mov_b32 s46, 272
    v_mul_u32_u24 v28, s46, v6
    v_lshl_add_u32 v28, v7, 4, v28
    v_add_u32 v24, s38, v6
    s_mov_b32 s46, 1280
    v_mul_lo_u32 v24, v24, s46
    v_lshl_add_u32 v24, v7, 4, v24
    s_lshl_b32 s46, s39, 1
    v_add_u32 v24, s46, v24
    v_add_u32 v2, 768, v0
    v_lshrrev_b32 v6, 4, v2
    s_mov_b32 s46, 16
    v_mul_u32_u24 v7, s46, v6
    v_sub_u32 v7, v2, v7
    s_mov_b32 s46, 272
    v_mul_u32_u24 v29, s46, v6
    v_lshl_add_u32 v29, v7, 4, v29
    v_add_u32 v25, s38, v6
    s_mov_b32 s46, 1280
    v_mul_lo_u32 v25, v25, s46
    v_lshl_add_u32 v25, v7, 4, v25
    s_lshl_b32 s46, s39, 1
    v_add_u32 v25, s46, v25
    v_mov_b32 v64, 0
    v_mov_b32 v65, 0
    v_mov_b32 v66, 0
    v_mov_b32 v67, 0
    v_mov_b32 v68, 0
    v_mov_b32 v69, 0
    v_mov_b32 v70, 0
    v_mov_b32 v71, 0
    v_mov_b32 v72, 0
    v_mov_b32 v73, 0
    v_mov_b32 v74, 0
    v_mov_b32 v75, 0
    v_mov_b32 v76, 0
    v_mov_b32 v77, 0
    v_mov_b32 v78, 0
    v_mov_b32 v79, 0
    v_mov_b32 v80, 0
    v_mov_b32 v81, 0
    v_mov_b32 v82, 0
    v_mov_b32 v83, 0
    v_mov_b32 v84, 0
    v_mov_b32 v85, 0
    v_mov_b32 v86, 0
    v_mov_b32 v87, 0
    v_mov_b32 v88, 0
    v_mov_b32 v89, 0
    v_mov_b32 v90, 0
    v_mov_b32 v91, 0
    v_mov_b32 v92, 0
    v_mov_b32 v93, 0
    v_mov_b32 v94, 0
    v_mov_b32 v95, 0
    s_mov_b32 s45, 2
g5a_kernel_loop5:
    s_barrier
    ds_read_b128 v[32:35], v16 offset:0
    ds_read_b64_tr_b16 v[36:37], v20 offset:0
    ds_read_b64_tr_b16 v[38:39], v20 offset:1024
    ds_read_b64_tr_b16 v[40:41], v21 offset:0
    ds_read_b64_tr_b16 v[42:43], v21 offset:1024
    ds_read_b128 v[44:47], v17 offset:0
    ds_read_b64_tr_b16 v[48:49], v20 offset:4096
    ds_read_b64_tr_b16 v[50:51], v20 offset:5120
    ds_read_b64_tr_b16 v[52:53], v21 offset:4096
    ds_read_b64_tr_b16 v[54:55], v21 offset:5120
    s_waitcnt lgkmcnt(5)
    v_mfma_f32_32x32x16_bf16 v[64:79], v[36:39], v[32:35], v[64:79]
    v_mfma_f32_32x32x16_bf16 v[80:95], v[40:43], v[32:35], v[80:95]
    ds_read_b128 v[32:35], v18 offset:0
    ds_read_b64_tr_b16 v[36:37], v20 offset:8192
    ds_read_b64_tr_b16 v[38:39], v20 offset:9216
    ds_read_b64_tr_b16 v[40:41], v21 offset:8192
    ds_read_b64_tr_b16 v[42:43], v21 offset:9216
    s_waitcnt lgkmcnt(5)
    v_mfma_f32_32x32x16_bf16 v[64:79], v[48:51], v[44:47], v[64:79]
    v_mfma_f32_32x32x16_bf16 v[80:95], v[52:55], v[44:47], v[80:95]
    ds_read_b128 v[44:47], v19 offset:0
    ds_read_b64_tr_b16 v[48:49], v20 offset:12288
    ds_read_b64_tr_b16 v[50:51], v20 offset:13312
    ds_read_b64_tr_b16 v[52:53], v21 offset:12288
    ds_read_b64_tr_b16 v[54:55], v21 offset:13312
    s_waitcnt lgkmcnt(5)
    v_mfma_f32_32x32x16_bf16 v[64:79], v[36:39], v[32:35], v[64:79]
    v_mfma_f32_32x32x16_bf16 v[80:95], v[40:43], v[32:35], v[80:95]
    s_waitcnt lgkmcnt(0)
    v_mfma_f32_32x32x16_bf16 v[64:79], v[48:51], v[44:47], v[64:79]
    v_mfma_f32_32x32x16_bf16 v[80:95], v[52:55], v[44:47], v[80:95]
    s_barrier
    ds_read_b128 v[32:35], v16 offset:8192
    ds_read_b64_tr_b16 v[36:37], v20 offset:16384
    ds_read_b64_tr_b16 v[38:39], v20 offset:17408
    ds_read_b64_tr_b16 v[40:41], v21 offset:16384
    ds_read_b64_tr_b16 v[42:43], v21 offset:17408
    ds_read_b128 v[44:47], v17 offset:8192
    ds_read_b64_tr_b16 v[48:49], v20 offset:20480
    ds_read_b64_tr_b16 v[50:51], v20 offset:21504
    ds_read_b64_tr_b16 v[52:53], v21 offset:20480
    ds_read_b64_tr_b16 v[54:55], v21 offset:21504
    s_waitcnt lgkmcnt(5)
    v_mfma_f32_32x32x16_bf16 v[64:79], v[36:39], v[32:35], v[64:79]
    v_mfma_f32_32x32x16_bf16 v[80:95], v[40:43], v[32:35], v[80:95]
    ds_read_b128 v[32:35], v18 offset:8192
    ds_read_b64_tr_b16 v[36:37], v20 offset:24576
    ds_read_b64_tr_b16 v[38:39], v20 offset:25600
    ds_read_b64_tr_b16 v[40:41], v21 offset:24576
    ds_read_b64_tr_b16 v[42:43], v21 offset:25600
    s_waitcnt lgkmcnt(5)
    v_mfma_f32_32x32x16_bf16 v[64:79], v[48:51], v[44:47], v[64:79]
    v_mfma_f32_32x32x16_bf16 v[80:95], v[52:55], v[44:47], v[80:95]
    ds_read_b128 v[44:47], v19 offset:8192
    ds_read_b64_tr_b16 v[48:49], v20 offset:28672
    ds_read_b64_tr_b16 v[50:51], v20 offset:29696
    ds_read_b64_tr_b16 v[52:53], v21 offset:28672
    ds_read_b64_tr_b16 v[54:55], v21 offset:29696
    s_waitcnt lgkmcnt(5)
    v_mfma_f32_32x32x16_bf16 v[64:79], v[36:39], v[32:35], v[64:79]
    v_mfma_f32_32x32x16_bf16 v[80:95], v[40:43], v[32:35], v[80:95]
    s_waitcnt lgkmcnt(0)
    v_mfma_f32_32x32x16_bf16 v[64:79], v[48:51], v[44:47], v[64:79]
    v_mfma_f32_32x32x16_bf16 v[80:95], v[52:55], v[44:47], v[80:95]
    s_barrier
    ds_read_b128 v[32:35], v16 offset:16384
    ds_read_b64_tr_b16 v[36:37], v20 offset:32768
    ds_read_b64_tr_b16 v[38:39], v20 offset:33792
    ds_read_b64_tr_b16 v[40:41], v21 offset:32768
    ds_read_b64_tr_b16 v[42:43], v21 offset:33792
    ds_read_b128 v[44:47], v17 offset:16384
    ds_read_b64_tr_b16 v[48:49], v20 offset:36864
    ds_read_b64_tr_b16 v[50:51], v20 offset:37888
    ds_read_b64_tr_b16 v[52:53], v21 offset:36864
    ds_read_b64_tr_b16 v[54:55], v21 offset:37888
    s_waitcnt lgkmcnt(5)
    v_mfma_f32_32x32x16_bf16 v[64:79], v[36:39], v[32:35], v[64:79]
    v_mfma_f32_32x32x16_bf16 v[80:95], v[40:43], v[32:35], v[80:95]
    ds_read_b128 v[32:35], v18 offset:16384
    ds_read_b64_tr_b16 v[36:37], v20 offset:40960
    ds_read_b64_tr_b16 v[38:39], v20 offset:41984
    ds_read_b64_tr_b16 v[40:41], v21 offset:40960
    ds_read_b64_tr_b16 v[42:43], v21 offset:41984
    s_waitcnt lgkmcnt(5)
    v_mfma_f32_32x32x16_bf16 v[64:79], v[48:51], v[44:47], v[64:79]
    v_mfma_f32_32x32x16_bf16 v[80:95], v[52:55], v[44:47], v[80:95]
    ds_read_b128 v[44:47], v19 offset:16384
    ds_read_b64_tr_b16 v[48:49], v20 offset:45056
    ds_read_b64_tr_b16 v[50:51], v20 offset:46080
    ds_read_b64_tr_b16 v[52:53], v21 offset:45056
    ds_read_b64_tr_b16 v[54:55], v21 offset:46080
    s_waitcnt lgkmcnt(5)
    v_mfma_f32_32x32x16_bf16 v[64:79], v[36:39], v[32:35], v[64:79]
    v_mfma_f32_32x32x16_bf16 v[80:95], v[40:43], v[32:35], v[80:95]
    s_waitcnt lgkmcnt(0)
    v_mfma_f32_32x32x16_bf16 v[64:79], v[48:51], v[44:47], v[64:79]
    v_mfma_f32_32x32x16_bf16 v[80:95], v[52:55], v[44:47], v[80:95]
    s_barrier
    ds_read_b128 v[32:35], v16 offset:24576
    ds_read_b64_tr_b16 v[36:37], v20 offset:49152
    ds_read_b64_tr_b16 v[38:39], v20 offset:50176
    ds_read_b64_tr_b16 v[40:41], v21 offset:49152
    ds_read_b64_tr_b16 v[42:43], v21 offset:50176
    ds_read_b128 v[44:47], v17 offset:24576
    ds_read_b64_tr_b16 v[48:49], v20 offset:53248
    ds_read_b64_tr_b16 v[50:51], v20 offset:54272
    ds_read_b64_tr_b16 v[52:53], v21 offset:53248
    ds_read_b64_tr_b16 v[54:55], v21 offset:54272
    s_waitcnt lgkmcnt(5)
    v_mfma_f32_32x32x16_bf16 v[64:79], v[36:39], v[32:35], v[64:79]
    v_mfma_f32_32x32x16_bf16 v[80:95], v[40:43], v[32:35], v[80:95]
    ds_read_b128 v[32:35], v18 offset:24576
    ds_read_b64_tr_b16 v[36:37], v20 offset:57344
    ds_read_b64_tr_b16 v[38:39], v20 offset:58368
    ds_read_b64_tr_b16 v[40:41], v21 offset:57344
    ds_read_b64_tr_b16 v[42:43], v21 offset:58368
    s_waitcnt lgkmcnt(5)
    v_mfma_f32_32x32x16_bf16 v[64:79], v[48:51], v[44:47], v[64:79]
    v_mfma_f32_32x32x16_bf16 v[80:95], v[52:55], v[44:47], v[80:95]
    ds_read_b128 v[44:47], v19 offset:24576
    ds_read_b64_tr_b16 v[48:49], v20 offset:61440
    ds_read_b64_tr_b16 v[50:51], v20 offset:62464
    ds_read_b64_tr_b16 v[52:53], v21 offset:61440
    ds_read_b64_tr_b16 v[54:55], v21 offset:62464
    s_waitcnt lgkmcnt(5)
    v_mfma_f32_32x32x16_bf16 v[64:79], v[36:39], v[32:35], v[64:79]
    v_mfma_f32_32x32x16_bf16 v[80:95], v[40:43], v[32:35], v[80:95]
    s_waitcnt lgkmcnt(0)
    v_mfma_f32_32x32x16_bf16 v[64:79], v[48:51], v[44:47], v[64:79]
    v_mfma_f32_32x32x16_bf16 v[80:95], v[52:55], v[44:47], v[80:95]
    s_sub_u32 s45, s45, 1
    s_cmp_lg_u32 s45, 0
    s_cbranch_scc1 g5a_kernel_loop5
    s_barrier
    ds_read_b128 v[32:35], v16 offset:0
    ds_read_b64_tr_b16 v[36:37], v20 offset:0
    ds_read_b64_tr_b16 v[38:39], v20 offset:1024
    ds_read_b64_tr_b16 v[40:41], v21 offset:0
    ds_read_b64_tr_b16 v[42:43], v21 offset:1024
    ds_read_b128 v[44:47], v17 offset:0
    ds_read_b64_tr_b16 v[48:49], v20 offset:4096
    ds_read_b64_tr_b16 v[50:51], v20 offset:5120
    ds_read_b64_tr_b16 v[52:53], v21 offset:4096
    ds_read_b64_tr_b16 v[54:55], v21 offset:5120
    s_waitcnt lgkmcnt(5)
    v_mfma_f32_32x32x16_bf16 v[64:79], v[36:39], v[32:35], v[64:79]
    v_mfma_f32_32x32x16_bf16 v[80:95], v[40:43], v[32:35], v[80:95]
    ds_read_b128 v[32:35], v18 offset:0
    ds_read_b64_tr_b16 v[36:37], v20 offset:8192
    ds_read_b64_tr_b16 v[38:39], v20 offset:9216
    ds_read_b64_tr_b16 v[40:41], v21 offset:8192
    ds_read_b64_tr_b16 v[42:43], v21 offset:9216
    s_waitcnt lgkmcnt(5)
    v_mfma_f32_32x32x16_bf16 v[64:79], v[48:51], v[44:47], v[64:79]
    v_mfma_f32_32x32x16_bf16 v[80:95], v[52:55], v[44:47], v[80:95]
    ds_read_b128 v[44:47], v19 offset:0
    ds_read_b64_tr_b16 v[48:49], v20 offset:12288
    ds_read_b64_tr_b16 v[50:51], v20 offset:13312
    ds_read_b64_tr_b16 v[52:53], v21 offset:12288
    ds_read_b64_tr_b16 v[54:55], v21 offset:13312
    s_waitcnt lgkmcnt(5)
    v_mfma_f32_32x32x16_bf16 v[64:79], v[36:39], v[32:35], v[64:79]
    v_mfma_f32_32x32x16_bf16 v[80:95], v[40:43], v[32:35], v[80:95]
    s_waitcnt lgkmcnt(0)
    v_mfma_f32_32x32x16_bf16 v[64:79], v[48:51], v[44:47], v[64:79]
    v_mfma_f32_32x32x16_bf16 v[80:95], v[52:55], v[44:47], v[80:95]
    s_add_u32 s20, s70, 10485760
    s_addc_u32 s21, s71, 0
    s_mov_b32 s22, 2621440
    s_mov_b32 s23, 0x00020000
    buffer_load_dwordx4 v[100:103], v22, s[20:23], 0 offen
    buffer_load_dwordx4 v[104:107], v23, s[20:23], 0 offen
    buffer_load_dwordx4 v[108:111], v24, s[20:23], 0 offen
    buffer_load_dwordx4 v[112:115], v25, s[20:23], 0 offen
    s_barrier
    ds_read_b128 v[32:35], v16 offset:8192
    ds_read_b64_tr_b16 v[36:37], v20 offset:16384
    ds_read_b64_tr_b16 v[38:39], v20 offset:17408
    ds_read_b64_tr_b16 v[40:41], v21 offset:16384
    ds_read_b64_tr_b16 v[42:43], v21 offset:17408
    ds_read_b128 v[44:47], v17 offset:8192
    ds_read_b64_tr_b16 v[48:49], v20 offset:20480
    ds_read_b64_tr_b16 v[50:51], v20 offset:21504
    ds_read_b64_tr_b16 v[52:53], v21 offset:20480
    ds_read_b64_tr_b16 v[54:55], v21 offset:21504
    s_waitcnt lgkmcnt(5)
    v_mfma_f32_32x32x16_bf16 v[64:79], v[36:39], v[32:35], v[64:79]
    v_mfma_f32_32x32x16_bf16 v[80:95], v[40:43], v[32:35], v[80:95]
    ds_read_b128 v[32:35], v18 offset:8192
    ds_read_b64_tr_b16 v[36:37], v20 offset:24576
    ds_read_b64_tr_b16 v[38:39], v20 offset:25600
    ds_read_b64_tr_b16 v[40:41], v21 offset:24576
    ds_read_b64_tr_b16 v[42:43], v21 offset:25600
    s_waitcnt lgkmcnt(5)
    v_mfma_f32_32x32x16_bf16 v[64:79], v[48:51], v[44:47], v[64:79]
    v_mfma_f32_32x32x16_bf16 v[80:95], v[52:55], v[44:47], v[80:95]
    ds_read_b128 v[44:47], v19 offset:8192
    ds_read_b64_tr_b16 v[48:49], v20 offset:28672
    ds_read_b64_tr_b16 v[50:51], v20 offset:29696
    ds_read_b64_tr_b16 v[52:53], v21 offset:28672
    ds_read_b64_tr_b16 v[54:55], v21 offset:29696
    s_waitcnt lgkmcnt(5)
    v_mfma_f32_32x32x16_bf16 v[64:79], v[36:39], v[32:35], v[64:79]
    v_mfma_f32_32x32x16_bf16 v[80:95], v[40:43], v[32:35], v[80:95]
    s_waitcnt lgkmcnt(0)
    v_mfma_f32_32x32x16_bf16 v[64:79], v[48:51], v[44:47], v[64:79]
    v_mfma_f32_32x32x16_bf16 v[80:95], v[52:55], v[44:47], v[80:95]
    s_barrier
    ds_read_b128 v[32:35], v16 offset:16384
    ds_read_b64_tr_b16 v[36:37], v20 offset:32768
    ds_read_b64_tr_b16 v[38:39], v20 offset:33792
    ds_read_b64_tr_b16 v[40:41], v21 offset:32768
    ds_read_b64_tr_b16 v[42:43], v21 offset:33792
    ds_read_b128 v[44:47], v17 offset:16384
    ds_read_b64_tr_b16 v[48:49], v20 offset:36864
    ds_read_b64_tr_b16 v[50:51], v20 offset:37888
    ds_read_b64_tr_b16 v[52:53], v21 offset:36864
    ds_read_b64_tr_b16 v[54:55], v21 offset:37888
    s_waitcnt lgkmcnt(5)
    v_mfma_f32_32x32x16_bf16 v[64:79], v[36:39], v[32:35], v[64:79]
    v_mfma_f32_32x32x16_bf16 v[80:95], v[40:43], v[32:35], v[80:95]
    ds_read_b128 v[32:35], v18 offset:16384
    ds_read_b64_tr_b16 v[36:37], v20 offset:40960
    ds_read_b64_tr_b16 v[38:39], v20 offset:41984
    ds_read_b64_tr_b16 v[40:41], v21 offset:40960
    ds_read_b64_tr_b16 v[42:43], v21 offset:41984
    s_waitcnt lgkmcnt(5)
    v_mfma_f32_32x32x16_bf16 v[64:79], v[48:51], v[44:47], v[64:79]
    v_mfma_f32_32x32x16_bf16 v[80:95], v[52:55], v[44:47], v[80:95]
    ds_read_b128 v[44:47], v19 offset:16384
    ds_read_b64_tr_b16 v[48:49], v20 offset:45056
    ds_read_b64_tr_b16 v[50:51], v20 offset:46080
    ds_read_b64_tr_b16 v[52:53], v21 offset:45056
    ds_read_b64_tr_b16 v[54:55], v21 offset:46080
    s_waitcnt lgkmcnt(5)
    v_mfma_f32_32x32x16_bf16 v[64:79], v[36:39], v[32:35], v[64:79]
    v_mfma_f32_32x32x16_bf16 v[80:95], v[40:43], v[32:35], v[80:95]
    s_waitcnt lgkmcnt(0)
    v_mfma_f32_32x32x16_bf16 v[64:79], v[48:51], v[44:47], v[64:79]
    v_mfma_f32_32x32x16_bf16 v[80:95], v[52:55], v[44:47], v[80:95]
    s_barrier
    ds_read_b128 v[32:35], v16 offset:24576
    ds_read_b64_tr_b16 v[36:37], v20 offset:49152
    ds_read_b64_tr_b16 v[38:39], v20 offset:50176
    ds_read_b64_tr_b16 v[40:41], v21 offset:49152
    ds_read_b64_tr_b16 v[42:43], v21 offset:50176
    ds_read_b128 v[44:47], v17 offset:24576
    ds_read_b64_tr_b16 v[48:49], v20 offset:53248
    ds_read_b64_tr_b16 v[50:51], v20 offset:54272
    ds_read_b64_tr_b16 v[52:53], v21 offset:53248
    ds_read_b64_tr_b16 v[54:55], v21 offset:54272
    s_waitcnt lgkmcnt(5)
    v_mfma_f32_32x32x16_bf16 v[64:79], v[36:39], v[32:35], v[64:79]
    v_mfma_f32_32x32x16_bf16 v[80:95], v[40:43], v[32:35], v[80:95]
    ds_read_b128 v[32:35], v18 offset:24576
    ds_read_b64_tr_b16 v[36:37], v20 offset:57344
    ds_read_b64_tr_b16 v[38:39], v20 offset:58368
    ds_read_b64_tr_b16 v[40:41], v21 offset:57344
    ds_read_b64_tr_b16 v[42:43], v21 offset:58368
    s_waitcnt lgkmcnt(5)
    v_mfma_f32_32x32x16_bf16 v[64:79], v[48:51], v[44:47], v[64:79]
    v_mfma_f32_32x32x16_bf16 v[80:95], v[52:55], v[44:47], v[80:95]
    ds_read_b128 v[44:47], v19 offset:24576
    ds_read_b64_tr_b16 v[48:49], v20 offset:61440
    ds_read_b64_tr_b16 v[50:51], v20 offset:62464
    ds_read_b64_tr_b16 v[52:53], v21 offset:61440
    ds_read_b64_tr_b16 v[54:55], v21 offset:62464
    s_waitcnt lgkmcnt(5)
    v_mfma_f32_32x32x16_bf16 v[64:79], v[36:39], v[32:35], v[64:79]
    v_mfma_f32_32x32x16_bf16 v[80:95], v[40:43], v[32:35], v[80:95]
    s_waitcnt lgkmcnt(0)
    v_mfma_f32_32x32x16_bf16 v[64:79], v[48:51], v[44:47], v[64:79]
    v_mfma_f32_32x32x16_bf16 v[80:95], v[52:55], v[44:47], v[80:95]
    s_barrier
    s_nop 15
    v_cvt_pk_bf16_f32 v124, v64, v65
    v_cvt_pk_bf16_f32 v125, v66, v67
    ds_write_b64 v30, v[124:125] offset:0
    v_cvt_pk_bf16_f32 v124, v68, v69
    v_cvt_pk_bf16_f32 v125, v70, v71
    ds_write_b64 v30, v[124:125] offset:16
    v_cvt_pk_bf16_f32 v124, v72, v73
    v_cvt_pk_bf16_f32 v125, v74, v75
    ds_write_b64 v30, v[124:125] offset:32
    v_cvt_pk_bf16_f32 v124, v76, v77
    v_cvt_pk_bf16_f32 v125, v78, v79
    ds_write_b64 v30, v[124:125] offset:48
    v_cvt_pk_bf16_f32 v124, v80, v81
    v_cvt_pk_bf16_f32 v125, v82, v83
    ds_write_b64 v30, v[124:125] offset:64
    v_cvt_pk_bf16_f32 v124, v84, v85
    v_cvt_pk_bf16_f32 v125, v86, v87
    ds_write_b64 v30, v[124:125] offset:80
    v_cvt_pk_bf16_f32 v124, v88, v89
    v_cvt_pk_bf16_f32 v125, v90, v91
    ds_write_b64 v30, v[124:125] offset:96
    v_cvt_pk_bf16_f32 v124, v92, v93
    v_cvt_pk_bf16_f32 v125, v94, v95
    ds_write_b64 v30, v[124:125] offset:112
    s_waitcnt lgkmcnt(0)
    s_barrier
    ds_read_b128 v[64:67], v26
    ds_read_b128 v[68:71], v27
    ds_read_b128 v[72:75], v28
    ds_read_b128 v[76:79], v29
    s_add_u32 s28, s70, 31096832
    s_addc_u32 s29, s71, 0
    s_mov_b32 s30, 81920
    s_mov_b32 s31, 0x00020000
    s_waitcnt vmcnt(0)
    s_waitcnt lgkmcnt(3)
    v_lshlrev_b32 v116, 16, v64
    v_and_b32 v117, 0xffff0000, v64
    v_lshlrev_b32 v124, 16, v100
    v_and_b32 v125, 0xffff0000, v100
    v_lshlrev_b32 v118, 16, v65
    v_and_b32 v119, 0xffff0000, v65
    v_lshlrev_b32 v126, 16, v101
    v_and_b32 v127, 0xffff0000, v101
    v_lshlrev_b32 v120, 16, v66
    v_and_b32 v121, 0xffff0000, v66
    v_lshlrev_b32 v128, 16, v102
    v_and_b32 v129, 0xffff0000, v102
    v_lshlrev_b32 v122, 16, v67
    v_and_b32 v123, 0xffff0000, v67
    v_lshlrev_b32 v130, 16, v103
    v_and_b32 v131, 0xffff0000, v103
    v_add_f32 v116, v116, v124
    v_add_f32 v117, v117, v125
    v_add_f32 v118, v118, v126
    v_add_f32 v119, v119, v127
    v_add_f32 v120, v120, v128
    v_add_f32 v121, v121, v129
    v_add_f32 v122, v122, v130
    v_add_f32 v123, v123, v131
    v_cvt_pk_bf16_f32 v64, v116, v117
    v_cvt_pk_bf16_f32 v65, v118, v119
    v_cvt_pk_bf16_f32 v66, v120, v121
    v_cvt_pk_bf16_f32 v67, v122, v123
    buffer_store_dwordx4 v[64:67], v22, s[16:19], 0 offen
    v_lshlrev_b32 v116, 16, v64
    v_and_b32 v117, 0xffff0000, v64
    v_lshlrev_b32 v118, 16, v65
    v_and_b32 v119, 0xffff0000, v65
    v_lshlrev_b32 v120, 16, v66
    v_and_b32 v121, 0xffff0000, v66
    v_lshlrev_b32 v122, 16, v67
    v_and_b32 v123, 0xffff0000, v67
    v_add_f32 v100, v116, v117
    v_mul_f32 v101, v116, v116
    v_fmac_f32 v101, v117, v117
    v_add_f32 v100, v100, v118
    v_fmac_f32 v101, v118, v118
    v_add_f32 v100, v100, v119
    v_fmac_f32 v101, v119, v119
    v_add_f32 v100, v100, v120
    v_fmac_f32 v101, v120, v120
    v_add_f32 v100, v100, v121
    v_fmac_f32 v101, v121, v121
    v_add_f32 v100, v100, v122
    v_fmac_f32 v101, v122, v122
    v_add_f32 v100, v100, v123
    v_fmac_f32 v101, v123, v123
    s_waitcnt lgkmcnt(2)
    v_lshlrev_b32 v116, 16, v68
    v_and_b32 v117, 0xffff0000, v68
    v_lshlrev_b32 v124, 16, v104
    v_and_b32 v125, 0xffff0000, v104
    v_lshlrev_b32 v118, 16, v69
    v_and_b32 v119, 0xffff0000, v69
    v_lshlrev_b32 v126, 16, v105
    v_and_b32 v127, 0xffff0000, v105
    v_lshlrev_b32 v120, 16, v70
    v_and_b32 v121, 0xffff0000, v70
    v_lshlrev_b32 v128, 16, v106
    v_and_b32 v129, 0xffff0000, v106
    v_lshlrev_b32 v122, 16, v71
    v_and_b32 v123, 0xffff0000, v71
    v_lshlrev_b32 v130, 16, v107
    v_and_b32 v131, 0xffff0000, v107
    v_add_f32 v116, v116, v124
    v_add_f32 v117, v117, v125
    v_add_f32 v118, v118, v126
    v_add_f32 v119, v119, v127
    v_add_f32 v120, v120, v128
    v_add_f32 v121, v121, v129
    v_add_f32 v122, v122, v130
    v_add_f32 v123, v123, v131
    v_cvt_pk_bf16_f32 v68, v116, v117
    v_cvt_pk_bf16_f32 v69, v118, v119
    v_cvt_pk_bf16_f32 v70, v120, v121
    v_cvt_pk_bf16_f32 v71, v122, v123
    buffer_store_dwordx4 v[68:71], v23, s[16:19], 0 offen
    v_lshlrev_b32 v116, 16, v68
    v_and_b32 v117, 0xffff0000, v68
    v_lshlrev_b32 v118, 16, v69
    v_and_b32 v119, 0xffff0000, v69
    v_lshlrev_b32 v120, 16, v70
    v_and_b32 v121, 0xffff0000, v70
    v_lshlrev_b32 v122, 16, v71
    v_and_b32 v123, 0xffff0000, v71
    v_add_f32 v104, v116, v117
    v_mul_f32 v105, v116, v116
    v_fmac_f32 v105, v117, v117
    v_add_f32 v104, v104, v118
    v_fmac_f32 v105, v118, v118
    v_add_f32 v104, v104, v119
    v_fmac_f32 v105, v119, v119
    v_add_f32 v104, v104, v120
    v_fmac_f32 v105, v120, v120
    v_add_f32 v104, v104, v121
    v_fmac_f32 v105, v121, v121
    v_add_f32 v104, v104, v122
    v_fmac_f32 v105, v122, v122
    v_add_f32 v104, v104, v123
    v_fmac_f32 v105, v123, v123
    s_waitcnt lgkmcnt(1)
    v_lshlrev_b32 v116, 16, v72
    v_and_b32 v117, 0xffff0000, v72
    v_lshlrev_b32 v124, 16, v108
    v_and_b32 v125, 0xffff0000, v108
    v_lshlrev_b32 v118, 16, v73
    v_and_b32 v119, 0xffff0000, v73
    v_lshlrev_b32 v126, 16, v109
    v_and_b32 v127, 0xffff0000, v109
    v_lshlrev_b32 v120, 16, v74
    v_and_b32 v121, 0xffff0000, v74
    v_lshlrev_b32 v128, 16, v110
    v_and_b32 v129, 0xffff0000, v110
    v_lshlrev_b32 v122, 16, v75
    v_and_b32 v123, 0xffff0000, v75
    v_lshlrev_b32 v130, 16, v111
    v_and_b32 v131, 0xffff0000, v111
    v_add_f32 v116, v116, v124
    v_add_f32 v117, v117, v125
    v_add_f32 v118, v118, v126
    v_add_f32 v119, v119, v127
    v_add_f32 v120, v120, v128
    v_add_f32 v121, v121, v129
    v_add_f32 v122, v122, v130
    v_add_f32 v123, v123, v131
    v_cvt_pk_bf16_f32 v72, v116, v117
    v_cvt_pk_bf16_f32 v73, v118, v119
    v_cvt_pk_bf16_f32 v74, v120, v121
    v_cvt_pk_bf16_f32 v75, v122, v123
    buffer_store_dwordx4 v[72:75], v24, s[16:19], 0 offen
    v_lshlrev_b32 v116, 16, v72
    v_and_b32 v117, 0xffff0000, v72
    v_lshlrev_b32 v118, 16, v73
    v_and_b32 v119, 0xffff0000, v73
    v_lshlrev_b32 v120, 16, v74
    v_and_b32 v121, 0xffff0000, v74
    v_lshlrev_b32 v122, 16, v75
    v_and_b32 v123, 0xffff0000, v75
    v_add_f32 v108, v116, v117
    v_mul_f32 v109, v116, v116
    v_fmac_f32 v109, v117, v117
    v_add_f32 v108, v108, v118
    v_fmac_f32 v109, v118, v118
    v_add_f32 v108, v108, v119
    v_fmac_f32 v109, v119, v119
    v_add_f32 v108, v108, v120
    v_fmac_f32 v109, v120, v120
    v_add_f32 v108, v108, v121
    v_fmac_f32 v109, v121, v121
    v_add_f32 v108, v108, v122
    v_fmac_f32 v109, v122, v122
    v_add_f32 v108, v108, v123
    v_fmac_f32 v109, v123, v123
    s_waitcnt lgkmcnt(0)
    v_lshlrev_b32 v116, 16, v76
    v_and_b32 v117, 0xffff0000, v76
    v_lshlrev_b32 v124, 16, v112
    v_and_b32 v125, 0xffff0000, v112
    v_lshlrev_b32 v118, 16, v77
    v_and_b32 v119, 0xffff0000, v77
    v_lshlrev_b32 v126, 16, v113
    v_and_b32 v127, 0xffff0000, v113
    v_lshlrev_b32 v120, 16, v78
    v_and_b32 v121, 0xffff0000, v78
    v_lshlrev_b32 v128, 16, v114
    v_and_b32 v129, 0xffff0000, v114
    v_lshlrev_b32 v122, 16, v79
    v_and_b32 v123, 0xffff0000, v79
    v_lshlrev_b32 v130, 16, v115
    v_and_b32 v131, 0xffff0000, v115
    v_add_f32 v116, v116, v124
    v_add_f32 v117, v117, v125
    v_add_f32 v118, v118, v126
    v_add_f32 v119, v119, v127
    v_add_f32 v120, v120, v128
    v_add_f32 v121, v121, v129
    v_add_f32 v122, v122, v130
    v_add_f32 v123, v123, v131
    v_cvt_pk_bf16_f32 v76, v116, v117
    v_cvt_pk_bf16_f32 v77, v118, v119
    v_cvt_pk_bf16_f32 v78, v120, v121
    v_cvt_pk_bf16_f32 v79, v122, v123
    buffer_store_dwordx4 v[76:79], v25, s[16:19], 0 offen
    v_lshlrev_b32 v116, 16, v76
    v_and_b32 v117, 0xffff0000, v76
    v_lshlrev_b32 v118, 16, v77
    v_and_b32 v119, 0xffff0000, v77
    v_lshlrev_b32 v120, 16, v78
    v_and_b32 v121, 0xffff0000, v78
    v_lshlrev_b32 v122, 16, v79
    v_and_b32 v123, 0xffff0000, v79
    v_add_f32 v112, v116, v117
    v_mul_f32 v113, v116, v116
    v_fmac_f32 v113, v117, v117
    v_add_f32 v112, v112, v118
    v_fmac_f32 v113, v118, v118
    v_add_f32 v112, v112, v119
    v_fmac_f32 v113, v119, v119
    v_add_f32 v112, v112, v120
    v_fmac_f32 v113, v120, v120
    v_add_f32 v112, v112, v121
    v_fmac_f32 v113, v121, v121
    v_add_f32 v112, v112, v122
    v_fmac_f32 v113, v122, v122
    v_add_f32 v112, v112, v123
    v_fmac_f32 v113, v123, v123
    s_nop 1
    v_add_f32_dpp v100, v100, v100 row_ror:8 row_mask:0xf bank_mask:0xf
    v_add_f32_dpp v101, v101, v101 row_ror:8 row_mask:0xf bank_mask:0xf
    v_add_f32_dpp v104, v104, v104 row_ror:8 row_mask:0xf bank_mask:0xf
    v_add_f32_dpp v105, v105, v105 row_ror:8 row_mask:0xf bank_mask:0xf
    v_add_f32_dpp v108, v108, v108 row_ror:8 row_mask:0xf bank_mask:0xf
    v_add_f32_dpp v109, v109, v109 row_ror:8 row_mask:0xf bank_mask:0xf
    v_add_f32_dpp v112, v112, v112 row_ror:8 row_mask:0xf bank_mask:0xf
    v_add_f32_dpp v113, v113, v113 row_ror:8 row_mask:0xf bank_mask:0xf
    s_nop 1
    v_add_f32_dpp v100, v100, v100 row_ror:4 row_mask:0xf bank_mask:0xf
    v_add_f32_dpp v101, v101, v101 row_ror:4 row_mask:0xf bank_mask:0xf
    v_add_f32_dpp v104, v104, v104 row_ror:4 row_mask:0xf bank_mask:0xf
    v_add_f32_dpp v105, v105, v105 row_ror:4 row_mask:0xf bank_mask:0xf
    v_add_f32_dpp v108, v108, v108 row_ror:4 row_mask:0xf bank_mask:0xf
    v_add_f32_dpp v109, v109, v109 row_ror:4 row_mask:0xf bank_mask:0xf
    v_add_f32_dpp v112, v112, v112 row_ror:4 row_mask:0xf bank_mask:0xf
    v_add_f32_dpp v113, v113, v113 row_ror:4 row_mask:0xf bank_mask:0xf
    s_nop 1
    v_add_f32_dpp v100, v100, v100 row_ror:2 row_mask:0xf bank_mask:0xf
    v_add_f32_dpp v101, v101, v101 row_ror:2 row_mask:0xf bank_mask:0xf
    v_add_f32_dpp v104, v104, v104 row_ror:2 row_mask:0xf bank_mask:0xf
    v_add_f32_dpp v105, v105, v105 row_ror:2 row_mask:0xf bank_mask:0xf
    v_add_f32_dpp v108, v108, v108 row_ror:2 row_mask:0xf bank_mask:0xf
    v_add_f32_dpp v109, v109, v109 row_ror:2 row_mask:0xf bank_mask:0xf
    v_add_f32_dpp v112, v112, v112 row_ror:2 row_mask:0xf bank_mask:0xf
    v_add_f32_dpp v113, v113, v113 row_ror:2 row_mask:0xf bank_mask:0xf
    s_nop 1
    v_add_f32_dpp v100, v100, v100 row_ror:1 row_mask:0xf bank_mask:0xf
    v_add_f32_dpp v101, v101, v101 row_ror:1 row_mask:0xf bank_mask:0xf
    v_add_f32_dpp v104, v104, v104 row_ror:1 row_mask:0xf bank_mask:0xf
    v_add_f32_dpp v105, v105, v105 row_ror:1 row_mask:0xf bank_mask:0xf
    v_add_f32_dpp v108, v108, v108 row_ror:1 row_mask:0xf bank_mask:0xf
    v_add_f32_dpp v109, v109, v109 row_ror:1 row_mask:0xf bank_mask:0xf
    v_add_f32_dpp v112, v112, v112 row_ror:1 row_mask:0xf bank_mask:0xf
    v_add_f32_dpp v113, v113, v113 row_ror:1 row_mask:0xf bank_mask:0xf
    v_lshrrev_b32 v2, 4, v0
    v_add_u32 v2, s38, v2
    s_mul_i32 s46, s37, 2048
    v_add_u32 v2, s46, v2
    v_lshlrev_b32 v2, 3, v2
    v_and_b32 v3, 15, v0
    v_cmp_eq_u32 vcc, 0, v3
    s_and_saveexec_b64 s[46:47], vcc
    buffer_store_dwordx2 v[100:101], v2, s[28:31], 0 offen offset:0
    buffer_store_dwordx2 v[104:105], v2, s[28:31], 0 offen offset:128
    buffer_store_dwordx2 v[108:109], v2, s[28:31], 0 offen offset:256
    buffer_store_dwordx2 v[112:113], v2, s[28:31], 0 offen offset:384
    s_mov_b64 exec, s[46:47]
g5a_kernel_end1:
    s_endpgm
.globl g1b_kernel
.p2align 8
.type g1b_kernel,@function
g1b_kernel:
    s_cmp_ge_u32 s2, 240
    s_cbranch_scc1 g1b_kernel_end1
    s_load_dwordx16 s[48:63], s[0:1], 0
    s_load_dwordx8 s[64:71], s[0:1], 64
    v_and_b32 v1, 63, v0
    v_lshrrev_b32 v2, 6, v0
    s_and_b32 s46, s2, 7
    s_lshr_b32 s47, s2, 3
    s_mul_i32 s36, s47, 137
    s_lshr_b32 s36, s36, 11
    s_mul_i32 s3, s36, 15
    s_sub_u32 s37, s47, s3
    s_mul_i32 s46, s46, 2
    s_add_u32 s36, s36, s46
    s_mul_i32 s38, s36, 128
    s_mul_i32 s39, s37, 128
    v_readfirstlane_b32 s40, v2
    s_lshr_b32 s74, s40, 2
    s_and_b32 s40, s40, 3
    s_cmp_eq_u32 s74, 0
    s_cbranch_scc0 g1b_kernel_prod2
    s_branch g1b_kernel_cons3
g1b_kernel_prod2:
    s_mul_i32 s41, s38, 1280
    s_lshl_b32 s42, s39, 1
    s_mul_i32 s43, s40, 4096
    s_mul_i32 s44, s40, 4096
    s_add_u32 s44, s44, 65536
    s_mul_i32 s46, s40, 256
    s_add_u32 s46, s46, 0
    v_add_u32 v2, s46, v1
    v_lshrrev_b32 v3, 3, v2
    v_and_b32 v4, 7, v2
    v_bfe_u32 v5, v3, 1, 3
    v_xor_b32 v4, v4, v5
    v_lshlrev_b32 v4, 4, v4
    s_mov_b32 s47, 1280
    v_mad_u32_u24 v10, v3, s47, v4
    s_mul_i32 s46, s40, 256
    s_add_u32 s46, s46, 64
    v_add_u32 v2, s46, v1
    v_lshrrev_b32 v3, 3, v2
    v_and_b32 v4, 7, v2
    v_bfe_u32 v5, v3, 1, 3
    v_xor_b32 v4, v4, v5
    v_lshlrev_b32 v4, 4, v4
    s_mov_b32 s47, 1280
    v_mad_u32_u24 v11, v3, s47, v4
    s_mul_i32 s46, s40, 256
    s_add_u32 s46, s46, 128
    v_add_u32 v2, s46, v1
    v_lshrrev_b32 v3, 3, v2
    v_and_b32 v4, 7, v2
    v_bfe_u32 v5, v3, 1, 3
    v_xor_b32 v4, v4, v5
    v_lshlrev_b32 v4, 4, v4
    s_mov_b32 s47, 1280
    v_mad_u32_u24 v12, v3, s47, v4
    s_mul_i32 s46, s40, 256
    s_add_u32 s46, s46, 192
    v_add_u32 v2, s46, v1
    v_lshrrev_b32 v3, 3, v2
    v_and_b32 v4, 7, v2
    v_bfe_u32 v5, v3, 1, 3
    v_xor_b32 v4, v4, v5
    v_lshlrev_b32 v4, 4, v4
    s_mov_b32 s47, 1280
    v_mad_u32_u24 v13, v3, s47, v4
    s_mul_i32 s46, s40, 256
    s_add_u32 s46, s46, 0
    v_add_u32 v2, s46, v1
    v_lshrrev_b32 v3, 4, v2
    s_mov_b32 s47, 16
    v_mul_u32_u24 v4, s47, v3
    v_sub_u32 v4, v2, v4
    v_and_b32 v5, 3, v3
    v_lshlrev_b32 v5, 2, v5
    v_xor_b32 v4, v4, v5
    v_lshlrev_b32 v4, 4, v4
    s_mov_b32 s47, 3840
    v_mad_u32_u24 v14, v3, s47, v4
    s_mul_i32 s46, s40, 256
    s_add_u32 s46, s46, 64
    v_add_u32 v2, s46, v1
    v_lshrrev_b32 v3, 4, v2
    s_mov_b32 s47, 16
    v_mul_u32_u24 v4, s47, v3
    v_sub_u32 v4, v2, v4
    v_and_b32 v5, 3, v3
    v_lshlrev_b32 v5, 2, v5
    v_xor_b32 v4, v4, v5
    v_lshlrev_b32 v4, 4, v4
    s_mov_b32 s47, 3840
    v_mad_u32_u24 v15, v3, s47, v4
    s_mul_i32 s46, s40, 256
    s_add_u32 s46, s46, 128
    v_add_u32 v2, s46, v1
    v_lshrrev_b32 v3, 4, v2
    s_mov_b32 s47, 16
    v_mul_u32_u24 v4, s47, v3
    v_sub_u32 v4, v2, v4
    v_and_b32 v5, 3, v3
    v_lshlrev_b32 v5, 2, v5
    v_xor_b32 v4, v4, v5
    v_lshlrev_b32 v4, 4, v4
    s_mov_b32 s47, 3840
    v_mad_u32_u24 v16, v3, s47, v4
    s_mul_i32 s46, s40, 256
    s_add_u32 s46, s46, 192
    v_add_u32 v2, s46, v1
    v_lshrrev_b32 v3, 4, v2
    s_mov_b32 s47, 16
    v_mul_u32_u24 v4, s47, v3
    v_sub_u32 v4, v2, v4
    v_and_b32 v5, 3, v3
    v_lshlrev_b32 v5, 2, v5
    v_xor_b32 v4, v4, v5
    v_lshlrev_b32 v4, 4, v4
    s_mov_b32 s47, 3840
    v_mad_u32_u24 v17, v3, s47, v4
    s_waitcnt lgkmcnt(0)
    s_add_u32 s8, s70, 13107200
    s_addc_u32 s9, s71, 0
    s_mov_b32 s10, 2621440
    s_mov_b32 s11, 0x00020000
    s_mov_b32 s12, s50
    s_mov_b32 s13, s51
    s_mov_b32 s14, 2457600
    s_mov_b32 s15, 0x00020000
    s_add_u32 m0, s43, 0
    s_nop 0
    buffer_load_dwordx4 v10, s[8:11], s41 offen lds
    s_add_u32 m0, s43, 1024
    s_nop 0
    buffer_load_dwordx4 v11, s[8:11], s41 offen lds
    s_add_u32 m0, s43, 2048
    s_nop 0
    buffer_load_dwordx4 v12, s[8:11], s41 offen lds
    s_add_u32 m0, s43, 3072
    s_nop 0
    buffer_load_dwordx4 v13, s[8:11], s41 offen lds
    s_add_u32 m0, s44, 0
    s_nop 0
    buffer_load_dwordx4 v14, s[12:15], s42 offen lds
    s_add_u32 m0, s44, 1024
    s_nop 0
    buffer_load_dwordx4 v15, s[12:15], s42 offen lds
    s_add_u32 m0, s44, 2048
    s_nop 0
    buffer_load_dwordx4 v16, s[12:15], s42 offen lds
    s_add_u32 m0, s44, 3072
    s_nop 0
    buffer_load_dwordx4 v17, s[12:15], s42 offen lds
    s_add_u32 s41, s41, 128
    s_add_u32 s42, s42, 245760
    s_add_u32 m0, s43, 16384
    s_nop 0
    buffer_load_dwordx4 v10, s[8:11], s41 offen lds
    s_add_u32 m0, s43, 17408
    s_nop 0
    buffer_load_dwordx4 v11, s[8:11], s41 offen lds
    s_add_u32 m0, s43, 18432
    s_nop 0
    buffer_load_dwordx4 v12, s[8:11], s41 offen lds
    s_add_u32 m0, s43, 19456
    s_nop 0
    buffer_load_dwordx4 v13, s[8:11], s41 offen lds
    s_add_u32 m0, s44, 16384
    s_nop 0
    buffer_load_dwordx4 v14, s[12:15], s42 offen lds
    s_add_u32 m0, s44, 17408
    s_nop 0
    buffer_load_dwordx4 v15, s[12:15], s42 offen lds
    s_add_u32 m0, s44, 18432
    s_nop 0
    buffer_load_dwordx4 v16, s[12:15], s42 offen lds
    s_add_u32 m0, s44, 19456
    s_nop 0
    buffer_load_dwordx4 v17, s[12:15], s42 offen lds
    s_add_u32 s41, s41, 128
    s_add_u32 s42, s42, 245760
    s_add_u32 m0, s43, 32768
    s_nop 0
    buffer_load_dwordx4 v10, s[8:11], s41 offen lds
    s_add_u32 m0, s43, 33792
    s_nop 0
    buffer_load_dwordx4 v11, s[8:11], s41 offen lds
    s_add_u32 m0, s43, 34816
    s_nop 0
    buffer_load_dwordx4 v12, s[8:11], s41 offen lds
    s_add_u32 m0, s43, 35840
    s_nop 0
    buffer_load_dwordx4 v13, s[8:11], s41 offen lds
    s_add_u32 m0, s44, 32768
    s_nop 0
    buffer_load_dwordx4 v14, s[12:15], s42 offen lds
    s_add_u32 m0, s44, 33792
    s_nop 0
    buffer_load_dwordx4 v15, s[12:15], s42 offen lds
    s_add_u32 m0, s44, 34816
    s_nop 0
    buffer_load_dwordx4 v16, s[12:15], s42 offen lds
    s_add_u32 m0, s44, 35840
    s_nop 0
    buffer_load_dwordx4 v17, s[12:15], s42 offen lds
    s_add_u32 s41, s41, 128
    s_add_u32 s42, s42, 245760
    s_waitcnt vmcnt(16)
    s_barrier
    s_add_u32 m0, s43, 49152
    s_nop 0
    buffer_load_dwordx4 v10, s[8:11], s41 offen lds
    s_add_u32 m0, s43, 50176
    s_nop 0
    buffer_load_dwordx4 v11, s[8:11], s41 offen lds
    s_add_u32 m0, s43, 51200
    s_nop 0
    buffer_load_dwordx4 v12, s[8:11], s41 offen lds
    s_add_u32 m0, s43, 52224
    s_nop 0
    buffer_load_dwordx4 v13, s[8:11], s41 offen lds
    s_add_u32 m0, s44, 49152
    s_nop 0
    buffer_load_dwordx4 v14, s[12:15], s42 offen lds
    s_add_u32 m0, s44, 50176
    s_nop 0
    buffer_load_dwordx4 v15, s[12:15], s42 offen lds
    s_add_u32 m0, s44, 51200
    s_nop 0
    buffer_load_dwordx4 v16, s[12:15], s42 offen lds
    s_add_u32 m0, s44, 52224
    s_nop 0
    buffer_load_dwordx4 v17, s[12:15], s42 offen lds
    s_add_u32 s41, s41, 128
    s_add_u32 s42, s42, 245760
    s_waitcnt vmcnt(16)
    s_barrier
    s_add_u32 m0, s43, 0
    s_nop 0
    buffer_load_dwordx4 v10, s[8:11], s41 offen lds
    s_add_u32 m0, s43, 1024
    s_nop 0
    buffer_load_dwordx4 v11, s[8:11], s41 offen lds
    s_add_u32 m0, s43, 2048
    s_nop 0
    buffer_load_dwordx4 v12, s[8:11], s41 offen lds
    s_add_u32 m0, s43, 3072
    s_nop 0
    buffer_load_dwordx4 v13, s[8:11], s41 offen lds
    s_add_u32 m0, s44, 0
    s_nop 0
    buffer_load_dwordx4 v14, s[12:15], s42 offen lds
    s_add_u32 m0, s44, 1024
    s_nop 0
    buffer_load_dwordx4 v15, s[12:15], s42 offen lds
    s_add_u32 m0, s44, 2048
    s_nop 0
    buffer_load_dwordx4 v16, s[12:15], s42 offen lds
    s_add_u32 m0, s44, 3072
    s_nop 0
    buffer_load_dwordx4 v17, s[12:15], s42 offen lds
    s_add_u32 s41, s41, 128
    s_add_u32 s42, s42, 245760
    s_waitcnt vmcnt(16)
    s_barrier
    s_add_u32 m0, s43, 16384
    s_nop 0
    buffer_load_dwordx4 v10, s[8:11], s41 offen lds
    s_add_u32 m0, s43, 17408
    s_nop 0
    buffer_load_dwordx4 v11, s[8:11], s41 offen lds
    s_add_u32 m0, s43, 18432
    s_nop 0
    buffer_load_dwordx4 v12, s[8:11], s41 offen lds
    s_add_u32 m0, s43, 19456
    s_nop 0
    buffer_load_dwordx4 v13, s[8:11], s41 offen lds
    s_add_u32 m0, s44, 16384
    s_nop 0
    buffer_load_dwordx4 v14, s[12:15], s42 offen lds
    s_add_u32 m0, s44, 17408
    s_nop 0
    buffer_load_dwordx4 v15, s[12:15], s42 offen lds
    s_add_u32 m0, s44, 18432
    s_nop 0
    buffer_load_dwordx4 v16, s[12:15], s42 offen lds
    s_add_u32 m0, s44, 19456
    s_nop 0
    buffer_load_dwordx4 v17, s[12:15], s42 offen lds
    s_add_u32 s41, s41, 128
    s_add_u32 s42, s42, 245760
    s_waitcnt vmcnt(16)
    s_barrier
    s_add_u32 m0, s43, 32768
    s_nop 0
    buffer_load_dwordx4 v10, s[8:11], s41 offen lds
    s_add_u32 m0, s43, 33792
    s_nop 0
    buffer_load_dwordx4 v11, s[8:11], s41 offen lds
    s_add_u32 m0, s43, 34816
    s_nop 0
    buffer_load_dwordx4 v12, s[8:11], s41 offen lds
    s_add_u32 m0, s43, 35840
    s_nop 0
    buffer_load_dwordx4 v13, s[8:11], s41 offen lds
    s_add_u32 m0, s44, 32768
    s_nop 0
    buffer_load_dwordx4 v14, s[12:15], s42 offen lds
    s_add_u32 m0, s44, 33792
    s_nop 0
    buffer_load_dwordx4 v15, s[12:15], s42 offen lds
    s_add_u32 m0, s44, 34816
    s_nop 0
    buffer_load_dwordx4 v16, s[12:15], s42 offen lds
    s_add_u32 m0, s44, 35840
    s_nop 0
    buffer_load_dwordx4 v17, s[12:15], s42 offen lds
    s_add_u32 s41, s41, 128
    s_add_u32 s42, s42, 245760
    s_waitcnt vmcnt(16)
    s_barrier
    s_add_u32 m0, s43, 49152
    s_nop 0
    buffer_load_dwordx4 v10, s[8:11], s41 offen lds
    s_add_u32 m0, s43, 50176
    s_nop 0
    buffer_load_dwordx4 v11, s[8:11], s41 offen lds
    s_add_u32 m0, s43, 51200
    s_nop 0
    buffer_load_dwordx4 v12, s[8:11], s41 offen lds
    s_add_u32 m0, s43, 52224
    s_nop 0
    buffer_load_dwordx4 v13, s[8:11], s41 offen lds
    s_add_u32 m0, s44, 49152
    s_nop 0
    buffer_load_dwordx4 v14, s[12:15], s42 offen lds
    s_add_u32 m0, s44, 50176
    s_nop 0
    buffer_load_dwordx4 v15, s[12:15], s42 offen lds
    s_add_u32 m0, s44, 51200
    s_nop 0
    buffer_load_dwordx4 v16, s[12:15], s42 offen lds
    s_add_u32 m0, s44, 52224
    s_nop 0
    buffer_load_dwordx4 v17, s[12:15], s42 offen lds
    s_add_u32 s41, s41, 128
    s_add_u32 s42, s42, 245760
    s_waitcnt vmcnt(16)
    s_barrier
    s_add_u32 m0, s43, 0
    s_nop 0
    buffer_load_dwordx4 v10, s[8:11], s41 offen lds
    s_add_u32 m0, s43, 1024
    s_nop 0
    buffer_load_dwordx4 v11, s[8:11], s41 offen lds
    s_add_u32 m0, s43, 2048
    s_nop 0
    buffer_load_dwordx4 v12, s[8:11], s41 offen lds
    s_add_u32 m0, s43, 3072
    s_nop 0
    buffer_load_dwordx4 v13, s[8:11], s41 offen lds
    s_add_u32 m0, s44, 0
    s_nop 0
    buffer_load_dwordx4 v14, s[12:15], s42 offen lds
    s_add_u32 m0, s44, 1024
    s_nop 0
    buffer_load_dwordx4 v15, s[12:15], s42 offen lds
    s_add_u32 m0, s44, 2048
    s_nop 0
    buffer_load_dwordx4 v16, s[12:15], s42 offen lds
    s_add_u32 m0, s44, 3072
    s_nop 0
    buffer_load_dwordx4 v17, s[12:15], s42 offen lds
    s_add_u32 s41, s41, 128
    s_add_u32 s42, s42, 245760
    s_waitcnt vmcnt(16)
    s_barrier
    s_add_u32 m0, s43, 16384
    s_nop 0
    buffer_load_dwordx4 v10, s[8:11], s41 offen lds
    s_add_u32 m0, s43, 17408
    s_nop 0
    buffer_load_dwordx4 v11, s[8:11], s41 offen lds
    s_add_u32 m0, s43, 18432
    s_nop 0
    buffer_load_dwordx4 v12, s[8:11], s41 offen lds
    s_add_u32 m0, s43, 19456
    s_nop 0
    buffer_load_dwordx4 v13, s[8:11], s41 offen lds
    s_add_u32 m0, s44, 16384
    s_nop 0
    buffer_load_dwordx4 v14, s[12:15], s42 offen lds
    s_add_u32 m0, s44, 17408
    s_nop 0
    buffer_load_dwordx4 v15, s[12:15], s42 offen lds
    s_add_u32 m0, s44, 18432
    s_nop 0
    buffer_load_dwordx4 v16, s[12:15], s42 offen lds
    s_add_u32 m0, s44, 19456
    s_nop 0
    buffer_load_dwordx4 v17, s[12:15], s42 offen lds
    s_add_u32 s41, s41, 128
    s_add_u32 s42, s42, 245760
    s_waitcnt vmcnt(16)
    s_barrier
    s_waitcnt vmcnt(8)
    s_barrier
    s_waitcnt vmcnt(0)
    s_barrier
    s_endpgm
g1b_kernel_cons3:
    s_waitcnt lgkmcnt(0)
    s_mov_b32 s16, s70
    s_mov_b32 s17, s71
    s_mov_b32 s18, 7864320
    s_mov_b32 s19, 0x00020000
    s_lshr_b32 s72, s40, 1
    s_and_b32 s73, s40, 1
    s_mul_i32 s46, s72, 64
    v_and_b32 v2, 31, v1
    v_add_u32 v2, s46, v2
    v_lshrrev_b32 v3, 5, v1
    v_bfe_u32 v4, v2, 1, 3
    v_xor_b32 v3, v3, v4
    v_lshlrev_b32 v3, 4, v3
    v_lshl_add_u32 v18, v2, 7, v3
    v_xor_b32 v19, 32, v18
    v_xor_b32 v20, 64, v18
    v_xor_b32 v21, 96, v18
    s_mul_i32 s46, s73, 8
    s_add_u32 s46, s46, 0
    v_bfe_u32 v2, v1, 4, 1
    v_lshlrev_b32 v2, 1, v2
    v_bfe_u32 v3, v1, 1, 1
    v_add3_u32 v2, v2, v3, s46
    v_bfe_u32 v4, v1, 2, 2
    v_lshlrev_b32 v5, 2, v4
    v_xor_b32 v2, v2, v5
    v_lshlrev_b32 v2, 4, v2
    v_and_b32 v3, 1, v1
    v_lshl_add_u32 v2, v3, 3, v2
    v_lshrrev_b32 v3, 5, v1
    v_lshl_add_u32 v3, v3, 3, v4
    s_mov_b32 s47, 256
    v_mad_u32_u24 v2, v3, s47, v2
    v_add_u32 v22, 65536, v2
    s_mul_i32 s46, s73, 8
    s_add_u32 s46, s46, 4
    v_bfe_u32 v2, v1, 4, 1
    v_lshlrev_b32 v2, 1, v2
    v_bfe_u32 v3, v1, 1, 1
    v_add3_u32 v2, v2, v3, s46
    v_bfe_u32 v4, v1, 2, 2
    v_lshlrev_b32 v5, 2, v4
    v_xor_b32 v2, v2, v5
    v_lshlrev_b32 v2, 4, v2
    v_and_b32 v3, 1, v1
    v_lshl_add_u32 v2, v3, 3, v2
    v_lshrrev_b32 v3, 5, v1
    v_lshl_add_u32 v3, v3, 3, v4
    s_mov_b32 s47, 256
    v_mad_u32_u24 v2, v3, s47, v2
    v_add_u32 v23, 65536, v2
    s_mul_i32 s46, s72, 64
    v_and_b32 v2, 31, v1
    v_add_u32 v2, s46, v2
    s_mov_b32 s47, 272
    v_mul_u32_u24 v2, s47, v2
    s_mul_i32 s46, s73, 128
    v_lshrrev_b32 v3, 5, v1
    v_lshlrev_b32 v3, 3, v3
    v_add3_u32 v40, v2, v3, s46
    v_add_u32 v2, 0, v0
    v_lshrrev_b32 v6, 4, v2
    s_mov_b32 s46, 16
    v_mul_u32_u24 v7, s46, v6
    v_sub_u32 v7, v2, v7
    s_mov_b32 s46, 272
    v_mul_u32_u24 v32, s46, v6
    v_lshl_add_u32 v32, v7, 4, v32
    v_add_u32 v24, s38, v6
    s_mov_b32 s46, 3840
    v_mul_lo_u32 v24, v24, s46
    v_lshl_add_u32 v24, v7, 4, v24
    s_lshl_b32 s46, s39, 1
    v_add_u32 v24, s46, v24
    v_add_u32 v2, 256, v0
    v_lshrrev_b32 v6, 4, v2
    s_mov_b32 s46, 16
    v_mul_u32_u24 v7, s46, v6
    v_sub_u32 v7, v2, v7
    s_mov_b32 s46, 272
    v_mul_u32_u24 v33, s46, v6
    v_lshl_add_u32 v33, v7, 4, v33
    v_add_u32 v25, s38, v6
    s_mov_b32 s46, 3840
    v_mul_lo_u32 v25, v25, s46
    v_lshl_add_u32 v25, v7, 4, v25
    s_lshl_b32 s46, s39, 1
    v_add_u32 v25, s46, v25
    v_add_u32 v2, 512, v0
    v_lshrrev_b32 v6, 4, v2
    s_mov_b32 s46, 16
    v_mul_u32_u24 v7, s46, v6
    v_sub_u32 v7, v2, v7
    s_mov_b32 s46, 272
    v_mul_u32_u24 v34, s46, v6
    v_lshl_add_u32 v34, v7, 4, v34
    v_add_u32 v26, s38, v6
    s_mov_b32 s46, 3840
    v_mul_lo_u32 v26, v26, s46
    v_lshl_add_u32 v26, v7, 4, v26
    s_lshl_b32 s46, s39, 1
    v_add_u32 v26, s46, v26
    v_add_u32 v2, 768, v0
    v_lshrrev_b32 v6, 4, v2
    s_mov_b32 s46, 16
    v_mul_u32_u24 v7, s46, v6
    v_sub_u32 v7, v2, v7
    s_mov_b32 s46, 272
    v_mul_u32_u24 v35, s46, v6
    v_lshl_add_u32 v35, v7, 4, v35
    v_add_u32 v27, s38, v6
    s_mov_b32 s46, 3840
    v_mul_lo_u32 v27, v27, s46
    v_lshl_add_u32 v27, v7, 4, v27
    s_lshl_b32 s46, s39, 1
    v_add_u32 v27, s46, v27
    v_add_u32 v2, 1024, v0
    v_lshrrev_b32 v6, 4, v2
    s_mov_b32 s46, 16
    v_mul_u32_u24 v7, s46, v6
    v_sub_u32 v7, v2, v7
    s_mov_b32 s46, 272
    v_mul_u32_u24 v36, s46, v6
    v_lshl_add_u32 v36, v7, 4, v36
    v_add_u32 v28, s38, v6
    s_mov_b32 s46, 3840
    v_mul_lo_u32 v28, v28, s46
    v_lshl_add_u32 v28, v7, 4, v28
    s_lshl_b32 s46, s39, 1
    v_add_u32 v28, s46, v28
    v_add_u32 v2, 1280, v0
    v_lshrrev_b32 v6, 4, v2
    s_mov_b32 s46, 16
    v_mul_u32_u24 v7, s46, v6
    v_sub_u32 v7, v2, v7
    s_mov_b32 s46, 272
    v_mul_u32_u24 v37, s46, v6
    v_lshl_add_u32 v37, v7, 4, v37
    v_add_u32 v29, s38, v6
    s_mov_b32 s46, 3840
    v_mul_lo_u32 v29, v29, s46
    v_lshl_add_u32 v29, v7, 4, v29
    s_lshl_b32 s46, s39, 1
    v_add_u32 v29, s46, v29
    v_add_u32 v2, 1536, v0
    v_lshrrev_b32 v6, 4, v2
    s_mov_b32 s46, 16
    v_mul_u32_u24 v7, s46, v6
    v_sub_u32 v7, v2, v7
    s_mov_b32 s46, 272
    v_mul_u32_u24 v38, s46, v6
    v_lshl_add_u32 v38, v7, 4, v38
    v_add_u32 v30, s38, v6
    s_mov_b32 s46, 3840
    v_mul_lo_u32 v30, v30, s46
    v_lshl_add_u32 v30, v7, 4, v30
    s_lshl_b32 s46, s39, 1
    v_add_u32 v30, s46, v30
    v_add_u32 v2, 1792, v0
    v_lshrrev_b32 v6, 4, v2
    s_mov_b32 s46, 16
    v_mul_u32_u24 v7, s46, v6
    v_sub_u32 v7, v2, v7
    s_mov_b32 s46, 272
    v_mul_u32_u24 v39, s46, v6
    v_lshl_add_u32 v39, v7, 4, v39
    v_add_u32 v31, s38, v6
    s_mov_b32 s46, 3840
    v_mul_lo_u32 v31, v31, s46
    v_lshl_add_u32 v31, v7, 4, v31
    s_lshl_b32 s46, s39, 1
    v_add_u32 v31, s46, v31
    v_mov_b32 v80, 0
    v_mov_b32 v81, 0
    v_mov_b32 v82, 0
    v_mov_b32 v83, 0
    v_mov_b32 v84, 0
    v_mov_b32 v85, 0
    v_mov_b32 v86, 0
    v_mov_b32 v87, 0
    v_mov_b32 v88, 0
    v_mov_b32 v89, 0
    v_mov_b32 v90, 0
    v_mov_b32 v91, 0
    v_mov_b32 v92, 0
    v_mov_b32 v93, 0
    v_mov_b32 v94, 0
    v_mov_b32 v95, 0
    v_mov_b32 v96, 0
    v_mov_b32 v97, 0
    v_mov_b32 v98, 0
    v_mov_b32 v99, 0
    v_mov_b32 v100, 0
    v_mov_b32 v101, 0
    v_mov_b32 v102, 0
    v_mov_b32 v103, 0
    v_mov_b32 v104, 0
    v_mov_b32 v105, 0
    v_mov_b32 v106, 0
    v_mov_b32 v107, 0
    v_mov_b32 v108, 0
    v_mov_b32 v109, 0
    v_mov_b32 v110, 0
    v_mov_b32 v111, 0
    v_mov_b32 v112, 0
    v_mov_b32 v113, 0
    v_mov_b32 v114, 0
    v_mov_b32 v115, 0
    v_mov_b32 v116, 0
    v_mov_b32 v117, 0
    v_mov_b32 v118, 0
    v_mov_b32 v119, 0
    v_mov_b32 v120, 0
    v_mov_b32 v121, 0
    v_mov_b32 v122, 0
    v_mov_b32 v123, 0
    v_mov_b32 v124, 0
    v_mov_b32 v125, 0
    v_mov_b32 v126, 0
    v_mov_b32 v127, 0
    v_mov_b32 v128, 0
    v_mov_b32 v129, 0
    v_mov_b32 v130, 0
    v_mov_b32 v131, 0
    v_mov_b32 v132, 0
    v_mov_b32 v133, 0
    v_mov_b32 v134, 0
    v_mov_b32 v135, 0
    v_mov_b32 v136, 0
    v_mov_b32 v137, 0
    v_mov_b32 v138, 0
    v_mov_b32 v139, 0
    v_mov_b32 v140, 0
    v_mov_b32 v141, 0
    v_mov_b32 v142, 0
    v_mov_b32 v143, 0
    s_barrier
    ds_read_b128 v[44:47], v18 offset:0
    ds_read_b128 v[48:51], v18 offset:4096
    ds_read_b64_tr_b16 v[52:53], v22 offset:0
    ds_read_b64_tr_b16 v[54:55], v22 offset:1024
    ds_read_b64_tr_b16 v[56:57], v23 offset:0
    ds_read_b64_tr_b16 v[58:59], v23 offset:1024
    ds_read_b128 v[60:63], v19 offset:0
    ds_read_b128 v[64:67], v19 offset:4096
    ds_read_b64_tr_b16 v[68:69], v22 offset:4096
    ds_read_b64_tr_b16 v[70:71], v22 offset:5120
    ds_read_b64_tr_b16 v[72:73], v23 offset:4096
    ds_read_b64_tr_b16 v[74:75], v23 offset:5120
    s_waitcnt lgkmcnt(6)
    v_mfma_f32_32x32x16_bf16 v[80:95], v[52:55], v[44:47], v[80:95]
    v_mfma_f32_32x32x16_bf16 v[96:111], v[52:55], v[48:51], v[96:111]
    v_mfma_f32_32x32x16_bf16 v[112:127], v[56:59], v[44:47], v[112:127]
    v_mfma_f32_32x32x16_bf16 v[128:143], v[56:59], v[48:51], v[128:143]
    ds_read_b128 v[44:47], v20 offset:0
    ds_read_b128 v[48:51], v20 offset:4096
    ds_read_b64_tr_b16 v[52:53], v22 offset:8192
    ds_read_b64_tr_b16 v[54:55], v22 offset:9216
    ds_read_b64_tr_b16 v[56:57], v23 offset:8192
    ds_read_b64_tr_b16 v[58:59], v23 offset:9216
    s_waitcnt lgkmcnt(6)
    v_mfma_f32_32x32x16_bf16 v[80:95], v[68:71], v[60:63], v[80:95]
    v_mfma_f32_32x32x16_bf16 v[96:111], v[68:71], v[64:67], v[96:111]
    v_mfma_f32_32x32x16_bf16 v[112:127], v[72:75], v[60:63], v[112:127]
    v_mfma_f32_32x32x16_bf16 v[128:143], v[72:75], v[64:67], v[128:143]
    ds_read_b128 v[60:63], v21 offset:0
    ds_read_b128 v[64:67], v21 offset:4096
    ds_read_b64_tr_b16 v[68:69], v22 offset:12288
    ds_read_b64_tr_b16 v[70:71], v22 offset:13312
    ds_read_b64_tr_b16 v[72:73], v23 offset:12288
    ds_read_b64_tr_b16 v[74:75], v23 offset:13312
    s_waitcnt lgkmcnt(6)
    v_mfma_f32_32x32x16_bf16 v[80:95], v[52:55], v[44:47], v[80:95]
    v_mfma_f32_32x32x16_bf16 v[96:111], v[52:55], v[48:51], v[96:111]
    v_mfma_f32_32x32x16_bf16 v[112:127], v[56:59], v[44:47], v[112:127]
    v_mfma_f32_32x32x16_bf16 v[128:143], v[56:59], v[48:51], v[128:143]
    s_waitcnt lgkmcnt(0)
    v_mfma_f32_32x32x16_bf16 v[80:95], v[68:71], v[60:63], v[80:95]
    v_mfma_f32_32x32x16_bf16 v[96:111], v[68:71], v[64:67], v[96:111]
    v_mfma_f32_32x32x16_bf16 v[112:127], v[72:75], v[60:63], v[112:127]
    v_mfma_f32_32x32x16_bf16 v[128:143], v[72:75], v[64:67], v[128:143]
    s_barrier
    ds_read_b128 v[44:47], v18 offset:16384
    ds_read_b128 v[48:51], v18 offset:20480
    ds_read_b64_tr_b16 v[52:53], v22 offset:16384
    ds_read_b64_tr_b16 v[54:55], v22 offset:17408
    ds_read_b64_tr_b16 v[56:57], v23 offset:16384
    ds_read_b64_tr_b16 v[58:59], v23 offset:17408
    ds_read_b128 v[60:63], v19 offset:16384
    ds_read_b128 v[64:67], v19 offset:20480
    ds_read_b64_tr_b16 v[68:69], v22 offset:20480
    ds_read_b64_tr_b16 v[70:71], v22 offset:21504
    ds_read_b64_tr_b16 v[72:73], v23 offset:20480
    ds_read_b64_tr_b16 v[74:75], v23 offset:21504
    s_waitcnt lgkmcnt(6)
    v_mfma_f32_32x32x16_bf16 v[80:95], v[52:55], v[44:47], v[80:95]
    v_mfma_f32_32x32x16_bf16 v[96:111], v[52:55], v[48:51], v[96:111]
    v_mfma_f32_32x32x16_bf16 v[112:127], v[56:59], v[44:47], v[112:127]
    v_mfma_f32_32x32x16_bf16 v[128:143], v[56:59], v[48:51], v[128:143]
    ds_read_b128 v[44:47], v20 offset:16384
    ds_read_b128 v[48:51], v20 offset:20480
    ds_read_b64_tr_b16 v[52:53], v22 offset:24576
    ds_read_b64_tr_b16 v[54:55], v22 offset:25600
    ds_read_b64_tr_b16 v[56:57], v23 offset:24576
    ds_read_b64_tr_b16 v[58:59], v23 offset:25600
    s_waitcnt lgkmcnt(6)
    v_mfma_f32_32x32x16_bf16 v[80:95], v[68:71], v[60:63], v[80:95]
    v_mfma_f32_32x32x16_bf16 v[96:111], v[68:71], v[64:67], v[96:111]
    v_mfma_f32_32x32x16_bf16 v[112:127], v[72:75], v[60:63], v[112:127]
    v_mfma_f32_32x32x16_bf16 v[128:143], v[72:75], v[64:67], v[128:143]
    ds_read_b128 v[60:63], v21 offset:16384
    ds_read_b128 v[64:67], v21 offset:20480
    ds_read_b64_tr_b16 v[68:69], v22 offset:28672
    ds_read_b64_tr_b16 v[70:71], v22 offset:29696
    ds_read_b64_tr_b16 v[72:73], v23 offset:28672
    ds_read_b64_tr_b16 v[74:75], v23 offset:29696
    s_waitcnt lgkmcnt(6)
    v_mfma_f32_32x32x16_bf16 v[80:95], v[52:55], v[44:47], v[80:95]
    v_mfma_f32_32x32x16_bf16 v[96:111], v[52:55], v[48:51], v[96:111]
    v_mfma_f32_32x32x16_bf16 v[112:127], v[56:59], v[44:47], v[112:127]
    v_mfma_f32_32x32x16_bf16 v[128:143], v[56:59], v[48:51], v[128:143]
    s_waitcnt lgkmcnt(0)
    v_mfma_f32_32x32x16_bf16 v[80:95], v[68:71], v[60:63], v[80:95]
    v_mfma_f32_32x32x16_bf16 v[96:111], v[68:71], v[64:67], v[96:111]
    v_mfma_f32_32x32x16_bf16 v[112:127], v[72:75], v[60:63], v[112:127]
    v_mfma_f32_32x32x16_bf16 v[128:143], v[72:75], v[64:67], v[128:143]
    s_barrier
    ds_read_b128 v[44:47], v18 offset:32768
    ds_read_b128 v[48:51], v18 offset:36864
    ds_read_b64_tr_b16 v[52:53], v22 offset:32768
    ds_read_b64_tr_b16 v[54:55], v22 offset:33792
    ds_read_b64_tr_b16 v[56:57], v23 offset:32768
    ds_read_b64_tr_b16 v[58:59], v23 offset:33792
    ds_read_b128 v[60:63], v19 offset:32768
    ds_read_b128 v[64:67], v19 offset:36864
    ds_read_b64_tr_b16 v[68:69], v22 offset:36864
    ds_read_b64_tr_b16 v[70:71], v22 offset:37888
    ds_read_b64_tr_b16 v[72:73], v23 offset:36864
    ds_read_b64_tr_b16 v[74:75], v23 offset:37888
    s_waitcnt lgkmcnt(6)
    v_mfma_f32_32x32x16_bf16 v[80:95], v[52:55], v[44:47], v[80:95]
    v_mfma_f32_32x32x16_bf16 v[96:111], v[52:55], v[48:51], v[96:111]
    v_mfma_f32_32x32x16_bf16 v[112:127], v[56:59], v[44:47], v[112:127]
    v_mfma_f32_32x32x16_bf16 v[128:143], v[56:59], v[48:51], v[128:143]
    ds_read_b128 v[44:47], v20 offset:32768
    ds_read_b128 v[48:51], v20 offset:36864
    ds_read_b64_tr_b16 v[52:53], v22 offset:40960
    ds_read_b64_tr_b16 v[54:55], v22 offset:41984
    ds_read_b64_tr_b16 v[56:57], v23 offset:40960
    ds_read_b64_tr_b16 v[58:59], v23 offset:41984
    s_waitcnt lgkmcnt(6)
    v_mfma_f32_32x32x16_bf16 v[80:95], v[68:71], v[60:63], v[80:95]
    v_mfma_f32_32x32x16_bf16 v[96:111], v[68:71], v[64:67], v[96:111]
    v_mfma_f32_32x32x16_bf16 v[112:127], v[72:75], v[60:63], v[112:127]
    v_mfma_f32_32x32x16_bf16 v[128:143], v[72:75], v[64:67], v[128:143]
    ds_read_b128 v[60:63], v21 offset:32768
    ds_read_b128 v[64:67], v21 offset:36864
    ds_read_b64_tr_b16 v[68:69], v22 offset:45056
    ds_read_b64_tr_b16 v[70:71], v22 offset:46080
    ds_read_b64_tr_b16 v[72:73], v23 offset:45056
    ds_read_b64_tr_b16 v[74:75], v23 offset:46080
    s_waitcnt lgkmcnt(6)
    v_mfma_f32_32x32x16_bf16 v[80:95], v[52:55], v[44:47], v[80:95]
    v_mfma_f32_32x32x16_bf16 v[96:111], v[52:55], v[48:51], v[96:111]
    v_mfma_f32_32x32x16_bf16 v[112:127], v[56:59], v[44:47], v[112:127]
    v_mfma_f32_32x32x16_bf16 v[128:143], v[56:59], v[48:51], v[128:143]
    s_waitcnt lgkmcnt(0)
    v_mfma_f32_32x32x16_bf16 v[80:95], v[68:71], v[60:63], v[80:95]
    v_mfma_f32_32x32x16_bf16 v[96:111], v[68:71], v[64:67], v[96:111]
    v_mfma_f32_32x32x16_bf16 v[112:127], v[72:75], v[60:63], v[112:127]
    v_mfma_f32_32x32x16_bf16 v[128:143], v[72:75], v[64:67], v[128:143]
    s_barrier
    ds_read_b128 v[44:47], v18 offset:49152
    ds_read_b128 v[48:51], v18 offset:53248
    ds_read_b64_tr_b16 v[52:53], v22 offset:49152
    ds_read_b64_tr_b16 v[54:55], v22 offset:50176
    ds_read_b64_tr_b16 v[56:57], v23 offset:49152
    ds_read_b64_tr_b16 v[58:59], v23 offset:50176
    ds_read_b128 v[60:63], v19 offset:49152
    ds_read_b128 v[64:67], v19 offset:53248
    ds_read_b64_tr_b16 v[68:69], v22 offset:53248
    ds_read_b64_tr_b16 v[70:71], v22 offset:54272
    ds_read_b64_tr_b16 v[72:73], v23 offset:53248
    ds_read_b64_tr_b16 v[74:75], v23 offset:54272
    s_waitcnt lgkmcnt(6)
    v_mfma_f32_32x32x16_bf16 v[80:95], v[52:55], v[44:47], v[80:95]
    v_mfma_f32_32x32x16_bf16 v[96:111], v[52:55], v[48:51], v[96:111]
    v_mfma_f32_32x32x16_bf16 v[112:127], v[56:59], v[44:47], v[112:127]
    v_mfma_f32_32x32x16_bf16 v[128:143], v[56:59], v[48:51], v[128:143]
    ds_read_b128 v[44:47], v20 offset:49152
    ds_read_b128 v[48:51], v20 offset:53248
    ds_read_b64_tr_b16 v[52:53], v22 offset:57344
    ds_read_b64_tr_b16 v[54:55], v22 offset:58368
    ds_read_b64_tr_b16 v[56:57], v23 offset:57344
    ds_read_b64_tr_b16 v[58:59], v23 offset:58368
    s_waitcnt lgkmcnt(6)
    v_mfma_f32_32x32x16_bf16 v[80:95], v[68:71], v[60:63], v[80:95]
    v_mfma_f32_32x32x16_bf16 v[96:111], v[68:71], v[64:67], v[96:111]
    v_mfma_f32_32x32x16_bf16 v[112:127], v[72:75], v[60:63], v[112:127]
    v_mfma_f32_32x32x16_bf16 v[128:143], v[72:75], v[64:67], v[128:143]
    ds_read_b128 v[60:63], v21 offset:49152
    ds_read_b128 v[64:67], v21 offset:53248
    ds_read_b64_tr_b16 v[68:69], v22 offset:61440
    ds_read_b64_tr_b16 v[70:71], v22 offset:62464
    ds_read_b64_tr_b16 v[72:73], v23 offset:61440
    ds_read_b64_tr_b16 v[74:75], v23 offset:62464
    s_waitcnt lgkmcnt(6)
    v_mfma_f32_32x32x16_bf16 v[80:95], v[52:55], v[44:47], v[80:95]
    v_mfma_f32_32x32x16_bf16 v[96:111], v[52:55], v[48:51], v[96:111]
    v_mfma_f32_32x32x16_bf16 v[112:127], v[56:59], v[44:47], v[112:127]
    v_mfma_f32_32x32x16_bf16 v[128:143], v[56:59], v[48:51], v[128:143]
    s_waitcnt lgkmcnt(0)
    v_mfma_f32_32x32x16_bf16 v[80:95], v[68:71], v[60:63], v[80:95]
    v_mfma_f32_32x32x16_bf16 v[96:111], v[68:71], v[64:67], v[96:111]
    v_mfma_f32_32x32x16_bf16 v[112:127], v[72:75], v[60:63], v[112:127]
    v_mfma_f32_32x32x16_bf16 v[128:143], v[72:75], v[64:67], v[128:143]
    s_barrier
    ds_read_b128 v[44:47], v18 offset:0
    ds_read_b128 v[48:51], v18 offset:4096
    ds_read_b64_tr_b16 v[52:53], v22 offset:0
    ds_read_b64_tr_b16 v[54:55], v22 offset:1024
    ds_read_b64_tr_b16 v[56:57], v23 offset:0
    ds_read_b64_tr_b16 v[58:59], v23 offset:1024
    ds_read_b128 v[60:63], v19 offset:0
    ds_read_b128 v[64:67], v19 offset:4096
    ds_read_b64_tr_b16 v[68:69], v22 offset:4096
    ds_read_b64_tr_b16 v[70:71], v22 offset:5120
    ds_read_b64_tr_b16 v[72:73], v23 offset:4096
    ds_read_b64_tr_b16 v[74:75], v23 offset:5120
    s_waitcnt lgkmcnt(6)
    v_mfma_f32_32x32x16_bf16 v[80:95], v[52:55], v[44:47], v[80:95]
    v_mfma_f32_32x32x16_bf16 v[96:111], v[52:55], v[48:51], v[96:111]
    v_mfma_f32_32x32x16_bf16 v[112:127], v[56:59], v[44:47], v[112:127]
    v_mfma_f32_32x32x16_bf16 v[128:143], v[56:59], v[48:51], v[128:143]
    ds_read_b128 v[44:47], v20 offset:0
    ds_read_b128 v[48:51], v20 offset:4096
    ds_read_b64_tr_b16 v[52:53], v22 offset:8192
    ds_read_b64_tr_b16 v[54:55], v22 offset:9216
    ds_read_b64_tr_b16 v[56:57], v23 offset:8192
    ds_read_b64_tr_b16 v[58:59], v23 offset:9216
    s_waitcnt lgkmcnt(6)
    v_mfma_f32_32x32x16_bf16 v[80:95], v[68:71], v[60:63], v[80:95]
    v_mfma_f32_32x32x16_bf16 v[96:111], v[68:71], v[64:67], v[96:111]
    v_mfma_f32_32x32x16_bf16 v[112:127], v[72:75], v[60:63], v[112:127]
    v_mfma_f32_32x32x16_bf16 v[128:143], v[72:75], v[64:67], v[128:143]
    ds_read_b128 v[60:63], v21 offset:0
    ds_read_b128 v[64:67], v21 offset:4096
    ds_read_b64_tr_b16 v[68:69], v22 offset:12288
    ds_read_b64_tr_b16 v[70:71], v22 offset:13312
    ds_read_b64_tr_b16 v[72:73], v23 offset:12288
    ds_read_b64_tr_b16 v[74:75], v23 offset:13312
    s_waitcnt lgkmcnt(6)
    v_mfma_f32_32x32x16_bf16 v[80:95], v[52:55], v[44:47], v[80:95]
    v_mfma_f32_32x32x16_bf16 v[96:111], v[52:55], v[48:51], v[96:111]
    v_mfma_f32_32x32x16_bf16 v[112:127], v[56:59], v[44:47], v[112:127]
    v_mfma_f32_32x32x16_bf16 v[128:143], v[56:59], v[48:51], v[128:143]
    s_waitcnt lgkmcnt(0)
    v_mfma_f32_32x32x16_bf16 v[80:95], v[68:71], v[60:63], v[80:95]
    v_mfma_f32_32x32x16_bf16 v[96:111], v[68:71], v[64:67], v[96:111]
    v_mfma_f32_32x32x16_bf16 v[112:127], v[72:75], v[60:63], v[112:127]
    v_mfma_f32_32x32x16_bf16 v[128:143], v[72:75], v[64:67], v[128:143]
    s_barrier
    ds_read_b128 v[44:47], v18 offset:16384
    ds_read_b128 v[48:51], v18 offset:20480
    ds_read_b64_tr_b16 v[52:53], v22 offset:16384
    ds_read_b64_tr_b16 v[54:55], v22 offset:17408
    ds_read_b64_tr_b16 v[56:57], v23 offset:16384
    ds_read_b64_tr_b16 v[58:59], v23 offset:17408
    ds_read_b128 v[60:63], v19 offset:16384
    ds_read_b128 v[64:67], v19 offset:20480
    ds_read_b64_tr_b16 v[68:69], v22 offset:20480
    ds_read_b64_tr_b16 v[70:71], v22 offset:21504
    ds_read_b64_tr_b16 v[72:73], v23 offset:20480
    ds_read_b64_tr_b16 v[74:75], v23 offset:21504
    s_waitcnt lgkmcnt(6)
    v_mfma_f32_32x32x16_bf16 v[80:95], v[52:55], v[44:47], v[80:95]
    v_mfma_f32_32x32x16_bf16 v[96:111], v[52:55], v[48:51], v[96:111]
    v_mfma_f32_32x32x16_bf16 v[112:127], v[56:59], v[44:47], v[112:127]
    v_mfma_f32_32x32x16_bf16 v[128:143], v[56:59], v[48:51], v[128:143]
    ds_read_b128 v[44:47], v20 offset:16384
    ds_read_b128 v[48:51], v20 offset:20480
    ds_read_b64_tr_b16 v[52:53], v22 offset:24576
    ds_read_b64_tr_b16 v[54:55], v22 offset:25600
    ds_read_b64_tr_b16 v[56:57], v23 offset:24576
    ds_read_b64_tr_b16 v[58:59], v23 offset:25600
    s_waitcnt lgkmcnt(6)
    v_mfma_f32_32x32x16_bf16 v[80:95], v[68:71], v[60:63], v[80:95]
    v_mfma_f32_32x32x16_bf16 v[96:111], v[68:71], v[64:67], v[96:111]
    v_mfma_f32_32x32x16_bf16 v[112:127], v[72:75], v[60:63], v[112:127]
    v_mfma_f32_32x32x16_bf16 v[128:143], v[72:75], v[64:67], v[128:143]
    ds_read_b128 v[60:63], v21 offset:16384
    ds_read_b128 v[64:67], v21 offset:20480
    ds_read_b64_tr_b16 v[68:69], v22 offset:28672
    ds_read_b64_tr_b16 v[70:71], v22 offset:29696
    ds_read_b64_tr_b16 v[72:73], v23 offset:28672
    ds_read_b64_tr_b16 v[74:75], v23 offset:29696
    s_waitcnt lgkmcnt(6)
    v_mfma_f32_32x32x16_bf16 v[80:95], v[52:55], v[44:47], v[80:95]
    v_mfma_f32_32x32x16_bf16 v[96:111], v[52:55], v[48:51], v[96:111]
    v_mfma_f32_32x32x16_bf16 v[112:127], v[56:59], v[44:47], v[112:127]
    v_mfma_f32_32x32x16_bf16 v[128:143], v[56:59], v[48:51], v[128:143]
    s_waitcnt lgkmcnt(0)
    v_mfma_f32_32x32x16_bf16 v[80:95], v[68:71], v[60:63], v[80:95]
    v_mfma_f32_32x32x16_bf16 v[96:111], v[68:71], v[64:67], v[96:111]
    v_mfma_f32_32x32x16_bf16 v[112:127], v[72:75], v[60:63], v[112:127]
    v_mfma_f32_32x32x16_bf16 v[128:143], v[72:75], v[64:67], v[128:143]
    s_barrier
    ds_read_b128 v[44:47], v18 offset:32768
    ds_read_b128 v[48:51], v18 offset:36864
    ds_read_b64_tr_b16 v[52:53], v22 offset:32768
    ds_read_b64_tr_b16 v[54:55], v22 offset:33792
    ds_read_b64_tr_b16 v[56:57], v23 offset:32768
    ds_read_b64_tr_b16 v[58:59], v23 offset:33792
    ds_read_b128 v[60:63], v19 offset:32768
    ds_read_b128 v[64:67], v19 offset:36864
    ds_read_b64_tr_b16 v[68:69], v22 offset:36864
    ds_read_b64_tr_b16 v[70:71], v22 offset:37888
    ds_read_b64_tr_b16 v[72:73], v23 offset:36864
    ds_read_b64_tr_b16 v[74:75], v23 offset:37888
    s_waitcnt lgkmcnt(6)
    v_mfma_f32_32x32x16_bf16 v[80:95], v[52:55], v[44:47], v[80:95]
    v_mfma_f32_32x32x16_bf16 v[96:111], v[52:55], v[48:51], v[96:111]
    v_mfma_f32_32x32x16_bf16 v[112:127], v[56:59], v[44:47], v[112:127]
    v_mfma_f32_32x32x16_bf16 v[128:143], v[56:59], v[48:51], v[128:143]
    ds_read_b128 v[44:47], v20 offset:32768
    ds_read_b128 v[48:51], v20 offset:36864
    ds_read_b64_tr_b16 v[52:53], v22 offset:40960
    ds_read_b64_tr_b16 v[54:55], v22 offset:41984
    ds_read_b64_tr_b16 v[56:57], v23 offset:40960
    ds_read_b64_tr_b16 v[58:59], v23 offset:41984
    s_waitcnt lgkmcnt(6)
    v_mfma_f32_32x32x16_bf16 v[80:95], v[68:71], v[60:63], v[80:95]
    v_mfma_f32_32x32x16_bf16 v[96:111], v[68:71], v[64:67], v[96:111]
    v_mfma_f32_32x32x16_bf16 v[112:127], v[72:75], v[60:63], v[112:127]
    v_mfma_f32_32x32x16_bf16 v[128:143], v[72:75], v[64:67], v[128:143]
    ds_read_b128 v[60:63], v21 offset:32768
    ds_read_b128 v[64:67], v21 offset:36864
    ds_read_b64_tr_b16 v[68:69], v22 offset:45056
    ds_read_b64_tr_b16 v[70:71], v22 offset:46080
    ds_read_b64_tr_b16 v[72:73], v23 offset:45056
    ds_read_b64_tr_b16 v[74:75], v23 offset:46080
    s_waitcnt lgkmcnt(6)
    v_mfma_f32_32x32x16_bf16 v[80:95], v[52:55], v[44:47], v[80:95]
    v_mfma_f32_32x32x16_bf16 v[96:111], v[52:55], v[48:51], v[96:111]
    v_mfma_f32_32x32x16_bf16 v[112:127], v[56:59], v[44:47], v[112:127]
    v_mfma_f32_32x32x16_bf16 v[128:143], v[56:59], v[48:51], v[128:143]
    s_waitcnt lgkmcnt(0)
    v_mfma_f32_32x32x16_bf16 v[80:95], v[68:71], v[60:63], v[80:95]
    v_mfma_f32_32x32x16_bf16 v[96:111], v[68:71], v[64:67], v[96:111]
    v_mfma_f32_32x32x16_bf16 v[112:127], v[72:75], v[60:63], v[112:127]
    v_mfma_f32_32x32x16_bf16 v[128:143], v[72:75], v[64:67], v[128:143]
    s_add_u32 s28, s70, 31096832
    s_addc_u32 s29, s71, 0
    s_mov_b32 s30, 81920
    s_mov_b32 s31, 0x00020000
    s_add_u32 s32, s70, 31260672
    s_addc_u32 s33, s71, 0
    s_mov_b32 s34, 7680
    s_mov_b32 s35, 0x00020000
    s_mul_i32 s46, s72, 64
    s_add_u32 s46, s46, s38
    v_and_b32 v2, 31, v1
    v_add_u32 v2, s46, v2
    v_lshlrev_b32 v2, 3, v2
    s_mov_b32 s47, 0
    buffer_load_dwordx2 v[148:149], v2, s[28:31], s47 offen offset:0
    s_mov_b32 s47, 16384
    buffer_load_dwordx2 v[150:151], v2, s[28:31], s47 offen offset:0
    s_mov_b32 s47, 32768
    buffer_load_dwordx2 v[152:153], v2, s[28:31], s47 offen offset:0
    s_mov_b32 s47, 49152
    buffer_load_dwordx2 v[154:155], v2, s[28:31], s47 offen offset:0
    s_mov_b32 s47, 65536
    buffer_load_dwordx2 v[156:157], v2, s[28:31], s47 offen offset:0
    s_mov_b32 s47, 0
    buffer_load_dwordx2 v[158:159], v2, s[28:31], s47 offen offset:256
    s_mov_b32 s47, 16384
    buffer_load_dwordx2 v[160:161], v2, s[28:31], s47 offen offset:256
    s_mov_b32 s47, 32768
    buffer_load_dwordx2 v[162:163], v2, s[28:31], s47 offen offset:256
    s_mov_b32 s47, 49152
    buffer_load_dwordx2 v[164:165], v2, s[28:31], s47 offen offset:256
    s_mov_b32 s47, 65536
    buffer_load_dwordx2 v[166:167], v2, s[28:31], s47 offen offset:256
    s_mul_i32 s46, s73, 64
    s_add_u32 s46, s46, s39
    v_lshrrev_b32 v2, 5, v1
    v_lshlrev_b32 v2, 2, v2
    v_add_u32 v2, s46, v2
    v_lshlrev_b32 v2, 2, v2
    buffer_load_dwordx4 v[168:171], v2, s[32:35], 0 offen offset:0
    buffer_load_dwordx4 v[172:175], v2, s[32:35], 0 offen offset:32
    buffer_load_dwordx4 v[176:179], v2, s[32:35], 0 offen offset:64
    buffer_load_dwordx4 v[180:183], v2, s[32:35], 0 offen offset:96
    buffer_load_dwordx4 v[184:187], v2, s[32:35], 0 offen offset:128
    buffer_load_dwordx4 v[188:191], v2, s[32:35], 0 offen offset:160
    buffer_load_dwordx4 v[192:195], v2, s[32:35], 0 offen offset:192
    buffer_load_dwordx4 v[196:199], v2, s[32:35], 0 offen offset:224
    s_barrier
    ds_read_b128 v[44:47], v18 offset:49152
    ds_read_b128 v[48:51], v18 offset:53248
    ds_read_b64_tr_b16 v[52:53], v22 offset:49152
    ds_read_b64_tr_b16 v[54:55], v22 offset:50176
    ds_read_b64_tr_b16 v[56:57], v23 offset:49152
    ds_read_b64_tr_b16 v[58:59], v23 offset:50176
    ds_read_b128 v[60:63], v19 offset:49152
    ds_read_b128 v[64:67], v19 offset:53248
    ds_read_b64_tr_b16 v[68:69], v22 offset:53248
    ds_read_b64_tr_b16 v[70:71], v22 offset:54272
    ds_read_b64_tr_b16 v[72:73], v23 offset:53248
    ds_read_b64_tr_b16 v[74:75], v23 offset:54272
    s_waitcnt lgkmcnt(6)
    v_mfma_f32_32x32x16_bf16 v[80:95], v[52:55], v[44:47], v[80:95]
    v_mfma_f32_32x32x16_bf16 v[96:111], v[52:55], v[48:51], v[96:111]
    v_mfma_f32_32x32x16_bf16 v[112:127], v[56:59], v[44:47], v[112:127]
    v_mfma_f32_32x32x16_bf16 v[128:143], v[56:59], v[48:51], v[128:143]
    ds_read_b128 v[44:47], v20 offset:49152
    ds_read_b128 v[48:51], v20 offset:53248
    ds_read_b64_tr_b16 v[52:53], v22 offset:57344
    ds_read_b64_tr_b16 v[54:55], v22 offset:58368
    ds_read_b64_tr_b16 v[56:57], v23 offset:57344
    ds_read_b64_tr_b16 v[58:59], v23 offset:58368
    s_waitcnt lgkmcnt(6)
    v_mfma_f32_32x32x16_bf16 v[80:95], v[68:71], v[60:63], v[80:95]
    v_mfma_f32_32x32x16_bf16 v[96:111], v[68:71], v[64:67], v[96:111]
    v_mfma_f32_32x32x16_bf16 v[112:127], v[72:75], v[60:63], v[112:127]
    v_mfma_f32_32x32x16_bf16 v[128:143], v[72:75], v[64:67], v[128:143]
    ds_read_b128 v[60:63], v21 offset:49152
    ds_read_b128 v[64:67], v21 offset:53248
    ds_read_b64_tr_b16 v[68:69], v22 offset:61440
    ds_read_b64_tr_b16 v[70:71], v22 offset:62464
    ds_read_b64_tr_b16 v[72:73], v23 offset:61440
    ds_read_b64_tr_b16 v[74:75], v23 offset:62464
    s_waitcnt lgkmcnt(6)
    v_mfma_f32_32x32x16_bf16 v[80:95], v[52:55], v[44:47], v[80:95]
    v_mfma_f32_32x32x16_bf16 v[96:111], v[52:55], v[48:51], v[96:111]
    v_mfma_f32_32x32x16_bf16 v[112:127], v[56:59], v[44:47], v[112:127]
    v_mfma_f32_32x32x16_bf16 v[128:143], v[56:59], v[48:51], v[128:143]
    s_waitcnt lgkmcnt(0)
    v_mfma_f32_32x32x16_bf16 v[80:95], v[68:71], v[60:63], v[80:95]
    v_mfma_f32_32x32x16_bf16 v[96:111], v[68:71], v[64:67], v[96:111]
    v_mfma_f32_32x32x16_bf16 v[112:127], v[72:75], v[60:63], v[112:127]
    v_mfma_f32_32x32x16_bf16 v[128:143], v[72:75], v[64:67], v[128:143]
    s_barrier
    ds_read_b128 v[44:47], v18 offset:0
    ds_read_b128 v[48:51], v18 offset:4096
    ds_read_b64_tr_b16 v[52:53], v22 offset:0
    ds_read_b64_tr_b16 v[54:55], v22 offset:1024
    ds_read_b64_tr_b16 v[56:57], v23 offset:0
    ds_read_b64_tr_b16 v[58:59], v23 offset:1024
    ds_read_b128 v[60:63], v19 offset:0
    ds_read_b128 v[64:67], v19 offset:4096
    ds_read_b64_tr_b16 v[68:69], v22 offset:4096
    ds_read_b64_tr_b16 v[70:71], v22 offset:5120
    ds_read_b64_tr_b16 v[72:73], v23 offset:4096
    ds_read_b64_tr_b16 v[74:75], v23 offset:5120
    s_waitcnt lgkmcnt(6)
    v_mfma_f32_32x32x16_bf16 v[80:95], v[52:55], v[44:47], v[80:95]
    v_mfma_f32_32x32x16_bf16 v[96:111], v[52:55], v[48:51], v[96:111]
    v_mfma_f32_32x32x16_bf16 v[112:127], v[56:59], v[44:47], v[112:127]
    v_mfma_f32_32x32x16_bf16 v[128:143], v[56:59], v[48:51], v[128:143]
    ds_read_b128 v[44:47], v20 offset:0
    ds_read_b128 v[48:51], v20 offset:4096
    ds_read_b64_tr_b16 v[52:53], v22 offset:8192
    ds_read_b64_tr_b16 v[54:55], v22 offset:9216
    ds_read_b64_tr_b16 v[56:57], v23 offset:8192
    ds_read_b64_tr_b16 v[58:59], v23 offset:9216
    s_waitcnt lgkmcnt(6)
    v_mfma_f32_32x32x16_bf16 v[80:95], v[68:71], v[60:63], v[80:95]
    v_mfma_f32_32x32x16_bf16 v[96:111], v[68:71], v[64:67], v[96:111]
    v_mfma_f32_32x32x16_bf16 v[112:127], v[72:75], v[60:63], v[112:127]
    v_mfma_f32_32x32x16_bf16 v[128:143], v[72:75], v[64:67], v[128:143]
    ds_read_b128 v[60:63], v21 offset:0
    ds_read_b128 v[64:67], v21 offset:4096
    ds_read_b64_tr_b16 v[68:69], v22 offset:12288
    ds_read_b64_tr_b16 v[70:71], v22 offset:13312
    ds_read_b64_tr_b16 v[72:73], v23 offset:12288
    ds_read_b64_tr_b16 v[74:75], v23 offset:13312
    s_waitcnt lgkmcnt(6)
    v_mfma_f32_32x32x16_bf16 v[80:95], v[52:55], v[44:47], v[80:95]
    v_mfma_f32_32x32x16_bf16 v[96:111], v[52:55], v[48:51], v[96:111]
    v_mfma_f32_32x32x16_bf16 v[112:127], v[56:59], v[44:47], v[112:127]
    v_mfma_f32_32x32x16_bf16 v[128:143], v[56:59], v[48:51], v[128:143]
    s_waitcnt lgkmcnt(0)
    v_mfma_f32_32x32x16_bf16 v[80:95], v[68:71], v[60:63], v[80:95]
    v_mfma_f32_32x32x16_bf16 v[96:111], v[68:71], v[64:67], v[96:111]
    v_mfma_f32_32x32x16_bf16 v[112:127], v[72:75], v[60:63], v[112:127]
    v_mfma_f32_32x32x16_bf16 v[128:143], v[72:75], v[64:67], v[128:143]
    s_barrier
    ds_read_b128 v[44:47], v18 offset:16384
    ds_read_b128 v[48:51], v18 offset:20480
    ds_read_b64_tr_b16 v[52:53], v22 offset:16384
    ds_read_b64_tr_b16 v[54:55], v22 offset:17408
    ds_read_b64_tr_b16 v[56:57], v23 offset:16384
    ds_read_b64_tr_b16 v[58:59], v23 offset:17408
    ds_read_b128 v[60:63], v19 offset:16384
    ds_read_b128 v[64:67], v19 offset:20480
    ds_read_b64_tr_b16 v[68:69], v22 offset:20480
    ds_read_b64_tr_b16 v[70:71], v22 offset:21504
    ds_read_b64_tr_b16 v[72:73], v23 offset:20480
    ds_read_b64_tr_b16 v[74:75], v23 offset:21504
    s_waitcnt lgkmcnt(6)
    v_mfma_f32_32x32x16_bf16 v[80:95], v[52:55], v[44:47], v[80:95]
    v_mfma_f32_32x32x16_bf16 v[96:111], v[52:55], v[48:51], v[96:111]
    v_mfma_f32_32x32x16_bf16 v[112:127], v[56:59], v[44:47], v[112:127]
    v_mfma_f32_32x32x16_bf16 v[128:143], v[56:59], v[48:51], v[128:143]
    ds_read_b128 v[44:47], v20 offset:16384
    ds_read_b128 v[48:51], v20 offset:20480
    ds_read_b64_tr_b16 v[52:53], v22 offset:24576
    ds_read_b64_tr_b16 v[54:55], v22 offset:25600
    ds_read_b64_tr_b16 v[56:57], v23 offset:24576
    ds_read_b64_tr_b16 v[58:59], v23 offset:25600
    s_waitcnt lgkmcnt(6)
    v_mfma_f32_32x32x16_bf16 v[80:95], v[68:71], v[60:63], v[80:95]
    v_mfma_f32_32x32x16_bf16 v[96:111], v[68:71], v[64:67], v[96:111]
    v_mfma_f32_32x32x16_bf16 v[112:127], v[72:75], v[60:63], v[112:127]
    v_mfma_f32_32x32x16_bf16 v[128:143], v[72:75], v[64:67], v[128:143]
    ds_read_b128 v[60:63], v21 offset:16384
    ds_read_b128 v[64:67], v21 offset:20480
    ds_read_b64_tr_b16 v[68:69], v22 offset:28672
    ds_read_b64_tr_b16 v[70:71], v22 offset:29696
    ds_read_b64_tr_b16 v[72:73], v23 offset:28672
    ds_read_b64_tr_b16 v[74:75], v23 offset:29696
    s_waitcnt lgkmcnt(6)
    v_mfma_f32_32x32x16_bf16 v[80:95], v[52:55], v[44:47], v[80:95]
    v_mfma_f32_32x32x16_bf16 v[96:111], v[52:55], v[48:51], v[96:111]
    v_mfma_f32_32x32x16_bf16 v[112:127], v[56:59], v[44:47], v[112:127]
    v_mfma_f32_32x32x16_bf16 v[128:143], v[56:59], v[48:51], v[128:143]
    s_waitcnt lgkmcnt(0)
    v_mfma_f32_32x32x16_bf16 v[80:95], v[68:71], v[60:63], v[80:95]
    v_mfma_f32_32x32x16_bf16 v[96:111], v[68:71], v[64:67], v[96:111]
    v_mfma_f32_32x32x16_bf16 v[112:127], v[72:75], v[60:63], v[112:127]
    v_mfma_f32_32x32x16_bf16 v[128:143], v[72:75], v[64:67], v[128:143]
    s_barrier
    s_nop 15
    s_waitcnt vmcnt(0)
    v_add_f32 v148, v148, v150
    v_add_f32 v149, v149, v151
    v_add_f32 v148, v148, v152
    v_add_f32 v149, v149, v153
    v_add_f32 v148, v148, v154
    v_add_f32 v149, v149, v155
    v_add_f32 v148, v148, v156
    v_add_f32 v149, v149, v157
    v_mul_f32 v148, 0x3acccccd, v148
    v_mul_f32 v149, 0x3acccccd, v149
    v_fma_f32 v149, -v148, v148, v149
    v_max_f32 v149, 0, v149
    v_cvt_pk_bf16_f32 v2, v149, v149
    v_lshlrev_b32 v149, 16, v2
    v_add_f32 v149, 0x3727c5ac, v149
    v_cvt_pk_bf16_f32 v2, v149, v149
    v_lshlrev_b32 v149, 16, v2
    v_sqrt_f32 v149, v149
    s_nop 0
    v_cvt_pk_bf16_f32 v2, v149, v149
    v_lshlrev_b32 v149, 16, v2
    v_rcp_f32 v146, v149
    v_cvt_pk_bf16_f32 v2, v148, v148
    v_lshlrev_b32 v148, 16, v2
    v_mov_b32 v144, v148
    v_add_f32 v158, v158, v160
    v_add_f32 v159, v159, v161
    v_add_f32 v158, v158, v162
    v_add_f32 v159, v159, v163
    v_add_f32 v158, v158, v164
    v_add_f32 v159, v159, v165
    v_add_f32 v158, v158, v166
    v_add_f32 v159, v159, v167
    v_mul_f32 v158, 0x3acccccd, v158
    v_mul_f32 v159, 0x3acccccd, v159
    v_fma_f32 v159, -v158, v158, v159
    v_max_f32 v159, 0, v159
    v_cvt_pk_bf16_f32 v2, v159, v159
    v_lshlrev_b32 v159, 16, v2
    v_add_f32 v159, 0x3727c5ac, v159
    v_cvt_pk_bf16_f32 v2, v159, v159
    v_lshlrev_b32 v159, 16, v2
    v_sqrt_f32 v159, v159
    s_nop 0
    v_cvt_pk_bf16_f32 v2, v159, v159
    v_lshlrev_b32 v159, 16, v2
    v_rcp_f32 v147, v159
    v_cvt_pk_bf16_f32 v2, v158, v158
    v_lshlrev_b32 v158, 16, v2
    v_mov_b32 v145, v158
    v_fma_f32 v80, -v144, v168, v80
    v_mul_f32 v80, v146, v80
    v_fma_f32 v81, -v144, v169, v81
    v_mul_f32 v81, v146, v81
    v_fma_f32 v82, -v144, v170, v82
    v_mul_f32 v82, v146, v82
    v_fma_f32 v83, -v144, v171, v83
    v_mul_f32 v83, v146, v83
    v_cvt_pk_bf16_f32 v208, v80, v81
    v_cvt_pk_bf16_f32 v209, v82, v83
    ds_write_b64 v40, v[208:209] offset:0
    v_fma_f32 v84, -v144, v172, v84
    v_mul_f32 v84, v146, v84
    v_fma_f32 v85, -v144, v173, v85
    v_mul_f32 v85, v146, v85
    v_fma_f32 v86, -v144, v174, v86
    v_mul_f32 v86, v146, v86
    v_fma_f32 v87, -v144, v175, v87
    v_mul_f32 v87, v146, v87
    v_cvt_pk_bf16_f32 v208, v84, v85
    v_cvt_pk_bf16_f32 v209, v86, v87
    ds_write_b64 v40, v[208:209] offset:16
    v_fma_f32 v88, -v144, v176, v88
    v_mul_f32 v88, v146, v88
    v_fma_f32 v89, -v144, v177, v89
    v_mul_f32 v89, v146, v89
    v_fma_f32 v90, -v144, v178, v90
    v_mul_f32 v90, v146, v90
    v_fma_f32 v91, -v144, v179, v91
    v_mul_f32 v91, v146, v91
    v_cvt_pk_bf16_f32 v208, v88, v89
    v_cvt_pk_bf16_f32 v209, v90, v91
    ds_write_b64 v40, v[208:209] offset:32
    v_fma_f32 v92, -v144, v180, v92
    v_mul_f32 v92, v146, v92
    v_fma_f32 v93, -v144, v181, v93
    v_mul_f32 v93, v146, v93
    v_fma_f32 v94, -v144, v182, v94
    v_mul_f32 v94, v146, v94
    v_fma_f32 v95, -v144, v183, v95
    v_mul_f32 v95, v146, v95
    v_cvt_pk_bf16_f32 v208, v92, v93
    v_cvt_pk_bf16_f32 v209, v94, v95
    ds_write_b64 v40, v[208:209] offset:48
    v_fma_f32 v96, -v145, v168, v96
    v_mul_f32 v96, v147, v96
    v_fma_f32 v97, -v145, v169, v97
    v_mul_f32 v97, v147, v97
    v_fma_f32 v98, -v145, v170, v98
    v_mul_f32 v98, v147, v98
    v_fma_f32 v99, -v145, v171, v99
    v_mul_f32 v99, v147, v99
    v_cvt_pk_bf16_f32 v208, v96, v97
    v_cvt_pk_bf16_f32 v209, v98, v99
    ds_write_b64 v40, v[208:209] offset:8704
    v_fma_f32 v100, -v145, v172, v100
    v_mul_f32 v100, v147, v100
    v_fma_f32 v101, -v145, v173, v101
    v_mul_f32 v101, v147, v101
    v_fma_f32 v102, -v145, v174, v102
    v_mul_f32 v102, v147, v102
    v_fma_f32 v103, -v145, v175, v103
    v_mul_f32 v103, v147, v103
    v_cvt_pk_bf16_f32 v208, v100, v101
    v_cvt_pk_bf16_f32 v209, v102, v103
    ds_write_b64 v40, v[208:209] offset:8720
    v_fma_f32 v104, -v145, v176, v104
    v_mul_f32 v104, v147, v104
    v_fma_f32 v105, -v145, v177, v105
    v_mul_f32 v105, v147, v105
    v_fma_f32 v106, -v145, v178, v106
    v_mul_f32 v106, v147, v106
    v_fma_f32 v107, -v145, v179, v107
    v_mul_f32 v107, v147, v107
    v_cvt_pk_bf16_f32 v208, v104, v105
    v_cvt_pk_bf16_f32 v209, v106, v107
    ds_write_b64 v40, v[208:209] offset:8736
    v_fma_f32 v108, -v145, v180, v108
    v_mul_f32 v108, v147, v108
    v_fma_f32 v109, -v145, v181, v109
    v_mul_f32 v109, v147, v109
    v_fma_f32 v110, -v145, v182, v110
    v_mul_f32 v110, v147, v110
    v_fma_f32 v111, -v145, v183, v111
    v_mul_f32 v111, v147, v111
    v_cvt_pk_bf16_f32 v208, v108, v109
    v_cvt_pk_bf16_f32 v209, v110, v111
    ds_write_b64 v40, v[208:209] offset:8752
    v_fma_f32 v112, -v144, v184, v112
    v_mul_f32 v112, v146, v112
    v_fma_f32 v113, -v144, v185, v113
    v_mul_f32 v113, v146, v113
    v_fma_f32 v114, -v144, v186, v114
    v_mul_f32 v114, v146, v114
    v_fma_f32 v115, -v144, v187, v115
    v_mul_f32 v115, v146, v115
    v_cvt_pk_bf16_f32 v208, v112, v113
    v_cvt_pk_bf16_f32 v209, v114, v115
    ds_write_b64 v40, v[208:209] offset:64
    v_fma_f32 v116, -v144, v188, v116
    v_mul_f32 v116, v146, v116
    v_fma_f32 v117, -v144, v189, v117
    v_mul_f32 v117, v146, v117
    v_fma_f32 v118, -v144, v190, v118
    v_mul_f32 v118, v146, v118
    v_fma_f32 v119, -v144, v191, v119
    v_mul_f32 v119, v146, v119
    v_cvt_pk_bf16_f32 v208, v116, v117
    v_cvt_pk_bf16_f32 v209, v118, v119
    ds_write_b64 v40, v[208:209] offset:80
    v_fma_f32 v120, -v144, v192, v120
    v_mul_f32 v120, v146, v120
    v_fma_f32 v121, -v144, v193, v121
    v_mul_f32 v121, v146, v121
    v_fma_f32 v122, -v144, v194, v122
    v_mul_f32 v122, v146, v122
    v_fma_f32 v123, -v144, v195, v123
    v_mul_f32 v123, v146, v123
    v_cvt_pk_bf16_f32 v208, v120, v121
    v_cvt_pk_bf16_f32 v209, v122, v123
    ds_write_b64 v40, v[208:209] offset:96
    v_fma_f32 v124, -v144, v196, v124
    v_mul_f32 v124, v146, v124
    v_fma_f32 v125, -v144, v197, v125
    v_mul_f32 v125, v146, v125
    v_fma_f32 v126, -v144, v198, v126
    v_mul_f32 v126, v146, v126
    v_fma_f32 v127, -v144, v199, v127
    v_mul_f32 v127, v146, v127
    v_cvt_pk_bf16_f32 v208, v124, v125
    v_cvt_pk_bf16_f32 v209, v126, v127
    ds_write_b64 v40, v[208:209] offset:112
    v_fma_f32 v128, -v145, v184, v128
    v_mul_f32 v128, v147, v128
    v_fma_f32 v129, -v145, v185, v129
    v_mul_f32 v129, v147, v129
    v_fma_f32 v130, -v145, v186, v130
    v_mul_f32 v130, v147, v130
    v_fma_f32 v131, -v145, v187, v131
    v_mul_f32 v131, v147, v131
    v_cvt_pk_bf16_f32 v208, v128, v129
    v_cvt_pk_bf16_f32 v209, v130, v131
    ds_write_b64 v40, v[208:209] offset:8768
    v_fma_f32 v132, -v145, v188, v132
    v_mul_f32 v132, v147, v132
    v_fma_f32 v133, -v145, v189, v133
    v_mul_f32 v133, v147, v133
    v_fma_f32 v134, -v145, v190, v134
    v_mul_f32 v134, v147, v134
    v_fma_f32 v135, -v145, v191, v135
    v_mul_f32 v135, v147, v135
    v_cvt_pk_bf16_f32 v208, v132, v133
    v_cvt_pk_bf16_f32 v209, v134, v135
    ds_write_b64 v40, v[208:209] offset:8784
    v_fma_f32 v136, -v145, v192, v136
    v_mul_f32 v136, v147, v136
    v_fma_f32 v137, -v145, v193, v137
    v_mul_f32 v137, v147, v137
    v_fma_f32 v138, -v145, v194, v138
    v_mul_f32 v138, v147, v138
    v_fma_f32 v139, -v145, v195, v139
    v_mul_f32 v139, v147, v139
    v_cvt_pk_bf16_f32 v208, v136, v137
    v_cvt_pk_bf16_f32 v209, v138, v139
    ds_write_b64 v40, v[208:209] offset:8800
    v_fma_f32 v140, -v145, v196, v140
    v_mul_f32 v140, v147, v140
    v_fma_f32 v141, -v145, v197, v141
    v_mul_f32 v141, v147, v141
    v_fma_f32 v142, -v145, v198, v142
    v_mul_f32 v142, v147, v142
    v_fma_f32 v143, -v145, v199, v143
    v_mul_f32 v143, v147, v143
    v_cvt_pk_bf16_f32 v208, v140, v141
    v_cvt_pk_bf16_f32 v209, v142, v143
    ds_write_b64 v40, v[208:209] offset:8816
    s_waitcnt lgkmcnt(0)
    s_barrier
    ds_read_b128 v[80:83], v32
    ds_read_b128 v[84:87], v33
    ds_read_b128 v[88:91], v34
    ds_read_b128 v[92:95], v35
    ds_read_b128 v[96:99], v36
    ds_read_b128 v[100:103], v37
    ds_read_b128 v[104:107], v38
    ds_read_b128 v[108:111], v39
    s_waitcnt lgkmcnt(7)
    buffer_store_dwordx4 v[80:83], v24, s[16:19], 0 offen
    s_waitcnt lgkmcnt(6)
    buffer_store_dwordx4 v[84:87], v25, s[16:19], 0 offen
    s_waitcnt lgkmcnt(5)
    buffer_store_dwordx4 v[88:91], v26, s[16:19], 0 offen
    s_waitcnt lgkmcnt(4)
    buffer_store_dwordx4 v[92:95], v27, s[16:19], 0 offen
    s_waitcnt lgkmcnt(3)
    buffer_store_dwordx4 v[96:99], v28, s[16:19], 0 offen
    s_waitcnt lgkmcnt(2)
    buffer_store_dwordx4 v[100:103], v29, s[16:19], 0 offen
    s_waitcnt lgkmcnt(1)
    buffer_store_dwordx4 v[104:107], v30, s[16:19], 0 offen
    s_waitcnt lgkmcnt(0)
    buffer_store_dwordx4 v[108:111], v31, s[16:19], 0 offen
g1b_kernel_end1:
    s_endpgm
.globl kvb_kernel
.p2align 8
.type kvb_kernel,@function
kvb_kernel:
    s_cmp_ge_u32 s2, 256
    s_cbranch_scc1 kvb_kernel_end1
    s_load_dwordx16 s[48:63], s[0:1], 0
    s_load_dwordx8 s[64:71], s[0:1], 64
    v_and_b32 v1, 63, v0
    v_lshrrev_b32 v2, 6, v0
    s_nop 0
    v_readfirstlane_b32 s40, v2
    v_cmp_lt_u32 vcc, 31, v1
    s_mov_b64 s[46:47], vcc
    s_waitcnt lgkmcnt(0)
    s_mov_b32 s8, s70
    s_mov_b32 s9, s71
    s_mov_b32 s10, 7864320
    s_mov_b32 s11, 0x00020000
    s_add_u32 s12, s70, 31277056
    s_addc_u32 s13, s71, 0
    s_mov_b32 s14, 65536
    s_mov_b32 s15, 0x00020000
    s_add_u32 s16, s70, 31604736
    s_addc_u32 s17, s71, 0
    s_mov_b32 s18, 262144
    s_mov_b32 s19, 0x00020000
    s_and_b32 s41, s2, 7
    s_lshr_b32 s42, s2, 3
    s_lshl_b32 s45, s41, 8
    s_lshl_b32 s48, s40, 5
    s_add_u32 s45, s45, s48
    v_and_b32 v5, 31, v1
    v_add_u32 v7, s45, v5
    s_mov_b32 s48, 3840
    v_mul_lo_u32 v7, v7, s48
    v_lshrrev_b32 v6, 5, v1
    v_lshl_add_u32 v7, v6, 4, v7
    s_mul_i32 s48, s42, 40
    v_add_u32 v120, s48, v7
    buffer_load_dwordx4 v[16:19], v120, s[8:11], 0 offen offset:1280
    buffer_load_dwordx2 v[20:21], v120, s[8:11], 0 offen offset:1312
    buffer_load_dwordx4 v[112:115], v120, s[8:11], 0 offen offset:2560
    buffer_load_dwordx2 v[116:117], v120, s[8:11], 0 offen offset:2592
    s_lshl_b32 s43, s42, 11
    v_lshlrev_b32 v3, 4, v1
    buffer_load_dwordx4 v[24:27], v3, s[12:15], s43 offen
    buffer_load_dwordx4 v[28:31], v3, s[12:15], s43 offen offset:1024
    s_lshl_b32 s44, s40, 13
    v_mov_b32 v32, 0
    v_mov_b32 v33, 0
    v_mov_b32 v34, 0
    v_mov_b32 v35, 0
    v_lshlrev_b32 v4, 4, v1
    v_add_u32 v4, s44, v4
    ds_write_b128 v4, v[32:35] offset:0
    ds_write_b128 v4, v[32:35] offset:1024
    ds_write_b128 v4, v[32:35] offset:2048
    ds_write_b128 v4, v[32:35] offset:3072
    ds_write_b128 v4, v[32:35] offset:4096
    ds_write_b128 v4, v[32:35] offset:5120
    v_lshlrev_b32 v7, 7, v5
    v_lshl_add_u32 v7, v6, 3, v7
    v_add_u32 v121, s44, v7
    v_lshlrev_b32 v7, 6, v5
    v_lshl_add_u32 v7, v6, 4, v7
    v_add_u32 v7, 4096, v7
    v_add_u32 v122, s44, v7
    v_bfe_u32 v8, v1, 2, 2
    v_lshl_add_u32 v8, v6, 3, v8
    v_bfe_u32 v9, v1, 4, 1
    v_and_b32 v10, 3, v1
    v_lshlrev_b32 v10, 3, v10
    v_lshl_add_u32 v10, v9, 5, v10
    v_lshl_add_u32 v11, v8, 7, v10
    v_add_u32 v123, s44, v11
    v_lshl_add_u32 v11, v8, 6, v10
    v_add_u32 v11, 4096, v11
    v_add_u32 v124, s44, v11
    v_mov_b32 v32, 0
    v_mov_b32 v33, 0
    v_mov_b32 v34, 0
    v_mov_b32 v35, 0
    v_mov_b32 v36, 0
    v_mov_b32 v37, 0
    v_mov_b32 v38, 0
    v_mov_b32 v39, 0
    v_mov_b32 v40, 0
    v_mov_b32 v41, 0
    v_mov_b32 v42, 0
    v_mov_b32 v43, 0
    v_mov_b32 v44, 0
    v_mov_b32 v45, 0
    v_mov_b32 v46, 0
    v_mov_b32 v47, 0
    v_mov_b32 v48, 0
    v_mov_b32 v49, 0
    v_mov_b32 v50, 0
    v_mov_b32 v51, 0
    v_mov_b32 v52, 0
    v_mov_b32 v53, 0
    v_mov_b32 v54, 0
    v_mov_b32 v55, 0
    v_mov_b32 v56, 0
    v_mov_b32 v57, 0
    v_mov_b32 v58, 0
    v_mov_b32 v59, 0
    v_mov_b32 v60, 0
    v_mov_b32 v61, 0
    v_mov_b32 v62, 0
    v_mov_b32 v63, 0
    v_mov_b32 v64, 0
    v_mov_b32 v65, 0
    v_mov_b32 v66, 0
    v_mov_b32 v67, 0
    v_mov_b32 v68, 0
    v_mov_b32 v69, 0
    v_mov_b32 v70, 0
    v_mov_b32 v71, 0
    v_mov_b32 v72, 0
    v_mov_b32 v73, 0
    v_mov_b32 v74, 0
    v_mov_b32 v75, 0
    v_mov_b32 v76, 0
    v_mov_b32 v77, 0
    v_mov_b32 v78, 0
    v_mov_b32 v79, 0
    s_waitcnt vmcnt(0) lgkmcnt(0)
    v_cndmask_b32 v20, v20, 0, s[46:47]
    v_cndmask_b32 v21, v21, 0, s[46:47]
    v_mov_b32 v22, 0
    v_mov_b32 v23, 0
    v_mov_b32 v104, 0x3f80
    v_cndmask_b32 v116, v116, v104, s[46:47]
    v_cndmask_b32 v117, v117, 0, s[46:47]
    s_nop 1
    v_mfma_f32_32x32x16_bf16 v[32:47], v[24:27], v[16:19], v[32:47]
    v_mfma_f32_32x32x16_bf16 v[32:47], v[28:31], v[20:23], v[32:47]
    ds_write_b128 v122, v[112:115]
    v_add_u32 v105, 32, v122
    v_lshlrev_b32 v106, 3, v6
    v_sub_u32 v105, v105, v106
    ds_write_b64 v105, v[116:117]
    s_nop 15
    s_nop 3
    v_cvt_pk_bf16_f32 v108, v32, v33
    v_lshlrev_b32 v32, 16, v108
    v_and_b32 v33, 0xffff0000, v108
    v_cvt_pk_bf16_f32 v108, v34, v35
    v_lshlrev_b32 v34, 16, v108
    v_and_b32 v35, 0xffff0000, v108
    v_cvt_pk_bf16_f32 v108, v36, v37
    v_lshlrev_b32 v36, 16, v108
    v_and_b32 v37, 0xffff0000, v108
    v_cvt_pk_bf16_f32 v108, v38, v39
    v_lshlrev_b32 v38, 16, v108
    v_and_b32 v39, 0xffff0000, v108
    v_cvt_pk_bf16_f32 v108, v40, v41
    v_lshlrev_b32 v40, 16, v108
    v_and_b32 v41, 0xffff0000, v108
    v_cvt_pk_bf16_f32 v108, v42, v43
    v_lshlrev_b32 v42, 16, v108
    v_and_b32 v43, 0xffff0000, v108
    v_mov_b32 v110, 0x7f000000
    v_mov_b32 v111, 0xff000000
    v_mov_b32 v80, v32
    v_mov_b32 v92, v32
    v_mov_b32 v81, v33
    v_mov_b32 v93, v33
    v_mov_b32 v82, v34
    v_mov_b32 v94, v34
    v_mov_b32 v83, v35
    v_mov_b32 v95, v35
    v_mov_b32 v84, v36
    v_mov_b32 v96, v36
    v_mov_b32 v85, v37
    v_mov_b32 v97, v37
    v_mov_b32 v86, v38
    v_mov_b32 v98, v38
    v_mov_b32 v87, v39
    v_mov_b32 v99, v39
    v_cndmask_b32 v88, v40, v111, s[46:47]
    v_cndmask_b32 v100, v40, v110, s[46:47]
    v_cndmask_b32 v89, v41, v111, s[46:47]
    v_cndmask_b32 v101, v41, v110, s[46:47]
    v_cndmask_b32 v90, v42, v111, s[46:47]
    v_cndmask_b32 v102, v42, v110, s[46:47]
    v_cndmask_b32 v91, v43, v111, s[46:47]
    v_cndmask_b32 v103, v43, v110, s[46:47]
    v_max_f32 v104, v80, v81
    v_min_f32 v105, v92, v93
    v_max_f32 v104, v104, v82
    v_min_f32 v105, v105, v94
    v_max_f32 v104, v104, v83
    v_min_f32 v105, v105, v95
    v_max_f32 v104, v104, v84
    v_min_f32 v105, v105, v96
    v_max_f32 v104, v104, v85
    v_min_f32 v105, v105, v97
    v_max_f32 v104, v104, v86
    v_min_f32 v105, v105, v98
    v_max_f32 v104, v104, v87
    v_min_f32 v105, v105, v99
    v_max_f32 v104, v104, v88
    v_min_f32 v105, v105, v100
    v_max_f32 v104, v104, v89
    v_min_f32 v105, v105, v101
    v_max_f32 v104, v104, v90
    v_min_f32 v105, v105, v102
    v_max_f32 v104, v104, v91
    v_min_f32 v105, v105, v103
    v_mov_b32 v108, v104
    v_mov_b32 v109, v104
    s_nop 1
    v_permlane32_swap_b32 v108, v109
    s_nop 1
    v_max_f32 v104, v108, v109
    v_mov_b32 v108, v105
    v_mov_b32 v109, v105
    s_nop 1
    v_permlane32_swap_b32 v108, v109
    s_nop 1
    v_min_f32 v105, v108, v109
    v_mov_b32 v108, 0x3fb8aa3b
    v_sub_f32 v80, v80, v104
    v_sub_f32 v92, v105, v92
    v_mul_f32 v80, v108, v80
    v_mul_f32 v92, v108, v92
    v_sub_f32 v81, v81, v104
    v_sub_f32 v93, v105, v93
    v_mul_f32 v81, v108, v81
    v_mul_f32 v93, v108, v93
    v_sub_f32 v82, v82, v104
    v_sub_f32 v94, v105, v94
    v_mul_f32 v82, v108, v82
    v_mul_f32 v94, v108, v94
    v_sub_f32 v83, v83, v104
    v_sub_f32 v95, v105, v95
    v_mul_f32 v83, v108, v83
    v_mul_f32 v95, v108, v95
    v_sub_f32 v84, v84, v104
    v_sub_f32 v96, v105, v96
    v_mul_f32 v84, v108, v84
    v_mul_f32 v96, v108, v96
    v_sub_f32 v85, v85, v104
    v_sub_f32 v97, v105, v97
    v_mul_f32 v85, v108, v85
    v_mul_f32 v97, v108, v97
    v_sub_f32 v86, v86, v104
    v_sub_f32 v98, v105, v98
    v_mul_f32 v86, v108, v86
    v_mul_f32 v98, v108, v98
    v_sub_f32 v87, v87, v104
    v_sub_f32 v99, v105, v99
    v_mul_f32 v87, v108, v87
    v_mul_f32 v99, v108, v99
    v_sub_f32 v88, v88, v104
    v_sub_f32 v100, v105, v100
    v_mul_f32 v88, v108, v88
    v_mul_f32 v100, v108, v100
    v_sub_f32 v89, v89, v104
    v_sub_f32 v101, v105, v101
    v_mul_f32 v89, v108, v89
    v_mul_f32 v101, v108, v101
    v_sub_f32 v90, v90, v104
    v_sub_f32 v102, v105, v102
    v_mul_f32 v90, v108, v90
    v_mul_f32 v102, v108, v102
    v_sub_f32 v91, v91, v104
    v_sub_f32 v103, v105, v103
    v_mul_f32 v91, v108, v91
    v_mul_f32 v103, v108, v103
    v_exp_f32 v80, v80
    v_exp_f32 v92, v92
    v_exp_f32 v81, v81
    v_exp_f32 v93, v93
    v_exp_f32 v82, v82
    v_exp_f32 v94, v94
    v_exp_f32 v83, v83
    v_exp_f32 v95, v95
    v_exp_f32 v84, v84
    v_exp_f32 v96, v96
    v_exp_f32 v85, v85
    v_exp_f32 v97, v97
    v_exp_f32 v86, v86
    v_exp_f32 v98, v98
    v_exp_f32 v87, v87
    v_exp_f32 v99, v99
    v_exp_f32 v88, v88
    v_exp_f32 v100, v100
    v_exp_f32 v89, v89
    v_exp_f32 v101, v101
    v_exp_f32 v90, v90
    v_exp_f32 v102, v102
    v_exp_f32 v91, v91
    v_exp_f32 v103, v103
    v_add_f32 v106, v80, v81
    v_add_f32 v107, v92, v93
    v_add_f32 v106, v106, v82
    v_add_f32 v107, v107, v94
    v_add_f32 v106, v106, v83
    v_add_f32 v107, v107, v95
    v_add_f32 v106, v106, v84
    v_add_f32 v107, v107, v96
    v_add_f32 v106, v106, v85
    v_add_f32 v107, v107, v97
    v_add_f32 v106, v106, v86
    v_add_f32 v107, v107, v98
    v_add_f32 v106, v106, v87
    v_add_f32 v107, v107, v99
    v_add_f32 v106, v106, v88
    v_add_f32 v107, v107, v100
    v_add_f32 v106, v106, v89
    v_add_f32 v107, v107, v101
    v_add_f32 v106, v106, v90
    v_add_f32 v107, v107, v102
    v_add_f32 v106, v106, v91
    v_add_f32 v107, v107, v103
    v_mov_b32 v108, v106
    v_mov_b32 v109, v106
    s_nop 1
    v_permlane32_swap_b32 v108, v109
    s_nop 1
    v_add_f32 v106, v108, v109
    v_mov_b32 v108, v107
    v_mov_b32 v109, v107
    s_nop 1
    v_permlane32_swap_b32 v108, v109
    s_nop 1
    v_add_f32 v107, v108, v109
    v_rcp_f32 v106, v106
    v_rcp_f32 v107, v107
    s_nop 0
    v_mul_f32 v80, v80, v106
    v_mul_f32 v92, v92, v107
    v_mul_f32 v81, v81, v106
    v_mul_f32 v93, v93, v107
    v_mul_f32 v82, v82, v106
    v_mul_f32 v94, v94, v107
    v_mul_f32 v83, v83, v106
    v_mul_f32 v95, v95, v107
    v_mul_f32 v84, v84, v106
    v_mul_f32 v96, v96, v107
    v_mul_f32 v85, v85, v106
    v_mul_f32 v97, v97, v107
    v_mul_f32 v86, v86, v106
    v_mul_f32 v98, v98, v107
    v_mul_f32 v87, v87, v106
    v_mul_f32 v99, v99, v107
    v_mul_f32 v88, v88, v106
    v_mul_f32 v100, v100, v107
    v_mul_f32 v89, v89, v106
    v_mul_f32 v101, v101, v107
    v_mul_f32 v90, v90, v106
    v_mul_f32 v102, v102, v107
    v_mul_f32 v91, v91, v106
    v_mul_f32 v103, v103, v107
    v_cvt_pk_bf16_f32 v104, v80, v81
    v_cvt_pk_bf16_f32 v105, v82, v83
    ds_write_b64 v121, v[104:105] offset:0
    v_cvt_pk_bf16_f32 v104, v84, v85
    v_cvt_pk_bf16_f32 v105, v86, v87
    ds_write_b64 v121, v[104:105] offset:16
    v_cvt_pk_bf16_f32 v104, v88, v89
    v_cvt_pk_bf16_f32 v105, v90, v91
    ds_write_b64 v121, v[104:105] offset:32
    v_cvt_pk_bf16_f32 v104, v92, v93
    v_cvt_pk_bf16_f32 v105, v94, v95
    ds_write_b64 v121, v[104:105] offset:64
    v_cvt_pk_bf16_f32 v104, v96, v97
    v_cvt_pk_bf16_f32 v105, v98, v99
    ds_write_b64 v121, v[104:105] offset:80
    v_cvt_pk_bf16_f32 v104, v100, v101
    v_cvt_pk_bf16_f32 v105, v102, v103
    ds_write_b64 v121, v[104:105] offset:96
    s_waitcnt lgkmcnt(0)
    ds_read_b64_tr_b16 v[16:17], v124 offset:0
    ds_read_b64_tr_b16 v[18:19], v124 offset:256
    ds_read_b64_tr_b16 v[112:113], v123 offset:0
    ds_read_b64_tr_b16 v[114:115], v123 offset:512
    ds_read_b64_tr_b16 v[116:117], v123 offset:64
    ds_read_b64_tr_b16 v[118:119], v123 offset:576
    ds_read_b64_tr_b16 v[20:21], v124 offset:1024
    ds_read_b64_tr_b16 v[22:23], v124 offset:1280
    ds_read_b64_tr_b16 v[32:33], v123 offset:2048
    ds_read_b64_tr_b16 v[34:35], v123 offset:2560
    ds_read_b64_tr_b16 v[36:37], v123 offset:2112
    ds_read_b64_tr_b16 v[38:39], v123 offset:2624
    s_waitcnt lgkmcnt(0)
    v_mfma_f32_32x32x16_bf16 v[48:63], v[112:115], v[16:19], v[48:63]
    v_mfma_f32_32x32x16_bf16 v[64:79], v[116:119], v[16:19], v[64:79]
    v_mfma_f32_32x32x16_bf16 v[48:63], v[32:35], v[20:23], v[48:63]
    v_mfma_f32_32x32x16_bf16 v[64:79], v[36:39], v[20:23], v[64:79]
    s_nop 15
    s_nop 7
    s_barrier
    v_lshlrev_b32 v4, 4, v1
    v_add_u32 v4, s44, v4
    ds_write_b128 v4, v[48:51] offset:0
    ds_write_b128 v4, v[52:55] offset:1024
    ds_write_b128 v4, v[56:59] offset:2048
    ds_write_b128 v4, v[60:63] offset:3072
    ds_write_b128 v4, v[64:67] offset:4096
    ds_write_b128 v4, v[68:71] offset:5120
    ds_write_b128 v4, v[72:75] offset:6144
    ds_write_b128 v4, v[76:79] offset:7168
    s_waitcnt lgkmcnt(0)
    s_barrier
    v_lshlrev_b32 v4, 4, v0
    ds_read_b128 v[48:51], v4 offset:0
    ds_read_b128 v[52:55], v4 offset:8192
    ds_read_b128 v[56:59], v4 offset:16384
    ds_read_b128 v[60:63], v4 offset:24576
    ds_read_b128 v[64:67], v4 offset:32768
    ds_read_b128 v[68:71], v4 offset:40960
    ds_read_b128 v[72:75], v4 offset:49152
    ds_read_b128 v[76:79], v4 offset:57344
    s_waitcnt lgkmcnt(0)
    v_add_f32 v48, v48, v52
    v_add_f32 v49, v49, v53
    v_add_f32 v50, v50, v54
    v_add_f32 v51, v51, v55
    v_add_f32 v48, v48, v56
    v_add_f32 v49, v49, v57
    v_add_f32 v50, v50, v58
    v_add_f32 v51, v51, v59
    v_add_f32 v48, v48, v60
    v_add_f32 v49, v49, v61
    v_add_f32 v50, v50, v62
    v_add_f32 v51, v51, v63
    v_add_f32 v48, v48, v64
    v_add_f32 v49, v49, v65
    v_add_f32 v50, v50, v66
    v_add_f32 v51, v51, v67
    v_add_f32 v48, v48, v68
    v_add_f32 v49, v49, v69
    v_add_f32 v50, v50, v70
    v_add_f32 v51, v51, v71
    v_add_f32 v48, v48, v72
    v_add_f32 v49, v49, v73
    v_add_f32 v50, v50, v74
    v_add_f32 v51, v51, v75
    v_add_f32 v48, v48, v76
    v_add_f32 v49, v49, v77
    v_add_f32 v50, v50, v78
    v_add_f32 v51, v51, v79
    v_lshrrev_b32 v5, 6, v0
    v_lshrrev_b32 v6, 2, v5
    v_and_b32 v7, 3, v5
    v_lshlrev_b32 v7, 3, v7
    v_lshrrev_b32 v8, 5, v1
    v_lshl_add_u32 v7, v8, 2, v7
    v_lshl_add_u32 v7, v6, 5, v7
    v_and_b32 v8, 31, v1
    v_lshl_add_u32 v7, v7, 5, v8
    v_lshlrev_b32 v7, 2, v7
    s_lshl_b32 s48, s42, 13
    buffer_atomic_add_f32 v48, v7, s[16:19], s48 offen offset:0
    buffer_atomic_add_f32 v49, v7, s[16:19], s48 offen offset:128
    buffer_atomic_add_f32 v50, v7, s[16:19], s48 offen offset:256
    buffer_atomic_add_f32 v51, v7, s[16:19], s48 offen offset:384
kvb_kernel_end1:
    s_endpgm
.globl ob_kernel
.p2align 8
.type ob_kernel,@function
ob_kernel:
    s_cmp_ge_u32 s2, 256
    s_cbranch_scc1 ob_kernel_end1
    s_load_dwordx16 s[48:63], s[0:1], 0
    s_load_dwordx8 s[64:71], s[0:1], 64
    v_and_b32 v1, 63, v0
    v_lshrrev_b32 v2, 6, v0
    s_nop 0
    v_readfirstlane_b32 s40, v2
    v_cmp_lt_u32 vcc, 31, v1
    s_mov_b64 s[46:47], vcc
    s_waitcnt lgkmcnt(0)
    s_mov_b32 s8, s70
    s_mov_b32 s9, s71
    s_mov_b32 s10, 7864320
    s_mov_b32 s11, 0x00020000
    s_add_u32 s12, s70, 31277056
    s_addc_u32 s13, s71, 0
    s_mov_b32 s14, 65536
    s_mov_b32 s15, 0x00020000
    s_add_u32 s16, s70, 31604736
    s_addc_u32 s17, s71, 0
    s_mov_b32 s18, 262144
    s_mov_b32 s19, 0x00020000
    s_add_u32 s20, s70, 7864320
    s_addc_u32 s21, s71, 0
    s_mov_b32 s22, 2621440
    s_mov_b32 s23, 0x00020000
    s_and_b32 s41, s2, 31
    s_lshr_b32 s42, s2, 5
    s_lshl_b32 s42, s42, 2
    s_and_b32 s43, s40, 3
    s_add_u32 s42, s42, s43
    s_lshr_b32 s49, s40, 2
    v_and_b32 v5, 31, v1
    v_lshrrev_b32 v6, 5, v1
    s_lshl_b32 s45, s41, 6
    s_lshl_b32 s48, s49, 5
    s_add_u32 s50, s45, s48
    v_add_u32 v8, s50, v5
    s_mov_b32 s48, 3840
    v_mul_lo_u32 v8, v8, s48
    v_lshl_add_u32 v8, v6, 4, v8
    s_mul_i32 s48, s42, 40
    v_add_u32 v128, s48, v8
    buffer_load_dwordx4 v[16:19], v128, s[8:11], 0 offen
    buffer_load_dwordx2 v[20:21], v128, s[8:11], 0 offen offset:32
    s_lshl_b32 s43, s42, 11
    v_lshlrev_b32 v3, 4, v1
    buffer_load_dwordx4 v[24:27], v3, s[12:15], s43 offen
    buffer_load_dwordx4 v[28:31], v3, s[12:15], s43 offen offset:1024
    v_lshlrev_b32 v7, 9, v6
    v_lshl_add_u32 v7, v5, 2, v7
    s_lshl_b32 s48, s42, 13
    s_add_u32 s49, s48, 4096
    buffer_load_dword v112, v7, s[16:19], s48 offen offset:0
    buffer_load_dword v113, v7, s[16:19], s48 offen offset:128
    buffer_load_dword v114, v7, s[16:19], s48 offen offset:256
    buffer_load_dword v115, v7, s[16:19], s48 offen offset:384
    buffer_load_dword v116, v7, s[16:19], s48 offen offset:1024
    buffer_load_dword v117, v7, s[16:19], s48 offen offset:1152
    buffer_load_dword v118, v7, s[16:19], s48 offen offset:1280
    buffer_load_dword v119, v7, s[16:19], s48 offen offset:1408
    buffer_load_dword v120, v7, s[16:19], s48 offen offset:2048
    buffer_load_dword v121, v7, s[16:19], s48 offen offset:2176
    buffer_load_dword v122, v7, s[16:19], s48 offen offset:2304
    buffer_load_dword v123, v7, s[16:19], s48 offen offset:2432
    buffer_load_dword v124, v7, s[16:19], s48 offen offset:3072
    buffer_load_dword v125, v7, s[16:19], s48 offen offset:3200
    buffer_load_dword v126, v7, s[16:19], s48 offen offset:3328
    buffer_load_dword v127, v7, s[16:19], s48 offen offset:3456
    buffer_load_dword v64, v7, s[16:19], s49 offen offset:0
    buffer_load_dword v65, v7, s[16:19], s49 offen offset:128
    buffer_load_dword v66, v7, s[16:19], s49 offen offset:256
    buffer_load_dword v67, v7, s[16:19], s49 offen offset:384
    buffer_load_dword v68, v7, s[16:19], s49 offen offset:1024
    buffer_load_dword v69, v7, s[16:19], s49 offen offset:1152
    buffer_load_dword v70, v7, s[16:19], s49 offen offset:1280
    buffer_load_dword v71, v7, s[16:19], s49 offen offset:1408
    buffer_load_dword v72, v7, s[16:19], s49 offen offset:2048
    buffer_load_dword v73, v7, s[16:19], s49 offen offset:2176
    buffer_load_dword v74, v7, s[16:19], s49 offen offset:2304
    buffer_load_dword v75, v7, s[16:19], s49 offen offset:2432
    buffer_load_dword v76, v7, s[16:19], s49 offen offset:3072
    buffer_load_dword v77, v7, s[16:19], s49 offen offset:3200
    buffer_load_dword v78, v7, s[16:19], s49 offen offset:3328
    buffer_load_dword v79, v7, s[16:19], s49 offen offset:3456
    s_lshr_b32 s48, s40, 2
    s_mul_i32 s48, s48, 5632
    v_mul_u32_u24 v8, 176, v5
    v_lshl_add_u32 v8, v6, 3, v8
    v_add_u32 v8, s48, v8
    s_and_b32 s48, s40, 3
    s_mul_i32 s48, s48, 40
    v_add_u32 v129, s48, v8
    v_mov_b32 v102, 0
    v_mov_b32 v103, 0
    v_mov_b32 v110, 0
    v_mov_b32 v111, 0
    v_mov_b32 v32, 0
    v_mov_b32 v33, 0
    v_mov_b32 v34, 0
    v_mov_b32 v35, 0
    v_mov_b32 v36, 0
    v_mov_b32 v37, 0
    v_mov_b32 v38, 0
    v_mov_b32 v39, 0
    v_mov_b32 v40, 0
    v_mov_b32 v41, 0
    v_mov_b32 v42, 0
    v_mov_b32 v43, 0
    v_mov_b32 v44, 0
    v_mov_b32 v45, 0
    v_mov_b32 v46, 0
    v_mov_b32 v47, 0
    s_waitcnt vmcnt(32)
    v_cndmask_b32 v20, v20, 0, s[46:47]
    v_cndmask_b32 v21, v21, 0, s[46:47]
    v_mov_b32 v22, 0
    v_mov_b32 v23, 0
    s_nop 1
    v_mfma_f32_32x32x16_bf16 v[32:47], v[24:27], v[16:19], v[32:47]
    v_mfma_f32_32x32x16_bf16 v[32:47], v[28:31], v[20:23], v[32:47]
    s_waitcnt vmcnt(0)
    v_cvt_pk_bf16_f32 v48, v112, v113
    v_cvt_pk_bf16_f32 v49, v114, v115
    v_cvt_pk_bf16_f32 v50, v116, v117
    v_cvt_pk_bf16_f32 v51, v118, v119
    v_cvt_pk_bf16_f32 v52, v120, v121
    v_cvt_pk_bf16_f32 v53, v122, v123
    v_cvt_pk_bf16_f32 v54, v124, v125
    v_cvt_pk_bf16_f32 v55, v126, v127
    v_cvt_pk_bf16_f32 v56, v64, v65
    v_cvt_pk_bf16_f32 v57, v66, v67
    v_cvt_pk_bf16_f32 v58, v68, v69
    v_cvt_pk_bf16_f32 v59, v70, v71
    v_cvt_pk_bf16_f32 v60, v72, v73
    v_cvt_pk_bf16_f32 v61, v74, v75
    v_cvt_pk_bf16_f32 v62, v76, v77
    v_cvt_pk_bf16_f32 v63, v78, v79
    s_nop 3
    v_cvt_pk_bf16_f32 v92, v32, v33
    v_lshlrev_b32 v32, 16, v92
    v_and_b32 v33, 0xffff0000, v92
    v_cvt_pk_bf16_f32 v92, v34, v35
    v_lshlrev_b32 v34, 16, v92
    v_and_b32 v35, 0xffff0000, v92
    v_cvt_pk_bf16_f32 v92, v36, v37
    v_lshlrev_b32 v36, 16, v92
    v_and_b32 v37, 0xffff0000, v92
    v_cvt_pk_bf16_f32 v92, v38, v39
    v_lshlrev_b32 v38, 16, v92
    v_and_b32 v39, 0xffff0000, v92
    v_cvt_pk_bf16_f32 v92, v40, v41
    v_lshlrev_b32 v40, 16, v92
    v_and_b32 v41, 0xffff0000, v92
    v_cvt_pk_bf16_f32 v92, v42, v43
    v_lshlrev_b32 v42, 16, v92
    v_and_b32 v43, 0xffff0000, v92
    v_mov_b32 v94, 0x7f000000
    v_mov_b32 v95, 0xff000000
    v_mov_b32 v64, v32
    v_mov_b32 v76, v32
    v_mov_b32 v65, v33
    v_mov_b32 v77, v33
    v_mov_b32 v66, v34
    v_mov_b32 v78, v34
    v_mov_b32 v67, v35
    v_mov_b32 v79, v35
    v_mov_b32 v68, v36
    v_mov_b32 v80, v36
    v_mov_b32 v69, v37
    v_mov_b32 v81, v37
    v_mov_b32 v70, v38
    v_mov_b32 v82, v38
    v_mov_b32 v71, v39
    v_mov_b32 v83, v39
    v_cndmask_b32 v72, v40, v95, s[46:47]
    v_cndmask_b32 v84, v40, v94, s[46:47]
    v_cndmask_b32 v73, v41, v95, s[46:47]
    v_cndmask_b32 v85, v41, v94, s[46:47]
    v_cndmask_b32 v74, v42, v95, s[46:47]
    v_cndmask_b32 v86, v42, v94, s[46:47]
    v_cndmask_b32 v75, v43, v95, s[46:47]
    v_cndmask_b32 v87, v43, v94, s[46:47]
    v_max_f32 v88, v64, v65
    v_min_f32 v89, v76, v77
    v_max_f32 v88, v88, v66
    v_min_f32 v89, v89, v78
    v_max_f32 v88, v88, v67
    v_min_f32 v89, v89, v79
    v_max_f32 v88, v88, v68
    v_min_f32 v89, v89, v80
    v_max_f32 v88, v88, v69
    v_min_f32 v89, v89, v81
    v_max_f32 v88, v88, v70
    v_min_f32 v89, v89, v82
    v_max_f32 v88, v88, v71
    v_min_f32 v89, v89, v83
    v_max_f32 v88, v88, v72
    v_min_f32 v89, v89, v84
    v_max_f32 v88, v88, v73
    v_min_f32 v89, v89, v85
    v_max_f32 v88, v88, v74
    v_min_f32 v89, v89, v86
    v_max_f32 v88, v88, v75
    v_min_f32 v89, v89, v87
    v_mov_b32 v92, v88
    v_mov_b32 v93, v88
    s_nop 1
    v_permlane32_swap_b32 v92, v93
    s_nop 1
    v_max_f32 v88, v92, v93
    v_mov_b32 v92, v89
    v_mov_b32 v93, v89
    s_nop 1
    v_permlane32_swap_b32 v92, v93
    s_nop 1
    v_min_f32 v89, v92, v93
    v_mov_b32 v92, 0x3fb8aa3b
    v_sub_f32 v64, v64, v88
    v_sub_f32 v76, v89, v76
    v_mul_f32 v64, v92, v64
    v_mul_f32 v76, v92, v76
    v_sub_f32 v65, v65, v88
    v_sub_f32 v77, v89, v77
    v_mul_f32 v65, v92, v65
    v_mul_f32 v77, v92, v77
    v_sub_f32 v66, v66, v88
    v_sub_f32 v78, v89, v78
    v_mul_f32 v66, v92, v66
    v_mul_f32 v78, v92, v78
    v_sub_f32 v67, v67, v88
    v_sub_f32 v79, v89, v79
    v_mul_f32 v67, v92, v67
    v_mul_f32 v79, v92, v79
    v_sub_f32 v68, v68, v88
    v_sub_f32 v80, v89, v80
    v_mul_f32 v68, v92, v68
    v_mul_f32 v80, v92, v80
    v_sub_f32 v69, v69, v88
    v_sub_f32 v81, v89, v81
    v_mul_f32 v69, v92, v69
    v_mul_f32 v81, v92, v81
    v_sub_f32 v70, v70, v88
    v_sub_f32 v82, v89, v82
    v_mul_f32 v70, v92, v70
    v_mul_f32 v82, v92, v82
    v_sub_f32 v71, v71, v88
    v_sub_f32 v83, v89, v83
    v_mul_f32 v71, v92, v71
    v_mul_f32 v83, v92, v83
    v_sub_f32 v72, v72, v88
    v_sub_f32 v84, v89, v84
    v_mul_f32 v72, v92, v72
    v_mul_f32 v84, v92, v84
    v_sub_f32 v73, v73, v88
    v_sub_f32 v85, v89, v85
    v_mul_f32 v73, v92, v73
    v_mul_f32 v85, v92, v85
    v_sub_f32 v74, v74, v88
    v_sub_f32 v86, v89, v86
    v_mul_f32 v74, v92, v74
    v_mul_f32 v86, v92, v86
    v_sub_f32 v75, v75, v88
    v_sub_f32 v87, v89, v87
    v_mul_f32 v75, v92, v75
    v_mul_f32 v87, v92, v87
    v_exp_f32 v64, v64
    v_exp_f32 v76, v76
    v_exp_f32 v65, v65
    v_exp_f32 v77, v77
    v_exp_f32 v66, v66
    v_exp_f32 v78, v78
    v_exp_f32 v67, v67
    v_exp_f32 v79, v79
    v_exp_f32 v68, v68
    v_exp_f32 v80, v80
    v_exp_f32 v69, v69
    v_exp_f32 v81, v81
    v_exp_f32 v70, v70
    v_exp_f32 v82, v82
    v_exp_f32 v71, v71
    v_exp_f32 v83, v83
    v_exp_f32 v72, v72
    v_exp_f32 v84, v84
    v_exp_f32 v73, v73
    v_exp_f32 v85, v85
    v_exp_f32 v74, v74
    v_exp_f32 v86, v86
    v_exp_f32 v75, v75
    v_exp_f32 v87, v87
    v_add_f32 v90, v64, v65
    v_add_f32 v91, v76, v77
    v_add_f32 v90, v90, v66
    v_add_f32 v91, v91, v78
    v_add_f32 v90, v90, v67
    v_add_f32 v91, v91, v79
    v_add_f32 v90, v90, v68
    v_add_f32 v91, v91, v80
    v_add_f32 v90, v90, v69
    v_add_f32 v91, v91, v81
    v_add_f32 v90, v90, v70
    v_add_f32 v91, v91, v82
    v_add_f32 v90, v90, v71
    v_add_f32 v91, v91, v83
    v_add_f32 v90, v90, v72
    v_add_f32 v91, v91, v84
    v_add_f32 v90, v90, v73
    v_add_f32 v91, v91, v85
    v_add_f32 v90, v90, v74
    v_add_f32 v91, v91, v86
    v_add_f32 v90, v90, v75
    v_add_f32 v91, v91, v87
    v_mov_b32 v92, v90
    v_mov_b32 v93, v90
    s_nop 1
    v_permlane32_swap_b32 v92, v93
    s_nop 1
    v_add_f32 v90, v92, v93
    v_mov_b32 v92, v91
    v_mov_b32 v93, v91
    s_nop 1
    v_permlane32_swap_b32 v92, v93
    s_nop 1
    v_add_f32 v91, v92, v93
    v_rcp_f32 v90, v90
    v_rcp_f32 v91, v91
    s_nop 0
    v_mul_f32 v64, v64, v90
    v_mul_f32 v76, v76, v91
    v_mul_f32 v65, v65, v90
    v_mul_f32 v77, v77, v91
    v_mul_f32 v66, v66, v90
    v_mul_f32 v78, v78, v91
    v_mul_f32 v67, v67, v90
    v_mul_f32 v79, v79, v91
    v_mul_f32 v68, v68, v90
    v_mul_f32 v80, v80, v91
    v_mul_f32 v69, v69, v90
    v_mul_f32 v81, v81, v91
    v_mul_f32 v70, v70, v90
    v_mul_f32 v82, v82, v91
    v_mul_f32 v71, v71, v90
    v_mul_f32 v83, v83, v91
    v_mul_f32 v72, v72, v90
    v_mul_f32 v84, v84, v91
    v_mul_f32 v73, v73, v90
    v_mul_f32 v85, v85, v91
    v_mul_f32 v74, v74, v90
    v_mul_f32 v86, v86, v91
    v_mul_f32 v75, v75, v90
    v_mul_f32 v87, v87, v91
    v_cvt_pk_bf16_f32 v96, v64, v65
    v_cvt_pk_bf16_f32 v97, v66, v67
    v_cvt_pk_bf16_f32 v98, v68, v69
    v_cvt_pk_bf16_f32 v99, v70, v71
    v_cvt_pk_bf16_f32 v100, v72, v73
    v_cvt_pk_bf16_f32 v101, v74, v75
    v_cvt_pk_bf16_f32 v104, v76, v77
    v_cvt_pk_bf16_f32 v105, v78, v79
    v_cvt_pk_bf16_f32 v106, v80, v81
    v_cvt_pk_bf16_f32 v107, v82, v83
    v_cvt_pk_bf16_f32 v108, v84, v85
    v_cvt_pk_bf16_f32 v109, v86, v87
    v_mov_b32 v112, 0
    v_mov_b32 v113, 0
    v_mov_b32 v114, 0
    v_mov_b32 v115, 0
    v_mov_b32 v116, 0
    v_mov_b32 v117, 0
    v_mov_b32 v118, 0
    v_mov_b32 v119, 0
    v_mov_b32 v120, 0
    v_mov_b32 v121, 0
    v_mov_b32 v122, 0
    v_mov_b32 v123, 0
    v_mov_b32 v124, 0
    v_mov_b32 v125, 0
    v_mov_b32 v126, 0
    v_mov_b32 v127, 0
    s_nop 1
    v_mfma_f32_32x32x16_bf16 v[112:127], v[48:51], v[96:99], v[112:127]
    v_mfma_f32_32x32x16_bf16 v[112:127], v[52:55], v[100:103], v[112:127]
    v_mfma_f32_32x32x16_bf16 v[112:127], v[56:59], v[104:107], v[112:127]
    v_mfma_f32_32x32x16_bf16 v[112:127], v[60:63], v[108:111], v[112:127]
    s_nop 15
    s_nop 3
    v_mov_b32 v88, v120
    v_mov_b32 v89, v120
    s_nop 1
    v_permlane32_swap_b32 v89, v88
    s_nop 1
    v_cvt_pk_bf16_f32 v90, v88, v88
    v_lshlrev_b32 v88, 16, v90
    v_add_f32 v88, 0x358637bd, v88
    v_cvt_pk_bf16_f32 v90, v88, v88
    v_lshlrev_b32 v88, 16, v90
    v_rcp_f32 v88, v88
    s_nop 0
    v_cvt_pk_bf16_f32 v90, v112, v113
    v_cvt_pk_bf16_f32 v91, v114, v115
    v_lshlrev_b32 v112, 16, v90
    v_and_b32 v113, 0xffff0000, v90
    v_lshlrev_b32 v114, 16, v91
    v_and_b32 v115, 0xffff0000, v91
    v_mul_f32 v112, v112, v88
    v_mul_f32 v113, v113, v88
    v_mul_f32 v114, v114, v88
    v_mul_f32 v115, v115, v88
    v_cvt_pk_bf16_f32 v90, v112, v113
    v_cvt_pk_bf16_f32 v91, v114, v115
    ds_write_b64 v129, v[90:91] offset:0
    v_cvt_pk_bf16_f32 v90, v116, v117
    v_cvt_pk_bf16_f32 v91, v118, v119
    v_lshlrev_b32 v116, 16, v90
    v_and_b32 v117, 0xffff0000, v90
    v_lshlrev_b32 v118, 16, v91
    v_and_b32 v119, 0xffff0000, v91
    v_mul_f32 v116, v116, v88
    v_mul_f32 v117, v117, v88
    v_mul_f32 v118, v118, v88
    v_mul_f32 v119, v119, v88
    v_cvt_pk_bf16_f32 v90, v116, v117
    v_cvt_pk_bf16_f32 v91, v118, v119
    ds_write_b64 v129, v[90:91] offset:16
    v_cvt_pk_bf16_f32 v90, v120, v121
    v_cvt_pk_bf16_f32 v91, v122, v123
    v_lshlrev_b32 v120, 16, v90
    v_and_b32 v121, 0xffff0000, v90
    v_lshlrev_b32 v122, 16, v91
    v_and_b32 v123, 0xffff0000, v91
    v_mul_f32 v120, v120, v88
    v_mul_f32 v121, v121, v88
    v_mul_f32 v122, v122, v88
    v_mul_f32 v123, v123, v88
    v_cvt_pk_bf16_f32 v90, v120, v121
    v_cvt_pk_bf16_f32 v91, v122, v123
    s_mov_b64 s[50:51], exec
    s_andn2_b64 exec, exec, s[46:47]
    ds_write_b64 v129, v[90:91] offset:32
    s_mov_b64 exec, s[50:51]
    s_waitcnt lgkmcnt(0)
    s_barrier
    v_add_u32 v4, 0, v0
    s_mov_b32 s48, 205
    v_mul_u32_u24 v5, s48, v4
    v_lshrrev_b32 v5, 11, v5
    v_mul_u32_u24 v6, 10, v5
    v_sub_u32 v6, v4, v6
    v_mul_u32_u24 v7, 176, v5
    v_lshl_add_u32 v7, v6, 4, v7
    ds_read_b128 v[32:35], v7
    v_add_u32 v8, s45, v5
    s_mov_b32 s48, 1280
    v_mul_lo_u32 v8, v8, s48
    v_lshl_add_u32 v8, v6, 4, v8
    s_lshr_b32 s48, s2, 5
    s_mul_i32 s48, s48, 160
    s_waitcnt lgkmcnt(0)
    buffer_store_dwordx4 v[32:35], v8, s[20:23], s48 offen
    v_add_u32 v4, 512, v0
    s_mov_b32 s48, 205
    v_mul_u32_u24 v5, s48, v4
    v_lshrrev_b32 v5, 11, v5
    v_mul_u32_u24 v6, 10, v5
    v_sub_u32 v6, v4, v6
    v_mul_u32_u24 v7, 176, v5
    v_lshl_add_u32 v7, v6, 4, v7
    v_cmp_gt_u32 vcc, 640, v4
    s_and_saveexec_b64 s[50:51], vcc
    s_cbranch_execz ob_kernel_end1
    ds_read_b128 v[32:35], v7
    v_add_u32 v8, s45, v5
    s_mov_b32 s48, 1280
    v_mul_lo_u32 v8, v8, s48
    v_lshl_add_u32 v8, v6, 4, v8
    s_lshr_b32 s48, s2, 5
    s_mul_i32 s48, s48, 160
    s_waitcnt lgkmcnt(0)
    buffer_store_dwordx4 v[32:35], v8, s[20:23], s48 offen
ob_kernel_end1:
    s_endpgm
.globl g2b_kernel
.p2align 8
.type g2b_kernel,@function
g2b_kernel:
    s_cmp_ge_u32 s2, 160
    s_cbranch_scc1 g2b_kernel_end1
    s_load_dwordx16 s[48:63], s[0:1], 0
    s_load_dwordx8 s[64:71], s[0:1], 64
    v_and_b32 v1, 63, v0
    v_lshrrev_b32 v2, 6, v0
    s_and_b32 s46, s2, 7
    s_lshr_b32 s47, s2, 3
    s_mul_i32 s36, s47, 103
    s_lshr_b32 s36, s36, 9
    s_mul_i32 s3, s36, 5
    s_sub_u32 s37, s47, s3
    s_mul_i32 s46, s46, 4
    s_add_u32 s36, s36, s46
    s_mul_i32 s38, s36, 64
    s_mul_i32 s39, s37, 128
    v_readfirstlane_b32 s40, v2
    s_lshr_b32 s74, s40, 2
    s_and_b32 s40, s40, 3
    s_cmp_eq_u32 s74, 0
    s_cbranch_scc0 g2b_kernel_prod2
    s_branch g2b_kernel_cons3
g2b_kernel_prod2:
    s_mul_i32 s41, s38, 1280
    s_lshl_b32 s42, s39, 1
    s_mul_i32 s43, s40, 2048
    s_mul_i32 s44, s40, 4096
    s_add_u32 s44, s44, 32768
    s_mul_i32 s46, s40, 128
    s_add_u32 s46, s46, 0
    v_add_u32 v2, s46, v1
    v_lshrrev_b32 v3, 3, v2
    v_and_b32 v4, 7, v2
    v_bfe_u32 v5, v3, 1, 3
    v_xor_b32 v4, v4, v5
    v_lshlrev_b32 v4, 4, v4
    s_mov_b32 s47, 1280
    v_mad_u32_u24 v10, v3, s47, v4
    s_mul_i32 s46, s40, 128
    s_add_u32 s46, s46, 64
    v_add_u32 v2, s46, v1
    v_lshrrev_b32 v3, 3, v2
    v_and_b32 v4, 7, v2
    v_bfe_u32 v5, v3, 1, 3
    v_xor_b32 v4, v4, v5
    v_lshlrev_b32 v4, 4, v4
    s_mov_b32 s47, 1280
    v_mad_u32_u24 v11, v3, s47, v4
    s_mul_i32 s46, s40, 256
    s_add_u32 s46, s46, 0
    v_add_u32 v2, s46, v1
    v_lshrrev_b32 v3, 4, v2
    s_mov_b32 s47, 16
    v_mul_u32_u24 v4, s47, v3
    v_sub_u32 v4, v2, v4
    v_and_b32 v5, 3, v3
    v_lshlrev_b32 v5, 2, v5
    v_xor_b32 v4, v4, v5
    v_lshlrev_b32 v4, 4, v4
    s_mov_b32 s47, 1280
    v_mad_u32_u24 v12, v3, s47, v4
    s_mul_i32 s46, s40, 256
    s_add_u32 s46, s46, 64
    v_add_u32 v2, s46, v1
    v_lshrrev_b32 v3, 4, v2
    s_mov_b32 s47, 16
    v_mul_u32_u24 v4, s47, v3
    v_sub_u32 v4, v2, v4
    v_and_b32 v5, 3, v3
    v_lshlrev_b32 v5, 2, v5
    v_xor_b32 v4, v4, v5
    v_lshlrev_b32 v4, 4, v4
    s_mov_b32 s47, 1280
    v_mad_u32_u24 v13, v3, s47, v4
    s_mul_i32 s46, s40, 256
    s_add_u32 s46, s46, 128
    v_add_u32 v2, s46, v1
    v_lshrrev_b32 v3, 4, v2
    s_mov_b32 s47, 16
    v_mul_u32_u24 v4, s47, v3
    v_sub_u32 v4, v2, v4
    v_and_b32 v5, 3, v3
    v_lshlrev_b32 v5, 2, v5
    v_xor_b32 v4, v4, v5
    v_lshlrev_b32 v4, 4, v4
    s_mov_b32 s47, 1280
    v_mad_u32_u24 v14, v3, s47, v4
    s_mul_i32 s46, s40, 256
    s_add_u32 s46, s46, 192
    v_add_u32 v2, s46, v1
    v_lshrrev_b32 v3, 4, v2
    s_mov_b32 s47, 16
    v_mul_u32_u24 v4, s47, v3
    v_sub_u32 v4, v2, v4
    v_and_b32 v5, 3, v3
    v_lshlrev_b32 v5, 2, v5
    v_xor_b32 v4, v4, v5
    v_lshlrev_b32 v4, 4, v4
    s_mov_b32 s47, 1280
    v_mad_u32_u24 v15, v3, s47, v4
    s_waitcnt lgkmcnt(0)
    s_add_u32 s8, s70, 7864320
    s_addc_u32 s9, s71, 0
    s_mov_b32 s10, 2621440
    s_mov_b32 s11, 0x00020000
    s_mov_b32 s12, s54
    s_mov_b32 s13, s55
    s_mov_b32 s14, 819200
    s_mov_b32 s15, 0x00020000
    s_add_u32 m0, s43, 0
    s_nop 0
    buffer_load_dwordx4 v10, s[8:11], s41 offen lds
    s_add_u32 m0, s43, 1024
    s_nop 0
    buffer_load_dwordx4 v11, s[8:11], s41 offen lds
    s_add_u32 m0, s44, 0
    s_nop 0
    buffer_load_dwordx4 v12, s[12:15], s42 offen lds
    s_add_u32 m0, s44, 1024
    s_nop 0
    buffer_load_dwordx4 v13, s[12:15], s42 offen lds
    s_add_u32 m0, s44, 2048
    s_nop 0
    buffer_load_dwordx4 v14, s[12:15], s42 offen lds
    s_add_u32 m0, s44, 3072
    s_nop 0
    buffer_load_dwordx4 v15, s[12:15], s42 offen lds
    s_add_u32 s41, s41, 128
    s_add_u32 s42, s42, 81920
    s_add_u32 m0, s43, 8192
    s_nop 0
    buffer_load_dwordx4 v10, s[8:11], s41 offen lds
    s_add_u32 m0, s43, 9216
    s_nop 0
    buffer_load_dwordx4 v11, s[8:11], s41 offen lds
    s_add_u32 m0, s44, 16384
    s_nop 0
    buffer_load_dwordx4 v12, s[12:15], s42 offen lds
    s_add_u32 m0, s44, 17408
    s_nop 0
    buffer_load_dwordx4 v13, s[12:15], s42 offen lds
    s_add_u32 m0, s44, 18432
    s_nop 0
    buffer_load_dwordx4 v14, s[12:15], s42 offen lds
    s_add_u32 m0, s44, 19456
    s_nop 0
    buffer_load_dwordx4 v15, s[12:15], s42 offen lds
    s_add_u32 s41, s41, 128
    s_add_u32 s42, s42, 81920
    s_add_u32 m0, s43, 16384
    s_nop 0
    buffer_load_dwordx4 v10, s[8:11], s41 offen lds
    s_add_u32 m0, s43, 17408
    s_nop 0
    buffer_load_dwordx4 v11, s[8:11], s41 offen lds
    s_add_u32 m0, s44, 32768
    s_nop 0
    buffer_load_dwordx4 v12, s[12:15], s42 offen lds
    s_add_u32 m0, s44, 33792
    s_nop 0
    buffer_load_dwordx4 v13, s[12:15], s42 offen lds
    s_add_u32 m0, s44, 34816
    s_nop 0
    buffer_load_dwordx4 v14, s[12:15], s42 offen lds
    s_add_u32 m0, s44, 35840
    s_nop 0
    buffer_load_dwordx4 v15, s[12:15], s42 offen lds
    s_add_u32 s41, s41, 128
    s_add_u32 s42, s42, 81920
    s_waitcnt vmcnt(12)
    s_barrier
    s_add_u32 m0, s43, 24576
    s_nop 0
    buffer_load_dwordx4 v10, s[8:11], s41 offen lds
    s_add_u32 m0, s43, 25600
    s_nop 0
    buffer_load_dwordx4 v11, s[8:11], s41 offen lds
    s_add_u32 m0, s44, 49152
    s_nop 0
    buffer_load_dwordx4 v12, s[12:15], s42 offen lds
    s_add_u32 m0, s44, 50176
    s_nop 0
    buffer_load_dwordx4 v13, s[12:15], s42 offen lds
    s_add_u32 m0, s44, 51200
    s_nop 0
    buffer_load_dwordx4 v14, s[12:15], s42 offen lds
    s_add_u32 m0, s44, 52224
    s_nop 0
    buffer_load_dwordx4 v15, s[12:15], s42 offen lds
    s_add_u32 s41, s41, 128
    s_add_u32 s42, s42, 81920
    s_waitcnt vmcnt(12)
    s_barrier
    s_add_u32 m0, s43, 0
    s_nop 0
    buffer_load_dwordx4 v10, s[8:11], s41 offen lds
    s_add_u32 m0, s43, 1024
    s_nop 0
    buffer_load_dwordx4 v11, s[8:11], s41 offen lds
    s_add_u32 m0, s44, 0
    s_nop 0
    buffer_load_dwordx4 v12, s[12:15], s42 offen lds
    s_add_u32 m0, s44, 1024
    s_nop 0
    buffer_load_dwordx4 v13, s[12:15], s42 offen lds
    s_add_u32 m0, s44, 2048
    s_nop 0
    buffer_load_dwordx4 v14, s[12:15], s42 offen lds
    s_add_u32 m0, s44, 3072
    s_nop 0
    buffer_load_dwordx4 v15, s[12:15], s42 offen lds
    s_add_u32 s41, s41, 128
    s_add_u32 s42, s42, 81920
    s_waitcnt vmcnt(12)
    s_barrier
    s_add_u32 m0, s43, 8192
    s_nop 0
    buffer_load_dwordx4 v10, s[8:11], s41 offen lds
    s_add_u32 m0, s43, 9216
    s_nop 0
    buffer_load_dwordx4 v11, s[8:11], s41 offen lds
    s_add_u32 m0, s44, 16384
    s_nop 0
    buffer_load_dwordx4 v12, s[12:15], s42 offen lds
    s_add_u32 m0, s44, 17408
    s_nop 0
    buffer_load_dwordx4 v13, s[12:15], s42 offen lds
    s_add_u32 m0, s44, 18432
    s_nop 0
    buffer_load_dwordx4 v14, s[12:15], s42 offen lds
    s_add_u32 m0, s44, 19456
    s_nop 0
    buffer_load_dwordx4 v15, s[12:15], s42 offen lds
    s_add_u32 s41, s41, 128
    s_add_u32 s42, s42, 81920
    s_waitcnt vmcnt(12)
    s_barrier
    s_add_u32 m0, s43, 16384
    s_nop 0
    buffer_load_dwordx4 v10, s[8:11], s41 offen lds
    s_add_u32 m0, s43, 17408
    s_nop 0
    buffer_load_dwordx4 v11, s[8:11], s41 offen lds
    s_add_u32 m0, s44, 32768
    s_nop 0
    buffer_load_dwordx4 v12, s[12:15], s42 offen lds
    s_add_u32 m0, s44, 33792
    s_nop 0
    buffer_load_dwordx4 v13, s[12:15], s42 offen lds
    s_add_u32 m0, s44, 34816
    s_nop 0
    buffer_load_dwordx4 v14, s[12:15], s42 offen lds
    s_add_u32 m0, s44, 35840
    s_nop 0
    buffer_load_dwordx4 v15, s[12:15], s42 offen lds
    s_add_u32 s41, s41, 128
    s_add_u32 s42, s42, 81920
    s_waitcnt vmcnt(12)
    s_barrier
    s_add_u32 m0, s43, 24576
    s_nop 0
    buffer_load_dwordx4 v10, s[8:11], s41 offen lds
    s_add_u32 m0, s43, 25600
    s_nop 0
    buffer_load_dwordx4 v11, s[8:11], s41 offen lds
    s_add_u32 m0, s44, 49152
    s_nop 0
    buffer_load_dwordx4 v12, s[12:15], s42 offen lds
    s_add_u32 m0, s44, 50176
    s_nop 0
    buffer_load_dwordx4 v13, s[12:15], s42 offen lds
    s_add_u32 m0, s44, 51200
    s_nop 0
    buffer_load_dwordx4 v14, s[12:15], s42 offen lds
    s_add_u32 m0, s44, 52224
    s_nop 0
    buffer_load_dwordx4 v15, s[12:15], s42 offen lds
    s_add_u32 s41, s41, 128
    s_add_u32 s42, s42, 81920
    s_waitcnt vmcnt(12)
    s_barrier
    s_add_u32 m0, s43, 0
    s_nop 0
    buffer_load_dwordx4 v10, s[8:11], s41 offen lds
    s_add_u32 m0, s43, 1024
    s_nop 0
    buffer_load_dwordx4 v11, s[8:11], s41 offen lds
    s_add_u32 m0, s44, 0
    s_nop 0
    buffer_load_dwordx4 v12, s[12:15], s42 offen lds
    s_add_u32 m0, s44, 1024
    s_nop 0
    buffer_load_dwordx4 v13, s[12:15], s42 offen lds
    s_add_u32 m0, s44, 2048
    s_nop 0
    buffer_load_dwordx4 v14, s[12:15], s42 offen lds
    s_add_u32 m0, s44, 3072
    s_nop 0
    buffer_load_dwordx4 v15, s[12:15], s42 offen lds
    s_add_u32 s41, s41, 128
    s_add_u32 s42, s42, 81920
    s_waitcnt vmcnt(12)
    s_barrier
    s_add_u32 m0, s43, 8192
    s_nop 0
    buffer_load_dwordx4 v10, s[8:11], s41 offen lds
    s_add_u32 m0, s43, 9216
    s_nop 0
    buffer_load_dwordx4 v11, s[8:11], s41 offen lds
    s_add_u32 m0, s44, 16384
    s_nop 0
    buffer_load_dwordx4 v12, s[12:15], s42 offen lds
    s_add_u32 m0, s44, 17408
    s_nop 0
    buffer_load_dwordx4 v13, s[12:15], s42 offen lds
    s_add_u32 m0, s44, 18432
    s_nop 0
    buffer_load_dwordx4 v14, s[12:15], s42 offen lds
    s_add_u32 m0, s44, 19456
    s_nop 0
    buffer_load_dwordx4 v15, s[12:15], s42 offen lds
    s_add_u32 s41, s41, 128
    s_add_u32 s42, s42, 81920
    s_waitcnt vmcnt(12)
    s_barrier
    s_waitcnt vmcnt(6)
    s_barrier
    s_waitcnt vmcnt(0)
    s_barrier
    s_endpgm
g2b_kernel_cons3:
    s_waitcnt lgkmcnt(0)
    s_add_u32 s16, s70, 15728640
    s_addc_u32 s17, s71, 0
    s_mov_b32 s18, 2621440
    s_mov_b32 s19, 0x00020000
    s_lshr_b32 s72, s40, 1
    s_and_b32 s73, s40, 1
    s_mul_i32 s46, s72, 32
    v_and_b32 v2, 31, v1
    v_add_u32 v2, s46, v2
    v_lshrrev_b32 v3, 5, v1
    v_bfe_u32 v4, v2, 1, 3
    v_xor_b32 v3, v3, v4
    v_lshlrev_b32 v3, 4, v3
    v_lshl_add_u32 v16, v2, 7, v3
    v_xor_b32 v17, 32, v16
    v_xor_b32 v18, 64, v16
    v_xor_b32 v19, 96, v16
    s_mul_i32 s46, s73, 8
    s_add_u32 s46, s46, 0
    v_bfe_u32 v2, v1, 4, 1
    v_lshlrev_b32 v2, 1, v2
    v_bfe_u32 v3, v1, 1, 1
    v_add3_u32 v2, v2, v3, s46
    v_bfe_u32 v4, v1, 2, 2
    v_lshlrev_b32 v5, 2, v4
    v_xor_b32 v2, v2, v5
    v_lshlrev_b32 v2, 4, v2
    v_and_b32 v3, 1, v1
    v_lshl_add_u32 v2, v3, 3, v2
    v_lshrrev_b32 v3, 5, v1
    v_lshl_add_u32 v3, v3, 3, v4
    s_mov_b32 s47, 256
    v_mad_u32_u24 v2, v3, s47, v2
    v_add_u32 v20, 32768, v2
    s_mul_i32 s46, s73, 8
    s_add_u32 s46, s46, 4
    v_bfe_u32 v2, v1, 4, 1
    v_lshlrev_b32 v2, 1, v2
    v_bfe_u32 v3, v1, 1, 1
    v_add3_u32 v2, v2, v3, s46
    v_bfe_u32 v4, v1, 2, 2
    v_lshlrev_b32 v5, 2, v4
    v_xor_b32 v2, v2, v5
    v_lshlrev_b32 v2, 4, v2
    v_and_b32 v3, 1, v1
    v_lshl_add_u32 v2, v3, 3, v2
    v_lshrrev_b32 v3, 5, v1
    v_lshl_add_u32 v3, v3, 3, v4
    s_mov_b32 s47, 256
    v_mad_u32_u24 v2, v3, s47, v2
    v_add_u32 v21, 32768, v2
    s_mul_i32 s46, s72, 32
    v_and_b32 v2, 31, v1
    v_add_u32 v2, s46, v2
    s_mov_b32 s47, 272
    v_mul_u32_u24 v2, s47, v2
    s_mul_i32 s46, s73, 128
    v_lshrrev_b32 v3, 5, v1
    v_lshlrev_b32 v3, 3, v3
    v_add3_u32 v30, v2, v3, s46
    v_add_u32 v2, 0, v0
    v_lshrrev_b32 v6, 4, v2
    s_mov_b32 s46, 16
    v_mul_u32_u24 v7, s46, v6
    v_sub_u32 v7, v2, v7
    s_mov_b32 s46, 272
    v_mul_u32_u24 v26, s46, v6
    v_lshl_add_u32 v26, v7, 4, v26
    v_add_u32 v22, s38, v6
    s_mov_b32 s46, 1280
    v_mul_lo_u32 v22, v22, s46
    v_lshl_add_u32 v22, v7, 4, v22
    s_lshl_b32 s46, s39, 1
    v_add_u32 v22, s46, v22
    v_add_u32 v2, 256, v0
    v_lshrrev_b32 v6, 4, v2
    s_mov_b32 s46, 16
    v_mul_u32_u24 v7, s46, v6
    v_sub_u32 v7, v2, v7
    s_mov_b32 s46, 272
    v_mul_u32_u24 v27, s46, v6
    v_lshl_add_u32 v27, v7, 4, v27
    v_add_u32 v23, s38, v6
    s_mov_b32 s46, 1280
    v_mul_lo_u32 v23, v23, s46
    v_lshl_add_u32 v23, v7, 4, v23
    s_lshl_b32 s46, s39, 1
    v_add_u32 v23, s46, v23
    v_add_u32 v2, 512, v0
    v_lshrrev_b32 v6, 4, v2
    s_mov_b32 s46, 16
    v_mul_u32_u24 v7, s46, v6
    v_sub_u32 v7, v2, v7
    s_mov_b32 s46, 272
    v_mul_u32_u24 v28, s46, v6
    v_lshl_add_u32 v28, v7, 4, v28
    v_add_u32 v24, s38, v6
    s_mov_b32 s46, 1280
    v_mul_lo_u32 v24, v24, s46
    v_lshl_add_u32 v24, v7, 4, v24
    s_lshl_b32 s46, s39, 1
    v_add_u32 v24, s46, v24
    v_add_u32 v2, 768, v0
    v_lshrrev_b32 v6, 4, v2
    s_mov_b32 s46, 16
    v_mul_u32_u24 v7, s46, v6
    v_sub_u32 v7, v2, v7
    s_mov_b32 s46, 272
    v_mul_u32_u24 v29, s46, v6
    v_lshl_add_u32 v29, v7, 4, v29
    v_add_u32 v25, s38, v6
    s_mov_b32 s46, 1280
    v_mul_lo_u32 v25, v25, s46
    v_lshl_add_u32 v25, v7, 4, v25
    s_lshl_b32 s46, s39, 1
    v_add_u32 v25, s46, v25
    v_mov_b32 v64, 0
    v_mov_b32 v65, 0
    v_mov_b32 v66, 0
    v_mov_b32 v67, 0
    v_mov_b32 v68, 0
    v_mov_b32 v69, 0
    v_mov_b32 v70, 0
    v_mov_b32 v71, 0
    v_mov_b32 v72, 0
    v_mov_b32 v73, 0
    v_mov_b32 v74, 0
    v_mov_b32 v75, 0
    v_mov_b32 v76, 0
    v_mov_b32 v77, 0
    v_mov_b32 v78, 0
    v_mov_b32 v79, 0
    v_mov_b32 v80, 0
    v_mov_b32 v81, 0
    v_mov_b32 v82, 0
    v_mov_b32 v83, 0
    v_mov_b32 v84, 0
    v_mov_b32 v85, 0
    v_mov_b32 v86, 0
    v_mov_b32 v87, 0
    v_mov_b32 v88, 0
    v_mov_b32 v89, 0
    v_mov_b32 v90, 0
    v_mov_b32 v91, 0
    v_mov_b32 v92, 0
    v_mov_b32 v93, 0
    v_mov_b32 v94, 0
    v_mov_b32 v95, 0
    s_barrier
    ds_read_b128 v[32:35], v16 offset:0
    ds_read_b64_tr_b16 v[36:37], v20 offset:0
    ds_read_b64_tr_b16 v[38:39], v20 offset:1024
    ds_read_b64_tr_b16 v[40:41], v21 offset:0
    ds_read_b64_tr_b16 v[42:43], v21 offset:1024
    ds_read_b128 v[44:47], v17 offset:0
    ds_read_b64_tr_b16 v[48:49], v20 offset:4096
    ds_read_b64_tr_b16 v[50:51], v20 offset:5120
    ds_read_b64_tr_b16 v[52:53], v21 offset:4096
    ds_read_b64_tr_b16 v[54:55], v21 offset:5120
    s_waitcnt lgkmcnt(5)
    v_mfma_f32_32x32x16_bf16 v[64:79], v[36:39], v[32:35], v[64:79]
    v_mfma_f32_32x32x16_bf16 v[80:95], v[40:43], v[32:35], v[80:95]
    ds_read_b128 v[32:35], v18 offset:0
    ds_read_b64_tr_b16 v[36:37], v20 offset:8192
    ds_read_b64_tr_b16 v[38:39], v20 offset:9216
    ds_read_b64_tr_b16 v[40:41], v21 offset:8192
    ds_read_b64_tr_b16 v[42:43], v21 offset:9216
    s_waitcnt lgkmcnt(5)
    v_mfma_f32_32x32x16_bf16 v[64:79], v[48:51], v[44:47], v[64:79]
    v_mfma_f32_32x32x16_bf16 v[80:95], v[52:55], v[44:47], v[80:95]
    ds_read_b128 v[44:47], v19 offset:0
    ds_read_b64_tr_b16 v[48:49], v20 offset:12288
    ds_read_b64_tr_b16 v[50:51], v20 offset:13312
    ds_read_b64_tr_b16 v[52:53], v21 offset:12288
    ds_read_b64_tr_b16 v[54:55], v21 offset:13312
    s_waitcnt lgkmcnt(5)
    v_mfma_f32_32x32x16_bf16 v[64:79], v[36:39], v[32:35], v[64:79]
    v_mfma_f32_32x32x16_bf16 v[80:95], v[40:43], v[32:35], v[80:95]
    s_waitcnt lgkmcnt(0)
    v_mfma_f32_32x32x16_bf16 v[64:79], v[48:51], v[44:47], v[64:79]
    v_mfma_f32_32x32x16_bf16 v[80:95], v[52:55], v[44:47], v[80:95]
    s_barrier
    ds_read_b128 v[32:35], v16 offset:8192
    ds_read_b64_tr_b16 v[36:37], v20 offset:16384
    ds_read_b64_tr_b16 v[38:39], v20 offset:17408
    ds_read_b64_tr_b16 v[40:41], v21 offset:16384
    ds_read_b64_tr_b16 v[42:43], v21 offset:17408
    ds_read_b128 v[44:47], v17 offset:8192
    ds_read_b64_tr_b16 v[48:49], v20 offset:20480
    ds_read_b64_tr_b16 v[50:51], v20 offset:21504
    ds_read_b64_tr_b16 v[52:53], v21 offset:20480
    ds_read_b64_tr_b16 v[54:55], v21 offset:21504
    s_waitcnt lgkmcnt(5)
    v_mfma_f32_32x32x16_bf16 v[64:79], v[36:39], v[32:35], v[64:79]
    v_mfma_f32_32x32x16_bf16 v[80:95], v[40:43], v[32:35], v[80:95]
    ds_read_b128 v[32:35], v18 offset:8192
    ds_read_b64_tr_b16 v[36:37], v20 offset:24576
    ds_read_b64_tr_b16 v[38:39], v20 offset:25600
    ds_read_b64_tr_b16 v[40:41], v21 offset:24576
    ds_read_b64_tr_b16 v[42:43], v21 offset:25600
    s_waitcnt lgkmcnt(5)
    v_mfma_f32_32x32x16_bf16 v[64:79], v[48:51], v[44:47], v[64:79]
    v_mfma_f32_32x32x16_bf16 v[80:95], v[52:55], v[44:47], v[80:95]
    ds_read_b128 v[44:47], v19 offset:8192
    ds_read_b64_tr_b16 v[48:49], v20 offset:28672
    ds_read_b64_tr_b16 v[50:51], v20 offset:29696
    ds_read_b64_tr_b16 v[52:53], v21 offset:28672
    ds_read_b64_tr_b16 v[54:55], v21 offset:29696
    s_waitcnt lgkmcnt(5)
    v_mfma_f32_32x32x16_bf16 v[64:79], v[36:39], v[32:35], v[64:79]
    v_mfma_f32_32x32x16_bf16 v[80:95], v[40:43], v[32:35], v[80:95]
    s_waitcnt lgkmcnt(0)
    v_mfma_f32_32x32x16_bf16 v[64:79], v[48:51], v[44:47], v[64:79]
    v_mfma_f32_32x32x16_bf16 v[80:95], v[52:55], v[44:47], v[80:95]
    s_barrier
    ds_read_b128 v[32:35], v16 offset:16384
    ds_read_b64_tr_b16 v[36:37], v20 offset:32768
    ds_read_b64_tr_b16 v[38:39], v20 offset:33792
    ds_read_b64_tr_b16 v[40:41], v21 offset:32768
    ds_read_b64_tr_b16 v[42:43], v21 offset:33792
    ds_read_b128 v[44:47], v17 offset:16384
    ds_read_b64_tr_b16 v[48:49], v20 offset:36864
    ds_read_b64_tr_b16 v[50:51], v20 offset:37888
    ds_read_b64_tr_b16 v[52:53], v21 offset:36864
    ds_read_b64_tr_b16 v[54:55], v21 offset:37888
    s_waitcnt lgkmcnt(5)
    v_mfma_f32_32x32x16_bf16 v[64:79], v[36:39], v[32:35], v[64:79]
    v_mfma_f32_32x32x16_bf16 v[80:95], v[40:43], v[32:35], v[80:95]
    ds_read_b128 v[32:35], v18 offset:16384
    ds_read_b64_tr_b16 v[36:37], v20 offset:40960
    ds_read_b64_tr_b16 v[38:39], v20 offset:41984
    ds_read_b64_tr_b16 v[40:41], v21 offset:40960
    ds_read_b64_tr_b16 v[42:43], v21 offset:41984
    s_waitcnt lgkmcnt(5)
    v_mfma_f32_32x32x16_bf16 v[64:79], v[48:51], v[44:47], v[64:79]
    v_mfma_f32_32x32x16_bf16 v[80:95], v[52:55], v[44:47], v[80:95]
    ds_read_b128 v[44:47], v19 offset:16384
    ds_read_b64_tr_b16 v[48:49], v20 offset:45056
    ds_read_b64_tr_b16 v[50:51], v20 offset:46080
    ds_read_b64_tr_b16 v[52:53], v21 offset:45056
    ds_read_b64_tr_b16 v[54:55], v21 offset:46080
    s_waitcnt lgkmcnt(5)
    v_mfma_f32_32x32x16_bf16 v[64:79], v[36:39], v[32:35], v[64:79]
    v_mfma_f32_32x32x16_bf16 v[80:95], v[40:43], v[32:35], v[80:95]
    s_waitcnt lgkmcnt(0)
    v_mfma_f32_32x32x16_bf16 v[64:79], v[48:51], v[44:47], v[64:79]
    v_mfma_f32_32x32x16_bf16 v[80:95], v[52:55], v[44:47], v[80:95]
    s_barrier
    ds_read_b128 v[32:35], v16 offset:24576
    ds_read_b64_tr_b16 v[36:37], v20 offset:49152
    ds_read_b64_tr_b16 v[38:39], v20 offset:50176
    ds_read_b64_tr_b16 v[40:41], v21 offset:49152
    ds_read_b64_tr_b16 v[42:43], v21 offset:50176
    ds_read_b128 v[44:47], v17 offset:24576
    ds_read_b64_tr_b16 v[48:49], v20 offset:53248
    ds_read_b64_tr_b16 v[50:51], v20 offset:54272
    ds_read_b64_tr_b16 v[52:53], v21 offset:53248
    ds_read_b64_tr_b16 v[54:55], v21 offset:54272
    s_waitcnt lgkmcnt(5)
    v_mfma_f32_32x32x16_bf16 v[64:79], v[36:39], v[32:35], v[64:79]
    v_mfma_f32_32x32x16_bf16 v[80:95], v[40:43], v[32:35], v[80:95]
    ds_read_b128 v[32:35], v18 offset:24576
    ds_read_b64_tr_b16 v[36:37], v20 offset:57344
    ds_read_b64_tr_b16 v[38:39], v20 offset:58368
    ds_read_b64_tr_b16 v[40:41], v21 offset:57344
    ds_read_b64_tr_b16 v[42:43], v21 offset:58368
    s_waitcnt lgkmcnt(5)
    v_mfma_f32_32x32x16_bf16 v[64:79], v[48:51], v[44:47], v[64:79]
    v_mfma_f32_32x32x16_bf16 v[80:95], v[52:55], v[44:47], v[80:95]
    ds_read_b128 v[44:47], v19 offset:24576
    ds_read_b64_tr_b16 v[48:49], v20 offset:61440
    ds_read_b64_tr_b16 v[50:51], v20 offset:62464
    ds_read_b64_tr_b16 v[52:53], v21 offset:61440
    ds_read_b64_tr_b16 v[54:55], v21 offset:62464
    s_waitcnt lgkmcnt(5)
    v_mfma_f32_32x32x16_bf16 v[64:79], v[36:39], v[32:35], v[64:79]
    v_mfma_f32_32x32x16_bf16 v[80:95], v[40:43], v[32:35], v[80:95]
    s_waitcnt lgkmcnt(0)
    v_mfma_f32_32x32x16_bf16 v[64:79], v[48:51], v[44:47], v[64:79]
    v_mfma_f32_32x32x16_bf16 v[80:95], v[52:55], v[44:47], v[80:95]
    s_barrier
    ds_read_b128 v[32:35], v16 offset:0
    ds_read_b64_tr_b16 v[36:37], v20 offset:0
    ds_read_b64_tr_b16 v[38:39], v20 offset:1024
    ds_read_b64_tr_b16 v[40:41], v21 offset:0
    ds_read_b64_tr_b16 v[42:43], v21 offset:1024
    ds_read_b128 v[44:47], v17 offset:0
    ds_read_b64_tr_b16 v[48:49], v20 offset:4096
    ds_read_b64_tr_b16 v[50:51], v20 offset:5120
    ds_read_b64_tr_b16 v[52:53], v21 offset:4096
    ds_read_b64_tr_b16 v[54:55], v21 offset:5120
    s_waitcnt lgkmcnt(5)
    v_mfma_f32_32x32x16_bf16 v[64:79], v[36:39], v[32:35], v[64:79]
    v_mfma_f32_32x32x16_bf16 v[80:95], v[40:43], v[32:35], v[80:95]
    ds_read_b128 v[32:35], v18 offset:0
    ds_read_b64_tr_b16 v[36:37], v20 offset:8192
    ds_read_b64_tr_b16 v[38:39], v20 offset:9216
    ds_read_b64_tr_b16 v[40:41], v21 offset:8192
    ds_read_b64_tr_b16 v[42:43], v21 offset:9216
    s_waitcnt lgkmcnt(5)
    v_mfma_f32_32x32x16_bf16 v[64:79], v[48:51], v[44:47], v[64:79]
    v_mfma_f32_32x32x16_bf16 v[80:95], v[52:55], v[44:47], v[80:95]
    ds_read_b128 v[44:47], v19 offset:0
    ds_read_b64_tr_b16 v[48:49], v20 offset:12288
    ds_read_b64_tr_b16 v[50:51], v20 offset:13312
    ds_read_b64_tr_b16 v[52:53], v21 offset:12288
    ds_read_b64_tr_b16 v[54:55], v21 offset:13312
    s_waitcnt lgkmcnt(5)
    v_mfma_f32_32x32x16_bf16 v[64:79], v[36:39], v[32:35], v[64:79]
    v_mfma_f32_32x32x16_bf16 v[80:95], v[40:43], v[32:35], v[80:95]
    s_waitcnt lgkmcnt(0)
    v_mfma_f32_32x32x16_bf16 v[64:79], v[48:51], v[44:47], v[64:79]
    v_mfma_f32_32x32x16_bf16 v[80:95], v[52:55], v[44:47], v[80:95]
    s_barrier
    ds_read_b128 v[32:35], v16 offset:8192
    ds_read_b64_tr_b16 v[36:37], v20 offset:16384
    ds_read_b64_tr_b16 v[38:39], v20 offset:17408
    ds_read_b64_tr_b16 v[40:41], v21 offset:16384
    ds_read_b64_tr_b16 v[42:43], v21 offset:17408
    ds_read_b128 v[44:47], v17 offset:8192
    ds_read_b64_tr_b16 v[48:49], v20 offset:20480
    ds_read_b64_tr_b16 v[50:51], v20 offset:21504
    ds_read_b64_tr_b16 v[52:53], v21 offset:20480
    ds_read_b64_tr_b16 v[54:55], v21 offset:21504
    s_waitcnt lgkmcnt(5)
    v_mfma_f32_32x32x16_bf16 v[64:79], v[36:39], v[32:35], v[64:79]
    v_mfma_f32_32x32x16_bf16 v[80:95], v[40:43], v[32:35], v[80:95]
    ds_read_b128 v[32:35], v18 offset:8192
    ds_read_b64_tr_b16 v[36:37], v20 offset:24576
    ds_read_b64_tr_b16 v[38:39], v20 offset:25600
    ds_read_b64_tr_b16 v[40:41], v21 offset:24576
    ds_read_b64_tr_b16 v[42:43], v21 offset:25600
    s_waitcnt lgkmcnt(5)
    v_mfma_f32_32x32x16_bf16 v[64:79], v[48:51], v[44:47], v[64:79]
    v_mfma_f32_32x32x16_bf16 v[80:95], v[52:55], v[44:47], v[80:95]
    ds_read_b128 v[44:47], v19 offset:8192
    ds_read_b64_tr_b16 v[48:49], v20 offset:28672
    ds_read_b64_tr_b16 v[50:51], v20 offset:29696
    ds_read_b64_tr_b16 v[52:53], v21 offset:28672
    ds_read_b64_tr_b16 v[54:55], v21 offset:29696
    s_waitcnt lgkmcnt(5)
    v_mfma_f32_32x32x16_bf16 v[64:79], v[36:39], v[32:35], v[64:79]
    v_mfma_f32_32x32x16_bf16 v[80:95], v[40:43], v[32:35], v[80:95]
    s_waitcnt lgkmcnt(0)
    v_mfma_f32_32x32x16_bf16 v[64:79], v[48:51], v[44:47], v[64:79]
    v_mfma_f32_32x32x16_bf16 v[80:95], v[52:55], v[44:47], v[80:95]
    s_barrier
    ds_read_b128 v[32:35], v16 offset:16384
    ds_read_b64_tr_b16 v[36:37], v20 offset:32768
    ds_read_b64_tr_b16 v[38:39], v20 offset:33792
    ds_read_b64_tr_b16 v[40:41], v21 offset:32768
    ds_read_b64_tr_b16 v[42:43], v21 offset:33792
    ds_read_b128 v[44:47], v17 offset:16384
    ds_read_b64_tr_b16 v[48:49], v20 offset:36864
    ds_read_b64_tr_b16 v[50:51], v20 offset:37888
    ds_read_b64_tr_b16 v[52:53], v21 offset:36864
    ds_read_b64_tr_b16 v[54:55], v21 offset:37888
    s_waitcnt lgkmcnt(5)
    v_mfma_f32_32x32x16_bf16 v[64:79], v[36:39], v[32:35], v[64:79]
    v_mfma_f32_32x32x16_bf16 v[80:95], v[40:43], v[32:35], v[80:95]
    ds_read_b128 v[32:35], v18 offset:16384
    ds_read_b64_tr_b16 v[36:37], v20 offset:40960
    ds_read_b64_tr_b16 v[38:39], v20 offset:41984
    ds_read_b64_tr_b16 v[40:41], v21 offset:40960
    ds_read_b64_tr_b16 v[42:43], v21 offset:41984
    s_waitcnt lgkmcnt(5)
    v_mfma_f32_32x32x16_bf16 v[64:79], v[48:51], v[44:47], v[64:79]
    v_mfma_f32_32x32x16_bf16 v[80:95], v[52:55], v[44:47], v[80:95]
    ds_read_b128 v[44:47], v19 offset:16384
    ds_read_b64_tr_b16 v[48:49], v20 offset:45056
    ds_read_b64_tr_b16 v[50:51], v20 offset:46080
    ds_read_b64_tr_b16 v[52:53], v21 offset:45056
    ds_read_b64_tr_b16 v[54:55], v21 offset:46080
    s_waitcnt lgkmcnt(5)
    v_mfma_f32_32x32x16_bf16 v[64:79], v[36:39], v[32:35], v[64:79]
    v_mfma_f32_32x32x16_bf16 v[80:95], v[40:43], v[32:35], v[80:95]
    s_waitcnt lgkmcnt(0)
    v_mfma_f32_32x32x16_bf16 v[64:79], v[48:51], v[44:47], v[64:79]
    v_mfma_f32_32x32x16_bf16 v[80:95], v[52:55], v[44:47], v[80:95]
    s_add_u32 s20, s70, 13107200
    s_addc_u32 s21, s71, 0
    s_mov_b32 s22, 2621440
    s_mov_b32 s23, 0x00020000
    buffer_load_dwordx4 v[100:103], v22, s[20:23], 0 offen
    buffer_load_dwordx4 v[104:107], v23, s[20:23], 0 offen
    buffer_load_dwordx4 v[108:111], v24, s[20:23], 0 offen
    buffer_load_dwordx4 v[112:115], v25, s[20:23], 0 offen
    s_barrier
    ds_read_b128 v[32:35], v16 offset:24576
    ds_read_b64_tr_b16 v[36:37], v20 offset:49152
    ds_read_b64_tr_b16 v[38:39], v20 offset:50176
    ds_read_b64_tr_b16 v[40:41], v21 offset:49152
    ds_read_b64_tr_b16 v[42:43], v21 offset:50176
    ds_read_b128 v[44:47], v17 offset:24576
    ds_read_b64_tr_b16 v[48:49], v20 offset:53248
    ds_read_b64_tr_b16 v[50:51], v20 offset:54272
    ds_read_b64_tr_b16 v[52:53], v21 offset:53248
    ds_read_b64_tr_b16 v[54:55], v21 offset:54272
    s_waitcnt lgkmcnt(5)
    v_mfma_f32_32x32x16_bf16 v[64:79], v[36:39], v[32:35], v[64:79]
    v_mfma_f32_32x32x16_bf16 v[80:95], v[40:43], v[32:35], v[80:95]
    ds_read_b128 v[32:35], v18 offset:24576
    ds_read_b64_tr_b16 v[36:37], v20 offset:57344
    ds_read_b64_tr_b16 v[38:39], v20 offset:58368
    ds_read_b64_tr_b16 v[40:41], v21 offset:57344
    ds_read_b64_tr_b16 v[42:43], v21 offset:58368
    s_waitcnt lgkmcnt(5)
    v_mfma_f32_32x32x16_bf16 v[64:79], v[48:51], v[44:47], v[64:79]
    v_mfma_f32_32x32x16_bf16 v[80:95], v[52:55], v[44:47], v[80:95]
    ds_read_b128 v[44:47], v19 offset:24576
    ds_read_b64_tr_b16 v[48:49], v20 offset:61440
    ds_read_b64_tr_b16 v[50:51], v20 offset:62464
    ds_read_b64_tr_b16 v[52:53], v21 offset:61440
    ds_read_b64_tr_b16 v[54:55], v21 offset:62464
    s_waitcnt lgkmcnt(5)
    v_mfma_f32_32x32x16_bf16 v[64:79], v[36:39], v[32:35], v[64:79]
    v_mfma_f32_32x32x16_bf16 v[80:95], v[40:43], v[32:35], v[80:95]
    s_waitcnt lgkmcnt(0)
    v_mfma_f32_32x32x16_bf16 v[64:79], v[48:51], v[44:47], v[64:79]
    v_mfma_f32_32x32x16_bf16 v[80:95], v[52:55], v[44:47], v[80:95]
    s_barrier
    ds_read_b128 v[32:35], v16 offset:0
    ds_read_b64_tr_b16 v[36:37], v20 offset:0
    ds_read_b64_tr_b16 v[38:39], v20 offset:1024
    ds_read_b64_tr_b16 v[40:41], v21 offset:0
    ds_read_b64_tr_b16 v[42:43], v21 offset:1024
    ds_read_b128 v[44:47], v17 offset:0
    ds_read_b64_tr_b16 v[48:49], v20 offset:4096
    ds_read_b64_tr_b16 v[50:51], v20 offset:5120
    ds_read_b64_tr_b16 v[52:53], v21 offset:4096
    ds_read_b64_tr_b16 v[54:55], v21 offset:5120
    s_waitcnt lgkmcnt(5)
    v_mfma_f32_32x32x16_bf16 v[64:79], v[36:39], v[32:35], v[64:79]
    v_mfma_f32_32x32x16_bf16 v[80:95], v[40:43], v[32:35], v[80:95]
    ds_read_b128 v[32:35], v18 offset:0
    ds_read_b64_tr_b16 v[36:37], v20 offset:8192
    ds_read_b64_tr_b16 v[38:39], v20 offset:9216
    ds_read_b64_tr_b16 v[40:41], v21 offset:8192
    ds_read_b64_tr_b16 v[42:43], v21 offset:9216
    s_waitcnt lgkmcnt(5)
    v_mfma_f32_32x32x16_bf16 v[64:79], v[48:51], v[44:47], v[64:79]
    v_mfma_f32_32x32x16_bf16 v[80:95], v[52:55], v[44:47], v[80:95]
    ds_read_b128 v[44:47], v19 offset:0
    ds_read_b64_tr_b16 v[48:49], v20 offset:12288
    ds_read_b64_tr_b16 v[50:51], v20 offset:13312
    ds_read_b64_tr_b16 v[52:53], v21 offset:12288
    ds_read_b64_tr_b16 v[54:55], v21 offset:13312
    s_waitcnt lgkmcnt(5)
    v_mfma_f32_32x32x16_bf16 v[64:79], v[36:39], v[32:35], v[64:79]
    v_mfma_f32_32x32x16_bf16 v[80:95], v[40:43], v[32:35], v[80:95]
    s_waitcnt lgkmcnt(0)
    v_mfma_f32_32x32x16_bf16 v[64:79], v[48:51], v[44:47], v[64:79]
    v_mfma_f32_32x32x16_bf16 v[80:95], v[52:55], v[44:47], v[80:95]
    s_barrier
    ds_read_b128 v[32:35], v16 offset:8192
    ds_read_b64_tr_b16 v[36:37], v20 offset:16384
    ds_read_b64_tr_b16 v[38:39], v20 offset:17408
    ds_read_b64_tr_b16 v[40:41], v21 offset:16384
    ds_read_b64_tr_b16 v[42:43], v21 offset:17408
    ds_read_b128 v[44:47], v17 offset:8192
    ds_read_b64_tr_b16 v[48:49], v20 offset:20480
    ds_read_b64_tr_b16 v[50:51], v20 offset:21504
    ds_read_b64_tr_b16 v[52:53], v21 offset:20480
    ds_read_b64_tr_b16 v[54:55], v21 offset:21504
    s_waitcnt lgkmcnt(5)
    v_mfma_f32_32x32x16_bf16 v[64:79], v[36:39], v[32:35], v[64:79]
    v_mfma_f32_32x32x16_bf16 v[80:95], v[40:43], v[32:35], v[80:95]
    ds_read_b128 v[32:35], v18 offset:8192
    ds_read_b64_tr_b16 v[36:37], v20 offset:24576
    ds_read_b64_tr_b16 v[38:39], v20 offset:25600
    ds_read_b64_tr_b16 v[40:41], v21 offset:24576
    ds_read_b64_tr_b16 v[42:43], v21 offset:25600
    s_waitcnt lgkmcnt(5)
    v_mfma_f32_32x32x16_bf16 v[64:79], v[48:51], v[44:47], v[64:79]
    v_mfma_f32_32x32x16_bf16 v[80:95], v[52:55], v[44:47], v[80:95]
    ds_read_b128 v[44:47], v19 offset:8192
    ds_read_b64_tr_b16 v[48:49], v20 offset:28672
    ds_read_b64_tr_b16 v[50:51], v20 offset:29696
    ds_read_b64_tr_b16 v[52:53], v21 offset:28672
    ds_read_b64_tr_b16 v[54:55], v21 offset:29696
    s_waitcnt lgkmcnt(5)
    v_mfma_f32_32x32x16_bf16 v[64:79], v[36:39], v[32:35], v[64:79]
    v_mfma_f32_32x32x16_bf16 v[80:95], v[40:43], v[32:35], v[80:95]
    s_waitcnt lgkmcnt(0)
    v_mfma_f32_32x32x16_bf16 v[64:79], v[48:51], v[44:47], v[64:79]
    v_mfma_f32_32x32x16_bf16 v[80:95], v[52:55], v[44:47], v[80:95]
    s_barrier
    s_nop 15
    v_cvt_pk_bf16_f32 v124, v64, v65
    v_cvt_pk_bf16_f32 v125, v66, v67
    ds_write_b64 v30, v[124:125] offset:0
    v_cvt_pk_bf16_f32 v124, v68, v69
    v_cvt_pk_bf16_f32 v125, v70, v71
    ds_write_b64 v30, v[124:125] offset:16
    v_cvt_pk_bf16_f32 v124, v72, v73
    v_cvt_pk_bf16_f32 v125, v74, v75
    ds_write_b64 v30, v[124:125] offset:32
    v_cvt_pk_bf16_f32 v124, v76, v77
    v_cvt_pk_bf16_f32 v125, v78, v79
    ds_write_b64 v30, v[124:125] offset:48
    v_cvt_pk_bf16_f32 v124, v80, v81
    v_cvt_pk_bf16_f32 v125, v82, v83
    ds_write_b64 v30, v[124:125] offset:64
    v_cvt_pk_bf16_f32 v124, v84, v85
    v_cvt_pk_bf16_f32 v125, v86, v87
    ds_write_b64 v30, v[124:125] offset:80
    v_cvt_pk_bf16_f32 v124, v88, v89
    v_cvt_pk_bf16_f32 v125, v90, v91
    ds_write_b64 v30, v[124:125] offset:96
    v_cvt_pk_bf16_f32 v124, v92, v93
    v_cvt_pk_bf16_f32 v125, v94, v95
    ds_write_b64 v30, v[124:125] offset:112
    s_waitcnt lgkmcnt(0)
    s_barrier
    ds_read_b128 v[64:67], v26
    ds_read_b128 v[68:71], v27
    ds_read_b128 v[72:75], v28
    ds_read_b128 v[76:79], v29
    s_add_u32 s28, s70, 31178752
    s_addc_u32 s29, s71, 0
    s_mov_b32 s30, 81920
    s_mov_b32 s31, 0x00020000
    s_waitcnt vmcnt(0)
    s_waitcnt lgkmcnt(3)
    v_lshlrev_b32 v116, 16, v64
    v_and_b32 v117, 0xffff0000, v64
    v_lshlrev_b32 v124, 16, v100
    v_and_b32 v125, 0xffff0000, v100
    v_lshlrev_b32 v118, 16, v65
    v_and_b32 v119, 0xffff0000, v65
    v_lshlrev_b32 v126, 16, v101
    v_and_b32 v127, 0xffff0000, v101
    v_lshlrev_b32 v120, 16, v66
    v_and_b32 v121, 0xffff0000, v66
    v_lshlrev_b32 v128, 16, v102
    v_and_b32 v129, 0xffff0000, v102
    v_lshlrev_b32 v122, 16, v67
    v_and_b32 v123, 0xffff0000, v67
    v_lshlrev_b32 v130, 16, v103
    v_and_b32 v131, 0xffff0000, v103
    v_add_f32 v116, v116, v124
    v_add_f32 v117, v117, v125
    v_add_f32 v118, v118, v126
    v_add_f32 v119, v119, v127
    v_add_f32 v120, v120, v128
    v_add_f32 v121, v121, v129
    v_add_f32 v122, v122, v130
    v_add_f32 v123, v123, v131
    v_cvt_pk_bf16_f32 v64, v116, v117
    v_cvt_pk_bf16_f32 v65, v118, v119
    v_cvt_pk_bf16_f32 v66, v120, v121
    v_cvt_pk_bf16_f32 v67, v122, v123
    buffer_store_dwordx4 v[64:67], v22, s[16:19], 0 offen
    v_lshlrev_b32 v116, 16, v64
    v_and_b32 v117, 0xffff0000, v64
    v_lshlrev_b32 v118, 16, v65
    v_and_b32 v119, 0xffff0000, v65
    v_lshlrev_b32 v120, 16, v66
    v_and_b32 v121, 0xffff0000, v66
    v_lshlrev_b32 v122, 16, v67
    v_and_b32 v123, 0xffff0000, v67
    v_add_f32 v100, v116, v117
    v_mul_f32 v101, v116, v116
    v_fmac_f32 v101, v117, v117
    v_add_f32 v100, v100, v118
    v_fmac_f32 v101, v118, v118
    v_add_f32 v100, v100, v119
    v_fmac_f32 v101, v119, v119
    v_add_f32 v100, v100, v120
    v_fmac_f32 v101, v120, v120
    v_add_f32 v100, v100, v121
    v_fmac_f32 v101, v121, v121
    v_add_f32 v100, v100, v122
    v_fmac_f32 v101, v122, v122
    v_add_f32 v100, v100, v123
    v_fmac_f32 v101, v123, v123
    s_waitcnt lgkmcnt(2)
    v_lshlrev_b32 v116, 16, v68
    v_and_b32 v117, 0xffff0000, v68
    v_lshlrev_b32 v124, 16, v104
    v_and_b32 v125, 0xffff0000, v104
    v_lshlrev_b32 v118, 16, v69
    v_and_b32 v119, 0xffff0000, v69
    v_lshlrev_b32 v126, 16, v105
    v_and_b32 v127, 0xffff0000, v105
    v_lshlrev_b32 v120, 16, v70
    v_and_b32 v121, 0xffff0000, v70
    v_lshlrev_b32 v128, 16, v106
    v_and_b32 v129, 0xffff0000, v106
    v_lshlrev_b32 v122, 16, v71
    v_and_b32 v123, 0xffff0000, v71
    v_lshlrev_b32 v130, 16, v107
    v_and_b32 v131, 0xffff0000, v107
    v_add_f32 v116, v116, v124
    v_add_f32 v117, v117, v125
    v_add_f32 v118, v118, v126
    v_add_f32 v119, v119, v127
    v_add_f32 v120, v120, v128
    v_add_f32 v121, v121, v129
    v_add_f32 v122, v122, v130
    v_add_f32 v123, v123, v131
    v_cvt_pk_bf16_f32 v68, v116, v117
    v_cvt_pk_bf16_f32 v69, v118, v119
    v_cvt_pk_bf16_f32 v70, v120, v121
    v_cvt_pk_bf16_f32 v71, v122, v123
    buffer_store_dwordx4 v[68:71], v23, s[16:19], 0 offen
    v_lshlrev_b32 v116, 16, v68
    v_and_b32 v117, 0xffff0000, v68
    v_lshlrev_b32 v118, 16, v69
    v_and_b32 v119, 0xffff0000, v69
    v_lshlrev_b32 v120, 16, v70
    v_and_b32 v121, 0xffff0000, v70
    v_lshlrev_b32 v122, 16, v71
    v_and_b32 v123, 0xffff0000, v71
    v_add_f32 v104, v116, v117
    v_mul_f32 v105, v116, v116
    v_fmac_f32 v105, v117, v117
    v_add_f32 v104, v104, v118
    v_fmac_f32 v105, v118, v118
    v_add_f32 v104, v104, v119
    v_fmac_f32 v105, v119, v119
    v_add_f32 v104, v104, v120
    v_fmac_f32 v105, v120, v120
    v_add_f32 v104, v104, v121
    v_fmac_f32 v105, v121, v121
    v_add_f32 v104, v104, v122
    v_fmac_f32 v105, v122, v122
    v_add_f32 v104, v104, v123
    v_fmac_f32 v105, v123, v123
    s_waitcnt lgkmcnt(1)
    v_lshlrev_b32 v116, 16, v72
    v_and_b32 v117, 0xffff0000, v72
    v_lshlrev_b32 v124, 16, v108
    v_and_b32 v125, 0xffff0000, v108
    v_lshlrev_b32 v118, 16, v73
    v_and_b32 v119, 0xffff0000, v73
    v_lshlrev_b32 v126, 16, v109
    v_and_b32 v127, 0xffff0000, v109
    v_lshlrev_b32 v120, 16, v74
    v_and_b32 v121, 0xffff0000, v74
    v_lshlrev_b32 v128, 16, v110
    v_and_b32 v129, 0xffff0000, v110
    v_lshlrev_b32 v122, 16, v75
    v_and_b32 v123, 0xffff0000, v75
    v_lshlrev_b32 v130, 16, v111
    v_and_b32 v131, 0xffff0000, v111
    v_add_f32 v116, v116, v124
    v_add_f32 v117, v117, v125
    v_add_f32 v118, v118, v126
    v_add_f32 v119, v119, v127
    v_add_f32 v120, v120, v128
    v_add_f32 v121, v121, v129
    v_add_f32 v122, v122, v130
    v_add_f32 v123, v123, v131
    v_cvt_pk_bf16_f32 v72, v116, v117
    v_cvt_pk_bf16_f32 v73, v118, v119
    v_cvt_pk_bf16_f32 v74, v120, v121
    v_cvt_pk_bf16_f32 v75, v122, v123
    buffer_store_dwordx4 v[72:75], v24, s[16:19], 0 offen
    v_lshlrev_b32 v116, 16, v72
    v_and_b32 v117, 0xffff0000, v72
    v_lshlrev_b32 v118, 16, v73
    v_and_b32 v119, 0xffff0000, v73
    v_lshlrev_b32 v120, 16, v74
    v_and_b32 v121, 0xffff0000, v74
    v_lshlrev_b32 v122, 16, v75
    v_and_b32 v123, 0xffff0000, v75
    v_add_f32 v108, v116, v117
    v_mul_f32 v109, v116, v116
    v_fmac_f32 v109, v117, v117
    v_add_f32 v108, v108, v118
    v_fmac_f32 v109, v118, v118
    v_add_f32 v108, v108, v119
    v_fmac_f32 v109, v119, v119
    v_add_f32 v108, v108, v120
    v_fmac_f32 v109, v120, v120
    v_add_f32 v108, v108, v121
    v_fmac_f32 v109, v121, v121
    v_add_f32 v108, v108, v122
    v_fmac_f32 v109, v122, v122
    v_add_f32 v108, v108, v123
    v_fmac_f32 v109, v123, v123
    s_waitcnt lgkmcnt(0)
    v_lshlrev_b32 v116, 16, v76
    v_and_b32 v117, 0xffff0000, v76
    v_lshlrev_b32 v124, 16, v112
    v_and_b32 v125, 0xffff0000, v112
    v_lshlrev_b32 v118, 16, v77
    v_and_b32 v119, 0xffff0000, v77
    v_lshlrev_b32 v126, 16, v113
    v_and_b32 v127, 0xffff0000, v113
    v_lshlrev_b32 v120, 16, v78
    v_and_b32 v121, 0xffff0000, v78
    v_lshlrev_b32 v128, 16, v114
    v_and_b32 v129, 0xffff0000, v114
    v_lshlrev_b32 v122, 16, v79
    v_and_b32 v123, 0xffff0000, v79
    v_lshlrev_b32 v130, 16, v115
    v_and_b32 v131, 0xffff0000, v115
    v_add_f32 v116, v116, v124
    v_add_f32 v117, v117, v125
    v_add_f32 v118, v118, v126
    v_add_f32 v119, v119, v127
    v_add_f32 v120, v120, v128
    v_add_f32 v121, v121, v129
    v_add_f32 v122, v122, v130
    v_add_f32 v123, v123, v131
    v_cvt_pk_bf16_f32 v76, v116, v117
    v_cvt_pk_bf16_f32 v77, v118, v119
    v_cvt_pk_bf16_f32 v78, v120, v121
    v_cvt_pk_bf16_f32 v79, v122, v123
    buffer_store_dwordx4 v[76:79], v25, s[16:19], 0 offen
    v_lshlrev_b32 v116, 16, v76
    v_and_b32 v117, 0xffff0000, v76
    v_lshlrev_b32 v118, 16, v77
    v_and_b32 v119, 0xffff0000, v77
    v_lshlrev_b32 v120, 16, v78
    v_and_b32 v121, 0xffff0000, v78
    v_lshlrev_b32 v122, 16, v79
    v_and_b32 v123, 0xffff0000, v79
    v_add_f32 v112, v116, v117
    v_mul_f32 v113, v116, v116
    v_fmac_f32 v113, v117, v117
    v_add_f32 v112, v112, v118
    v_fmac_f32 v113, v118, v118
    v_add_f32 v112, v112, v119
    v_fmac_f32 v113, v119, v119
    v_add_f32 v112, v112, v120
    v_fmac_f32 v113, v120, v120
    v_add_f32 v112, v112, v121
    v_fmac_f32 v113, v121, v121
    v_add_f32 v112, v112, v122
    v_fmac_f32 v113, v122, v122
    v_add_f32 v112, v112, v123
    v_fmac_f32 v113, v123, v123
    s_nop 1
    v_add_f32_dpp v100, v100, v100 row_ror:8 row_mask:0xf bank_mask:0xf
    v_add_f32_dpp v101, v101, v101 row_ror:8 row_mask:0xf bank_mask:0xf
    v_add_f32_dpp v104, v104, v104 row_ror:8 row_mask:0xf bank_mask:0xf
    v_add_f32_dpp v105, v105, v105 row_ror:8 row_mask:0xf bank_mask:0xf
    v_add_f32_dpp v108, v108, v108 row_ror:8 row_mask:0xf bank_mask:0xf
    v_add_f32_dpp v109, v109, v109 row_ror:8 row_mask:0xf bank_mask:0xf
    v_add_f32_dpp v112, v112, v112 row_ror:8 row_mask:0xf bank_mask:0xf
    v_add_f32_dpp v113, v113, v113 row_ror:8 row_mask:0xf bank_mask:0xf
    s_nop 1
    v_add_f32_dpp v100, v100, v100 row_ror:4 row_mask:0xf bank_mask:0xf
    v_add_f32_dpp v101, v101, v101 row_ror:4 row_mask:0xf bank_mask:0xf
    v_add_f32_dpp v104, v104, v104 row_ror:4 row_mask:0xf bank_mask:0xf
    v_add_f32_dpp v105, v105, v105 row_ror:4 row_mask:0xf bank_mask:0xf
    v_add_f32_dpp v108, v108, v108 row_ror:4 row_mask:0xf bank_mask:0xf
    v_add_f32_dpp v109, v109, v109 row_ror:4 row_mask:0xf bank_mask:0xf
    v_add_f32_dpp v112, v112, v112 row_ror:4 row_mask:0xf bank_mask:0xf
    v_add_f32_dpp v113, v113, v113 row_ror:4 row_mask:0xf bank_mask:0xf
    s_nop 1
    v_add_f32_dpp v100, v100, v100 row_ror:2 row_mask:0xf bank_mask:0xf
    v_add_f32_dpp v101, v101, v101 row_ror:2 row_mask:0xf bank_mask:0xf
    v_add_f32_dpp v104, v104, v104 row_ror:2 row_mask:0xf bank_mask:0xf
    v_add_f32_dpp v105, v105, v105 row_ror:2 row_mask:0xf bank_mask:0xf
    v_add_f32_dpp v108, v108, v108 row_ror:2 row_mask:0xf bank_mask:0xf
    v_add_f32_dpp v109, v109, v109 row_ror:2 row_mask:0xf bank_mask:0xf
    v_add_f32_dpp v112, v112, v112 row_ror:2 row_mask:0xf bank_mask:0xf
    v_add_f32_dpp v113, v113, v113 row_ror:2 row_mask:0xf bank_mask:0xf
    s_nop 1
    v_add_f32_dpp v100, v100, v100 row_ror:1 row_mask:0xf bank_mask:0xf
    v_add_f32_dpp v101, v101, v101 row_ror:1 row_mask:0xf bank_mask:0xf
    v_add_f32_dpp v104, v104, v104 row_ror:1 row_mask:0xf bank_mask:0xf
    v_add_f32_dpp v105, v105, v105 row_ror:1 row_mask:0xf bank_mask:0xf
    v_add_f32_dpp v108, v108, v108 row_ror:1 row_mask:0xf bank_mask:0xf
    v_add_f32_dpp v109, v109, v109 row_ror:1 row_mask:0xf bank_mask:0xf
    v_add_f32_dpp v112, v112, v112 row_ror:1 row_mask:0xf bank_mask:0xf
    v_add_f32_dpp v113, v113, v113 row_ror:1 row_mask:0xf bank_mask:0xf
    v_lshrrev_b32 v2, 4, v0
    v_add_u32 v2, s38, v2
    s_mul_i32 s46, s37, 2048
    v_add_u32 v2, s46, v2
    v_lshlrev_b32 v2, 3, v2
    v_and_b32 v3, 15, v0
    v_cmp_eq_u32 vcc, 0, v3
    s_and_saveexec_b64 s[46:47], vcc
    buffer_store_dwordx2 v[100:101], v2, s[28:31], 0 offen offset:0
    buffer_store_dwordx2 v[104:105], v2, s[28:31], 0 offen offset:128
    buffer_store_dwordx2 v[108:109], v2, s[28:31], 0 offen offset:256
    buffer_store_dwordx2 v[112:113], v2, s[28:31], 0 offen offset:384
    s_mov_b64 exec, s[46:47]
g2b_kernel_end1:
    s_endpgm
.globl g3b_kernel
.p2align 8
.type g3b_kernel,@function
g3b_kernel:
    s_cmp_ge_u32 s2, 256
    s_cbranch_scc1 g3b_kernel_end1
    s_load_dwordx16 s[48:63], s[0:1], 0
    s_load_dwordx8 s[64:71], s[0:1], 64
    v_and_b32 v1, 63, v0
    v_lshrrev_b32 v2, 6, v0
    s_and_b32 s46, s2, 7
    s_lshr_b32 s47, s2, 3
    s_mul_i32 s36, s47, 257
    s_lshr_b32 s36, s36, 12
    s_mul_i32 s3, s36, 16
    s_sub_u32 s37, s47, s3
    s_mul_i32 s46, s46, 2
    s_add_u32 s36, s36, s46
    s_mul_i32 s38, s36, 128
    s_mul_i32 s39, s37, 96
    v_readfirstlane_b32 s40, v2
    s_lshr_b32 s74, s40, 2
    s_and_b32 s40, s40, 3
    s_cmp_eq_u32 s74, 0
    s_cbranch_scc0 g3b_kernel_prod2
    s_branch g3b_kernel_cons3
g3b_kernel_prod2:
    s_mul_i32 s41, s38, 1280
    s_lshl_b32 s42, s39, 1
    s_mul_i32 s43, s40, 4096
    s_mul_i32 s44, s40, 3072
    s_add_u32 s44, s44, 65536
    s_mul_i32 s46, s40, 256
    s_add_u32 s46, s46, 0
    v_add_u32 v2, s46, v1
    v_lshrrev_b32 v3, 3, v2
    v_and_b32 v4, 7, v2
    v_bfe_u32 v5, v3, 1, 3
    v_xor_b32 v4, v4, v5
    v_lshlrev_b32 v4, 4, v4
    s_mov_b32 s47, 1280
    v_mad_u32_u24 v10, v3, s47, v4
    s_mul_i32 s46, s40, 256
    s_add_u32 s46, s46, 64
    v_add_u32 v2, s46, v1
    v_lshrrev_b32 v3, 3, v2
    v_and_b32 v4, 7, v2
    v_bfe_u32 v5, v3, 1, 3
    v_xor_b32 v4, v4, v5
    v_lshlrev_b32 v4, 4, v4
    s_mov_b32 s47, 1280
    v_mad_u32_u24 v11, v3, s47, v4
    s_mul_i32 s46, s40, 256
    s_add_u32 s46, s46, 128
    v_add_u32 v2, s46, v1
    v_lshrrev_b32 v3, 3, v2
    v_and_b32 v4, 7, v2
    v_bfe_u32 v5, v3, 1, 3
    v_xor_b32 v4, v4, v5
    v_lshlrev_b32 v4, 4, v4
    s_mov_b32 s47, 1280
    v_mad_u32_u24 v12, v3, s47, v4
    s_mul_i32 s46, s40, 256
    s_add_u32 s46, s46, 192
    v_add_u32 v2, s46, v1
    v_lshrrev_b32 v3, 3, v2
    v_and_b32 v4, 7, v2
    v_bfe_u32 v5, v3, 1, 3
    v_xor_b32 v4, v4, v5
    v_lshlrev_b32 v4, 4, v4
    s_mov_b32 s47, 1280
    v_mad_u32_u24 v13, v3, s47, v4
    s_mul_i32 s46, s40, 192
    s_add_u32 s46, s46, 0
    v_add_u32 v2, s46, v1
    s_mov_b32 s47, 683
    v_mul_u32_u24 v3, s47, v2
    v_lshrrev_b32 v3, 13, v3
    s_mov_b32 s47, 12
    v_mul_u32_u24 v4, s47, v3
    v_sub_u32 v4, v2, v4
    v_lshlrev_b32 v4, 4, v4
    s_mov_b32 s47, 3072
    v_mad_u32_u24 v14, v3, s47, v4
    s_mul_i32 s46, s40, 192
    s_add_u32 s46, s46, 64
    v_add_u32 v2, s46, v1
    s_mov_b32 s47, 683
    v_mul_u32_u24 v3, s47, v2
    v_lshrrev_b32 v3, 13, v3
    s_mov_b32 s47, 12
    v_mul_u32_u24 v4, s47, v3
    v_sub_u32 v4, v2, v4
    v_lshlrev_b32 v4, 4, v4
    s_mov_b32 s47, 3072
    v_mad_u32_u24 v15, v3, s47, v4
    s_mul_i32 s46, s40, 192
    s_add_u32 s46, s46, 128
    v_add_u32 v2, s46, v1
    s_mov_b32 s47, 683
    v_mul_u32_u24 v3, s47, v2
    v_lshrrev_b32 v3, 13, v3
    s_mov_b32 s47, 12
    v_mul_u32_u24 v4, s47, v3
    v_sub_u32 v4, v2, v4
    v_lshlrev_b32 v4, 4, v4
    s_mov_b32 s47, 3072
    v_mad_u32_u24 v16, v3, s47, v4
    s_waitcnt lgkmcnt(0)
    s_add_u32 s8, s70, 15728640
    s_addc_u32 s9, s71, 0
    s_mov_b32 s10, 2621440
    s_mov_b32 s11, 0x00020000
    s_mov_b32 s12, s58
    s_mov_b32 s13, s59
    s_mov_b32 s14, 1966080
    s_mov_b32 s15, 0x00020000
    s_add_u32 m0, s43, 0
    s_nop 0
    buffer_load_dwordx4 v10, s[8:11], s41 offen lds
    s_add_u32 m0, s43, 1024
    s_nop 0
    buffer_load_dwordx4 v11, s[8:11], s41 offen lds
    s_add_u32 m0, s43, 2048
    s_nop 0
    buffer_load_dwordx4 v12, s[8:11], s41 offen lds
    s_add_u32 m0, s43, 3072
    s_nop 0
    buffer_load_dwordx4 v13, s[8:11], s41 offen lds
    s_add_u32 m0, s44, 0
    s_nop 0
    buffer_load_dwordx4 v14, s[12:15], s42 offen lds
    s_add_u32 m0, s44, 1024
    s_nop 0
    buffer_load_dwordx4 v15, s[12:15], s42 offen lds
    s_add_u32 m0, s44, 2048
    s_nop 0
    buffer_load_dwordx4 v16, s[12:15], s42 offen lds
    s_add_u32 s41, s41, 128
    s_add_u32 s42, s42, 196608
    s_add_u32 m0, s43, 16384
    s_nop 0
    buffer_load_dwordx4 v10, s[8:11], s41 offen lds
    s_add_u32 m0, s43, 17408
    s_nop 0
    buffer_load_dwordx4 v11, s[8:11], s41 offen lds
    s_add_u32 m0, s43, 18432
    s_nop 0
    buffer_load_dwordx4 v12, s[8:11], s41 offen lds
    s_add_u32 m0, s43, 19456
    s_nop 0
    buffer_load_dwordx4 v13, s[8:11], s41 offen lds
    s_add_u32 m0, s44, 12288
    s_nop 0
    buffer_load_dwordx4 v14, s[12:15], s42 offen lds
    s_add_u32 m0, s44, 13312
    s_nop 0
    buffer_load_dwordx4 v15, s[12:15], s42 offen lds
    s_add_u32 m0, s44, 14336
    s_nop 0
    buffer_load_dwordx4 v16, s[12:15], s42 offen lds
    s_add_u32 s41, s41, 128
    s_add_u32 s42, s42, 196608
    s_add_u32 m0, s43, 32768
    s_nop 0
    buffer_load_dwordx4 v10, s[8:11], s41 offen lds
    s_add_u32 m0, s43, 33792
    s_nop 0
    buffer_load_dwordx4 v11, s[8:11], s41 offen lds
    s_add_u32 m0, s43, 34816
    s_nop 0
    buffer_load_dwordx4 v12, s[8:11], s41 offen lds
    s_add_u32 m0, s43, 35840
    s_nop 0
    buffer_load_dwordx4 v13, s[8:11], s41 offen lds
    s_add_u32 m0, s44, 24576
    s_nop 0
    buffer_load_dwordx4 v14, s[12:15], s42 offen lds
    s_add_u32 m0, s44, 25600
    s_nop 0
    buffer_load_dwordx4 v15, s[12:15], s42 offen lds
    s_add_u32 m0, s44, 26624
    s_nop 0
    buffer_load_dwordx4 v16, s[12:15], s42 offen lds
    s_add_u32 s41, s41, 128
    s_add_u32 s42, s42, 196608
    s_waitcnt vmcnt(14)
    s_barrier
    s_add_u32 m0, s43, 49152
    s_nop 0
    buffer_load_dwordx4 v10, s[8:11], s41 offen lds
    s_add_u32 m0, s43, 50176
    s_nop 0
    buffer_load_dwordx4 v11, s[8:11], s41 offen lds
    s_add_u32 m0, s43, 51200
    s_nop 0
    buffer_load_dwordx4 v12, s[8:11], s41 offen lds
    s_add_u32 m0, s43, 52224
    s_nop 0
    buffer_load_dwordx4 v13, s[8:11], s41 offen lds
    s_add_u32 m0, s44, 36864
    s_nop 0
    buffer_load_dwordx4 v14, s[12:15], s42 offen lds
    s_add_u32 m0, s44, 37888
    s_nop 0
    buffer_load_dwordx4 v15, s[12:15], s42 offen lds
    s_add_u32 m0, s44, 38912
    s_nop 0
    buffer_load_dwordx4 v16, s[12:15], s42 offen lds
    s_add_u32 s41, s41, 128
    s_add_u32 s42, s42, 196608
    s_waitcnt vmcnt(14)
    s_barrier
    s_add_u32 m0, s43, 0
    s_nop 0
    buffer_load_dwordx4 v10, s[8:11], s41 offen lds
    s_add_u32 m0, s43, 1024
    s_nop 0
    buffer_load_dwordx4 v11, s[8:11], s41 offen lds
    s_add_u32 m0, s43, 2048
    s_nop 0
    buffer_load_dwordx4 v12, s[8:11], s41 offen lds
    s_add_u32 m0, s43, 3072
    s_nop 0
    buffer_load_dwordx4 v13, s[8:11], s41 offen lds
    s_add_u32 m0, s44, 0
    s_nop 0
    buffer_load_dwordx4 v14, s[12:15], s42 offen lds
    s_add_u32 m0, s44, 1024
    s_nop 0
    buffer_load_dwordx4 v15, s[12:15], s42 offen lds
    s_add_u32 m0, s44, 2048
    s_nop 0
    buffer_load_dwordx4 v16, s[12:15], s42 offen lds
    s_add_u32 s41, s41, 128
    s_add_u32 s42, s42, 196608
    s_waitcnt vmcnt(14)
    s_barrier
    s_add_u32 m0, s43, 16384
    s_nop 0
    buffer_load_dwordx4 v10, s[8:11], s41 offen lds
    s_add_u32 m0, s43, 17408
    s_nop 0
    buffer_load_dwordx4 v11, s[8:11], s41 offen lds
    s_add_u32 m0, s43, 18432
    s_nop 0
    buffer_load_dwordx4 v12, s[8:11], s41 offen lds
    s_add_u32 m0, s43, 19456
    s_nop 0
    buffer_load_dwordx4 v13, s[8:11], s41 offen lds
    s_add_u32 m0, s44, 12288
    s_nop 0
    buffer_load_dwordx4 v14, s[12:15], s42 offen lds
    s_add_u32 m0, s44, 13312
    s_nop 0
    buffer_load_dwordx4 v15, s[12:15], s42 offen lds
    s_add_u32 m0, s44, 14336
    s_nop 0
    buffer_load_dwordx4 v16, s[12:15], s42 offen lds
    s_add_u32 s41, s41, 128
    s_add_u32 s42, s42, 196608
    s_waitcnt vmcnt(14)
    s_barrier
    s_add_u32 m0, s43, 32768
    s_nop 0
    buffer_load_dwordx4 v10, s[8:11], s41 offen lds
    s_add_u32 m0, s43, 33792
    s_nop 0
    buffer_load_dwordx4 v11, s[8:11], s41 offen lds
    s_add_u32 m0, s43, 34816
    s_nop 0
    buffer_load_dwordx4 v12, s[8:11], s41 offen lds
    s_add_u32 m0, s43, 35840
    s_nop 0
    buffer_load_dwordx4 v13, s[8:11], s41 offen lds
    s_add_u32 m0, s44, 24576
    s_nop 0
    buffer_load_dwordx4 v14, s[12:15], s42 offen lds
    s_add_u32 m0, s44, 25600
    s_nop 0
    buffer_load_dwordx4 v15, s[12:15], s42 offen lds
    s_add_u32 m0, s44, 26624
    s_nop 0
    buffer_load_dwordx4 v16, s[12:15], s42 offen lds
    s_add_u32 s41, s41, 128
    s_add_u32 s42, s42, 196608
    s_waitcnt vmcnt(14)
    s_barrier
    s_add_u32 m0, s43, 49152
    s_nop 0
    buffer_load_dwordx4 v10, s[8:11], s41 offen lds
    s_add_u32 m0, s43, 50176
    s_nop 0
    buffer_load_dwordx4 v11, s[8:11], s41 offen lds
    s_add_u32 m0, s43, 51200
    s_nop 0
    buffer_load_dwordx4 v12, s[8:11], s41 offen lds
    s_add_u32 m0, s43, 52224
    s_nop 0
    buffer_load_dwordx4 v13, s[8:11], s41 offen lds
    s_add_u32 m0, s44, 36864
    s_nop 0
    buffer_load_dwordx4 v14, s[12:15], s42 offen lds
    s_add_u32 m0, s44, 37888
    s_nop 0
    buffer_load_dwordx4 v15, s[12:15], s42 offen lds
    s_add_u32 m0, s44, 38912
    s_nop 0
    buffer_load_dwordx4 v16, s[12:15], s42 offen lds
    s_add_u32 s41, s41, 128
    s_add_u32 s42, s42, 196608
    s_waitcnt vmcnt(14)
    s_barrier
    s_add_u32 m0, s43, 0
    s_nop 0
    buffer_load_dwordx4 v10, s[8:11], s41 offen lds
    s_add_u32 m0, s43, 1024
    s_nop 0
    buffer_load_dwordx4 v11, s[8:11], s41 offen lds
    s_add_u32 m0, s43, 2048
    s_nop 0
    buffer_load_dwordx4 v12, s[8:11], s41 offen lds
    s_add_u32 m0, s43, 3072
    s_nop 0
    buffer_load_dwordx4 v13, s[8:11], s41 offen lds
    s_add_u32 m0, s44, 0
    s_nop 0
    buffer_load_dwordx4 v14, s[12:15], s42 offen lds
    s_add_u32 m0, s44, 1024
    s_nop 0
    buffer_load_dwordx4 v15, s[12:15], s42 offen lds
    s_add_u32 m0, s44, 2048
    s_nop 0
    buffer_load_dwordx4 v16, s[12:15], s42 offen lds
    s_add_u32 s41, s41, 128
    s_add_u32 s42, s42, 196608
    s_waitcnt vmcnt(14)
    s_barrier
    s_add_u32 m0, s43, 16384
    s_nop 0
    buffer_load_dwordx4 v10, s[8:11], s41 offen lds
    s_add_u32 m0, s43, 17408
    s_nop 0
    buffer_load_dwordx4 v11, s[8:11], s41 offen lds
    s_add_u32 m0, s43, 18432
    s_nop 0
    buffer_load_dwordx4 v12, s[8:11], s41 offen lds
    s_add_u32 m0, s43, 19456
    s_nop 0
    buffer_load_dwordx4 v13, s[8:11], s41 offen lds
    s_add_u32 m0, s44, 12288
    s_nop 0
    buffer_load_dwordx4 v14, s[12:15], s42 offen lds
    s_add_u32 m0, s44, 13312
    s_nop 0
    buffer_load_dwordx4 v15, s[12:15], s42 offen lds
    s_add_u32 m0, s44, 14336
    s_nop 0
    buffer_load_dwordx4 v16, s[12:15], s42 offen lds
    s_add_u32 s41, s41, 128
    s_add_u32 s42, s42, 196608
    s_waitcnt vmcnt(14)
    s_barrier
    s_waitcnt vmcnt(7)
    s_barrier
    s_waitcnt vmcnt(0)
    s_barrier
    s_endpgm
g3b_kernel_cons3:
    s_waitcnt lgkmcnt(0)
    s_add_u32 s16, s70, 18350080
    s_addc_u32 s17, s71, 0
    s_mov_b32 s18, 6291456
    s_mov_b32 s19, 0x00020000
    s_lshr_b32 s72, s40, 0
    s_and_b32 s73, s40, 0
    s_mul_i32 s46, s72, 32
    v_and_b32 v2, 31, v1
    v_add_u32 v2, s46, v2
    v_lshrrev_b32 v3, 5, v1
    v_bfe_u32 v4, v2, 1, 3
    v_xor_b32 v3, v3, v4
    v_lshlrev_b32 v3, 4, v3
    v_lshl_add_u32 v17, v2, 7, v3
    v_xor_b32 v18, 32, v17
    v_xor_b32 v19, 64, v17
    v_xor_b32 v20, 96, v17
    s_mul_i32 s46, s73, 12
    s_add_u32 s46, s46, 0
    v_bfe_u32 v2, v1, 4, 1
    v_lshlrev_b32 v2, 1, v2
    v_bfe_u32 v3, v1, 1, 1
    v_add3_u32 v2, v2, v3, s46
    v_bfe_u32 v4, v1, 2, 2
    v_lshlrev_b32 v2, 4, v2
    v_and_b32 v3, 1, v1
    v_lshl_add_u32 v2, v3, 3, v2
    v_lshrrev_b32 v3, 5, v1
    v_lshl_add_u32 v3, v3, 3, v4
    s_mov_b32 s47, 192
    v_mad_u32_u24 v2, v3, s47, v2
    v_add_u32 v21, 65536, v2
    s_mul_i32 s46, s73, 12
    s_add_u32 s46, s46, 4
    v_bfe_u32 v2, v1, 4, 1
    v_lshlrev_b32 v2, 1, v2
    v_bfe_u32 v3, v1, 1, 1
    v_add3_u32 v2, v2, v3, s46
    v_bfe_u32 v4, v1, 2, 2
    v_lshlrev_b32 v2, 4, v2
    v_and_b32 v3, 1, v1
    v_lshl_add_u32 v2, v3, 3, v2
    v_lshrrev_b32 v3, 5, v1
    v_lshl_add_u32 v3, v3, 3, v4
    s_mov_b32 s47, 192
    v_mad_u32_u24 v2, v3, s47, v2
    v_add_u32 v22, 65536, v2
    s_mul_i32 s46, s73, 12
    s_add_u32 s46, s46, 8
    v_bfe_u32 v2, v1, 4, 1
    v_lshlrev_b32 v2, 1, v2
    v_bfe_u32 v3, v1, 1, 1
    v_add3_u32 v2, v2, v3, s46
    v_bfe_u32 v4, v1, 2, 2
    v_lshlrev_b32 v2, 4, v2
    v_and_b32 v3, 1, v1
    v_lshl_add_u32 v2, v3, 3, v2
    v_lshrrev_b32 v3, 5, v1
    v_lshl_add_u32 v3, v3, 3, v4
    s_mov_b32 s47, 192
    v_mad_u32_u24 v2, v3, s47, v2
    v_add_u32 v23, 65536, v2
    s_mul_i32 s46, s72, 32
    v_and_b32 v2, 31, v1
    v_add_u32 v2, s46, v2
    s_mov_b32 s47, 208
    v_mul_u32_u24 v2, s47, v2
    s_mul_i32 s46, s73, 192
    v_lshrrev_b32 v3, 5, v1
    v_lshlrev_b32 v3, 3, v3
    v_add3_u32 v36, v2, v3, s46
    v_add_u32 v2, 0, v0
    s_mov_b32 s46, 683
    v_mul_u32_u24 v6, s46, v2
    v_lshrrev_b32 v6, 13, v6
    s_mov_b32 s46, 12
    v_mul_u32_u24 v7, s46, v6
    v_sub_u32 v7, v2, v7
    s_mov_b32 s46, 208
    v_mul_u32_u24 v30, s46, v6
    v_lshl_add_u32 v30, v7, 4, v30
    v_add_u32 v24, s38, v6
    s_mov_b32 s46, 3072
    v_mul_lo_u32 v24, v24, s46
    v_lshl_add_u32 v24, v7, 4, v24
    s_lshl_b32 s46, s39, 1
    v_add_u32 v24, s46, v24
    v_add_u32 v2, 256, v0
    s_mov_b32 s46, 683
    v_mul_u32_u24 v6, s46, v2
    v_lshrrev_b32 v6, 13, v6
    s_mov_b32 s46, 12
    v_mul_u32_u24 v7, s46, v6
    v_sub_u32 v7, v2, v7
    s_mov_b32 s46, 208
    v_mul_u32_u24 v31, s46, v6
    v_lshl_add_u32 v31, v7, 4, v31
    v_add_u32 v25, s38, v6
    s_mov_b32 s46, 3072
    v_mul_lo_u32 v25, v25, s46
    v_lshl_add_u32 v25, v7, 4, v25
    s_lshl_b32 s46, s39, 1
    v_add_u32 v25, s46, v25
    v_add_u32 v2, 512, v0
    s_mov_b32 s46, 683
    v_mul_u32_u24 v6, s46, v2
    v_lshrrev_b32 v6, 13, v6
    s_mov_b32 s46, 12
    v_mul_u32_u24 v7, s46, v6
    v_sub_u32 v7, v2, v7
    s_mov_b32 s46, 208
    v_mul_u32_u24 v32, s46, v6
    v_lshl_add_u32 v32, v7, 4, v32
    v_add_u32 v26, s38, v6
    s_mov_b32 s46, 3072
    v_mul_lo_u32 v26, v26, s46
    v_lshl_add_u32 v26, v7, 4, v26
    s_lshl_b32 s46, s39, 1
    v_add_u32 v26, s46, v26
    v_add_u32 v2, 768, v0
    s_mov_b32 s46, 683
    v_mul_u32_u24 v6, s46, v2
    v_lshrrev_b32 v6, 13, v6
    s_mov_b32 s46, 12
    v_mul_u32_u24 v7, s46, v6
    v_sub_u32 v7, v2, v7
    s_mov_b32 s46, 208
    v_mul_u32_u24 v33, s46, v6
    v_lshl_add_u32 v33, v7, 4, v33
    v_add_u32 v27, s38, v6
    s_mov_b32 s46, 3072
    v_mul_lo_u32 v27, v27, s46
    v_lshl_add_u32 v27, v7, 4, v27
    s_lshl_b32 s46, s39, 1
    v_add_u32 v27, s46, v27
    v_add_u32 v2, 1024, v0
    s_mov_b32 s46, 683
    v_mul_u32_u24 v6, s46, v2
    v_lshrrev_b32 v6, 13, v6
    s_mov_b32 s46, 12
    v_mul_u32_u24 v7, s46, v6
    v_sub_u32 v7, v2, v7
    s_mov_b32 s46, 208
    v_mul_u32_u24 v34, s46, v6
    v_lshl_add_u32 v34, v7, 4, v34
    v_add_u32 v28, s38, v6
    s_mov_b32 s46, 3072
    v_mul_lo_u32 v28, v28, s46
    v_lshl_add_u32 v28, v7, 4, v28
    s_lshl_b32 s46, s39, 1
    v_add_u32 v28, s46, v28
    v_add_u32 v2, 1280, v0
    s_mov_b32 s46, 683
    v_mul_u32_u24 v6, s46, v2
    v_lshrrev_b32 v6, 13, v6
    s_mov_b32 s46, 12
    v_mul_u32_u24 v7, s46, v6
    v_sub_u32 v7, v2, v7
    s_mov_b32 s46, 208
    v_mul_u32_u24 v35, s46, v6
    v_lshl_add_u32 v35, v7, 4, v35
    v_add_u32 v29, s38, v6
    s_mov_b32 s46, 3072
    v_mul_lo_u32 v29, v29, s46
    v_lshl_add_u32 v29, v7, 4, v29
    s_lshl_b32 s46, s39, 1
    v_add_u32 v29, s46, v29
    v_mov_b32 v80, 0
    v_mov_b32 v81, 0
    v_mov_b32 v82, 0
    v_mov_b32 v83, 0
    v_mov_b32 v84, 0
    v_mov_b32 v85, 0
    v_mov_b32 v86, 0
    v_mov_b32 v87, 0
    v_mov_b32 v88, 0
    v_mov_b32 v89, 0
    v_mov_b32 v90, 0
    v_mov_b32 v91, 0
    v_mov_b32 v92, 0
    v_mov_b32 v93, 0
    v_mov_b32 v94, 0
    v_mov_b32 v95, 0
    v_mov_b32 v96, 0
    v_mov_b32 v97, 0
    v_mov_b32 v98, 0
    v_mov_b32 v99, 0
    v_mov_b32 v100, 0
    v_mov_b32 v101, 0
    v_mov_b32 v102, 0
    v_mov_b32 v103, 0
    v_mov_b32 v104, 0
    v_mov_b32 v105, 0
    v_mov_b32 v106, 0
    v_mov_b32 v107, 0
    v_mov_b32 v108, 0
    v_mov_b32 v109, 0
    v_mov_b32 v110, 0
    v_mov_b32 v111, 0
    v_mov_b32 v112, 0
    v_mov_b32 v113, 0
    v_mov_b32 v114, 0
    v_mov_b32 v115, 0
    v_mov_b32 v116, 0
    v_mov_b32 v117, 0
    v_mov_b32 v118, 0
    v_mov_b32 v119, 0
    v_mov_b32 v120, 0
    v_mov_b32 v121, 0
    v_mov_b32 v122, 0
    v_mov_b32 v123, 0
    v_mov_b32 v124, 0
    v_mov_b32 v125, 0
    v_mov_b32 v126, 0
    v_mov_b32 v127, 0
    s_barrier
    ds_read_b128 v[40:43], v17 offset:0
    ds_read_b64_tr_b16 v[44:45], v21 offset:0
    ds_read_b64_tr_b16 v[46:47], v21 offset:768
    ds_read_b64_tr_b16 v[48:49], v22 offset:0
    ds_read_b64_tr_b16 v[50:51], v22 offset:768
    ds_read_b64_tr_b16 v[52:53], v23 offset:0
    ds_read_b64_tr_b16 v[54:55], v23 offset:768
    ds_read_b128 v[56:59], v18 offset:0
    ds_read_b64_tr_b16 v[60:61], v21 offset:3072
    ds_read_b64_tr_b16 v[62:63], v21 offset:3840
    ds_read_b64_tr_b16 v[64:65], v22 offset:3072
    ds_read_b64_tr_b16 v[66:67], v22 offset:3840
    ds_read_b64_tr_b16 v[68:69], v23 offset:3072
    ds_read_b64_tr_b16 v[70:71], v23 offset:3840
    s_waitcnt lgkmcnt(7)
    v_mfma_f32_32x32x16_bf16 v[80:95], v[44:47], v[40:43], v[80:95]
    v_mfma_f32_32x32x16_bf16 v[96:111], v[48:51], v[40:43], v[96:111]
    v_mfma_f32_32x32x16_bf16 v[112:127], v[52:55], v[40:43], v[112:127]
    ds_read_b128 v[40:43], v19 offset:0
    ds_read_b64_tr_b16 v[44:45], v21 offset:6144
    ds_read_b64_tr_b16 v[46:47], v21 offset:6912
    ds_read_b64_tr_b16 v[48:49], v22 offset:6144
    ds_read_b64_tr_b16 v[50:51], v22 offset:6912
    ds_read_b64_tr_b16 v[52:53], v23 offset:6144
    ds_read_b64_tr_b16 v[54:55], v23 offset:6912
    s_waitcnt lgkmcnt(7)
    v_mfma_f32_32x32x16_bf16 v[80:95], v[60:63], v[56:59], v[80:95]
    v_mfma_f32_32x32x16_bf16 v[96:111], v[64:67], v[56:59], v[96:111]
    v_mfma_f32_32x32x16_bf16 v[112:127], v[68:71], v[56:59], v[112:127]
    ds_read_b128 v[56:59], v20 offset:0
    ds_read_b64_tr_b16 v[60:61], v21 offset:9216
    ds_read_b64_tr_b16 v[62:63], v21 offset:9984
    ds_read_b64_tr_b16 v[64:65], v22 offset:9216
    ds_read_b64_tr_b16 v[66:67], v22 offset:9984
    ds_read_b64_tr_b16 v[68:69], v23 offset:9216
    ds_read_b64_tr_b16 v[70:71], v23 offset:9984
    s_waitcnt lgkmcnt(7)
    v_mfma_f32_32x32x16_bf16 v[80:95], v[44:47], v[40:43], v[80:95]
    v_mfma_f32_32x32x16_bf16 v[96:111], v[48:51], v[40:43], v[96:111]
    v_mfma_f32_32x32x16_bf16 v[112:127], v[52:55], v[40:43], v[112:127]
    s_waitcnt lgkmcnt(0)
    v_mfma_f32_32x32x16_bf16 v[80:95], v[60:63], v[56:59], v[80:95]
    v_mfma_f32_32x32x16_bf16 v[96:111], v[64:67], v[56:59], v[96:111]
    v_mfma_f32_32x32x16_bf16 v[112:127], v[68:71], v[56:59], v[112:127]
    s_barrier
    ds_read_b128 v[40:43], v17 offset:16384
    ds_read_b64_tr_b16 v[44:45], v21 offset:12288
    ds_read_b64_tr_b16 v[46:47], v21 offset:13056
    ds_read_b64_tr_b16 v[48:49], v22 offset:12288
    ds_read_b64_tr_b16 v[50:51], v22 offset:13056
    ds_read_b64_tr_b16 v[52:53], v23 offset:12288
    ds_read_b64_tr_b16 v[54:55], v23 offset:13056
    ds_read_b128 v[56:59], v18 offset:16384
    ds_read_b64_tr_b16 v[60:61], v21 offset:15360
    ds_read_b64_tr_b16 v[62:63], v21 offset:16128
    ds_read_b64_tr_b16 v[64:65], v22 offset:15360
    ds_read_b64_tr_b16 v[66:67], v22 offset:16128
    ds_read_b64_tr_b16 v[68:69], v23 offset:15360
    ds_read_b64_tr_b16 v[70:71], v23 offset:16128
    s_waitcnt lgkmcnt(7)
    v_mfma_f32_32x32x16_bf16 v[80:95], v[44:47], v[40:43], v[80:95]
    v_mfma_f32_32x32x16_bf16 v[96:111], v[48:51], v[40:43], v[96:111]
    v_mfma_f32_32x32x16_bf16 v[112:127], v[52:55], v[40:43], v[112:127]
    ds_read_b128 v[40:43], v19 offset:16384
    ds_read_b64_tr_b16 v[44:45], v21 offset:18432
    ds_read_b64_tr_b16 v[46:47], v21 offset:19200
    ds_read_b64_tr_b16 v[48:49], v22 offset:18432
    ds_read_b64_tr_b16 v[50:51], v22 offset:19200
    ds_read_b64_tr_b16 v[52:53], v23 offset:18432
    ds_read_b64_tr_b16 v[54:55], v23 offset:19200
    s_waitcnt lgkmcnt(7)
    v_mfma_f32_32x32x16_bf16 v[80:95], v[60:63], v[56:59], v[80:95]
    v_mfma_f32_32x32x16_bf16 v[96:111], v[64:67], v[56:59], v[96:111]
    v_mfma_f32_32x32x16_bf16 v[112:127], v[68:71], v[56:59], v[112:127]
    ds_read_b128 v[56:59], v20 offset:16384
    ds_read_b64_tr_b16 v[60:61], v21 offset:21504
    ds_read_b64_tr_b16 v[62:63], v21 offset:22272
    ds_read_b64_tr_b16 v[64:65], v22 offset:21504
    ds_read_b64_tr_b16 v[66:67], v22 offset:22272
    ds_read_b64_tr_b16 v[68:69], v23 offset:21504
    ds_read_b64_tr_b16 v[70:71], v23 offset:22272
    s_waitcnt lgkmcnt(7)
    v_mfma_f32_32x32x16_bf16 v[80:95], v[44:47], v[40:43], v[80:95]
    v_mfma_f32_32x32x16_bf16 v[96:111], v[48:51], v[40:43], v[96:111]
    v_mfma_f32_32x32x16_bf16 v[112:127], v[52:55], v[40:43], v[112:127]
    s_waitcnt lgkmcnt(0)
    v_mfma_f32_32x32x16_bf16 v[80:95], v[60:63], v[56:59], v[80:95]
    v_mfma_f32_32x32x16_bf16 v[96:111], v[64:67], v[56:59], v[96:111]
    v_mfma_f32_32x32x16_bf16 v[112:127], v[68:71], v[56:59], v[112:127]
    s_barrier
    ds_read_b128 v[40:43], v17 offset:32768
    ds_read_b64_tr_b16 v[44:45], v21 offset:24576
    ds_read_b64_tr_b16 v[46:47], v21 offset:25344
    ds_read_b64_tr_b16 v[48:49], v22 offset:24576
    ds_read_b64_tr_b16 v[50:51], v22 offset:25344
    ds_read_b64_tr_b16 v[52:53], v23 offset:24576
    ds_read_b64_tr_b16 v[54:55], v23 offset:25344
    ds_read_b128 v[56:59], v18 offset:32768
    ds_read_b64_tr_b16 v[60:61], v21 offset:27648
    ds_read_b64_tr_b16 v[62:63], v21 offset:28416
    ds_read_b64_tr_b16 v[64:65], v22 offset:27648
    ds_read_b64_tr_b16 v[66:67], v22 offset:28416
    ds_read_b64_tr_b16 v[68:69], v23 offset:27648
    ds_read_b64_tr_b16 v[70:71], v23 offset:28416
    s_waitcnt lgkmcnt(7)
    v_mfma_f32_32x32x16_bf16 v[80:95], v[44:47], v[40:43], v[80:95]
    v_mfma_f32_32x32x16_bf16 v[96:111], v[48:51], v[40:43], v[96:111]
    v_mfma_f32_32x32x16_bf16 v[112:127], v[52:55], v[40:43], v[112:127]
    ds_read_b128 v[40:43], v19 offset:32768
    ds_read_b64_tr_b16 v[44:45], v21 offset:30720
    ds_read_b64_tr_b16 v[46:47], v21 offset:31488
    ds_read_b64_tr_b16 v[48:49], v22 offset:30720
    ds_read_b64_tr_b16 v[50:51], v22 offset:31488
    ds_read_b64_tr_b16 v[52:53], v23 offset:30720
    ds_read_b64_tr_b16 v[54:55], v23 offset:31488
    s_waitcnt lgkmcnt(7)
    v_mfma_f32_32x32x16_bf16 v[80:95], v[60:63], v[56:59], v[80:95]
    v_mfma_f32_32x32x16_bf16 v[96:111], v[64:67], v[56:59], v[96:111]
    v_mfma_f32_32x32x16_bf16 v[112:127], v[68:71], v[56:59], v[112:127]
    ds_read_b128 v[56:59], v20 offset:32768
    ds_read_b64_tr_b16 v[60:61], v21 offset:33792
    ds_read_b64_tr_b16 v[62:63], v21 offset:34560
    ds_read_b64_tr_b16 v[64:65], v22 offset:33792
    ds_read_b64_tr_b16 v[66:67], v22 offset:34560
    ds_read_b64_tr_b16 v[68:69], v23 offset:33792
    ds_read_b64_tr_b16 v[70:71], v23 offset:34560
    s_waitcnt lgkmcnt(7)
    v_mfma_f32_32x32x16_bf16 v[80:95], v[44:47], v[40:43], v[80:95]
    v_mfma_f32_32x32x16_bf16 v[96:111], v[48:51], v[40:43], v[96:111]
    v_mfma_f32_32x32x16_bf16 v[112:127], v[52:55], v[40:43], v[112:127]
    s_waitcnt lgkmcnt(0)
    v_mfma_f32_32x32x16_bf16 v[80:95], v[60:63], v[56:59], v[80:95]
    v_mfma_f32_32x32x16_bf16 v[96:111], v[64:67], v[56:59], v[96:111]
    v_mfma_f32_32x32x16_bf16 v[112:127], v[68:71], v[56:59], v[112:127]
    s_barrier
    ds_read_b128 v[40:43], v17 offset:49152
    ds_read_b64_tr_b16 v[44:45], v21 offset:36864
    ds_read_b64_tr_b16 v[46:47], v21 offset:37632
    ds_read_b64_tr_b16 v[48:49], v22 offset:36864
    ds_read_b64_tr_b16 v[50:51], v22 offset:37632
    ds_read_b64_tr_b16 v[52:53], v23 offset:36864
    ds_read_b64_tr_b16 v[54:55], v23 offset:37632
    ds_read_b128 v[56:59], v18 offset:49152
    ds_read_b64_tr_b16 v[60:61], v21 offset:39936
    ds_read_b64_tr_b16 v[62:63], v21 offset:40704
    ds_read_b64_tr_b16 v[64:65], v22 offset:39936
    ds_read_b64_tr_b16 v[66:67], v22 offset:40704
    ds_read_b64_tr_b16 v[68:69], v23 offset:39936
    ds_read_b64_tr_b16 v[70:71], v23 offset:40704
    s_waitcnt lgkmcnt(7)
    v_mfma_f32_32x32x16_bf16 v[80:95], v[44:47], v[40:43], v[80:95]
    v_mfma_f32_32x32x16_bf16 v[96:111], v[48:51], v[40:43], v[96:111]
    v_mfma_f32_32x32x16_bf16 v[112:127], v[52:55], v[40:43], v[112:127]
    ds_read_b128 v[40:43], v19 offset:49152
    ds_read_b64_tr_b16 v[44:45], v21 offset:43008
    ds_read_b64_tr_b16 v[46:47], v21 offset:43776
    ds_read_b64_tr_b16 v[48:49], v22 offset:43008
    ds_read_b64_tr_b16 v[50:51], v22 offset:43776
    ds_read_b64_tr_b16 v[52:53], v23 offset:43008
    ds_read_b64_tr_b16 v[54:55], v23 offset:43776
    s_waitcnt lgkmcnt(7)
    v_mfma_f32_32x32x16_bf16 v[80:95], v[60:63], v[56:59], v[80:95]
    v_mfma_f32_32x32x16_bf16 v[96:111], v[64:67], v[56:59], v[96:111]
    v_mfma_f32_32x32x16_bf16 v[112:127], v[68:71], v[56:59], v[112:127]
    ds_read_b128 v[56:59], v20 offset:49152
    ds_read_b64_tr_b16 v[60:61], v21 offset:46080
    ds_read_b64_tr_b16 v[62:63], v21 offset:46848
    ds_read_b64_tr_b16 v[64:65], v22 offset:46080
    ds_read_b64_tr_b16 v[66:67], v22 offset:46848
    ds_read_b64_tr_b16 v[68:69], v23 offset:46080
    ds_read_b64_tr_b16 v[70:71], v23 offset:46848
    s_waitcnt lgkmcnt(7)
    v_mfma_f32_32x32x16_bf16 v[80:95], v[44:47], v[40:43], v[80:95]
    v_mfma_f32_32x32x16_bf16 v[96:111], v[48:51], v[40:43], v[96:111]
    v_mfma_f32_32x32x16_bf16 v[112:127], v[52:55], v[40:43], v[112:127]
    s_waitcnt lgkmcnt(0)
    v_mfma_f32_32x32x16_bf16 v[80:95], v[60:63], v[56:59], v[80:95]
    v_mfma_f32_32x32x16_bf16 v[96:111], v[64:67], v[56:59], v[96:111]
    v_mfma_f32_32x32x16_bf16 v[112:127], v[68:71], v[56:59], v[112:127]
    s_barrier
    ds_read_b128 v[40:43], v17 offset:0
    ds_read_b64_tr_b16 v[44:45], v21 offset:0
    ds_read_b64_tr_b16 v[46:47], v21 offset:768
    ds_read_b64_tr_b16 v[48:49], v22 offset:0
    ds_read_b64_tr_b16 v[50:51], v22 offset:768
    ds_read_b64_tr_b16 v[52:53], v23 offset:0
    ds_read_b64_tr_b16 v[54:55], v23 offset:768
    ds_read_b128 v[56:59], v18 offset:0
    ds_read_b64_tr_b16 v[60:61], v21 offset:3072
    ds_read_b64_tr_b16 v[62:63], v21 offset:3840
    ds_read_b64_tr_b16 v[64:65], v22 offset:3072
    ds_read_b64_tr_b16 v[66:67], v22 offset:3840
    ds_read_b64_tr_b16 v[68:69], v23 offset:3072
    ds_read_b64_tr_b16 v[70:71], v23 offset:3840
    s_waitcnt lgkmcnt(7)
    v_mfma_f32_32x32x16_bf16 v[80:95], v[44:47], v[40:43], v[80:95]
    v_mfma_f32_32x32x16_bf16 v[96:111], v[48:51], v[40:43], v[96:111]
    v_mfma_f32_32x32x16_bf16 v[112:127], v[52:55], v[40:43], v[112:127]
    ds_read_b128 v[40:43], v19 offset:0
    ds_read_b64_tr_b16 v[44:45], v21 offset:6144
    ds_read_b64_tr_b16 v[46:47], v21 offset:6912
    ds_read_b64_tr_b16 v[48:49], v22 offset:6144
    ds_read_b64_tr_b16 v[50:51], v22 offset:6912
    ds_read_b64_tr_b16 v[52:53], v23 offset:6144
    ds_read_b64_tr_b16 v[54:55], v23 offset:6912
    s_waitcnt lgkmcnt(7)
    v_mfma_f32_32x32x16_bf16 v[80:95], v[60:63], v[56:59], v[80:95]
    v_mfma_f32_32x32x16_bf16 v[96:111], v[64:67], v[56:59], v[96:111]
    v_mfma_f32_32x32x16_bf16 v[112:127], v[68:71], v[56:59], v[112:127]
    ds_read_b128 v[56:59], v20 offset:0
    ds_read_b64_tr_b16 v[60:61], v21 offset:9216
    ds_read_b64_tr_b16 v[62:63], v21 offset:9984
    ds_read_b64_tr_b16 v[64:65], v22 offset:9216
    ds_read_b64_tr_b16 v[66:67], v22 offset:9984
    ds_read_b64_tr_b16 v[68:69], v23 offset:9216
    ds_read_b64_tr_b16 v[70:71], v23 offset:9984
    s_waitcnt lgkmcnt(7)
    v_mfma_f32_32x32x16_bf16 v[80:95], v[44:47], v[40:43], v[80:95]
    v_mfma_f32_32x32x16_bf16 v[96:111], v[48:51], v[40:43], v[96:111]
    v_mfma_f32_32x32x16_bf16 v[112:127], v[52:55], v[40:43], v[112:127]
    s_waitcnt lgkmcnt(0)
    v_mfma_f32_32x32x16_bf16 v[80:95], v[60:63], v[56:59], v[80:95]
    v_mfma_f32_32x32x16_bf16 v[96:111], v[64:67], v[56:59], v[96:111]
    v_mfma_f32_32x32x16_bf16 v[112:127], v[68:71], v[56:59], v[112:127]
    s_barrier
    ds_read_b128 v[40:43], v17 offset:16384
    ds_read_b64_tr_b16 v[44:45], v21 offset:12288
    ds_read_b64_tr_b16 v[46:47], v21 offset:13056
    ds_read_b64_tr_b16 v[48:49], v22 offset:12288
    ds_read_b64_tr_b16 v[50:51], v22 offset:13056
    ds_read_b64_tr_b16 v[52:53], v23 offset:12288
    ds_read_b64_tr_b16 v[54:55], v23 offset:13056
    ds_read_b128 v[56:59], v18 offset:16384
    ds_read_b64_tr_b16 v[60:61], v21 offset:15360
    ds_read_b64_tr_b16 v[62:63], v21 offset:16128
    ds_read_b64_tr_b16 v[64:65], v22 offset:15360
    ds_read_b64_tr_b16 v[66:67], v22 offset:16128
    ds_read_b64_tr_b16 v[68:69], v23 offset:15360
    ds_read_b64_tr_b16 v[70:71], v23 offset:16128
    s_waitcnt lgkmcnt(7)
    v_mfma_f32_32x32x16_bf16 v[80:95], v[44:47], v[40:43], v[80:95]
    v_mfma_f32_32x32x16_bf16 v[96:111], v[48:51], v[40:43], v[96:111]
    v_mfma_f32_32x32x16_bf16 v[112:127], v[52:55], v[40:43], v[112:127]
    ds_read_b128 v[40:43], v19 offset:16384
    ds_read_b64_tr_b16 v[44:45], v21 offset:18432
    ds_read_b64_tr_b16 v[46:47], v21 offset:19200
    ds_read_b64_tr_b16 v[48:49], v22 offset:18432
    ds_read_b64_tr_b16 v[50:51], v22 offset:19200
    ds_read_b64_tr_b16 v[52:53], v23 offset:18432
    ds_read_b64_tr_b16 v[54:55], v23 offset:19200
    s_waitcnt lgkmcnt(7)
    v_mfma_f32_32x32x16_bf16 v[80:95], v[60:63], v[56:59], v[80:95]
    v_mfma_f32_32x32x16_bf16 v[96:111], v[64:67], v[56:59], v[96:111]
    v_mfma_f32_32x32x16_bf16 v[112:127], v[68:71], v[56:59], v[112:127]
    ds_read_b128 v[56:59], v20 offset:16384
    ds_read_b64_tr_b16 v[60:61], v21 offset:21504
    ds_read_b64_tr_b16 v[62:63], v21 offset:22272
    ds_read_b64_tr_b16 v[64:65], v22 offset:21504
    ds_read_b64_tr_b16 v[66:67], v22 offset:22272
    ds_read_b64_tr_b16 v[68:69], v23 offset:21504
    ds_read_b64_tr_b16 v[70:71], v23 offset:22272
    s_waitcnt lgkmcnt(7)
    v_mfma_f32_32x32x16_bf16 v[80:95], v[44:47], v[40:43], v[80:95]
    v_mfma_f32_32x32x16_bf16 v[96:111], v[48:51], v[40:43], v[96:111]
    v_mfma_f32_32x32x16_bf16 v[112:127], v[52:55], v[40:43], v[112:127]
    s_waitcnt lgkmcnt(0)
    v_mfma_f32_32x32x16_bf16 v[80:95], v[60:63], v[56:59], v[80:95]
    v_mfma_f32_32x32x16_bf16 v[96:111], v[64:67], v[56:59], v[96:111]
    v_mfma_f32_32x32x16_bf16 v[112:127], v[68:71], v[56:59], v[112:127]
    s_barrier
    ds_read_b128 v[40:43], v17 offset:32768
    ds_read_b64_tr_b16 v[44:45], v21 offset:24576
    ds_read_b64_tr_b16 v[46:47], v21 offset:25344
    ds_read_b64_tr_b16 v[48:49], v22 offset:24576
    ds_read_b64_tr_b16 v[50:51], v22 offset:25344
    ds_read_b64_tr_b16 v[52:53], v23 offset:24576
    ds_read_b64_tr_b16 v[54:55], v23 offset:25344
    ds_read_b128 v[56:59], v18 offset:32768
    ds_read_b64_tr_b16 v[60:61], v21 offset:27648
    ds_read_b64_tr_b16 v[62:63], v21 offset:28416
    ds_read_b64_tr_b16 v[64:65], v22 offset:27648
    ds_read_b64_tr_b16 v[66:67], v22 offset:28416
    ds_read_b64_tr_b16 v[68:69], v23 offset:27648
    ds_read_b64_tr_b16 v[70:71], v23 offset:28416
    s_waitcnt lgkmcnt(7)
    v_mfma_f32_32x32x16_bf16 v[80:95], v[44:47], v[40:43], v[80:95]
    v_mfma_f32_32x32x16_bf16 v[96:111], v[48:51], v[40:43], v[96:111]
    v_mfma_f32_32x32x16_bf16 v[112:127], v[52:55], v[40:43], v[112:127]
    ds_read_b128 v[40:43], v19 offset:32768
    ds_read_b64_tr_b16 v[44:45], v21 offset:30720
    ds_read_b64_tr_b16 v[46:47], v21 offset:31488
    ds_read_b64_tr_b16 v[48:49], v22 offset:30720
    ds_read_b64_tr_b16 v[50:51], v22 offset:31488
    ds_read_b64_tr_b16 v[52:53], v23 offset:30720
    ds_read_b64_tr_b16 v[54:55], v23 offset:31488
    s_waitcnt lgkmcnt(7)
    v_mfma_f32_32x32x16_bf16 v[80:95], v[60:63], v[56:59], v[80:95]
    v_mfma_f32_32x32x16_bf16 v[96:111], v[64:67], v[56:59], v[96:111]
    v_mfma_f32_32x32x16_bf16 v[112:127], v[68:71], v[56:59], v[112:127]
    ds_read_b128 v[56:59], v20 offset:32768
    ds_read_b64_tr_b16 v[60:61], v21 offset:33792
    ds_read_b64_tr_b16 v[62:63], v21 offset:34560
    ds_read_b64_tr_b16 v[64:65], v22 offset:33792
    ds_read_b64_tr_b16 v[66:67], v22 offset:34560
    ds_read_b64_tr_b16 v[68:69], v23 offset:33792
    ds_read_b64_tr_b16 v[70:71], v23 offset:34560
    s_waitcnt lgkmcnt(7)
    v_mfma_f32_32x32x16_bf16 v[80:95], v[44:47], v[40:43], v[80:95]
    v_mfma_f32_32x32x16_bf16 v[96:111], v[48:51], v[40:43], v[96:111]
    v_mfma_f32_32x32x16_bf16 v[112:127], v[52:55], v[40:43], v[112:127]
    s_waitcnt lgkmcnt(0)
    v_mfma_f32_32x32x16_bf16 v[80:95], v[60:63], v[56:59], v[80:95]
    v_mfma_f32_32x32x16_bf16 v[96:111], v[64:67], v[56:59], v[96:111]
    v_mfma_f32_32x32x16_bf16 v[112:127], v[68:71], v[56:59], v[112:127]
    s_add_u32 s28, s70, 31178752
    s_addc_u32 s29, s71, 0
    s_mov_b32 s30, 81920
    s_mov_b32 s31, 0x00020000
    s_add_u32 s32, s70, 31268864
    s_addc_u32 s33, s71, 0
    s_mov_b32 s34, 6144
    s_mov_b32 s35, 0x00020000
    s_mul_i32 s46, s72, 32
    s_add_u32 s46, s46, s38
    v_and_b32 v2, 31, v1
    v_add_u32 v2, s46, v2
    v_lshlrev_b32 v2, 3, v2
    s_mov_b32 s47, 0
    buffer_load_dwordx2 v[130:131], v2, s[28:31], s47 offen offset:0
    s_mov_b32 s47, 16384
    buffer_load_dwordx2 v[132:133], v2, s[28:31], s47 offen offset:0
    s_mov_b32 s47, 32768
    buffer_load_dwordx2 v[134:135], v2, s[28:31], s47 offen offset:0
    s_mov_b32 s47, 49152
    buffer_load_dwordx2 v[136:137], v2, s[28:31], s47 offen offset:0
    s_mov_b32 s47, 65536
    buffer_load_dwordx2 v[138:139], v2, s[28:31], s47 offen offset:0
    s_mul_i32 s46, s73, 96
    s_add_u32 s46, s46, s39
    v_lshrrev_b32 v2, 5, v1
    v_lshlrev_b32 v2, 2, v2
    v_add_u32 v2, s46, v2
    v_lshlrev_b32 v2, 2, v2
    buffer_load_dwordx4 v[140:143], v2, s[32:35], 0 offen offset:0
    buffer_load_dwordx4 v[144:147], v2, s[32:35], 0 offen offset:32
    buffer_load_dwordx4 v[148:151], v2, s[32:35], 0 offen offset:64
    buffer_load_dwordx4 v[152:155], v2, s[32:35], 0 offen offset:96
    buffer_load_dwordx4 v[156:159], v2, s[32:35], 0 offen offset:128
    buffer_load_dwordx4 v[160:163], v2, s[32:35], 0 offen offset:160
    buffer_load_dwordx4 v[164:167], v2, s[32:35], 0 offen offset:192
    buffer_load_dwordx4 v[168:171], v2, s[32:35], 0 offen offset:224
    buffer_load_dwordx4 v[172:175], v2, s[32:35], 0 offen offset:256
    buffer_load_dwordx4 v[176:179], v2, s[32:35], 0 offen offset:288
    buffer_load_dwordx4 v[180:183], v2, s[32:35], 0 offen offset:320
    buffer_load_dwordx4 v[184:187], v2, s[32:35], 0 offen offset:352
    s_barrier
    ds_read_b128 v[40:43], v17 offset:49152
    ds_read_b64_tr_b16 v[44:45], v21 offset:36864
    ds_read_b64_tr_b16 v[46:47], v21 offset:37632
    ds_read_b64_tr_b16 v[48:49], v22 offset:36864
    ds_read_b64_tr_b16 v[50:51], v22 offset:37632
    ds_read_b64_tr_b16 v[52:53], v23 offset:36864
    ds_read_b64_tr_b16 v[54:55], v23 offset:37632
    ds_read_b128 v[56:59], v18 offset:49152
    ds_read_b64_tr_b16 v[60:61], v21 offset:39936
    ds_read_b64_tr_b16 v[62:63], v21 offset:40704
    ds_read_b64_tr_b16 v[64:65], v22 offset:39936
    ds_read_b64_tr_b16 v[66:67], v22 offset:40704
    ds_read_b64_tr_b16 v[68:69], v23 offset:39936
    ds_read_b64_tr_b16 v[70:71], v23 offset:40704
    s_waitcnt lgkmcnt(7)
    v_mfma_f32_32x32x16_bf16 v[80:95], v[44:47], v[40:43], v[80:95]
    v_mfma_f32_32x32x16_bf16 v[96:111], v[48:51], v[40:43], v[96:111]
    v_mfma_f32_32x32x16_bf16 v[112:127], v[52:55], v[40:43], v[112:127]
    ds_read_b128 v[40:43], v19 offset:49152
    ds_read_b64_tr_b16 v[44:45], v21 offset:43008
    ds_read_b64_tr_b16 v[46:47], v21 offset:43776
    ds_read_b64_tr_b16 v[48:49], v22 offset:43008
    ds_read_b64_tr_b16 v[50:51], v22 offset:43776
    ds_read_b64_tr_b16 v[52:53], v23 offset:43008
    ds_read_b64_tr_b16 v[54:55], v23 offset:43776
    s_waitcnt lgkmcnt(7)
    v_mfma_f32_32x32x16_bf16 v[80:95], v[60:63], v[56:59], v[80:95]
    v_mfma_f32_32x32x16_bf16 v[96:111], v[64:67], v[56:59], v[96:111]
    v_mfma_f32_32x32x16_bf16 v[112:127], v[68:71], v[56:59], v[112:127]
    ds_read_b128 v[56:59], v20 offset:49152
    ds_read_b64_tr_b16 v[60:61], v21 offset:46080
    ds_read_b64_tr_b16 v[62:63], v21 offset:46848
    ds_read_b64_tr_b16 v[64:65], v22 offset:46080
    ds_read_b64_tr_b16 v[66:67], v22 offset:46848
    ds_read_b64_tr_b16 v[68:69], v23 offset:46080
    ds_read_b64_tr_b16 v[70:71], v23 offset:46848
    s_waitcnt lgkmcnt(7)
    v_mfma_f32_32x32x16_bf16 v[80:95], v[44:47], v[40:43], v[80:95]
    v_mfma_f32_32x32x16_bf16 v[96:111], v[48:51], v[40:43], v[96:111]
    v_mfma_f32_32x32x16_bf16 v[112:127], v[52:55], v[40:43], v[112:127]
    s_waitcnt lgkmcnt(0)
    v_mfma_f32_32x32x16_bf16 v[80:95], v[60:63], v[56:59], v[80:95]
    v_mfma_f32_32x32x16_bf16 v[96:111], v[64:67], v[56:59], v[96:111]
    v_mfma_f32_32x32x16_bf16 v[112:127], v[68:71], v[56:59], v[112:127]
    s_barrier
    ds_read_b128 v[40:43], v17 offset:0
    ds_read_b64_tr_b16 v[44:45], v21 offset:0
    ds_read_b64_tr_b16 v[46:47], v21 offset:768
    ds_read_b64_tr_b16 v[48:49], v22 offset:0
    ds_read_b64_tr_b16 v[50:51], v22 offset:768
    ds_read_b64_tr_b16 v[52:53], v23 offset:0
    ds_read_b64_tr_b16 v[54:55], v23 offset:768
    ds_read_b128 v[56:59], v18 offset:0
    ds_read_b64_tr_b16 v[60:61], v21 offset:3072
    ds_read_b64_tr_b16 v[62:63], v21 offset:3840
    ds_read_b64_tr_b16 v[64:65], v22 offset:3072
    ds_read_b64_tr_b16 v[66:67], v22 offset:3840
    ds_read_b64_tr_b16 v[68:69], v23 offset:3072
    ds_read_b64_tr_b16 v[70:71], v23 offset:3840
    s_waitcnt lgkmcnt(7)
    v_mfma_f32_32x32x16_bf16 v[80:95], v[44:47], v[40:43], v[80:95]
    v_mfma_f32_32x32x16_bf16 v[96:111], v[48:51], v[40:43], v[96:111]
    v_mfma_f32_32x32x16_bf16 v[112:127], v[52:55], v[40:43], v[112:127]
    ds_read_b128 v[40:43], v19 offset:0
    ds_read_b64_tr_b16 v[44:45], v21 offset:6144
    ds_read_b64_tr_b16 v[46:47], v21 offset:6912
    ds_read_b64_tr_b16 v[48:49], v22 offset:6144
    ds_read_b64_tr_b16 v[50:51], v22 offset:6912
    ds_read_b64_tr_b16 v[52:53], v23 offset:6144
    ds_read_b64_tr_b16 v[54:55], v23 offset:6912
    s_waitcnt lgkmcnt(7)
    v_mfma_f32_32x32x16_bf16 v[80:95], v[60:63], v[56:59], v[80:95]
    v_mfma_f32_32x32x16_bf16 v[96:111], v[64:67], v[56:59], v[96:111]
    v_mfma_f32_32x32x16_bf16 v[112:127], v[68:71], v[56:59], v[112:127]
    ds_read_b128 v[56:59], v20 offset:0
    ds_read_b64_tr_b16 v[60:61], v21 offset:9216
    ds_read_b64_tr_b16 v[62:63], v21 offset:9984
    ds_read_b64_tr_b16 v[64:65], v22 offset:9216
    ds_read_b64_tr_b16 v[66:67], v22 offset:9984
    ds_read_b64_tr_b16 v[68:69], v23 offset:9216
    ds_read_b64_tr_b16 v[70:71], v23 offset:9984
    s_waitcnt lgkmcnt(7)
    v_mfma_f32_32x32x16_bf16 v[80:95], v[44:47], v[40:43], v[80:95]
    v_mfma_f32_32x32x16_bf16 v[96:111], v[48:51], v[40:43], v[96:111]
    v_mfma_f32_32x32x16_bf16 v[112:127], v[52:55], v[40:43], v[112:127]
    s_waitcnt lgkmcnt(0)
    v_mfma_f32_32x32x16_bf16 v[80:95], v[60:63], v[56:59], v[80:95]
    v_mfma_f32_32x32x16_bf16 v[96:111], v[64:67], v[56:59], v[96:111]
    v_mfma_f32_32x32x16_bf16 v[112:127], v[68:71], v[56:59], v[112:127]
    s_barrier
    ds_read_b128 v[40:43], v17 offset:16384
    ds_read_b64_tr_b16 v[44:45], v21 offset:12288
    ds_read_b64_tr_b16 v[46:47], v21 offset:13056
    ds_read_b64_tr_b16 v[48:49], v22 offset:12288
    ds_read_b64_tr_b16 v[50:51], v22 offset:13056
    ds_read_b64_tr_b16 v[52:53], v23 offset:12288
    ds_read_b64_tr_b16 v[54:55], v23 offset:13056
    ds_read_b128 v[56:59], v18 offset:16384
    ds_read_b64_tr_b16 v[60:61], v21 offset:15360
    ds_read_b64_tr_b16 v[62:63], v21 offset:16128
    ds_read_b64_tr_b16 v[64:65], v22 offset:15360
    ds_read_b64_tr_b16 v[66:67], v22 offset:16128
    ds_read_b64_tr_b16 v[68:69], v23 offset:15360
    ds_read_b64_tr_b16 v[70:71], v23 offset:16128
    s_waitcnt lgkmcnt(7)
    v_mfma_f32_32x32x16_bf16 v[80:95], v[44:47], v[40:43], v[80:95]
    v_mfma_f32_32x32x16_bf16 v[96:111], v[48:51], v[40:43], v[96:111]
    v_mfma_f32_32x32x16_bf16 v[112:127], v[52:55], v[40:43], v[112:127]
    ds_read_b128 v[40:43], v19 offset:16384
    ds_read_b64_tr_b16 v[44:45], v21 offset:18432
    ds_read_b64_tr_b16 v[46:47], v21 offset:19200
    ds_read_b64_tr_b16 v[48:49], v22 offset:18432
    ds_read_b64_tr_b16 v[50:51], v22 offset:19200
    ds_read_b64_tr_b16 v[52:53], v23 offset:18432
    ds_read_b64_tr_b16 v[54:55], v23 offset:19200
    s_waitcnt lgkmcnt(7)
    v_mfma_f32_32x32x16_bf16 v[80:95], v[60:63], v[56:59], v[80:95]
    v_mfma_f32_32x32x16_bf16 v[96:111], v[64:67], v[56:59], v[96:111]
    v_mfma_f32_32x32x16_bf16 v[112:127], v[68:71], v[56:59], v[112:127]
    ds_read_b128 v[56:59], v20 offset:16384
    ds_read_b64_tr_b16 v[60:61], v21 offset:21504
    ds_read_b64_tr_b16 v[62:63], v21 offset:22272
    ds_read_b64_tr_b16 v[64:65], v22 offset:21504
    ds_read_b64_tr_b16 v[66:67], v22 offset:22272
    ds_read_b64_tr_b16 v[68:69], v23 offset:21504
    ds_read_b64_tr_b16 v[70:71], v23 offset:22272
    s_waitcnt lgkmcnt(7)
    v_mfma_f32_32x32x16_bf16 v[80:95], v[44:47], v[40:43], v[80:95]
    v_mfma_f32_32x32x16_bf16 v[96:111], v[48:51], v[40:43], v[96:111]
    v_mfma_f32_32x32x16_bf16 v[112:127], v[52:55], v[40:43], v[112:127]
    s_waitcnt lgkmcnt(0)
    v_mfma_f32_32x32x16_bf16 v[80:95], v[60:63], v[56:59], v[80:95]
    v_mfma_f32_32x32x16_bf16 v[96:111], v[64:67], v[56:59], v[96:111]
    v_mfma_f32_32x32x16_bf16 v[112:127], v[68:71], v[56:59], v[112:127]
    s_barrier
    s_nop 15
    s_waitcnt vmcnt(0)
    v_add_f32 v130, v130, v132
    v_add_f32 v131, v131, v133
    v_add_f32 v130, v130, v134
    v_add_f32 v131, v131, v135
    v_add_f32 v130, v130, v136
    v_add_f32 v131, v131, v137
    v_add_f32 v130, v130, v138
    v_add_f32 v131, v131, v139
    v_mul_f32 v130, 0x3acccccd, v130
    v_mul_f32 v131, 0x3acccccd, v131
    v_fma_f32 v131, -v130, v130, v131
    v_max_f32 v131, 0, v131
    v_cvt_pk_bf16_f32 v2, v131, v131
    v_lshlrev_b32 v131, 16, v2
    v_add_f32 v131, 0x3727c5ac, v131
    v_cvt_pk_bf16_f32 v2, v131, v131
    v_lshlrev_b32 v131, 16, v2
    v_sqrt_f32 v131, v131
    s_nop 0
    v_cvt_pk_bf16_f32 v2, v131, v131
    v_lshlrev_b32 v131, 16, v2
    v_rcp_f32 v129, v131
    v_cvt_pk_bf16_f32 v2, v130, v130
    v_lshlrev_b32 v130, 16, v2
    v_mov_b32 v128, v130
    v_mov_b32 v198, 0xc0135761
    v_mov_b32 v199, 0xbdd2d3e8
    v_fma_f32 v80, -v128, v140, v80
    v_mul_f32 v80, v129, v80
    v_fma_f32 v81, -v128, v141, v81
    v_mul_f32 v81, v129, v81
    v_fma_f32 v82, -v128, v142, v82
    v_mul_f32 v82, v129, v82
    v_fma_f32 v83, -v128, v143, v83
    v_mul_f32 v83, v129, v83
    v_cvt_pk_bf16_f32 v188, v80, v81
    v_cvt_pk_bf16_f32 v189, v82, v83
    v_lshlrev_b32 v80, 16, v188
    v_and_b32 v81, 0xffff0000, v188
    v_lshlrev_b32 v82, 16, v189
    v_and_b32 v83, 0xffff0000, v189
    v_mul_f32 v190, v80, v80
    v_fma_f32 v190, v190, v199, v198
    v_mul_f32 v190, v190, v80
    v_exp_f32 v190, v190
    v_mul_f32 v191, v81, v81
    v_fma_f32 v191, v191, v199, v198
    v_mul_f32 v191, v191, v81
    v_exp_f32 v191, v191
    v_mul_f32 v192, v82, v82
    v_fma_f32 v192, v192, v199, v198
    v_mul_f32 v192, v192, v82
    v_exp_f32 v192, v192
    v_mul_f32 v193, v83, v83
    v_fma_f32 v193, v193, v199, v198
    v_mul_f32 v193, v193, v83
    v_exp_f32 v193, v193
    v_add_f32 v190, 1.0, v190
    v_rcp_f32 v190, v190
    v_add_f32 v191, 1.0, v191
    v_rcp_f32 v191, v191
    v_add_f32 v192, 1.0, v192
    v_rcp_f32 v192, v192
    v_add_f32 v193, 1.0, v193
    v_rcp_f32 v193, v193
    v_mul_f32 v80, v80, v190
    v_mul_f32 v81, v81, v191
    v_mul_f32 v82, v82, v192
    v_mul_f32 v83, v83, v193
    v_cvt_pk_bf16_f32 v196, v80, v81
    v_cvt_pk_bf16_f32 v197, v82, v83
    ds_write_b64 v36, v[196:197] offset:0
    v_fma_f32 v84, -v128, v144, v84
    v_mul_f32 v84, v129, v84
    v_fma_f32 v85, -v128, v145, v85
    v_mul_f32 v85, v129, v85
    v_fma_f32 v86, -v128, v146, v86
    v_mul_f32 v86, v129, v86
    v_fma_f32 v87, -v128, v147, v87
    v_mul_f32 v87, v129, v87
    v_cvt_pk_bf16_f32 v188, v84, v85
    v_cvt_pk_bf16_f32 v189, v86, v87
    v_lshlrev_b32 v84, 16, v188
    v_and_b32 v85, 0xffff0000, v188
    v_lshlrev_b32 v86, 16, v189
    v_and_b32 v87, 0xffff0000, v189
    v_mul_f32 v190, v84, v84
    v_fma_f32 v190, v190, v199, v198
    v_mul_f32 v190, v190, v84
    v_exp_f32 v190, v190
    v_mul_f32 v191, v85, v85
    v_fma_f32 v191, v191, v199, v198
    v_mul_f32 v191, v191, v85
    v_exp_f32 v191, v191
    v_mul_f32 v192, v86, v86
    v_fma_f32 v192, v192, v199, v198
    v_mul_f32 v192, v192, v86
    v_exp_f32 v192, v192
    v_mul_f32 v193, v87, v87
    v_fma_f32 v193, v193, v199, v198
    v_mul_f32 v193, v193, v87
    v_exp_f32 v193, v193
    v_add_f32 v190, 1.0, v190
    v_rcp_f32 v190, v190
    v_add_f32 v191, 1.0, v191
    v_rcp_f32 v191, v191
    v_add_f32 v192, 1.0, v192
    v_rcp_f32 v192, v192
    v_add_f32 v193, 1.0, v193
    v_rcp_f32 v193, v193
    v_mul_f32 v84, v84, v190
    v_mul_f32 v85, v85, v191
    v_mul_f32 v86, v86, v192
    v_mul_f32 v87, v87, v193
    v_cvt_pk_bf16_f32 v196, v84, v85
    v_cvt_pk_bf16_f32 v197, v86, v87
    ds_write_b64 v36, v[196:197] offset:16
    v_fma_f32 v88, -v128, v148, v88
    v_mul_f32 v88, v129, v88
    v_fma_f32 v89, -v128, v149, v89
    v_mul_f32 v89, v129, v89
    v_fma_f32 v90, -v128, v150, v90
    v_mul_f32 v90, v129, v90
    v_fma_f32 v91, -v128, v151, v91
    v_mul_f32 v91, v129, v91
    v_cvt_pk_bf16_f32 v188, v88, v89
    v_cvt_pk_bf16_f32 v189, v90, v91
    v_lshlrev_b32 v88, 16, v188
    v_and_b32 v89, 0xffff0000, v188
    v_lshlrev_b32 v90, 16, v189
    v_and_b32 v91, 0xffff0000, v189
    v_mul_f32 v190, v88, v88
    v_fma_f32 v190, v190, v199, v198
    v_mul_f32 v190, v190, v88
    v_exp_f32 v190, v190
    v_mul_f32 v191, v89, v89
    v_fma_f32 v191, v191, v199, v198
    v_mul_f32 v191, v191, v89
    v_exp_f32 v191, v191
    v_mul_f32 v192, v90, v90
    v_fma_f32 v192, v192, v199, v198
    v_mul_f32 v192, v192, v90
    v_exp_f32 v192, v192
    v_mul_f32 v193, v91, v91
    v_fma_f32 v193, v193, v199, v198
    v_mul_f32 v193, v193, v91
    v_exp_f32 v193, v193
    v_add_f32 v190, 1.0, v190
    v_rcp_f32 v190, v190
    v_add_f32 v191, 1.0, v191
    v_rcp_f32 v191, v191
    v_add_f32 v192, 1.0, v192
    v_rcp_f32 v192, v192
    v_add_f32 v193, 1.0, v193
    v_rcp_f32 v193, v193
    v_mul_f32 v88, v88, v190
    v_mul_f32 v89, v89, v191
    v_mul_f32 v90, v90, v192
    v_mul_f32 v91, v91, v193
    v_cvt_pk_bf16_f32 v196, v88, v89
    v_cvt_pk_bf16_f32 v197, v90, v91
    ds_write_b64 v36, v[196:197] offset:32
    v_fma_f32 v92, -v128, v152, v92
    v_mul_f32 v92, v129, v92
    v_fma_f32 v93, -v128, v153, v93
    v_mul_f32 v93, v129, v93
    v_fma_f32 v94, -v128, v154, v94
    v_mul_f32 v94, v129, v94
    v_fma_f32 v95, -v128, v155, v95
    v_mul_f32 v95, v129, v95
    v_cvt_pk_bf16_f32 v188, v92, v93
    v_cvt_pk_bf16_f32 v189, v94, v95
    v_lshlrev_b32 v92, 16, v188
    v_and_b32 v93, 0xffff0000, v188
    v_lshlrev_b32 v94, 16, v189
    v_and_b32 v95, 0xffff0000, v189
    v_mul_f32 v190, v92, v92
    v_fma_f32 v190, v190, v199, v198
    v_mul_f32 v190, v190, v92
    v_exp_f32 v190, v190
    v_mul_f32 v191, v93, v93
    v_fma_f32 v191, v191, v199, v198
    v_mul_f32 v191, v191, v93
    v_exp_f32 v191, v191
    v_mul_f32 v192, v94, v94
    v_fma_f32 v192, v192, v199, v198
    v_mul_f32 v192, v192, v94
    v_exp_f32 v192, v192
    v_mul_f32 v193, v95, v95
    v_fma_f32 v193, v193, v199, v198
    v_mul_f32 v193, v193, v95
    v_exp_f32 v193, v193
    v_add_f32 v190, 1.0, v190
    v_rcp_f32 v190, v190
    v_add_f32 v191, 1.0, v191
    v_rcp_f32 v191, v191
    v_add_f32 v192, 1.0, v192
    v_rcp_f32 v192, v192
    v_add_f32 v193, 1.0, v193
    v_rcp_f32 v193, v193
    v_mul_f32 v92, v92, v190
    v_mul_f32 v93, v93, v191
    v_mul_f32 v94, v94, v192
    v_mul_f32 v95, v95, v193
    v_cvt_pk_bf16_f32 v196, v92, v93
    v_cvt_pk_bf16_f32 v197, v94, v95
    ds_write_b64 v36, v[196:197] offset:48
    v_fma_f32 v96, -v128, v156, v96
    v_mul_f32 v96, v129, v96
    v_fma_f32 v97, -v128, v157, v97
    v_mul_f32 v97, v129, v97
    v_fma_f32 v98, -v128, v158, v98
    v_mul_f32 v98, v129, v98
    v_fma_f32 v99, -v128, v159, v99
    v_mul_f32 v99, v129, v99
    v_cvt_pk_bf16_f32 v188, v96, v97
    v_cvt_pk_bf16_f32 v189, v98, v99
    v_lshlrev_b32 v96, 16, v188
    v_and_b32 v97, 0xffff0000, v188
    v_lshlrev_b32 v98, 16, v189
    v_and_b32 v99, 0xffff0000, v189
    v_mul_f32 v190, v96, v96
    v_fma_f32 v190, v190, v199, v198
    v_mul_f32 v190, v190, v96
    v_exp_f32 v190, v190
    v_mul_f32 v191, v97, v97
    v_fma_f32 v191, v191, v199, v198
    v_mul_f32 v191, v191, v97
    v_exp_f32 v191, v191
    v_mul_f32 v192, v98, v98
    v_fma_f32 v192, v192, v199, v198
    v_mul_f32 v192, v192, v98
    v_exp_f32 v192, v192
    v_mul_f32 v193, v99, v99
    v_fma_f32 v193, v193, v199, v198
    v_mul_f32 v193, v193, v99
    v_exp_f32 v193, v193
    v_add_f32 v190, 1.0, v190
    v_rcp_f32 v190, v190
    v_add_f32 v191, 1.0, v191
    v_rcp_f32 v191, v191
    v_add_f32 v192, 1.0, v192
    v_rcp_f32 v192, v192
    v_add_f32 v193, 1.0, v193
    v_rcp_f32 v193, v193
    v_mul_f32 v96, v96, v190
    v_mul_f32 v97, v97, v191
    v_mul_f32 v98, v98, v192
    v_mul_f32 v99, v99, v193
    v_cvt_pk_bf16_f32 v196, v96, v97
    v_cvt_pk_bf16_f32 v197, v98, v99
    ds_write_b64 v36, v[196:197] offset:64
    v_fma_f32 v100, -v128, v160, v100
    v_mul_f32 v100, v129, v100
    v_fma_f32 v101, -v128, v161, v101
    v_mul_f32 v101, v129, v101
    v_fma_f32 v102, -v128, v162, v102
    v_mul_f32 v102, v129, v102
    v_fma_f32 v103, -v128, v163, v103
    v_mul_f32 v103, v129, v103
    v_cvt_pk_bf16_f32 v188, v100, v101
    v_cvt_pk_bf16_f32 v189, v102, v103
    v_lshlrev_b32 v100, 16, v188
    v_and_b32 v101, 0xffff0000, v188
    v_lshlrev_b32 v102, 16, v189
    v_and_b32 v103, 0xffff0000, v189
    v_mul_f32 v190, v100, v100
    v_fma_f32 v190, v190, v199, v198
    v_mul_f32 v190, v190, v100
    v_exp_f32 v190, v190
    v_mul_f32 v191, v101, v101
    v_fma_f32 v191, v191, v199, v198
    v_mul_f32 v191, v191, v101
    v_exp_f32 v191, v191
    v_mul_f32 v192, v102, v102
    v_fma_f32 v192, v192, v199, v198
    v_mul_f32 v192, v192, v102
    v_exp_f32 v192, v192
    v_mul_f32 v193, v103, v103
    v_fma_f32 v193, v193, v199, v198
    v_mul_f32 v193, v193, v103
    v_exp_f32 v193, v193
    v_add_f32 v190, 1.0, v190
    v_rcp_f32 v190, v190
    v_add_f32 v191, 1.0, v191
    v_rcp_f32 v191, v191
    v_add_f32 v192, 1.0, v192
    v_rcp_f32 v192, v192
    v_add_f32 v193, 1.0, v193
    v_rcp_f32 v193, v193
    v_mul_f32 v100, v100, v190
    v_mul_f32 v101, v101, v191
    v_mul_f32 v102, v102, v192
    v_mul_f32 v103, v103, v193
    v_cvt_pk_bf16_f32 v196, v100, v101
    v_cvt_pk_bf16_f32 v197, v102, v103
    ds_write_b64 v36, v[196:197] offset:80
    v_fma_f32 v104, -v128, v164, v104
    v_mul_f32 v104, v129, v104
    v_fma_f32 v105, -v128, v165, v105
    v_mul_f32 v105, v129, v105
    v_fma_f32 v106, -v128, v166, v106
    v_mul_f32 v106, v129, v106
    v_fma_f32 v107, -v128, v167, v107
    v_mul_f32 v107, v129, v107
    v_cvt_pk_bf16_f32 v188, v104, v105
    v_cvt_pk_bf16_f32 v189, v106, v107
    v_lshlrev_b32 v104, 16, v188
    v_and_b32 v105, 0xffff0000, v188
    v_lshlrev_b32 v106, 16, v189
    v_and_b32 v107, 0xffff0000, v189
    v_mul_f32 v190, v104, v104
    v_fma_f32 v190, v190, v199, v198
    v_mul_f32 v190, v190, v104
    v_exp_f32 v190, v190
    v_mul_f32 v191, v105, v105
    v_fma_f32 v191, v191, v199, v198
    v_mul_f32 v191, v191, v105
    v_exp_f32 v191, v191
    v_mul_f32 v192, v106, v106
    v_fma_f32 v192, v192, v199, v198
    v_mul_f32 v192, v192, v106
    v_exp_f32 v192, v192
    v_mul_f32 v193, v107, v107
    v_fma_f32 v193, v193, v199, v198
    v_mul_f32 v193, v193, v107
    v_exp_f32 v193, v193
    v_add_f32 v190, 1.0, v190
    v_rcp_f32 v190, v190
    v_add_f32 v191, 1.0, v191
    v_rcp_f32 v191, v191
    v_add_f32 v192, 1.0, v192
    v_rcp_f32 v192, v192
    v_add_f32 v193, 1.0, v193
    v_rcp_f32 v193, v193
    v_mul_f32 v104, v104, v190
    v_mul_f32 v105, v105, v191
    v_mul_f32 v106, v106, v192
    v_mul_f32 v107, v107, v193
    v_cvt_pk_bf16_f32 v196, v104, v105
    v_cvt_pk_bf16_f32 v197, v106, v107
    ds_write_b64 v36, v[196:197] offset:96
    v_fma_f32 v108, -v128, v168, v108
    v_mul_f32 v108, v129, v108
    v_fma_f32 v109, -v128, v169, v109
    v_mul_f32 v109, v129, v109
    v_fma_f32 v110, -v128, v170, v110
    v_mul_f32 v110, v129, v110
    v_fma_f32 v111, -v128, v171, v111
    v_mul_f32 v111, v129, v111
    v_cvt_pk_bf16_f32 v188, v108, v109
    v_cvt_pk_bf16_f32 v189, v110, v111
    v_lshlrev_b32 v108, 16, v188
    v_and_b32 v109, 0xffff0000, v188
    v_lshlrev_b32 v110, 16, v189
    v_and_b32 v111, 0xffff0000, v189
    v_mul_f32 v190, v108, v108
    v_fma_f32 v190, v190, v199, v198
    v_mul_f32 v190, v190, v108
    v_exp_f32 v190, v190
    v_mul_f32 v191, v109, v109
    v_fma_f32 v191, v191, v199, v198
    v_mul_f32 v191, v191, v109
    v_exp_f32 v191, v191
    v_mul_f32 v192, v110, v110
    v_fma_f32 v192, v192, v199, v198
    v_mul_f32 v192, v192, v110
    v_exp_f32 v192, v192
    v_mul_f32 v193, v111, v111
    v_fma_f32 v193, v193, v199, v198
    v_mul_f32 v193, v193, v111
    v_exp_f32 v193, v193
    v_add_f32 v190, 1.0, v190
    v_rcp_f32 v190, v190
    v_add_f32 v191, 1.0, v191
    v_rcp_f32 v191, v191
    v_add_f32 v192, 1.0, v192
    v_rcp_f32 v192, v192
    v_add_f32 v193, 1.0, v193
    v_rcp_f32 v193, v193
    v_mul_f32 v108, v108, v190
    v_mul_f32 v109, v109, v191
    v_mul_f32 v110, v110, v192
    v_mul_f32 v111, v111, v193
    v_cvt_pk_bf16_f32 v196, v108, v109
    v_cvt_pk_bf16_f32 v197, v110, v111
    ds_write_b64 v36, v[196:197] offset:112
    v_fma_f32 v112, -v128, v172, v112
    v_mul_f32 v112, v129, v112
    v_fma_f32 v113, -v128, v173, v113
    v_mul_f32 v113, v129, v113
    v_fma_f32 v114, -v128, v174, v114
    v_mul_f32 v114, v129, v114
    v_fma_f32 v115, -v128, v175, v115
    v_mul_f32 v115, v129, v115
    v_cvt_pk_bf16_f32 v188, v112, v113
    v_cvt_pk_bf16_f32 v189, v114, v115
    v_lshlrev_b32 v112, 16, v188
    v_and_b32 v113, 0xffff0000, v188
    v_lshlrev_b32 v114, 16, v189
    v_and_b32 v115, 0xffff0000, v189
    v_mul_f32 v190, v112, v112
    v_fma_f32 v190, v190, v199, v198
    v_mul_f32 v190, v190, v112
    v_exp_f32 v190, v190
    v_mul_f32 v191, v113, v113
    v_fma_f32 v191, v191, v199, v198
    v_mul_f32 v191, v191, v113
    v_exp_f32 v191, v191
    v_mul_f32 v192, v114, v114
    v_fma_f32 v192, v192, v199, v198
    v_mul_f32 v192, v192, v114
    v_exp_f32 v192, v192
    v_mul_f32 v193, v115, v115
    v_fma_f32 v193, v193, v199, v198
    v_mul_f32 v193, v193, v115
    v_exp_f32 v193, v193
    v_add_f32 v190, 1.0, v190
    v_rcp_f32 v190, v190
    v_add_f32 v191, 1.0, v191
    v_rcp_f32 v191, v191
    v_add_f32 v192, 1.0, v192
    v_rcp_f32 v192, v192
    v_add_f32 v193, 1.0, v193
    v_rcp_f32 v193, v193
    v_mul_f32 v112, v112, v190
    v_mul_f32 v113, v113, v191
    v_mul_f32 v114, v114, v192
    v_mul_f32 v115, v115, v193
    v_cvt_pk_bf16_f32 v196, v112, v113
    v_cvt_pk_bf16_f32 v197, v114, v115
    ds_write_b64 v36, v[196:197] offset:128
    v_fma_f32 v116, -v128, v176, v116
    v_mul_f32 v116, v129, v116
    v_fma_f32 v117, -v128, v177, v117
    v_mul_f32 v117, v129, v117
    v_fma_f32 v118, -v128, v178, v118
    v_mul_f32 v118, v129, v118
    v_fma_f32 v119, -v128, v179, v119
    v_mul_f32 v119, v129, v119
    v_cvt_pk_bf16_f32 v188, v116, v117
    v_cvt_pk_bf16_f32 v189, v118, v119
    v_lshlrev_b32 v116, 16, v188
    v_and_b32 v117, 0xffff0000, v188
    v_lshlrev_b32 v118, 16, v189
    v_and_b32 v119, 0xffff0000, v189
    v_mul_f32 v190, v116, v116
    v_fma_f32 v190, v190, v199, v198
    v_mul_f32 v190, v190, v116
    v_exp_f32 v190, v190
    v_mul_f32 v191, v117, v117
    v_fma_f32 v191, v191, v199, v198
    v_mul_f32 v191, v191, v117
    v_exp_f32 v191, v191
    v_mul_f32 v192, v118, v118
    v_fma_f32 v192, v192, v199, v198
    v_mul_f32 v192, v192, v118
    v_exp_f32 v192, v192
    v_mul_f32 v193, v119, v119
    v_fma_f32 v193, v193, v199, v198
    v_mul_f32 v193, v193, v119
    v_exp_f32 v193, v193
    v_add_f32 v190, 1.0, v190
    v_rcp_f32 v190, v190
    v_add_f32 v191, 1.0, v191
    v_rcp_f32 v191, v191
    v_add_f32 v192, 1.0, v192
    v_rcp_f32 v192, v192
    v_add_f32 v193, 1.0, v193
    v_rcp_f32 v193, v193
    v_mul_f32 v116, v116, v190
    v_mul_f32 v117, v117, v191
    v_mul_f32 v118, v118, v192
    v_mul_f32 v119, v119, v193
    v_cvt_pk_bf16_f32 v196, v116, v117
    v_cvt_pk_bf16_f32 v197, v118, v119
    ds_write_b64 v36, v[196:197] offset:144
    v_fma_f32 v120, -v128, v180, v120
    v_mul_f32 v120, v129, v120
    v_fma_f32 v121, -v128, v181, v121
    v_mul_f32 v121, v129, v121
    v_fma_f32 v122, -v128, v182, v122
    v_mul_f32 v122, v129, v122
    v_fma_f32 v123, -v128, v183, v123
    v_mul_f32 v123, v129, v123
    v_cvt_pk_bf16_f32 v188, v120, v121
    v_cvt_pk_bf16_f32 v189, v122, v123
    v_lshlrev_b32 v120, 16, v188
    v_and_b32 v121, 0xffff0000, v188
    v_lshlrev_b32 v122, 16, v189
    v_and_b32 v123, 0xffff0000, v189
    v_mul_f32 v190, v120, v120
    v_fma_f32 v190, v190, v199, v198
    v_mul_f32 v190, v190, v120
    v_exp_f32 v190, v190
    v_mul_f32 v191, v121, v121
    v_fma_f32 v191, v191, v199, v198
    v_mul_f32 v191, v191, v121
    v_exp_f32 v191, v191
    v_mul_f32 v192, v122, v122
    v_fma_f32 v192, v192, v199, v198
    v_mul_f32 v192, v192, v122
    v_exp_f32 v192, v192
    v_mul_f32 v193, v123, v123
    v_fma_f32 v193, v193, v199, v198
    v_mul_f32 v193, v193, v123
    v_exp_f32 v193, v193
    v_add_f32 v190, 1.0, v190
    v_rcp_f32 v190, v190
    v_add_f32 v191, 1.0, v191
    v_rcp_f32 v191, v191
    v_add_f32 v192, 1.0, v192
    v_rcp_f32 v192, v192
    v_add_f32 v193, 1.0, v193
    v_rcp_f32 v193, v193
    v_mul_f32 v120, v120, v190
    v_mul_f32 v121, v121, v191
    v_mul_f32 v122, v122, v192
    v_mul_f32 v123, v123, v193
    v_cvt_pk_bf16_f32 v196, v120, v121
    v_cvt_pk_bf16_f32 v197, v122, v123
    ds_write_b64 v36, v[196:197] offset:160
    v_fma_f32 v124, -v128, v184, v124
    v_mul_f32 v124, v129, v124
    v_fma_f32 v125, -v128, v185, v125
    v_mul_f32 v125, v129, v125
    v_fma_f32 v126, -v128, v186, v126
    v_mul_f32 v126, v129, v126
    v_fma_f32 v127, -v128, v187, v127
    v_mul_f32 v127, v129, v127
    v_cvt_pk_bf16_f32 v188, v124, v125
    v_cvt_pk_bf16_f32 v189, v126, v127
    v_lshlrev_b32 v124, 16, v188
    v_and_b32 v125, 0xffff0000, v188
    v_lshlrev_b32 v126, 16, v189
    v_and_b32 v127, 0xffff0000, v189
    v_mul_f32 v190, v124, v124
    v_fma_f32 v190, v190, v199, v198
    v_mul_f32 v190, v190, v124
    v_exp_f32 v190, v190
    v_mul_f32 v191, v125, v125
    v_fma_f32 v191, v191, v199, v198
    v_mul_f32 v191, v191, v125
    v_exp_f32 v191, v191
    v_mul_f32 v192, v126, v126
    v_fma_f32 v192, v192, v199, v198
    v_mul_f32 v192, v192, v126
    v_exp_f32 v192, v192
    v_mul_f32 v193, v127, v127
    v_fma_f32 v193, v193, v199, v198
    v_mul_f32 v193, v193, v127
    v_exp_f32 v193, v193
    v_add_f32 v190, 1.0, v190
    v_rcp_f32 v190, v190
    v_add_f32 v191, 1.0, v191
    v_rcp_f32 v191, v191
    v_add_f32 v192, 1.0, v192
    v_rcp_f32 v192, v192
    v_add_f32 v193, 1.0, v193
    v_rcp_f32 v193, v193
    v_mul_f32 v124, v124, v190
    v_mul_f32 v125, v125, v191
    v_mul_f32 v126, v126, v192
    v_mul_f32 v127, v127, v193
    v_cvt_pk_bf16_f32 v196, v124, v125
    v_cvt_pk_bf16_f32 v197, v126, v127
    ds_write_b64 v36, v[196:197] offset:176
    s_waitcnt lgkmcnt(0)
    s_barrier
    ds_read_b128 v[80:83], v30
    ds_read_b128 v[84:87], v31
    ds_read_b128 v[88:91], v32
    ds_read_b128 v[92:95], v33
    ds_read_b128 v[96:99], v34
    ds_read_b128 v[100:103], v35
    s_waitcnt lgkmcnt(5)
    buffer_store_dwordx4 v[80:83], v24, s[16:19], 0 offen
    s_waitcnt lgkmcnt(4)
    buffer_store_dwordx4 v[84:87], v25, s[16:19], 0 offen
    s_waitcnt lgkmcnt(3)
    buffer_store_dwordx4 v[88:91], v26, s[16:19], 0 offen
    s_waitcnt lgkmcnt(2)
    buffer_store_dwordx4 v[92:95], v27, s[16:19], 0 offen
    s_waitcnt lgkmcnt(1)
    buffer_store_dwordx4 v[96:99], v28, s[16:19], 0 offen
    s_waitcnt lgkmcnt(0)
    buffer_store_dwordx4 v[100:103], v29, s[16:19], 0 offen
g3b_kernel_end1:
    s_endpgm
.globl lnb_kernel
.p2align 8
.type lnb_kernel,@function
lnb_kernel:
    s_cmp_ge_u32 s2, 256
    s_cbranch_scc1 lnb_kernel_end1
    s_load_dwordx16 s[48:63], s[0:1], 0
    s_load_dwordx8 s[64:71], s[0:1], 64
    v_and_b32 v1, 63, v0
    v_lshrrev_b32 v2, 6, v0
    s_nop 0
    v_readfirstlane_b32 s40, v2
    s_waitcnt lgkmcnt(0)
    s_add_u32 s8, s70, 18350080
    s_addc_u32 s9, s71, 0
    s_mov_b32 s10, 6291456
    s_mov_b32 s11, 0x00020000
    s_add_u32 s12, s70, 24641536
    s_addc_u32 s13, s71, 0
    s_mov_b32 s14, 3145728
    s_mov_b32 s15, 0x00020000
    s_lshl_b32 s41, s2, 3
    s_lshl_b32 s42, s40, 1
    s_add_u32 s41, s41, s42
    s_mul_i32 s43, s41, 3072
    s_mul_i32 s44, s41, 1536
    v_lshlrev_b32 v2, 4, v1
    v_cmp_gt_u32 vcc, 32, v1
    s_mov_b64 s[46:47], vcc
    s_add_u32 s45, s43, 1536
    buffer_load_dwordx4 v[8:11], v2, s[8:11], s45 offen
    s_mov_b64 exec, s[46:47]
    buffer_load_dwordx4 v[12:15], v2, s[8:11], s45 offen offset:1024
    s_mov_b64 exec, -1
    s_add_u32 s45, s43, 4608
    buffer_load_dwordx4 v[16:19], v2, s[8:11], s45 offen
    s_mov_b64 exec, s[46:47]
    buffer_load_dwordx4 v[20:23], v2, s[8:11], s45 offen offset:1024
    s_mov_b64 exec, -1
    s_waitcnt vmcnt(0)
    v_cndmask_b32 v12, 0, v12, s[46:47]
    v_cndmask_b32 v13, 0, v13, s[46:47]
    v_cndmask_b32 v14, 0, v14, s[46:47]
    v_cndmask_b32 v15, 0, v15, s[46:47]
    v_lshlrev_b32 v24, 16, v8
    v_and_b32 v25, 0xffff0000, v8
    v_lshlrev_b32 v26, 16, v9
    v_and_b32 v27, 0xffff0000, v9
    v_lshlrev_b32 v28, 16, v10
    v_and_b32 v29, 0xffff0000, v10
    v_lshlrev_b32 v30, 16, v11
    v_and_b32 v31, 0xffff0000, v11
    v_lshlrev_b32 v32, 16, v12
    v_and_b32 v33, 0xffff0000, v12
    v_lshlrev_b32 v34, 16, v13
    v_and_b32 v35, 0xffff0000, v13
    v_lshlrev_b32 v36, 16, v14
    v_and_b32 v37, 0xffff0000, v14
    v_lshlrev_b32 v38, 16, v15
    v_and_b32 v39, 0xffff0000, v15
    v_add_f32 v40, v24, v25
    v_add_f32 v40, v40, v26
    v_add_f32 v40, v40, v27
    v_add_f32 v40, v40, v28
    v_add_f32 v40, v40, v29
    v_add_f32 v40, v40, v30
    v_add_f32 v40, v40, v31
    v_add_f32 v40, v40, v32
    v_add_f32 v40, v40, v33
    v_add_f32 v40, v40, v34
    v_add_f32 v40, v40, v35
    v_add_f32 v40, v40, v36
    v_add_f32 v40, v40, v37
    v_add_f32 v40, v40, v38
    v_add_f32 v40, v40, v39
    s_nop 1
    v_add_f32_dpp v40, v40, v40 row_ror:8 row_mask:0xf bank_mask:0xf
    s_nop 1
    v_add_f32_dpp v40, v40, v40 row_ror:4 row_mask:0xf bank_mask:0xf
    s_nop 1
    v_add_f32_dpp v40, v40, v40 row_ror:2 row_mask:0xf bank_mask:0xf
    s_nop 1
    v_add_f32_dpp v40, v40, v40 row_ror:1 row_mask:0xf bank_mask:0xf
    s_nop 1
    v_readlane_b32 s48, v40, 0
    v_readlane_b32 s49, v40, 16
    v_readlane_b32 s50, v40, 32
    v_readlane_b32 s51, v40, 48
    s_nop 1
    v_mov_b32 v40, s48
    v_add_f32 v40, s49, v40
    v_add_f32 v40, s50, v40
    v_add_f32 v40, s51, v40
    v_mul_f32 v40, 0x3aaaaaab, v40
    v_mov_b32 v41, 0
    v_sub_f32 v42, v24, v40
    v_fmac_f32 v41, v42, v42
    v_sub_f32 v42, v25, v40
    v_fmac_f32 v41, v42, v42
    v_sub_f32 v42, v26, v40
    v_fmac_f32 v41, v42, v42
    v_sub_f32 v42, v27, v40
    v_fmac_f32 v41, v42, v42
    v_sub_f32 v42, v28, v40
    v_fmac_f32 v41, v42, v42
    v_sub_f32 v42, v29, v40
    v_fmac_f32 v41, v42, v42
    v_sub_f32 v42, v30, v40
    v_fmac_f32 v41, v42, v42
    v_sub_f32 v42, v31, v40
    v_fmac_f32 v41, v42, v42
    v_sub_f32 v42, v32, v40
    v_cndmask_b32 v42, 0, v42, s[46:47]
    v_fmac_f32 v41, v42, v42
    v_sub_f32 v42, v33, v40
    v_cndmask_b32 v42, 0, v42, s[46:47]
    v_fmac_f32 v41, v42, v42
    v_sub_f32 v42, v34, v40
    v_cndmask_b32 v42, 0, v42, s[46:47]
    v_fmac_f32 v41, v42, v42
    v_sub_f32 v42, v35, v40
    v_cndmask_b32 v42, 0, v42, s[46:47]
    v_fmac_f32 v41, v42, v42
    v_sub_f32 v42, v36, v40
    v_cndmask_b32 v42, 0, v42, s[46:47]
    v_fmac_f32 v41, v42, v42
    v_sub_f32 v42, v37, v40
    v_cndmask_b32 v42, 0, v42, s[46:47]
    v_fmac_f32 v41, v42, v42
    v_sub_f32 v42, v38, v40
    v_cndmask_b32 v42, 0, v42, s[46:47]
    v_fmac_f32 v41, v42, v42
    v_sub_f32 v42, v39, v40
    v_cndmask_b32 v42, 0, v42, s[46:47]
    v_fmac_f32 v41, v42, v42
    s_nop 1
    v_add_f32_dpp v41, v41, v41 row_ror:8 row_mask:0xf bank_mask:0xf
    s_nop 1
    v_add_f32_dpp v41, v41, v41 row_ror:4 row_mask:0xf bank_mask:0xf
    s_nop 1
    v_add_f32_dpp v41, v41, v41 row_ror:2 row_mask:0xf bank_mask:0xf
    s_nop 1
    v_add_f32_dpp v41, v41, v41 row_ror:1 row_mask:0xf bank_mask:0xf
    s_nop 1
    v_readlane_b32 s48, v41, 0
    v_readlane_b32 s49, v41, 16
    v_readlane_b32 s50, v41, 32
    v_readlane_b32 s51, v41, 48
    s_nop 1
    v_mov_b32 v41, s48
    v_add_f32 v41, s49, v41
    v_add_f32 v41, s50, v41
    v_add_f32 v41, s51, v41
    v_mul_f32 v41, 0x3aaaaaab, v41
    v_cvt_pk_bf16_f32 v42, v41, v41
    v_lshlrev_b32 v41, 16, v42
    v_add_f32 v41, 0x3727c5ac, v41
    v_cvt_pk_bf16_f32 v42, v41, v41
    v_lshlrev_b32 v41, 16, v42
    v_sqrt_f32 v41, v41
    s_nop 0
    v_cvt_pk_bf16_f32 v42, v41, v41
    v_lshlrev_b32 v41, 16, v42
    v_rcp_f32 v41, v41
    v_cvt_pk_bf16_f32 v42, v40, v40
    v_lshlrev_b32 v40, 16, v42
    v_sub_f32 v24, v24, v40
    v_sub_f32 v25, v25, v40
    v_cvt_pk_bf16_f32 v42, v24, v25
    v_lshlrev_b32 v24, 16, v42
    v_and_b32 v25, 0xffff0000, v42
    v_mul_f32 v24, v24, v41
    v_mul_f32 v25, v25, v41
    v_cvt_pk_bf16_f32 v8, v24, v25
    v_sub_f32 v26, v26, v40
    v_sub_f32 v27, v27, v40
    v_cvt_pk_bf16_f32 v42, v26, v27
    v_lshlrev_b32 v26, 16, v42
    v_and_b32 v27, 0xffff0000, v42
    v_mul_f32 v26, v26, v41
    v_mul_f32 v27, v27, v41
    v_cvt_pk_bf16_f32 v9, v26, v27
    v_sub_f32 v28, v28, v40
    v_sub_f32 v29, v29, v40
    v_cvt_pk_bf16_f32 v42, v28, v29
    v_lshlrev_b32 v28, 16, v42
    v_and_b32 v29, 0xffff0000, v42
    v_mul_f32 v28, v28, v41
    v_mul_f32 v29, v29, v41
    v_cvt_pk_bf16_f32 v10, v28, v29
    v_sub_f32 v30, v30, v40
    v_sub_f32 v31, v31, v40
    v_cvt_pk_bf16_f32 v42, v30, v31
    v_lshlrev_b32 v30, 16, v42
    v_and_b32 v31, 0xffff0000, v42
    v_mul_f32 v30, v30, v41
    v_mul_f32 v31, v31, v41
    v_cvt_pk_bf16_f32 v11, v30, v31
    v_sub_f32 v32, v32, v40
    v_sub_f32 v33, v33, v40
    v_cvt_pk_bf16_f32 v42, v32, v33
    v_lshlrev_b32 v32, 16, v42
    v_and_b32 v33, 0xffff0000, v42
    v_mul_f32 v32, v32, v41
    v_mul_f32 v33, v33, v41
    v_cvt_pk_bf16_f32 v12, v32, v33
    v_sub_f32 v34, v34, v40
    v_sub_f32 v35, v35, v40
    v_cvt_pk_bf16_f32 v42, v34, v35
    v_lshlrev_b32 v34, 16, v42
    v_and_b32 v35, 0xffff0000, v42
    v_mul_f32 v34, v34, v41
    v_mul_f32 v35, v35, v41
    v_cvt_pk_bf16_f32 v13, v34, v35
    v_sub_f32 v36, v36, v40
    v_sub_f32 v37, v37, v40
    v_cvt_pk_bf16_f32 v42, v36, v37
    v_lshlrev_b32 v36, 16, v42
    v_and_b32 v37, 0xffff0000, v42
    v_mul_f32 v36, v36, v41
    v_mul_f32 v37, v37, v41
    v_cvt_pk_bf16_f32 v14, v36, v37
    v_sub_f32 v38, v38, v40
    v_sub_f32 v39, v39, v40
    v_cvt_pk_bf16_f32 v42, v38, v39
    v_lshlrev_b32 v38, 16, v42
    v_and_b32 v39, 0xffff0000, v42
    v_mul_f32 v38, v38, v41
    v_mul_f32 v39, v39, v41
    v_cvt_pk_bf16_f32 v15, v38, v39
    s_add_u32 s45, s44, 0
    buffer_store_dwordx4 v[8:11], v2, s[12:15], s45 offen
    s_mov_b64 exec, s[46:47]
    buffer_store_dwordx4 v[12:15], v2, s[12:15], s45 offen offset:1024
    s_mov_b64 exec, -1
    v_cndmask_b32 v20, 0, v20, s[46:47]
    v_cndmask_b32 v21, 0, v21, s[46:47]
    v_cndmask_b32 v22, 0, v22, s[46:47]
    v_cndmask_b32 v23, 0, v23, s[46:47]
    v_lshlrev_b32 v24, 16, v16
    v_and_b32 v25, 0xffff0000, v16
    v_lshlrev_b32 v26, 16, v17
    v_and_b32 v27, 0xffff0000, v17
    v_lshlrev_b32 v28, 16, v18
    v_and_b32 v29, 0xffff0000, v18
    v_lshlrev_b32 v30, 16, v19
    v_and_b32 v31, 0xffff0000, v19
    v_lshlrev_b32 v32, 16, v20
    v_and_b32 v33, 0xffff0000, v20
    v_lshlrev_b32 v34, 16, v21
    v_and_b32 v35, 0xffff0000, v21
    v_lshlrev_b32 v36, 16, v22
    v_and_b32 v37, 0xffff0000, v22
    v_lshlrev_b32 v38, 16, v23
    v_and_b32 v39, 0xffff0000, v23
    v_add_f32 v40, v24, v25
    v_add_f32 v40, v40, v26
    v_add_f32 v40, v40, v27
    v_add_f32 v40, v40, v28
    v_add_f32 v40, v40, v29
    v_add_f32 v40, v40, v30
    v_add_f32 v40, v40, v31
    v_add_f32 v40, v40, v32
    v_add_f32 v40, v40, v33
    v_add_f32 v40, v40, v34
    v_add_f32 v40, v40, v35
    v_add_f32 v40, v40, v36
    v_add_f32 v40, v40, v37
    v_add_f32 v40, v40, v38
    v_add_f32 v40, v40, v39
    s_nop 1
    v_add_f32_dpp v40, v40, v40 row_ror:8 row_mask:0xf bank_mask:0xf
    s_nop 1
    v_add_f32_dpp v40, v40, v40 row_ror:4 row_mask:0xf bank_mask:0xf
    s_nop 1
    v_add_f32_dpp v40, v40, v40 row_ror:2 row_mask:0xf bank_mask:0xf
    s_nop 1
    v_add_f32_dpp v40, v40, v40 row_ror:1 row_mask:0xf bank_mask:0xf
    s_nop 1
    v_readlane_b32 s48, v40, 0
    v_readlane_b32 s49, v40, 16
    v_readlane_b32 s50, v40, 32
    v_readlane_b32 s51, v40, 48
    s_nop 1
    v_mov_b32 v40, s48
    v_add_f32 v40, s49, v40
    v_add_f32 v40, s50, v40
    v_add_f32 v40, s51, v40
    v_mul_f32 v40, 0x3aaaaaab, v40
    v_mov_b32 v41, 0
    v_sub_f32 v42, v24, v40
    v_fmac_f32 v41, v42, v42
    v_sub_f32 v42, v25, v40
    v_fmac_f32 v41, v42, v42
    v_sub_f32 v42, v26, v40
    v_fmac_f32 v41, v42, v42
    v_sub_f32 v42, v27, v40
    v_fmac_f32 v41, v42, v42
    v_sub_f32 v42, v28, v40
    v_fmac_f32 v41, v42, v42
    v_sub_f32 v42, v29, v40
    v_fmac_f32 v41, v42, v42
    v_sub_f32 v42, v30, v40
    v_fmac_f32 v41, v42, v42
    v_sub_f32 v42, v31, v40
    v_fmac_f32 v41, v42, v42
    v_sub_f32 v42, v32, v40
    v_cndmask_b32 v42, 0, v42, s[46:47]
    v_fmac_f32 v41, v42, v42
    v_sub_f32 v42, v33, v40
    v_cndmask_b32 v42, 0, v42, s[46:47]
    v_fmac_f32 v41, v42, v42
    v_sub_f32 v42, v34, v40
    v_cndmask_b32 v42, 0, v42, s[46:47]
    v_fmac_f32 v41, v42, v42
    v_sub_f32 v42, v35, v40
    v_cndmask_b32 v42, 0, v42, s[46:47]
    v_fmac_f32 v41, v42, v42
    v_sub_f32 v42, v36, v40
    v_cndmask_b32 v42, 0, v42, s[46:47]
    v_fmac_f32 v41, v42, v42
    v_sub_f32 v42, v37, v40
    v_cndmask_b32 v42, 0, v42, s[46:47]
    v_fmac_f32 v41, v42, v42
    v_sub_f32 v42, v38, v40
    v_cndmask_b32 v42, 0, v42, s[46:47]
    v_fmac_f32 v41, v42, v42
    v_sub_f32 v42, v39, v40
    v_cndmask_b32 v42, 0, v42, s[46:47]
    v_fmac_f32 v41, v42, v42
    s_nop 1
    v_add_f32_dpp v41, v41, v41 row_ror:8 row_mask:0xf bank_mask:0xf
    s_nop 1
    v_add_f32_dpp v41, v41, v41 row_ror:4 row_mask:0xf bank_mask:0xf
    s_nop 1
    v_add_f32_dpp v41, v41, v41 row_ror:2 row_mask:0xf bank_mask:0xf
    s_nop 1
    v_add_f32_dpp v41, v41, v41 row_ror:1 row_mask:0xf bank_mask:0xf
    s_nop 1
    v_readlane_b32 s48, v41, 0
    v_readlane_b32 s49, v41, 16
    v_readlane_b32 s50, v41, 32
    v_readlane_b32 s51, v41, 48
    s_nop 1
    v_mov_b32 v41, s48
    v_add_f32 v41, s49, v41
    v_add_f32 v41, s50, v41
    v_add_f32 v41, s51, v41
    v_mul_f32 v41, 0x3aaaaaab, v41
    v_cvt_pk_bf16_f32 v42, v41, v41
    v_lshlrev_b32 v41, 16, v42
    v_add_f32 v41, 0x3727c5ac, v41
    v_cvt_pk_bf16_f32 v42, v41, v41
    v_lshlrev_b32 v41, 16, v42
    v_sqrt_f32 v41, v41
    s_nop 0
    v_cvt_pk_bf16_f32 v42, v41, v41
    v_lshlrev_b32 v41, 16, v42
    v_rcp_f32 v41, v41
    v_cvt_pk_bf16_f32 v42, v40, v40
    v_lshlrev_b32 v40, 16, v42
    v_sub_f32 v24, v24, v40
    v_sub_f32 v25, v25, v40
    v_cvt_pk_bf16_f32 v42, v24, v25
    v_lshlrev_b32 v24, 16, v42
    v_and_b32 v25, 0xffff0000, v42
    v_mul_f32 v24, v24, v41
    v_mul_f32 v25, v25, v41
    v_cvt_pk_bf16_f32 v16, v24, v25
    v_sub_f32 v26, v26, v40
    v_sub_f32 v27, v27, v40
    v_cvt_pk_bf16_f32 v42, v26, v27
    v_lshlrev_b32 v26, 16, v42
    v_and_b32 v27, 0xffff0000, v42
    v_mul_f32 v26, v26, v41
    v_mul_f32 v27, v27, v41
    v_cvt_pk_bf16_f32 v17, v26, v27
    v_sub_f32 v28, v28, v40
    v_sub_f32 v29, v29, v40
    v_cvt_pk_bf16_f32 v42, v28, v29
    v_lshlrev_b32 v28, 16, v42
    v_and_b32 v29, 0xffff0000, v42
    v_mul_f32 v28, v28, v41
    v_mul_f32 v29, v29, v41
    v_cvt_pk_bf16_f32 v18, v28, v29
    v_sub_f32 v30, v30, v40
    v_sub_f32 v31, v31, v40
    v_cvt_pk_bf16_f32 v42, v30, v31
    v_lshlrev_b32 v30, 16, v42
    v_and_b32 v31, 0xffff0000, v42
    v_mul_f32 v30, v30, v41
    v_mul_f32 v31, v31, v41
    v_cvt_pk_bf16_f32 v19, v30, v31
    v_sub_f32 v32, v32, v40
    v_sub_f32 v33, v33, v40
    v_cvt_pk_bf16_f32 v42, v32, v33
    v_lshlrev_b32 v32, 16, v42
    v_and_b32 v33, 0xffff0000, v42
    v_mul_f32 v32, v32, v41
    v_mul_f32 v33, v33, v41
    v_cvt_pk_bf16_f32 v20, v32, v33
    v_sub_f32 v34, v34, v40
    v_sub_f32 v35, v35, v40
    v_cvt_pk_bf16_f32 v42, v34, v35
    v_lshlrev_b32 v34, 16, v42
    v_and_b32 v35, 0xffff0000, v42
    v_mul_f32 v34, v34, v41
    v_mul_f32 v35, v35, v41
    v_cvt_pk_bf16_f32 v21, v34, v35
    v_sub_f32 v36, v36, v40
    v_sub_f32 v37, v37, v40
    v_cvt_pk_bf16_f32 v42, v36, v37
    v_lshlrev_b32 v36, 16, v42
    v_and_b32 v37, 0xffff0000, v42
    v_mul_f32 v36, v36, v41
    v_mul_f32 v37, v37, v41
    v_cvt_pk_bf16_f32 v22, v36, v37
    v_sub_f32 v38, v38, v40
    v_sub_f32 v39, v39, v40
    v_cvt_pk_bf16_f32 v42, v38, v39
    v_lshlrev_b32 v38, 16, v42
    v_and_b32 v39, 0xffff0000, v42
    v_mul_f32 v38, v38, v41
    v_mul_f32 v39, v39, v41
    v_cvt_pk_bf16_f32 v23, v38, v39
    s_add_u32 s45, s44, 1536
    buffer_store_dwordx4 v[16:19], v2, s[12:15], s45 offen
    s_mov_b64 exec, s[46:47]
    buffer_store_dwordx4 v[20:23], v2, s[12:15], s45 offen offset:1024
    s_mov_b64 exec, -1
lnb_kernel_end1:
    s_endpgm
.globl g4b_kernel
.p2align 8
.type g4b_kernel,@function
g4b_kernel:
    s_cmp_ge_u32 s2, 192
    s_cbranch_scc1 g4b_kernel_end1
    s_load_dwordx16 s[48:63], s[0:1], 0
    s_load_dwordx8 s[64:71], s[0:1], 64
    v_and_b32 v1, 63, v0
    v_lshrrev_b32 v2, 6, v0
    s_and_b32 s46, s2, 7
    s_lshr_b32 s47, s2, 3
    s_mul_i32 s36, s47, 171
    s_lshr_b32 s36, s36, 11
    s_mul_i32 s3, s36, 12
    s_sub_u32 s37, s47, s3
    s_mul_i32 s46, s46, 2
    s_add_u32 s36, s36, s46
    s_mul_i32 s38, s36, 128
    s_mul_i32 s39, s37, 64
    v_readfirstlane_b32 s40, v2
    s_lshr_b32 s74, s40, 2
    s_and_b32 s40, s40, 3
    s_cmp_eq_u32 s74, 0
    s_cbranch_scc0 g4b_kernel_prod2
    s_branch g4b_kernel_cons3
g4b_kernel_prod2:
    s_mul_i32 s41, s38, 4096
    s_lshl_b32 s42, s39, 1
    s_mul_i32 s43, s40, 4096
    s_mul_i32 s44, s40, 2048
    s_add_u32 s44, s44, 65536
    s_mul_i32 s46, s40, 256
    s_add_u32 s46, s46, 0
    v_add_u32 v2, s46, v1
    v_lshrrev_b32 v3, 3, v2
    v_and_b32 v4, 7, v2
    v_bfe_u32 v5, v3, 1, 3
    v_xor_b32 v4, v4, v5
    v_lshlrev_b32 v4, 4, v4
    s_mov_b32 s47, 4096
    v_mad_u32_u24 v10, v3, s47, v4
    s_mul_i32 s46, s40, 256
    s_add_u32 s46, s46, 64
    v_add_u32 v2, s46, v1
    v_lshrrev_b32 v3, 3, v2
    v_and_b32 v4, 7, v2
    v_bfe_u32 v5, v3, 1, 3
    v_xor_b32 v4, v4, v5
    v_lshlrev_b32 v4, 4, v4
    s_mov_b32 s47, 4096
    v_mad_u32_u24 v11, v3, s47, v4
    s_mul_i32 s46, s40, 256
    s_add_u32 s46, s46, 128
    v_add_u32 v2, s46, v1
    v_lshrrev_b32 v3, 3, v2
    v_and_b32 v4, 7, v2
    v_bfe_u32 v5, v3, 1, 3
    v_xor_b32 v4, v4, v5
    v_lshlrev_b32 v4, 4, v4
    s_mov_b32 s47, 4096
    v_mad_u32_u24 v12, v3, s47, v4
    s_mul_i32 s46, s40, 256
    s_add_u32 s46, s46, 192
    v_add_u32 v2, s46, v1
    v_lshrrev_b32 v3, 3, v2
    v_and_b32 v4, 7, v2
    v_bfe_u32 v5, v3, 1, 3
    v_xor_b32 v4, v4, v5
    v_lshlrev_b32 v4, 4, v4
    s_mov_b32 s47, 4096
    v_mad_u32_u24 v13, v3, s47, v4
    s_mul_i32 s46, s40, 128
    s_add_u32 s46, s46, 0
    v_add_u32 v2, s46, v1
    v_lshrrev_b32 v3, 3, v2
    s_mov_b32 s47, 8
    v_mul_u32_u24 v4, s47, v3
    v_sub_u32 v4, v2, v4
    v_bfe_u32 v5, v3, 1, 1
    v_lshlrev_b32 v5, 2, v5
    v_xor_b32 v4, v4, v5
    v_lshlrev_b32 v4, 4, v4
    s_mov_b32 s47, 1536
    v_mad_u32_u24 v14, v3, s47, v4
    s_mul_i32 s46, s40, 128
    s_add_u32 s46, s46, 64
    v_add_u32 v2, s46, v1
    v_lshrrev_b32 v3, 3, v2
    s_mov_b32 s47, 8
    v_mul_u32_u24 v4, s47, v3
    v_sub_u32 v4, v2, v4
    v_bfe_u32 v5, v3, 1, 1
    v_lshlrev_b32 v5, 2, v5
    v_xor_b32 v4, v4, v5
    v_lshlrev_b32 v4, 4, v4
    s_mov_b32 s47, 1536
    v_mad_u32_u24 v15, v3, s47, v4
    s_waitcnt lgkmcnt(0)
    s_mov_b32 s8, s60
    s_mov_b32 s9, s61
    s_mov_b32 s10, 8388608
    s_mov_b32 s11, 0x00020000
    s_add_u32 s12, s70, 24641536
    s_addc_u32 s13, s71, 0
    s_mov_b32 s14, 3145728
    s_mov_b32 s15, 0x00020000
    s_add_u32 m0, s43, 0
    s_nop 0
    buffer_load_dwordx4 v10, s[8:11], s41 offen lds
    s_add_u32 m0, s43, 1024
    s_nop 0
    buffer_load_dwordx4 v11, s[8:11], s41 offen lds
    s_add_u32 m0, s43, 2048
    s_nop 0
    buffer_load_dwordx4 v12, s[8:11], s41 offen lds
    s_add_u32 m0, s43, 3072
    s_nop 0
    buffer_load_dwordx4 v13, s[8:11], s41 offen lds
    s_add_u32 m0, s44, 0
    s_nop 0
    buffer_load_dwordx4 v14, s[12:15], s42 offen lds
    s_add_u32 m0, s44, 1024
    s_nop 0
    buffer_load_dwordx4 v15, s[12:15], s42 offen lds
    s_add_u32 s41, s41, 128
    s_add_u32 s42, s42, 98304
    s_add_u32 m0, s43, 16384
    s_nop 0
    buffer_load_dwordx4 v10, s[8:11], s41 offen lds
    s_add_u32 m0, s43, 17408
    s_nop 0
    buffer_load_dwordx4 v11, s[8:11], s41 offen lds
    s_add_u32 m0, s43, 18432
    s_nop 0
    buffer_load_dwordx4 v12, s[8:11], s41 offen lds
    s_add_u32 m0, s43, 19456
    s_nop 0
    buffer_load_dwordx4 v13, s[8:11], s41 offen lds
    s_add_u32 m0, s44, 8192
    s_nop 0
    buffer_load_dwordx4 v14, s[12:15], s42 offen lds
    s_add_u32 m0, s44, 9216
    s_nop 0
    buffer_load_dwordx4 v15, s[12:15], s42 offen lds
    s_add_u32 s41, s41, 128
    s_add_u32 s42, s42, 98304
    s_add_u32 m0, s43, 32768
    s_nop 0
    buffer_load_dwordx4 v10, s[8:11], s41 offen lds
    s_add_u32 m0, s43, 33792
    s_nop 0
    buffer_load_dwordx4 v11, s[8:11], s41 offen lds
    s_add_u32 m0, s43, 34816
    s_nop 0
    buffer_load_dwordx4 v12, s[8:11], s41 offen lds
    s_add_u32 m0, s43, 35840
    s_nop 0
    buffer_load_dwordx4 v13, s[8:11], s41 offen lds
    s_add_u32 m0, s44, 16384
    s_nop 0
    buffer_load_dwordx4 v14, s[12:15], s42 offen lds
    s_add_u32 m0, s44, 17408
    s_nop 0
    buffer_load_dwordx4 v15, s[12:15], s42 offen lds
    s_add_u32 s41, s41, 128
    s_add_u32 s42, s42, 98304
    s_mov_b32 s45, 7
g4b_kernel_ploop4:
    s_waitcnt vmcnt(12)
    s_barrier
    s_add_u32 m0, s43, 49152
    s_nop 0
    buffer_load_dwordx4 v10, s[8:11], s41 offen lds
    s_add_u32 m0, s43, 50176
    s_nop 0
    buffer_load_dwordx4 v11, s[8:11], s41 offen lds
    s_add_u32 m0, s43, 51200
    s_nop 0
    buffer_load_dwordx4 v12, s[8:11], s41 offen lds
    s_add_u32 m0, s43, 52224
    s_nop 0
    buffer_load_dwordx4 v13, s[8:11], s41 offen lds
    s_add_u32 m0, s44, 24576
    s_nop 0
    buffer_load_dwordx4 v14, s[12:15], s42 offen lds
    s_add_u32 m0, s44, 25600
    s_nop 0
    buffer_load_dwordx4 v15, s[12:15], s42 offen lds
    s_add_u32 s41, s41, 128
    s_add_u32 s42, s42, 98304
    s_waitcnt vmcnt(12)
    s_barrier
    s_add_u32 m0, s43, 0
    s_nop 0
    buffer_load_dwordx4 v10, s[8:11], s41 offen lds
    s_add_u32 m0, s43, 1024
    s_nop 0
    buffer_load_dwordx4 v11, s[8:11], s41 offen lds
    s_add_u32 m0, s43, 2048
    s_nop 0
    buffer_load_dwordx4 v12, s[8:11], s41 offen lds
    s_add_u32 m0, s43, 3072
    s_nop 0
    buffer_load_dwordx4 v13, s[8:11], s41 offen lds
    s_add_u32 m0, s44, 0
    s_nop 0
    buffer_load_dwordx4 v14, s[12:15], s42 offen lds
    s_add_u32 m0, s44, 1024
    s_nop 0
    buffer_load_dwordx4 v15, s[12:15], s42 offen lds
    s_add_u32 s41, s41, 128
    s_add_u32 s42, s42, 98304
    s_waitcnt vmcnt(12)
    s_barrier
    s_add_u32 m0, s43, 16384
    s_nop 0
    buffer_load_dwordx4 v10, s[8:11], s41 offen lds
    s_add_u32 m0, s43, 17408
    s_nop 0
    buffer_load_dwordx4 v11, s[8:11], s41 offen lds
    s_add_u32 m0, s43, 18432
    s_nop 0
    buffer_load_dwordx4 v12, s[8:11], s41 offen lds
    s_add_u32 m0, s43, 19456
    s_nop 0
    buffer_load_dwordx4 v13, s[8:11], s41 offen lds
    s_add_u32 m0, s44, 8192
    s_nop 0
    buffer_load_dwordx4 v14, s[12:15], s42 offen lds
    s_add_u32 m0, s44, 9216
    s_nop 0
    buffer_load_dwordx4 v15, s[12:15], s42 offen lds
    s_add_u32 s41, s41, 128
    s_add_u32 s42, s42, 98304
    s_waitcnt vmcnt(12)
    s_barrier
    s_add_u32 m0, s43, 32768
    s_nop 0
    buffer_load_dwordx4 v10, s[8:11], s41 offen lds
    s_add_u32 m0, s43, 33792
    s_nop 0
    buffer_load_dwordx4 v11, s[8:11], s41 offen lds
    s_add_u32 m0, s43, 34816
    s_nop 0
    buffer_load_dwordx4 v12, s[8:11], s41 offen lds
    s_add_u32 m0, s43, 35840
    s_nop 0
    buffer_load_dwordx4 v13, s[8:11], s41 offen lds
    s_add_u32 m0, s44, 16384
    s_nop 0
    buffer_load_dwordx4 v14, s[12:15], s42 offen lds
    s_add_u32 m0, s44, 17408
    s_nop 0
    buffer_load_dwordx4 v15, s[12:15], s42 offen lds
    s_add_u32 s41, s41, 128
    s_add_u32 s42, s42, 98304
    s_sub_u32 s45, s45, 1
    s_cmp_lg_u32 s45, 0
    s_cbranch_scc1 g4b_kernel_ploop4
    s_waitcnt vmcnt(12)
    s_barrier
    s_add_u32 m0, s43, 49152
    s_nop 0
    buffer_load_dwordx4 v10, s[8:11], s41 offen lds
    s_add_u32 m0, s43, 50176
    s_nop 0
    buffer_load_dwordx4 v11, s[8:11], s41 offen lds
    s_add_u32 m0, s43, 51200
    s_nop 0
    buffer_load_dwordx4 v12, s[8:11], s41 offen lds
    s_add_u32 m0, s43, 52224
    s_nop 0
    buffer_load_dwordx4 v13, s[8:11], s41 offen lds
    s_add_u32 m0, s44, 24576
    s_nop 0
    buffer_load_dwordx4 v14, s[12:15], s42 offen lds
    s_add_u32 m0, s44, 25600
    s_nop 0
    buffer_load_dwordx4 v15, s[12:15], s42 offen lds
    s_add_u32 s41, s41, 128
    s_add_u32 s42, s42, 98304
    s_waitcnt vmcnt(12)
    s_barrier
    s_waitcnt vmcnt(6)
    s_barrier
    s_waitcnt vmcnt(0)
    s_barrier
    s_endpgm
g4b_kernel_cons3:
    s_waitcnt lgkmcnt(0)
    s_add_u32 s16, s70, 27787264
    s_addc_u32 s17, s71, 0
    s_mov_b32 s18, 3145728
    s_mov_b32 s19, 0x00020000
    s_lshr_b32 s72, s40, 1
    s_and_b32 s73, s40, 1
    s_mul_i32 s46, s72, 64
    v_and_b32 v2, 31, v1
    v_add_u32 v2, s46, v2
    v_lshrrev_b32 v3, 5, v1
    v_bfe_u32 v4, v2, 1, 3
    v_xor_b32 v3, v3, v4
    v_lshlrev_b32 v3, 4, v3
    v_lshl_add_u32 v16, v2, 7, v3
    v_xor_b32 v17, 32, v16
    v_xor_b32 v18, 64, v16
    v_xor_b32 v19, 96, v16
    s_mul_i32 s46, s73, 4
    s_add_u32 s46, s46, 0
    v_bfe_u32 v2, v1, 4, 1
    v_lshlrev_b32 v2, 1, v2
    v_bfe_u32 v3, v1, 1, 1
    v_add3_u32 v2, v2, v3, s46
    v_bfe_u32 v4, v1, 2, 2
    v_bfe_u32 v5, v4, 1, 1
    v_lshlrev_b32 v5, 2, v5
    v_xor_b32 v2, v2, v5
    v_lshlrev_b32 v2, 4, v2
    v_and_b32 v3, 1, v1
    v_lshl_add_u32 v2, v3, 3, v2
    v_lshrrev_b32 v3, 5, v1
    v_lshl_add_u32 v3, v3, 3, v4
    s_mov_b32 s47, 128
    v_mad_u32_u24 v2, v3, s47, v2
    v_add_u32 v20, 65536, v2
    s_mul_i32 s46, s72, 64
    v_and_b32 v2, 31, v1
    v_add_u32 v2, s46, v2
    s_mov_b32 s47, 144
    v_mul_u32_u24 v2, s47, v2
    s_mul_i32 s46, s73, 64
    v_lshrrev_b32 v3, 5, v1
    v_lshlrev_b32 v3, 3, v3
    v_add3_u32 v29, v2, v3, s46
    v_add_u32 v2, 0, v0
    v_lshrrev_b32 v6, 3, v2
    s_mov_b32 s46, 8
    v_mul_u32_u24 v7, s46, v6
    v_sub_u32 v7, v2, v7
    s_mov_b32 s46, 144
    v_mul_u32_u24 v25, s46, v6
    v_lshl_add_u32 v25, v7, 4, v25
    v_add_u32 v21, s38, v6
    s_mov_b32 s46, 1536
    v_mul_lo_u32 v21, v21, s46
    v_lshl_add_u32 v21, v7, 4, v21
    s_lshl_b32 s46, s39, 1
    v_add_u32 v21, s46, v21
    v_add_u32 v2, 256, v0
    v_lshrrev_b32 v6, 3, v2
    s_mov_b32 s46, 8
    v_mul_u32_u24 v7, s46, v6
    v_sub_u32 v7, v2, v7
    s_mov_b32 s46, 144
    v_mul_u32_u24 v26, s46, v6
    v_lshl_add_u32 v26, v7, 4, v26
    v_add_u32 v22, s38, v6
    s_mov_b32 s46, 1536
    v_mul_lo_u32 v22, v22, s46
    v_lshl_add_u32 v22, v7, 4, v22
    s_lshl_b32 s46, s39, 1
    v_add_u32 v22, s46, v22
    v_add_u32 v2, 512, v0
    v_lshrrev_b32 v6, 3, v2
    s_mov_b32 s46, 8
    v_mul_u32_u24 v7, s46, v6
    v_sub_u32 v7, v2, v7
    s_mov_b32 s46, 144
    v_mul_u32_u24 v27, s46, v6
    v_lshl_add_u32 v27, v7, 4, v27
    v_add_u32 v23, s38, v6
    s_mov_b32 s46, 1536
    v_mul_lo_u32 v23, v23, s46
    v_lshl_add_u32 v23, v7, 4, v23
    s_lshl_b32 s46, s39, 1
    v_add_u32 v23, s46, v23
    v_add_u32 v2, 768, v0
    v_lshrrev_b32 v6, 3, v2
    s_mov_b32 s46, 8
    v_mul_u32_u24 v7, s46, v6
    v_sub_u32 v7, v2, v7
    s_mov_b32 s46, 144
    v_mul_u32_u24 v28, s46, v6
    v_lshl_add_u32 v28, v7, 4, v28
    v_add_u32 v24, s38, v6
    s_mov_b32 s46, 1536
    v_mul_lo_u32 v24, v24, s46
    v_lshl_add_u32 v24, v7, 4, v24
    s_lshl_b32 s46, s39, 1
    v_add_u32 v24, s46, v24
    v_mov_b32 v64, 0
    v_mov_b32 v65, 0
    v_mov_b32 v66, 0
    v_mov_b32 v67, 0
    v_mov_b32 v68, 0
    v_mov_b32 v69, 0
    v_mov_b32 v70, 0
    v_mov_b32 v71, 0
    v_mov_b32 v72, 0
    v_mov_b32 v73, 0
    v_mov_b32 v74, 0
    v_mov_b32 v75, 0
    v_mov_b32 v76, 0
    v_mov_b32 v77, 0
    v_mov_b32 v78, 0
    v_mov_b32 v79, 0
    v_mov_b32 v80, 0
    v_mov_b32 v81, 0
    v_mov_b32 v82, 0
    v_mov_b32 v83, 0
    v_mov_b32 v84, 0
    v_mov_b32 v85, 0
    v_mov_b32 v86, 0
    v_mov_b32 v87, 0
    v_mov_b32 v88, 0
    v_mov_b32 v89, 0
    v_mov_b32 v90, 0
    v_mov_b32 v91, 0
    v_mov_b32 v92, 0
    v_mov_b32 v93, 0
    v_mov_b32 v94, 0
    v_mov_b32 v95, 0
    s_mov_b32 s45, 7
g4b_kernel_loop5:
    s_barrier
    ds_read_b128 v[32:35], v16 offset:0
    ds_read_b128 v[36:39], v16 offset:4096
    ds_read_b64_tr_b16 v[40:41], v20 offset:0
    ds_read_b64_tr_b16 v[42:43], v20 offset:512
    ds_read_b128 v[44:47], v17 offset:0
    ds_read_b128 v[48:51], v17 offset:4096
    ds_read_b64_tr_b16 v[52:53], v20 offset:2048
    ds_read_b64_tr_b16 v[54:55], v20 offset:2560
    s_waitcnt lgkmcnt(4)
    v_mfma_f32_32x32x16_bf16 v[64:79], v[40:43], v[32:35], v[64:79]
    v_mfma_f32_32x32x16_bf16 v[80:95], v[40:43], v[36:39], v[80:95]
    ds_read_b128 v[32:35], v18 offset:0
    ds_read_b128 v[36:39], v18 offset:4096
    ds_read_b64_tr_b16 v[40:41], v20 offset:4096
    ds_read_b64_tr_b16 v[42:43], v20 offset:4608
    s_waitcnt lgkmcnt(4)
    v_mfma_f32_32x32x16_bf16 v[64:79], v[52:55], v[44:47], v[64:79]
    v_mfma_f32_32x32x16_bf16 v[80:95], v[52:55], v[48:51], v[80:95]
    ds_read_b128 v[44:47], v19 offset:0
    ds_read_b128 v[48:51], v19 offset:4096
    ds_read_b64_tr_b16 v[52:53], v20 offset:6144
    ds_read_b64_tr_b16 v[54:55], v20 offset:6656
    s_waitcnt lgkmcnt(4)
    v_mfma_f32_32x32x16_bf16 v[64:79], v[40:43], v[32:35], v[64:79]
    v_mfma_f32_32x32x16_bf16 v[80:95], v[40:43], v[36:39], v[80:95]
    s_waitcnt lgkmcnt(0)
    v_mfma_f32_32x32x16_bf16 v[64:79], v[52:55], v[44:47], v[64:79]
    v_mfma_f32_32x32x16_bf16 v[80:95], v[52:55], v[48:51], v[80:95]
    s_barrier
    ds_read_b128 v[32:35], v16 offset:16384
    ds_read_b128 v[36:39], v16 offset:20480
    ds_read_b64_tr_b16 v[40:41], v20 offset:8192
    ds_read_b64_tr_b16 v[42:43], v20 offset:8704
    ds_read_b128 v[44:47], v17 offset:16384
    ds_read_b128 v[48:51], v17 offset:20480
    ds_read_b64_tr_b16 v[52:53], v20 offset:10240
    ds_read_b64_tr_b16 v[54:55], v20 offset:10752
    s_waitcnt lgkmcnt(4)
    v_mfma_f32_32x32x16_bf16 v[64:79], v[40:43], v[32:35], v[64:79]
    v_mfma_f32_32x32x16_bf16 v[80:95], v[40:43], v[36:39], v[80:95]
    ds_read_b128 v[32:35], v18 offset:16384
    ds_read_b128 v[36:39], v18 offset:20480
    ds_read_b64_tr_b16 v[40:41], v20 offset:12288
    ds_read_b64_tr_b16 v[42:43], v20 offset:12800
    s_waitcnt lgkmcnt(4)
    v_mfma_f32_32x32x16_bf16 v[64:79], v[52:55], v[44:47], v[64:79]
    v_mfma_f32_32x32x16_bf16 v[80:95], v[52:55], v[48:51], v[80:95]
    ds_read_b128 v[44:47], v19 offset:16384
    ds_read_b128 v[48:51], v19 offset:20480
    ds_read_b64_tr_b16 v[52:53], v20 offset:14336
    ds_read_b64_tr_b16 v[54:55], v20 offset:14848
    s_waitcnt lgkmcnt(4)
    v_mfma_f32_32x32x16_bf16 v[64:79], v[40:43], v[32:35], v[64:79]
    v_mfma_f32_32x32x16_bf16 v[80:95], v[40:43], v[36:39], v[80:95]
    s_waitcnt lgkmcnt(0)
    v_mfma_f32_32x32x16_bf16 v[64:79], v[52:55], v[44:47], v[64:79]
    v_mfma_f32_32x32x16_bf16 v[80:95], v[52:55], v[48:51], v[80:95]
    s_barrier
    ds_read_b128 v[32:35], v16 offset:32768
    ds_read_b128 v[36:39], v16 offset:36864
    ds_read_b64_tr_b16 v[40:41], v20 offset:16384
    ds_read_b64_tr_b16 v[42:43], v20 offset:16896
    ds_read_b128 v[44:47], v17 offset:32768
    ds_read_b128 v[48:51], v17 offset:36864
    ds_read_b64_tr_b16 v[52:53], v20 offset:18432
    ds_read_b64_tr_b16 v[54:55], v20 offset:18944
    s_waitcnt lgkmcnt(4)
    v_mfma_f32_32x32x16_bf16 v[64:79], v[40:43], v[32:35], v[64:79]
    v_mfma_f32_32x32x16_bf16 v[80:95], v[40:43], v[36:39], v[80:95]
    ds_read_b128 v[32:35], v18 offset:32768
    ds_read_b128 v[36:39], v18 offset:36864
    ds_read_b64_tr_b16 v[40:41], v20 offset:20480
    ds_read_b64_tr_b16 v[42:43], v20 offset:20992
    s_waitcnt lgkmcnt(4)
    v_mfma_f32_32x32x16_bf16 v[64:79], v[52:55], v[44:47], v[64:79]
    v_mfma_f32_32x32x16_bf16 v[80:95], v[52:55], v[48:51], v[80:95]
    ds_read_b128 v[44:47], v19 offset:32768
    ds_read_b128 v[48:51], v19 offset:36864
    ds_read_b64_tr_b16 v[52:53], v20 offset:22528
    ds_read_b64_tr_b16 v[54:55], v20 offset:23040
    s_waitcnt lgkmcnt(4)
    v_mfma_f32_32x32x16_bf16 v[64:79], v[40:43], v[32:35], v[64:79]
    v_mfma_f32_32x32x16_bf16 v[80:95], v[40:43], v[36:39], v[80:95]
    s_waitcnt lgkmcnt(0)
    v_mfma_f32_32x32x16_bf16 v[64:79], v[52:55], v[44:47], v[64:79]
    v_mfma_f32_32x32x16_bf16 v[80:95], v[52:55], v[48:51], v[80:95]
    s_barrier
    ds_read_b128 v[32:35], v16 offset:49152
    ds_read_b128 v[36:39], v16 offset:53248
    ds_read_b64_tr_b16 v[40:41], v20 offset:24576
    ds_read_b64_tr_b16 v[42:43], v20 offset:25088
    ds_read_b128 v[44:47], v17 offset:49152
    ds_read_b128 v[48:51], v17 offset:53248
    ds_read_b64_tr_b16 v[52:53], v20 offset:26624
    ds_read_b64_tr_b16 v[54:55], v20 offset:27136
    s_waitcnt lgkmcnt(4)
    v_mfma_f32_32x32x16_bf16 v[64:79], v[40:43], v[32:35], v[64:79]
    v_mfma_f32_32x32x16_bf16 v[80:95], v[40:43], v[36:39], v[80:95]
    ds_read_b128 v[32:35], v18 offset:49152
    ds_read_b128 v[36:39], v18 offset:53248
    ds_read_b64_tr_b16 v[40:41], v20 offset:28672
    ds_read_b64_tr_b16 v[42:43], v20 offset:29184
    s_waitcnt lgkmcnt(4)
    v_mfma_f32_32x32x16_bf16 v[64:79], v[52:55], v[44:47], v[64:79]
    v_mfma_f32_32x32x16_bf16 v[80:95], v[52:55], v[48:51], v[80:95]
    ds_read_b128 v[44:47], v19 offset:49152
    ds_read_b128 v[48:51], v19 offset:53248
    ds_read_b64_tr_b16 v[52:53], v20 offset:30720
    ds_read_b64_tr_b16 v[54:55], v20 offset:31232
    s_waitcnt lgkmcnt(4)
    v_mfma_f32_32x32x16_bf16 v[64:79], v[40:43], v[32:35], v[64:79]
    v_mfma_f32_32x32x16_bf16 v[80:95], v[40:43], v[36:39], v[80:95]
    s_waitcnt lgkmcnt(0)
    v_mfma_f32_32x32x16_bf16 v[64:79], v[52:55], v[44:47], v[64:79]
    v_mfma_f32_32x32x16_bf16 v[80:95], v[52:55], v[48:51], v[80:95]
    s_sub_u32 s45, s45, 1
    s_cmp_lg_u32 s45, 0
    s_cbranch_scc1 g4b_kernel_loop5
    s_barrier
    ds_read_b128 v[32:35], v16 offset:0
    ds_read_b128 v[36:39], v16 offset:4096
    ds_read_b64_tr_b16 v[40:41], v20 offset:0
    ds_read_b64_tr_b16 v[42:43], v20 offset:512
    ds_read_b128 v[44:47], v17 offset:0
    ds_read_b128 v[48:51], v17 offset:4096
    ds_read_b64_tr_b16 v[52:53], v20 offset:2048
    ds_read_b64_tr_b16 v[54:55], v20 offset:2560
    s_waitcnt lgkmcnt(4)
    v_mfma_f32_32x32x16_bf16 v[64:79], v[40:43], v[32:35], v[64:79]
    v_mfma_f32_32x32x16_bf16 v[80:95], v[40:43], v[36:39], v[80:95]
    ds_read_b128 v[32:35], v18 offset:0
    ds_read_b128 v[36:39], v18 offset:4096
    ds_read_b64_tr_b16 v[40:41], v20 offset:4096
    ds_read_b64_tr_b16 v[42:43], v20 offset:4608
    s_waitcnt lgkmcnt(4)
    v_mfma_f32_32x32x16_bf16 v[64:79], v[52:55], v[44:47], v[64:79]
    v_mfma_f32_32x32x16_bf16 v[80:95], v[52:55], v[48:51], v[80:95]
    ds_read_b128 v[44:47], v19 offset:0
    ds_read_b128 v[48:51], v19 offset:4096
    ds_read_b64_tr_b16 v[52:53], v20 offset:6144
    ds_read_b64_tr_b16 v[54:55], v20 offset:6656
    s_waitcnt lgkmcnt(4)
    v_mfma_f32_32x32x16_bf16 v[64:79], v[40:43], v[32:35], v[64:79]
    v_mfma_f32_32x32x16_bf16 v[80:95], v[40:43], v[36:39], v[80:95]
    s_waitcnt lgkmcnt(0)
    v_mfma_f32_32x32x16_bf16 v[64:79], v[52:55], v[44:47], v[64:79]
    v_mfma_f32_32x32x16_bf16 v[80:95], v[52:55], v[48:51], v[80:95]
    s_mov_b32 s28, s62
    s_mov_b32 s29, s63
    s_mov_b32 s30, 4096
    s_mov_b32 s31, 0x00020000
    s_mul_i32 s46, s72, 64
    s_add_u32 s46, s46, s38
    v_and_b32 v2, 31, v1
    v_add_u32 v2, s46, v2
    v_lshlrev_b32 v2, 1, v2
    buffer_load_ushort v96, v2, s[28:31], 0 offen offset:0
    buffer_load_ushort v97, v2, s[28:31], 0 offen offset:64
    s_add_u32 s20, s70, 18350080
    s_addc_u32 s21, s71, 0
    s_mov_b32 s22, 6291456
    s_mov_b32 s23, 0x00020000
    v_add_u32 v2, 0, v0
    v_lshrrev_b32 v6, 3, v2
    s_mov_b32 s46, 8
    v_mul_u32_u24 v7, s46, v6
    v_sub_u32 v7, v2, v7
    v_add_u32 v3, s38, v6
    s_mov_b32 s46, 3072
    v_mul_lo_u32 v3, v3, s46
    v_lshl_add_u32 v3, v7, 4, v3
    s_lshl_b32 s46, s39, 1
    v_add_u32 v3, s46, v3
    buffer_load_dwordx4 v[100:103], v3, s[20:23], 0 offen
    v_add_u32 v2, 256, v0
    v_lshrrev_b32 v6, 3, v2
    s_mov_b32 s46, 8
    v_mul_u32_u24 v7, s46, v6
    v_sub_u32 v7, v2, v7
    v_add_u32 v3, s38, v6
    s_mov_b32 s46, 3072
    v_mul_lo_u32 v3, v3, s46
    v_lshl_add_u32 v3, v7, 4, v3
    s_lshl_b32 s46, s39, 1
    v_add_u32 v3, s46, v3
    buffer_load_dwordx4 v[104:107], v3, s[20:23], 0 offen
    v_add_u32 v2, 512, v0
    v_lshrrev_b32 v6, 3, v2
    s_mov_b32 s46, 8
    v_mul_u32_u24 v7, s46, v6
    v_sub_u32 v7, v2, v7
    v_add_u32 v3, s38, v6
    s_mov_b32 s46, 3072
    v_mul_lo_u32 v3, v3, s46
    v_lshl_add_u32 v3, v7, 4, v3
    s_lshl_b32 s46, s39, 1
    v_add_u32 v3, s46, v3
    buffer_load_dwordx4 v[108:111], v3, s[20:23], 0 offen
    v_add_u32 v2, 768, v0
    v_lshrrev_b32 v6, 3, v2
    s_mov_b32 s46, 8
    v_mul_u32_u24 v7, s46, v6
    v_sub_u32 v7, v2, v7
    v_add_u32 v3, s38, v6
    s_mov_b32 s46, 3072
    v_mul_lo_u32 v3, v3, s46
    v_lshl_add_u32 v3, v7, 4, v3
    s_lshl_b32 s46, s39, 1
    v_add_u32 v3, s46, v3
    buffer_load_dwordx4 v[112:115], v3, s[20:23], 0 offen
    s_barrier
    ds_read_b128 v[32:35], v16 offset:16384
    ds_read_b128 v[36:39], v16 offset:20480
    ds_read_b64_tr_b16 v[40:41], v20 offset:8192
    ds_read_b64_tr_b16 v[42:43], v20 offset:8704
    ds_read_b128 v[44:47], v17 offset:16384
    ds_read_b128 v[48:51], v17 offset:20480
    ds_read_b64_tr_b16 v[52:53], v20 offset:10240
    ds_read_b64_tr_b16 v[54:55], v20 offset:10752
    s_waitcnt lgkmcnt(4)
    v_mfma_f32_32x32x16_bf16 v[64:79], v[40:43], v[32:35], v[64:79]
    v_mfma_f32_32x32x16_bf16 v[80:95], v[40:43], v[36:39], v[80:95]
    ds_read_b128 v[32:35], v18 offset:16384
    ds_read_b128 v[36:39], v18 offset:20480
    ds_read_b64_tr_b16 v[40:41], v20 offset:12288
    ds_read_b64_tr_b16 v[42:43], v20 offset:12800
    s_waitcnt lgkmcnt(4)
    v_mfma_f32_32x32x16_bf16 v[64:79], v[52:55], v[44:47], v[64:79]
    v_mfma_f32_32x32x16_bf16 v[80:95], v[52:55], v[48:51], v[80:95]
    ds_read_b128 v[44:47], v19 offset:16384
    ds_read_b128 v[48:51], v19 offset:20480
    ds_read_b64_tr_b16 v[52:53], v20 offset:14336
    ds_read_b64_tr_b16 v[54:55], v20 offset:14848
    s_waitcnt lgkmcnt(4)
    v_mfma_f32_32x32x16_bf16 v[64:79], v[40:43], v[32:35], v[64:79]
    v_mfma_f32_32x32x16_bf16 v[80:95], v[40:43], v[36:39], v[80:95]
    s_waitcnt lgkmcnt(0)
    v_mfma_f32_32x32x16_bf16 v[64:79], v[52:55], v[44:47], v[64:79]
    v_mfma_f32_32x32x16_bf16 v[80:95], v[52:55], v[48:51], v[80:95]
    s_barrier
    ds_read_b128 v[32:35], v16 offset:32768
    ds_read_b128 v[36:39], v16 offset:36864
    ds_read_b64_tr_b16 v[40:41], v20 offset:16384
    ds_read_b64_tr_b16 v[42:43], v20 offset:16896
    ds_read_b128 v[44:47], v17 offset:32768
    ds_read_b128 v[48:51], v17 offset:36864
    ds_read_b64_tr_b16 v[52:53], v20 offset:18432
    ds_read_b64_tr_b16 v[54:55], v20 offset:18944
    s_waitcnt lgkmcnt(4)
    v_mfma_f32_32x32x16_bf16 v[64:79], v[40:43], v[32:35], v[64:79]
    v_mfma_f32_32x32x16_bf16 v[80:95], v[40:43], v[36:39], v[80:95]
    ds_read_b128 v[32:35], v18 offset:32768
    ds_read_b128 v[36:39], v18 offset:36864
    ds_read_b64_tr_b16 v[40:41], v20 offset:20480
    ds_read_b64_tr_b16 v[42:43], v20 offset:20992
    s_waitcnt lgkmcnt(4)
    v_mfma_f32_32x32x16_bf16 v[64:79], v[52:55], v[44:47], v[64:79]
    v_mfma_f32_32x32x16_bf16 v[80:95], v[52:55], v[48:51], v[80:95]
    ds_read_b128 v[44:47], v19 offset:32768
    ds_read_b128 v[48:51], v19 offset:36864
    ds_read_b64_tr_b16 v[52:53], v20 offset:22528
    ds_read_b64_tr_b16 v[54:55], v20 offset:23040
    s_waitcnt lgkmcnt(4)
    v_mfma_f32_32x32x16_bf16 v[64:79], v[40:43], v[32:35], v[64:79]
    v_mfma_f32_32x32x16_bf16 v[80:95], v[40:43], v[36:39], v[80:95]
    s_waitcnt lgkmcnt(0)
    v_mfma_f32_32x32x16_bf16 v[64:79], v[52:55], v[44:47], v[64:79]
    v_mfma_f32_32x32x16_bf16 v[80:95], v[52:55], v[48:51], v[80:95]
    s_barrier
    ds_read_b128 v[32:35], v16 offset:49152
    ds_read_b128 v[36:39], v16 offset:53248
    ds_read_b64_tr_b16 v[40:41], v20 offset:24576
    ds_read_b64_tr_b16 v[42:43], v20 offset:25088
    ds_read_b128 v[44:47], v17 offset:49152
    ds_read_b128 v[48:51], v17 offset:53248
    ds_read_b64_tr_b16 v[52:53], v20 offset:26624
    ds_read_b64_tr_b16 v[54:55], v20 offset:27136
    s_waitcnt lgkmcnt(4)
    v_mfma_f32_32x32x16_bf16 v[64:79], v[40:43], v[32:35], v[64:79]
    v_mfma_f32_32x32x16_bf16 v[80:95], v[40:43], v[36:39], v[80:95]
    ds_read_b128 v[32:35], v18 offset:49152
    ds_read_b128 v[36:39], v18 offset:53248
    ds_read_b64_tr_b16 v[40:41], v20 offset:28672
    ds_read_b64_tr_b16 v[42:43], v20 offset:29184
    s_waitcnt lgkmcnt(4)
    v_mfma_f32_32x32x16_bf16 v[64:79], v[52:55], v[44:47], v[64:79]
    v_mfma_f32_32x32x16_bf16 v[80:95], v[52:55], v[48:51], v[80:95]
    ds_read_b128 v[44:47], v19 offset:49152
    ds_read_b128 v[48:51], v19 offset:53248
    ds_read_b64_tr_b16 v[52:53], v20 offset:30720
    ds_read_b64_tr_b16 v[54:55], v20 offset:31232
    s_waitcnt lgkmcnt(4)
    v_mfma_f32_32x32x16_bf16 v[64:79], v[40:43], v[32:35], v[64:79]
    v_mfma_f32_32x32x16_bf16 v[80:95], v[40:43], v[36:39], v[80:95]
    s_waitcnt lgkmcnt(0)
    v_mfma_f32_32x32x16_bf16 v[64:79], v[52:55], v[44:47], v[64:79]
    v_mfma_f32_32x32x16_bf16 v[80:95], v[52:55], v[48:51], v[80:95]
    s_barrier
    s_nop 15
    s_waitcnt vmcnt(0)
    v_lshlrev_b32 v96, 16, v96
    v_lshlrev_b32 v97, 16, v97
    v_cvt_pk_bf16_f32 v116, v64, v65
    v_cvt_pk_bf16_f32 v117, v66, v67
    v_lshlrev_b32 v64, 16, v116
    v_and_b32 v65, 0xffff0000, v116
    v_lshlrev_b32 v66, 16, v117
    v_and_b32 v67, 0xffff0000, v117
    v_add_f32 v64, v96, v64
    v_add_f32 v65, v96, v65
    v_add_f32 v66, v96, v66
    v_add_f32 v67, v96, v67
    v_cvt_pk_bf16_f32 v124, v64, v65
    v_cvt_pk_bf16_f32 v125, v66, v67
    ds_write_b64 v29, v[124:125] offset:0
    v_cvt_pk_bf16_f32 v116, v68, v69
    v_cvt_pk_bf16_f32 v117, v70, v71
    v_lshlrev_b32 v68, 16, v116
    v_and_b32 v69, 0xffff0000, v116
    v_lshlrev_b32 v70, 16, v117
    v_and_b32 v71, 0xffff0000, v117
    v_add_f32 v68, v96, v68
    v_add_f32 v69, v96, v69
    v_add_f32 v70, v96, v70
    v_add_f32 v71, v96, v71
    v_cvt_pk_bf16_f32 v124, v68, v69
    v_cvt_pk_bf16_f32 v125, v70, v71
    ds_write_b64 v29, v[124:125] offset:16
    v_cvt_pk_bf16_f32 v116, v72, v73
    v_cvt_pk_bf16_f32 v117, v74, v75
    v_lshlrev_b32 v72, 16, v116
    v_and_b32 v73, 0xffff0000, v116
    v_lshlrev_b32 v74, 16, v117
    v_and_b32 v75, 0xffff0000, v117
    v_add_f32 v72, v96, v72
    v_add_f32 v73, v96, v73
    v_add_f32 v74, v96, v74
    v_add_f32 v75, v96, v75
    v_cvt_pk_bf16_f32 v124, v72, v73
    v_cvt_pk_bf16_f32 v125, v74, v75
    ds_write_b64 v29, v[124:125] offset:32
    v_cvt_pk_bf16_f32 v116, v76, v77
    v_cvt_pk_bf16_f32 v117, v78, v79
    v_lshlrev_b32 v76, 16, v116
    v_and_b32 v77, 0xffff0000, v116
    v_lshlrev_b32 v78, 16, v117
    v_and_b32 v79, 0xffff0000, v117
    v_add_f32 v76, v96, v76
    v_add_f32 v77, v96, v77
    v_add_f32 v78, v96, v78
    v_add_f32 v79, v96, v79
    v_cvt_pk_bf16_f32 v124, v76, v77
    v_cvt_pk_bf16_f32 v125, v78, v79
    ds_write_b64 v29, v[124:125] offset:48
    v_cvt_pk_bf16_f32 v116, v80, v81
    v_cvt_pk_bf16_f32 v117, v82, v83
    v_lshlrev_b32 v80, 16, v116
    v_and_b32 v81, 0xffff0000, v116
    v_lshlrev_b32 v82, 16, v117
    v_and_b32 v83, 0xffff0000, v117
    v_add_f32 v80, v97, v80
    v_add_f32 v81, v97, v81
    v_add_f32 v82, v97, v82
    v_add_f32 v83, v97, v83
    v_cvt_pk_bf16_f32 v124, v80, v81
    v_cvt_pk_bf16_f32 v125, v82, v83
    ds_write_b64 v29, v[124:125] offset:4608
    v_cvt_pk_bf16_f32 v116, v84, v85
    v_cvt_pk_bf16_f32 v117, v86, v87
    v_lshlrev_b32 v84, 16, v116
    v_and_b32 v85, 0xffff0000, v116
    v_lshlrev_b32 v86, 16, v117
    v_and_b32 v87, 0xffff0000, v117
    v_add_f32 v84, v97, v84
    v_add_f32 v85, v97, v85
    v_add_f32 v86, v97, v86
    v_add_f32 v87, v97, v87
    v_cvt_pk_bf16_f32 v124, v84, v85
    v_cvt_pk_bf16_f32 v125, v86, v87
    ds_write_b64 v29, v[124:125] offset:4624
    v_cvt_pk_bf16_f32 v116, v88, v89
    v_cvt_pk_bf16_f32 v117, v90, v91
    v_lshlrev_b32 v88, 16, v116
    v_and_b32 v89, 0xffff0000, v116
    v_lshlrev_b32 v90, 16, v117
    v_and_b32 v91, 0xffff0000, v117
    v_add_f32 v88, v97, v88
    v_add_f32 v89, v97, v89
    v_add_f32 v90, v97, v90
    v_add_f32 v91, v97, v91
    v_cvt_pk_bf16_f32 v124, v88, v89
    v_cvt_pk_bf16_f32 v125, v90, v91
    ds_write_b64 v29, v[124:125] offset:4640
    v_cvt_pk_bf16_f32 v116, v92, v93
    v_cvt_pk_bf16_f32 v117, v94, v95
    v_lshlrev_b32 v92, 16, v116
    v_and_b32 v93, 0xffff0000, v116
    v_lshlrev_b32 v94, 16, v117
    v_and_b32 v95, 0xffff0000, v117
    v_add_f32 v92, v97, v92
    v_add_f32 v93, v97, v93
    v_add_f32 v94, v97, v94
    v_add_f32 v95, v97, v95
    v_cvt_pk_bf16_f32 v124, v92, v93
    v_cvt_pk_bf16_f32 v125, v94, v95
    ds_write_b64 v29, v[124:125] offset:4656
    s_waitcnt lgkmcnt(0)
    s_barrier
    ds_read_b128 v[64:67], v25
    ds_read_b128 v[68:71], v26
    ds_read_b128 v[72:75], v27
    ds_read_b128 v[76:79], v28
    s_waitcnt vmcnt(0)
    s_waitcnt lgkmcnt(3)
    v_lshlrev_b32 v116, 16, v64
    v_and_b32 v117, 0xffff0000, v64
    v_lshlrev_b32 v124, 16, v100
    v_and_b32 v125, 0xffff0000, v100
    v_lshlrev_b32 v118, 16, v65
    v_and_b32 v119, 0xffff0000, v65
    v_lshlrev_b32 v126, 16, v101
    v_and_b32 v127, 0xffff0000, v101
    v_lshlrev_b32 v120, 16, v66
    v_and_b32 v121, 0xffff0000, v66
    v_lshlrev_b32 v128, 16, v102
    v_and_b32 v129, 0xffff0000, v102
    v_lshlrev_b32 v122, 16, v67
    v_and_b32 v123, 0xffff0000, v67
    v_lshlrev_b32 v130, 16, v103
    v_and_b32 v131, 0xffff0000, v103
    v_mul_f32 v116, v116, v124
    v_mul_f32 v117, v117, v125
    v_mul_f32 v118, v118, v126
    v_mul_f32 v119, v119, v127
    v_mul_f32 v120, v120, v128
    v_mul_f32 v121, v121, v129
    v_mul_f32 v122, v122, v130
    v_mul_f32 v123, v123, v131
    v_cvt_pk_bf16_f32 v64, v116, v117
    v_cvt_pk_bf16_f32 v65, v118, v119
    v_cvt_pk_bf16_f32 v66, v120, v121
    v_cvt_pk_bf16_f32 v67, v122, v123
    buffer_store_dwordx4 v[64:67], v21, s[16:19], 0 offen
    s_waitcnt lgkmcnt(2)
    v_lshlrev_b32 v116, 16, v68
    v_and_b32 v117, 0xffff0000, v68
    v_lshlrev_b32 v124, 16, v104
    v_and_b32 v125, 0xffff0000, v104
    v_lshlrev_b32 v118, 16, v69
    v_and_b32 v119, 0xffff0000, v69
    v_lshlrev_b32 v126, 16, v105
    v_and_b32 v127, 0xffff0000, v105
    v_lshlrev_b32 v120, 16, v70
    v_and_b32 v121, 0xffff0000, v70
    v_lshlrev_b32 v128, 16, v106
    v_and_b32 v129, 0xffff0000, v106
    v_lshlrev_b32 v122, 16, v71
    v_and_b32 v123, 0xffff0000, v71
    v_lshlrev_b32 v130, 16, v107
    v_and_b32 v131, 0xffff0000, v107
    v_mul_f32 v116, v116, v124
    v_mul_f32 v117, v117, v125
    v_mul_f32 v118, v118, v126
    v_mul_f32 v119, v119, v127
    v_mul_f32 v120, v120, v128
    v_mul_f32 v121, v121, v129
    v_mul_f32 v122, v122, v130
    v_mul_f32 v123, v123, v131
    v_cvt_pk_bf16_f32 v68, v116, v117
    v_cvt_pk_bf16_f32 v69, v118, v119
    v_cvt_pk_bf16_f32 v70, v120, v121
    v_cvt_pk_bf16_f32 v71, v122, v123
    buffer_store_dwordx4 v[68:71], v22, s[16:19], 0 offen
    s_waitcnt lgkmcnt(1)
    v_lshlrev_b32 v116, 16, v72
    v_and_b32 v117, 0xffff0000, v72
    v_lshlrev_b32 v124, 16, v108
    v_and_b32 v125, 0xffff0000, v108
    v_lshlrev_b32 v118, 16, v73
    v_and_b32 v119, 0xffff0000, v73
    v_lshlrev_b32 v126, 16, v109
    v_and_b32 v127, 0xffff0000, v109
    v_lshlrev_b32 v120, 16, v74
    v_and_b32 v121, 0xffff0000, v74
    v_lshlrev_b32 v128, 16, v110
    v_and_b32 v129, 0xffff0000, v110
    v_lshlrev_b32 v122, 16, v75
    v_and_b32 v123, 0xffff0000, v75
    v_lshlrev_b32 v130, 16, v111
    v_and_b32 v131, 0xffff0000, v111
    v_mul_f32 v116, v116, v124
    v_mul_f32 v117, v117, v125
    v_mul_f32 v118, v118, v126
    v_mul_f32 v119, v119, v127
    v_mul_f32 v120, v120, v128
    v_mul_f32 v121, v121, v129
    v_mul_f32 v122, v122, v130
    v_mul_f32 v123, v123, v131
    v_cvt_pk_bf16_f32 v72, v116, v117
    v_cvt_pk_bf16_f32 v73, v118, v119
    v_cvt_pk_bf16_f32 v74, v120, v121
    v_cvt_pk_bf16_f32 v75, v122, v123
    buffer_store_dwordx4 v[72:75], v23, s[16:19], 0 offen
    s_waitcnt lgkmcnt(0)
    v_lshlrev_b32 v116, 16, v76
    v_and_b32 v117, 0xffff0000, v76
    v_lshlrev_b32 v124, 16, v112
    v_and_b32 v125, 0xffff0000, v112
    v_lshlrev_b32 v118, 16, v77
    v_and_b32 v119, 0xffff0000, v77
    v_lshlrev_b32 v126, 16, v113
    v_and_b32 v127, 0xffff0000, v113
    v_lshlrev_b32 v120, 16, v78
    v_and_b32 v121, 0xffff0000, v78
    v_lshlrev_b32 v128, 16, v114
    v_and_b32 v129, 0xffff0000, v114
    v_lshlrev_b32 v122, 16, v79
    v_and_b32 v123, 0xffff0000, v79
    v_lshlrev_b32 v130, 16, v115
    v_and_b32 v131, 0xffff0000, v115
    v_mul_f32 v116, v116, v124
    v_mul_f32 v117, v117, v125
    v_mul_f32 v118, v118, v126
    v_mul_f32 v119, v119, v127
    v_mul_f32 v120, v120, v128
    v_mul_f32 v121, v121, v129
    v_mul_f32 v122, v122, v130
    v_mul_f32 v123, v123, v131
    v_cvt_pk_bf16_f32 v76, v116, v117
    v_cvt_pk_bf16_f32 v77, v118, v119
    v_cvt_pk_bf16_f32 v78, v120, v121
    v_cvt_pk_bf16_f32 v79, v122, v123
    buffer_store_dwordx4 v[76:79], v24, s[16:19], 0 offen
g4b_kernel_end1:
    s_endpgm
.globl g5b_kernel
.p2align 8
.type g5b_kernel,@function
g5b_kernel:
    s_cmp_ge_u32 s2, 160
    s_cbranch_scc1 g5b_kernel_end1
    s_load_dwordx16 s[48:63], s[0:1], 0
    s_load_dwordx8 s[64:71], s[0:1], 64
    v_and_b32 v1, 63, v0
    v_lshrrev_b32 v2, 6, v0
    s_and_b32 s46, s2, 7
    s_lshr_b32 s47, s2, 3
    s_mul_i32 s36, s47, 103
    s_lshr_b32 s36, s36, 9
    s_mul_i32 s3, s36, 5
    s_sub_u32 s37, s47, s3
    s_mul_i32 s46, s46, 4
    s_add_u32 s36, s36, s46
    s_mul_i32 s38, s36, 64
    s_mul_i32 s39, s37, 128
    v_readfirstlane_b32 s40, v2
    s_lshr_b32 s74, s40, 2
    s_and_b32 s40, s40, 3
    s_cmp_eq_u32 s74, 0
    s_cbranch_scc0 g5b_kernel_prod2
    s_branch g5b_kernel_cons3
g5b_kernel_prod2:
    s_mul_i32 s41, s38, 1536
    s_lshl_b32 s42, s39, 1
    s_mul_i32 s43, s40, 2048
    s_mul_i32 s44, s40, 4096
    s_add_u32 s44, s44, 32768
    s_mul_i32 s46, s40, 128
    s_add_u32 s46, s46, 0
    v_add_u32 v2, s46, v1
    v_lshrrev_b32 v3, 3, v2
    v_and_b32 v4, 7, v2
    v_bfe_u32 v5, v3, 1, 3
    v_xor_b32 v4, v4, v5
    v_lshlrev_b32 v4, 4, v4
    s_mov_b32 s47, 1536
    v_mad_u32_u24 v10, v3, s47, v4
    s_mul_i32 s46, s40, 128
    s_add_u32 s46, s46, 64
    v_add_u32 v2, s46, v1
    v_lshrrev_b32 v3, 3, v2
    v_and_b32 v4, 7, v2
    v_bfe_u32 v5, v3, 1, 3
    v_xor_b32 v4, v4, v5
    v_lshlrev_b32 v4, 4, v4
    s_mov_b32 s47, 1536
    v_mad_u32_u24 v11, v3, s47, v4
    s_mul_i32 s46, s40, 256
    s_add_u32 s46, s46, 0
    v_add_u32 v2, s46, v1
    v_lshrrev_b32 v3, 4, v2
    s_mov_b32 s47, 16
    v_mul_u32_u24 v4, s47, v3
    v_sub_u32 v4, v2, v4
    v_and_b32 v5, 3, v3
    v_lshlrev_b32 v5, 2, v5
    v_xor_b32 v4, v4, v5
    v_lshlrev_b32 v4, 4, v4
    s_mov_b32 s47, 1280
    v_mad_u32_u24 v12, v3, s47, v4
    s_mul_i32 s46, s40, 256
    s_add_u32 s46, s46, 64
    v_add_u32 v2, s46, v1
    v_lshrrev_b32 v3, 4, v2
    s_mov_b32 s47, 16
    v_mul_u32_u24 v4, s47, v3
    v_sub_u32 v4, v2, v4
    v_and_b32 v5, 3, v3
    v_lshlrev_b32 v5, 2, v5
    v_xor_b32 v4, v4, v5
    v_lshlrev_b32 v4, 4, v4
    s_mov_b32 s47, 1280
    v_mad_u32_u24 v13, v3, s47, v4
    s_mul_i32 s46, s40, 256
    s_add_u32 s46, s46, 128
    v_add_u32 v2, s46, v1
    v_lshrrev_b32 v3, 4, v2
    s_mov_b32 s47, 16
    v_mul_u32_u24 v4, s47, v3
    v_sub_u32 v4, v2, v4
    v_and_b32 v5, 3, v3
    v_lshlrev_b32 v5, 2, v5
    v_xor_b32 v4, v4, v5
    v_lshlrev_b32 v4, 4, v4
    s_mov_b32 s47, 1280
    v_mad_u32_u24 v14, v3, s47, v4
    s_mul_i32 s46, s40, 256
    s_add_u32 s46, s46, 192
    v_add_u32 v2, s46, v1
    v_lshrrev_b32 v3, 4, v2
    s_mov_b32 s47, 16
    v_mul_u32_u24 v4, s47, v3
    v_sub_u32 v4, v2, v4
    v_and_b32 v5, 3, v3
    v_lshlrev_b32 v5, 2, v5
    v_xor_b32 v4, v4, v5
    v_lshlrev_b32 v4, 4, v4
    s_mov_b32 s47, 1280
    v_mad_u32_u24 v15, v3, s47, v4
    s_waitcnt lgkmcnt(0)
    s_add_u32 s8, s70, 27787264
    s_addc_u32 s9, s71, 0
    s_mov_b32 s10, 3145728
    s_mov_b32 s11, 0x00020000
    s_mov_b32 s12, s64
    s_mov_b32 s13, s65
    s_mov_b32 s14, 983040
    s_mov_b32 s15, 0x00020000
    s_add_u32 m0, s43, 0
    s_nop 0
    buffer_load_dwordx4 v10, s[8:11], s41 offen lds
    s_add_u32 m0, s43, 1024
    s_nop 0
    buffer_load_dwordx4 v11, s[8:11], s41 offen lds
    s_add_u32 m0, s44, 0
    s_nop 0
    buffer_load_dwordx4 v12, s[12:15], s42 offen lds
    s_add_u32 m0, s44, 1024
    s_nop 0
    buffer_load_dwordx4 v13, s[12:15], s42 offen lds
    s_add_u32 m0, s44, 2048
    s_nop 0
    buffer_load_dwordx4 v14, s[12:15], s42 offen lds
    s_add_u32 m0, s44, 3072
    s_nop 0
    buffer_load_dwordx4 v15, s[12:15], s42 offen lds
    s_add_u32 s41, s41, 128
    s_add_u32 s42, s42, 81920
    s_add_u32 m0, s43, 8192
    s_nop 0
    buffer_load_dwordx4 v10, s[8:11], s41 offen lds
    s_add_u32 m0, s43, 9216
    s_nop 0
    buffer_load_dwordx4 v11, s[8:11], s41 offen lds
    s_add_u32 m0, s44, 16384
    s_nop 0
    buffer_load_dwordx4 v12, s[12:15], s42 offen lds
    s_add_u32 m0, s44, 17408
    s_nop 0
    buffer_load_dwordx4 v13, s[12:15], s42 offen lds
    s_add_u32 m0, s44, 18432
    s_nop 0
    buffer_load_dwordx4 v14, s[12:15], s42 offen lds
    s_add_u32 m0, s44, 19456
    s_nop 0
    buffer_load_dwordx4 v15, s[12:15], s42 offen lds
    s_add_u32 s41, s41, 128
    s_add_u32 s42, s42, 81920
    s_add_u32 m0, s43, 16384
    s_nop 0
    buffer_load_dwordx4 v10, s[8:11], s41 offen lds
    s_add_u32 m0, s43, 17408
    s_nop 0
    buffer_load_dwordx4 v11, s[8:11], s41 offen lds
    s_add_u32 m0, s44, 32768
    s_nop 0
    buffer_load_dwordx4 v12, s[12:15], s42 offen lds
    s_add_u32 m0, s44, 33792
    s_nop 0
    buffer_load_dwordx4 v13, s[12:15], s42 offen lds
    s_add_u32 m0, s44, 34816
    s_nop 0
    buffer_load_dwordx4 v14, s[12:15], s42 offen lds
    s_add_u32 m0, s44, 35840
    s_nop 0
    buffer_load_dwordx4 v15, s[12:15], s42 offen lds
    s_add_u32 s41, s41, 128
    s_add_u32 s42, s42, 81920
    s_mov_b32 s45, 2
g5b_kernel_ploop4:
    s_waitcnt vmcnt(12)
    s_barrier
    s_add_u32 m0, s43, 24576
    s_nop 0
    buffer_load_dwordx4 v10, s[8:11], s41 offen lds
    s_add_u32 m0, s43, 25600
    s_nop 0
    buffer_load_dwordx4 v11, s[8:11], s41 offen lds
    s_add_u32 m0, s44, 49152
    s_nop 0
    buffer_load_dwordx4 v12, s[12:15], s42 offen lds
    s_add_u32 m0, s44, 50176
    s_nop 0
    buffer_load_dwordx4 v13, s[12:15], s42 offen lds
    s_add_u32 m0, s44, 51200
    s_nop 0
    buffer_load_dwordx4 v14, s[12:15], s42 offen lds
    s_add_u32 m0, s44, 52224
    s_nop 0
    buffer_load_dwordx4 v15, s[12:15], s42 offen lds
    s_add_u32 s41, s41, 128
    s_add_u32 s42, s42, 81920
    s_waitcnt vmcnt(12)
    s_barrier
    s_add_u32 m0, s43, 0
    s_nop 0
    buffer_load_dwordx4 v10, s[8:11], s41 offen lds
    s_add_u32 m0, s43, 1024
    s_nop 0
    buffer_load_dwordx4 v11, s[8:11], s41 offen lds
    s_add_u32 m0, s44, 0
    s_nop 0
    buffer_load_dwordx4 v12, s[12:15], s42 offen lds
    s_add_u32 m0, s44, 1024
    s_nop 0
    buffer_load_dwordx4 v13, s[12:15], s42 offen lds
    s_add_u32 m0, s44, 2048
    s_nop 0
    buffer_load_dwordx4 v14, s[12:15], s42 offen lds
    s_add_u32 m0, s44, 3072
    s_nop 0
    buffer_load_dwordx4 v15, s[12:15], s42 offen lds
    s_add_u32 s41, s41, 128
    s_add_u32 s42, s42, 81920
    s_waitcnt vmcnt(12)
    s_barrier
    s_add_u32 m0, s43, 8192
    s_nop 0
    buffer_load_dwordx4 v10, s[8:11], s41 offen lds
    s_add_u32 m0, s43, 9216
    s_nop 0
    buffer_load_dwordx4 v11, s[8:11], s41 offen lds
    s_add_u32 m0, s44, 16384
    s_nop 0
    buffer_load_dwordx4 v12, s[12:15], s42 offen lds
    s_add_u32 m0, s44, 17408
    s_nop 0
    buffer_load_dwordx4 v13, s[12:15], s42 offen lds
    s_add_u32 m0, s44, 18432
    s_nop 0
    buffer_load_dwordx4 v14, s[12:15], s42 offen lds
    s_add_u32 m0, s44, 19456
    s_nop 0
    buffer_load_dwordx4 v15, s[12:15], s42 offen lds
    s_add_u32 s41, s41, 128
    s_add_u32 s42, s42, 81920
    s_waitcnt vmcnt(12)
    s_barrier
    s_add_u32 m0, s43, 16384
    s_nop 0
    buffer_load_dwordx4 v10, s[8:11], s41 offen lds
    s_add_u32 m0, s43, 17408
    s_nop 0
    buffer_load_dwordx4 v11, s[8:11], s41 offen lds
    s_add_u32 m0, s44, 32768
    s_nop 0
    buffer_load_dwordx4 v12, s[12:15], s42 offen lds
    s_add_u32 m0, s44, 33792
    s_nop 0
    buffer_load_dwordx4 v13, s[12:15], s42 offen lds
    s_add_u32 m0, s44, 34816
    s_nop 0
    buffer_load_dwordx4 v14, s[12:15], s42 offen lds
    s_add_u32 m0, s44, 35840
    s_nop 0
    buffer_load_dwordx4 v15, s[12:15], s42 offen lds
    s_add_u32 s41, s41, 128
    s_add_u32 s42, s42, 81920
    s_sub_u32 s45, s45, 1
    s_cmp_lg_u32 s45, 0
    s_cbranch_scc1 g5b_kernel_ploop4
    s_waitcnt vmcnt(12)
    s_barrier
    s_add_u32 m0, s43, 24576
    s_nop 0
    buffer_load_dwordx4 v10, s[8:11], s41 offen lds
    s_add_u32 m0, s43, 25600
    s_nop 0
    buffer_load_dwordx4 v11, s[8:11], s41 offen lds
    s_add_u32 m0, s44, 49152
    s_nop 0
    buffer_load_dwordx4 v12, s[12:15], s42 offen lds
    s_add_u32 m0, s44, 50176
    s_nop 0
    buffer_load_dwordx4 v13, s[12:15], s42 offen lds
    s_add_u32 m0, s44, 51200
    s_nop 0
    buffer_load_dwordx4 v14, s[12:15], s42 offen lds
    s_add_u32 m0, s44, 52224
    s_nop 0
    buffer_load_dwordx4 v15, s[12:15], s42 offen lds
    s_add_u32 s41, s41, 128
    s_add_u32 s42, s42, 81920
    s_waitcnt vmcnt(12)
    s_barrier
    s_waitcnt vmcnt(6)
    s_barrier
    s_waitcnt vmcnt(0)
    s_barrier
    s_endpgm
g5b_kernel_cons3:
    s_waitcnt lgkmcnt(0)
    s_mov_b32 s16, s66
    s_mov_b32 s17, s67
    s_mov_b32 s18, 2621440
    s_mov_b32 s19, 0x00020000
    s_lshr_b32 s72, s40, 1
    s_and_b32 s73, s40, 1
    s_mul_i32 s46, s72, 32
    v_and_b32 v2, 31, v1
    v_add_u32 v2, s46, v2
    v_lshrrev_b32 v3, 5, v1
    v_bfe_u32 v4, v2, 1, 3
    v_xor_b32 v3, v3, v4
    v_lshlrev_b32 v3, 4, v3
    v_lshl_add_u32 v16, v2, 7, v3
    v_xor_b32 v17, 32, v16
    v_xor_b32 v18, 64, v16
    v_xor_b32 v19, 96, v16
    s_mul_i32 s46, s73, 8
    s_add_u32 s46, s46, 0
    v_bfe_u32 v2, v1, 4, 1
    v_lshlrev_b32 v2, 1, v2
    v_bfe_u32 v3, v1, 1, 1
    v_add3_u32 v2, v2, v3, s46
    v_bfe_u32 v4, v1, 2, 2
    v_lshlrev_b32 v5, 2, v4
    v_xor_b32 v2, v2, v5
    v_lshlrev_b32 v2, 4, v2
    v_and_b32 v3, 1, v1
    v_lshl_add_u32 v2, v3, 3, v2
    v_lshrrev_b32 v3, 5, v1
    v_lshl_add_u32 v3, v3, 3, v4
    s_mov_b32 s47, 256
    v_mad_u32_u24 v2, v3, s47, v2
    v_add_u32 v20, 32768, v2
    s_mul_i32 s46, s73, 8
    s_add_u32 s46, s46, 4
    v_bfe_u32 v2, v1, 4, 1
    v_lshlrev_b32 v2, 1, v2
    v_bfe_u32 v3, v1, 1, 1
    v_add3_u32 v2, v2, v3, s46
    v_bfe_u32 v4, v1, 2, 2
    v_lshlrev_b32 v5, 2, v4
    v_xor_b32 v2, v2, v5
    v_lshlrev_b32 v2, 4, v2
    v_and_b32 v3, 1, v1
    v_lshl_add_u32 v2, v3, 3, v2
    v_lshrrev_b32 v3, 5, v1
    v_lshl_add_u32 v3, v3, 3, v4
    s_mov_b32 s47, 256
    v_mad_u32_u24 v2, v3, s47, v2
    v_add_u32 v21, 32768, v2
    s_mul_i32 s46, s72, 32
    v_and_b32 v2, 31, v1
    v_add_u32 v2, s46, v2
    s_mov_b32 s47, 272
    v_mul_u32_u24 v2, s47, v2
    s_mul_i32 s46, s73, 128
    v_lshrrev_b32 v3, 5, v1
    v_lshlrev_b32 v3, 3, v3
    v_add3_u32 v30, v2, v3, s46
    v_add_u32 v2, 0, v0
    v_lshrrev_b32 v6, 4, v2
    s_mov_b32 s46, 16
    v_mul_u32_u24 v7, s46, v6
    v_sub_u32 v7, v2, v7
    s_mov_b32 s46, 272
    v_mul_u32_u24 v26, s46, v6
    v_lshl_add_u32 v26, v7, 4, v26
    v_add_u32 v22, s38, v6
    s_mov_b32 s46, 1280
    v_mul_lo_u32 v22, v22, s46
    v_lshl_add_u32 v22, v7, 4, v22
    s_lshl_b32 s46, s39, 1
    v_add_u32 v22, s46, v22
    v_add_u32 v2, 256, v0
    v_lshrrev_b32 v6, 4, v2
    s_mov_b32 s46, 16
    v_mul_u32_u24 v7, s46, v6
    v_sub_u32 v7, v2, v7
    s_mov_b32 s46, 272
    v_mul_u32_u24 v27, s46, v6
    v_lshl_add_u32 v27, v7, 4, v27
    v_add_u32 v23, s38, v6
    s_mov_b32 s46, 1280
    v_mul_lo_u32 v23, v23, s46
    v_lshl_add_u32 v23, v7, 4, v23
    s_lshl_b32 s46, s39, 1
    v_add_u32 v23, s46, v23
    v_add_u32 v2, 512, v0
    v_lshrrev_b32 v6, 4, v2
    s_mov_b32 s46, 16
    v_mul_u32_u24 v7, s46, v6
    v_sub_u32 v7, v2, v7
    s_mov_b32 s46, 272
    v_mul_u32_u24 v28, s46, v6
    v_lshl_add_u32 v28, v7, 4, v28
    v_add_u32 v24, s38, v6
    s_mov_b32 s46, 1280
    v_mul_lo_u32 v24, v24, s46
    v_lshl_add_u32 v24, v7, 4, v24
    s_lshl_b32 s46, s39, 1
    v_add_u32 v24, s46, v24
    v_add_u32 v2, 768, v0
    v_lshrrev_b32 v6, 4, v2
    s_mov_b32 s46, 16
    v_mul_u32_u24 v7, s46, v6
    v_sub_u32 v7, v2, v7
    s_mov_b32 s46, 272
    v_mul_u32_u24 v29, s46, v6
    v_lshl_add_u32 v29, v7, 4, v29
    v_add_u32 v25, s38, v6
    s_mov_b32 s46, 1280
    v_mul_lo_u32 v25, v25, s46
    v_lshl_add_u32 v25, v7, 4, v25
    s_lshl_b32 s46, s39, 1
    v_add_u32 v25, s46, v25
    v_mov_b32 v64, 0
    v_mov_b32 v65, 0
    v_mov_b32 v66, 0
    v_mov_b32 v67, 0
    v_mov_b32 v68, 0
    v_mov_b32 v69, 0
    v_mov_b32 v70, 0
    v_mov_b32 v71, 0
    v_mov_b32 v72, 0
    v_mov_b32 v73, 0
    v_mov_b32 v74, 0
    v_mov_b32 v75, 0
    v_mov_b32 v76, 0
    v_mov_b32 v77, 0
    v_mov_b32 v78, 0
    v_mov_b32 v79, 0
    v_mov_b32 v80, 0
    v_mov_b32 v81, 0
    v_mov_b32 v82, 0
    v_mov_b32 v83, 0
    v_mov_b32 v84, 0
    v_mov_b32 v85, 0
    v_mov_b32 v86, 0
    v_mov_b32 v87, 0
    v_mov_b32 v88, 0
    v_mov_b32 v89, 0
    v_mov_b32 v90, 0
    v_mov_b32 v91, 0
    v_mov_b32 v92, 0
    v_mov_b32 v93, 0
    v_mov_b32 v94, 0
    v_mov_b32 v95, 0
    s_mov_b32 s45, 2
g5b_kernel_loop5:
    s_barrier
    ds_read_b128 v[32:35], v16 offset:0
    ds_read_b64_tr_b16 v[36:37], v20 offset:0
    ds_read_b64_tr_b16 v[38:39], v20 offset:1024
    ds_read_b64_tr_b16 v[40:41], v21 offset:0
    ds_read_b64_tr_b16 v[42:43], v21 offset:1024
    ds_read_b128 v[44:47], v17 offset:0
    ds_read_b64_tr_b16 v[48:49], v20 offset:4096
    ds_read_b64_tr_b16 v[50:51], v20 offset:5120
    ds_read_b64_tr_b16 v[52:53], v21 offset:4096
    ds_read_b64_tr_b16 v[54:55], v21 offset:5120
    s_waitcnt lgkmcnt(5)
    v_mfma_f32_32x32x16_bf16 v[64:79], v[36:39], v[32:35], v[64:79]
    v_mfma_f32_32x32x16_bf16 v[80:95], v[40:43], v[32:35], v[80:95]
    ds_read_b128 v[32:35], v18 offset:0
    ds_read_b64_tr_b16 v[36:37], v20 offset:8192
    ds_read_b64_tr_b16 v[38:39], v20 offset:9216
    ds_read_b64_tr_b16 v[40:41], v21 offset:8192
    ds_read_b64_tr_b16 v[42:43], v21 offset:9216
    s_waitcnt lgkmcnt(5)
    v_mfma_f32_32x32x16_bf16 v[64:79], v[48:51], v[44:47], v[64:79]
    v_mfma_f32_32x32x16_bf16 v[80:95], v[52:55], v[44:47], v[80:95]
    ds_read_b128 v[44:47], v19 offset:0
    ds_read_b64_tr_b16 v[48:49], v20 offset:12288
    ds_read_b64_tr_b16 v[50:51], v20 offset:13312
    ds_read_b64_tr_b16 v[52:53], v21 offset:12288
    ds_read_b64_tr_b16 v[54:55], v21 offset:13312
    s_waitcnt lgkmcnt(5)
    v_mfma_f32_32x32x16_bf16 v[64:79], v[36:39], v[32:35], v[64:79]
    v_mfma_f32_32x32x16_bf16 v[80:95], v[40:43], v[32:35], v[80:95]
    s_waitcnt lgkmcnt(0)
    v_mfma_f32_32x32x16_bf16 v[64:79], v[48:51], v[44:47], v[64:79]
    v_mfma_f32_32x32x16_bf16 v[80:95], v[52:55], v[44:47], v[80:95]
    s_barrier
    ds_read_b128 v[32:35], v16 offset:8192
    ds_read_b64_tr_b16 v[36:37], v20 offset:16384
    ds_read_b64_tr_b16 v[38:39], v20 offset:17408
    ds_read_b64_tr_b16 v[40:41], v21 offset:16384
    ds_read_b64_tr_b16 v[42:43], v21 offset:17408
    ds_read_b128 v[44:47], v17 offset:8192
    ds_read_b64_tr_b16 v[48:49], v20 offset:20480
    ds_read_b64_tr_b16 v[50:51], v20 offset:21504
    ds_read_b64_tr_b16 v[52:53], v21 offset:20480
    ds_read_b64_tr_b16 v[54:55], v21 offset:21504
    s_waitcnt lgkmcnt(5)
    v_mfma_f32_32x32x16_bf16 v[64:79], v[36:39], v[32:35], v[64:79]
    v_mfma_f32_32x32x16_bf16 v[80:95], v[40:43], v[32:35], v[80:95]
    ds_read_b128 v[32:35], v18 offset:8192
    ds_read_b64_tr_b16 v[36:37], v20 offset:24576
    ds_read_b64_tr_b16 v[38:39], v20 offset:25600
    ds_read_b64_tr_b16 v[40:41], v21 offset:24576
    ds_read_b64_tr_b16 v[42:43], v21 offset:25600
    s_waitcnt lgkmcnt(5)
    v_mfma_f32_32x32x16_bf16 v[64:79], v[48:51], v[44:47], v[64:79]
    v_mfma_f32_32x32x16_bf16 v[80:95], v[52:55], v[44:47], v[80:95]
    ds_read_b128 v[44:47], v19 offset:8192
    ds_read_b64_tr_b16 v[48:49], v20 offset:28672
    ds_read_b64_tr_b16 v[50:51], v20 offset:29696
    ds_read_b64_tr_b16 v[52:53], v21 offset:28672
    ds_read_b64_tr_b16 v[54:55], v21 offset:29696
    s_waitcnt lgkmcnt(5)
    v_mfma_f32_32x32x16_bf16 v[64:79], v[36:39], v[32:35], v[64:79]
    v_mfma_f32_32x32x16_bf16 v[80:95], v[40:43], v[32:35], v[80:95]
    s_waitcnt lgkmcnt(0)
    v_mfma_f32_32x32x16_bf16 v[64:79], v[48:51], v[44:47], v[64:79]
    v_mfma_f32_32x32x16_bf16 v[80:95], v[52:55], v[44:47], v[80:95]
    s_barrier
    ds_read_b128 v[32:35], v16 offset:16384
    ds_read_b64_tr_b16 v[36:37], v20 offset:32768
    ds_read_b64_tr_b16 v[38:39], v20 offset:33792
    ds_read_b64_tr_b16 v[40:41], v21 offset:32768
    ds_read_b64_tr_b16 v[42:43], v21 offset:33792
    ds_read_b128 v[44:47], v17 offset:16384
    ds_read_b64_tr_b16 v[48:49], v20 offset:36864
    ds_read_b64_tr_b16 v[50:51], v20 offset:37888
    ds_read_b64_tr_b16 v[52:53], v21 offset:36864
    ds_read_b64_tr_b16 v[54:55], v21 offset:37888
    s_waitcnt lgkmcnt(5)
    v_mfma_f32_32x32x16_bf16 v[64:79], v[36:39], v[32:35], v[64:79]
    v_mfma_f32_32x32x16_bf16 v[80:95], v[40:43], v[32:35], v[80:95]
    ds_read_b128 v[32:35], v18 offset:16384
    ds_read_b64_tr_b16 v[36:37], v20 offset:40960
    ds_read_b64_tr_b16 v[38:39], v20 offset:41984
    ds_read_b64_tr_b16 v[40:41], v21 offset:40960
    ds_read_b64_tr_b16 v[42:43], v21 offset:41984
    s_waitcnt lgkmcnt(5)
    v_mfma_f32_32x32x16_bf16 v[64:79], v[48:51], v[44:47], v[64:79]
    v_mfma_f32_32x32x16_bf16 v[80:95], v[52:55], v[44:47], v[80:95]
    ds_read_b128 v[44:47], v19 offset:16384
    ds_read_b64_tr_b16 v[48:49], v20 offset:45056
    ds_read_b64_tr_b16 v[50:51], v20 offset:46080
    ds_read_b64_tr_b16 v[52:53], v21 offset:45056
    ds_read_b64_tr_b16 v[54:55], v21 offset:46080
    s_waitcnt lgkmcnt(5)
    v_mfma_f32_32x32x16_bf16 v[64:79], v[36:39], v[32:35], v[64:79]
    v_mfma_f32_32x32x16_bf16 v[80:95], v[40:43], v[32:35], v[80:95]
    s_waitcnt lgkmcnt(0)
    v_mfma_f32_32x32x16_bf16 v[64:79], v[48:51], v[44:47], v[64:79]
    v_mfma_f32_32x32x16_bf16 v[80:95], v[52:55], v[44:47], v[80:95]
    s_barrier
    ds_read_b128 v[32:35], v16 offset:24576
    ds_read_b64_tr_b16 v[36:37], v20 offset:49152
    ds_read_b64_tr_b16 v[38:39], v20 offset:50176
    ds_read_b64_tr_b16 v[40:41], v21 offset:49152
    ds_read_b64_tr_b16 v[42:43], v21 offset:50176
    ds_read_b128 v[44:47], v17 offset:24576
    ds_read_b64_tr_b16 v[48:49], v20 offset:53248
    ds_read_b64_tr_b16 v[50:51], v20 offset:54272
    ds_read_b64_tr_b16 v[52:53], v21 offset:53248
    ds_read_b64_tr_b16 v[54:55], v21 offset:54272
    s_waitcnt lgkmcnt(5)
    v_mfma_f32_32x32x16_bf16 v[64:79], v[36:39], v[32:35], v[64:79]
    v_mfma_f32_32x32x16_bf16 v[80:95], v[40:43], v[32:35], v[80:95]
    ds_read_b128 v[32:35], v18 offset:24576
    ds_read_b64_tr_b16 v[36:37], v20 offset:57344
    ds_read_b64_tr_b16 v[38:39], v20 offset:58368
    ds_read_b64_tr_b16 v[40:41], v21 offset:57344
    ds_read_b64_tr_b16 v[42:43], v21 offset:58368
    s_waitcnt lgkmcnt(5)
    v_mfma_f32_32x32x16_bf16 v[64:79], v[48:51], v[44:47], v[64:79]
    v_mfma_f32_32x32x16_bf16 v[80:95], v[52:55], v[44:47], v[80:95]
    ds_read_b128 v[44:47], v19 offset:24576
    ds_read_b64_tr_b16 v[48:49], v20 offset:61440
    ds_read_b64_tr_b16 v[50:51], v20 offset:62464
    ds_read_b64_tr_b16 v[52:53], v21 offset:61440
    ds_read_b64_tr_b16 v[54:55], v21 offset:62464
    s_waitcnt lgkmcnt(5)
    v_mfma_f32_32x32x16_bf16 v[64:79], v[36:39], v[32:35], v[64:79]
    v_mfma_f32_32x32x16_bf16 v[80:95], v[40:43], v[32:35], v[80:95]
    s_waitcnt lgkmcnt(0)
    v_mfma_f32_32x32x16_bf16 v[64:79], v[48:51], v[44:47], v[64:79]
    v_mfma_f32_32x32x16_bf16 v[80:95], v[52:55], v[44:47], v[80:95]
    s_sub_u32 s45, s45, 1
    s_cmp_lg_u32 s45, 0
    s_cbranch_scc1 g5b_kernel_loop5
    s_barrier
    ds_read_b128 v[32:35], v16 offset:0
    ds_read_b64_tr_b16 v[36:37], v20 offset:0
    ds_read_b64_tr_b16 v[38:39], v20 offset:1024
    ds_read_b64_tr_b16 v[40:41], v21 offset:0
    ds_read_b64_tr_b16 v[42:43], v21 offset:1024
    ds_read_b128 v[44:47], v17 offset:0
    ds_read_b64_tr_b16 v[48:49], v20 offset:4096
    ds_read_b64_tr_b16 v[50:51], v20 offset:5120
    ds_read_b64_tr_b16 v[52:53], v21 offset:4096
    ds_read_b64_tr_b16 v[54:55], v21 offset:5120
    s_waitcnt lgkmcnt(5)
    v_mfma_f32_32x32x16_bf16 v[64:79], v[36:39], v[32:35], v[64:79]
    v_mfma_f32_32x32x16_bf16 v[80:95], v[40:43], v[32:35], v[80:95]
    ds_read_b128 v[32:35], v18 offset:0
    ds_read_b64_tr_b16 v[36:37], v20 offset:8192
    ds_read_b64_tr_b16 v[38:39], v20 offset:9216
    ds_read_b64_tr_b16 v[40:41], v21 offset:8192
    ds_read_b64_tr_b16 v[42:43], v21 offset:9216
    s_waitcnt lgkmcnt(5)
    v_mfma_f32_32x32x16_bf16 v[64:79], v[48:51], v[44:47], v[64:79]
    v_mfma_f32_32x32x16_bf16 v[80:95], v[52:55], v[44:47], v[80:95]
    ds_read_b128 v[44:47], v19 offset:0
    ds_read_b64_tr_b16 v[48:49], v20 offset:12288
    ds_read_b64_tr_b16 v[50:51], v20 offset:13312
    ds_read_b64_tr_b16 v[52:53], v21 offset:12288
    ds_read_b64_tr_b16 v[54:55], v21 offset:13312
    s_waitcnt lgkmcnt(5)
    v_mfma_f32_32x32x16_bf16 v[64:79], v[36:39], v[32:35], v[64:79]
    v_mfma_f32_32x32x16_bf16 v[80:95], v[40:43], v[32:35], v[80:95]
    s_waitcnt lgkmcnt(0)
    v_mfma_f32_32x32x16_bf16 v[64:79], v[48:51], v[44:47], v[64:79]
    v_mfma_f32_32x32x16_bf16 v[80:95], v[52:55], v[44:47], v[80:95]
    s_add_u32 s20, s70, 15728640
    s_addc_u32 s21, s71, 0
    s_mov_b32 s22, 2621440
    s_mov_b32 s23, 0x00020000
    buffer_load_dwordx4 v[100:103], v22, s[20:23], 0 offen
    buffer_load_dwordx4 v[104:107], v23, s[20:23], 0 offen
    buffer_load_dwordx4 v[108:111], v24, s[20:23], 0 offen
    buffer_load_dwordx4 v[112:115], v25, s[20:23], 0 offen
    s_barrier
    ds_read_b128 v[32:35], v16 offset:8192
    ds_read_b64_tr_b16 v[36:37], v20 offset:16384
    ds_read_b64_tr_b16 v[38:39], v20 offset:17408
    ds_read_b64_tr_b16 v[40:41], v21 offset:16384
    ds_read_b64_tr_b16 v[42:43], v21 offset:17408
    ds_read_b128 v[44:47], v17 offset:8192
    ds_read_b64_tr_b16 v[48:49], v20 offset:20480
    ds_read_b64_tr_b16 v[50:51], v20 offset:21504
    ds_read_b64_tr_b16 v[52:53], v21 offset:20480
    ds_read_b64_tr_b16 v[54:55], v21 offset:21504
    s_waitcnt lgkmcnt(5)
    v_mfma_f32_32x32x16_bf16 v[64:79], v[36:39], v[32:35], v[64:79]
    v_mfma_f32_32x32x16_bf16 v[80:95], v[40:43], v[32:35], v[80:95]
    ds_read_b128 v[32:35], v18 offset:8192
    ds_read_b64_tr_b16 v[36:37], v20 offset:24576
    ds_read_b64_tr_b16 v[38:39], v20 offset:25600
    ds_read_b64_tr_b16 v[40:41], v21 offset:24576
    ds_read_b64_tr_b16 v[42:43], v21 offset:25600
    s_waitcnt lgkmcnt(5)
    v_mfma_f32_32x32x16_bf16 v[64:79], v[48:51], v[44:47], v[64:79]
    v_mfma_f32_32x32x16_bf16 v[80:95], v[52:55], v[44:47], v[80:95]
    ds_read_b128 v[44:47], v19 offset:8192
    ds_read_b64_tr_b16 v[48:49], v20 offset:28672
    ds_read_b64_tr_b16 v[50:51], v20 offset:29696
    ds_read_b64_tr_b16 v[52:53], v21 offset:28672
    ds_read_b64_tr_b16 v[54:55], v21 offset:29696
    s_waitcnt lgkmcnt(5)
    v_mfma_f32_32x32x16_bf16 v[64:79], v[36:39], v[32:35], v[64:79]
    v_mfma_f32_32x32x16_bf16 v[80:95], v[40:43], v[32:35], v[80:95]
    s_waitcnt lgkmcnt(0)
    v_mfma_f32_32x32x16_bf16 v[64:79], v[48:51], v[44:47], v[64:79]
    v_mfma_f32_32x32x16_bf16 v[80:95], v[52:55], v[44:47], v[80:95]
    s_barrier
    ds_read_b128 v[32:35], v16 offset:16384
    ds_read_b64_tr_b16 v[36:37], v20 offset:32768
    ds_read_b64_tr_b16 v[38:39], v20 offset:33792
    ds_read_b64_tr_b16 v[40:41], v21 offset:32768
    ds_read_b64_tr_b16 v[42:43], v21 offset:33792
    ds_read_b128 v[44:47], v17 offset:16384
    ds_read_b64_tr_b16 v[48:49], v20 offset:36864
    ds_read_b64_tr_b16 v[50:51], v20 offset:37888
    ds_read_b64_tr_b16 v[52:53], v21 offset:36864
    ds_read_b64_tr_b16 v[54:55], v21 offset:37888
    s_waitcnt lgkmcnt(5)
    v_mfma_f32_32x32x16_bf16 v[64:79], v[36:39], v[32:35], v[64:79]
    v_mfma_f32_32x32x16_bf16 v[80:95], v[40:43], v[32:35], v[80:95]
    ds_read_b128 v[32:35], v18 offset:16384
    ds_read_b64_tr_b16 v[36:37], v20 offset:40960
    ds_read_b64_tr_b16 v[38:39], v20 offset:41984
    ds_read_b64_tr_b16 v[40:41], v21 offset:40960
    ds_read_b64_tr_b16 v[42:43], v21 offset:41984
    s_waitcnt lgkmcnt(5)
    v_mfma_f32_32x32x16_bf16 v[64:79], v[48:51], v[44:47], v[64:79]
    v_mfma_f32_32x32x16_bf16 v[80:95], v[52:55], v[44:47], v[80:95]
    ds_read_b128 v[44:47], v19 offset:16384
    ds_read_b64_tr_b16 v[48:49], v20 offset:45056
    ds_read_b64_tr_b16 v[50:51], v20 offset:46080
    ds_read_b64_tr_b16 v[52:53], v21 offset:45056
    ds_read_b64_tr_b16 v[54:55], v21 offset:46080
    s_waitcnt lgkmcnt(5)
    v_mfma_f32_32x32x16_bf16 v[64:79], v[36:39], v[32:35], v[64:79]
    v_mfma_f32_32x32x16_bf16 v[80:95], v[40:43], v[32:35], v[80:95]
    s_waitcnt lgkmcnt(0)
    v_mfma_f32_32x32x16_bf16 v[64:79], v[48:51], v[44:47], v[64:79]
    v_mfma_f32_32x32x16_bf16 v[80:95], v[52:55], v[44:47], v[80:95]
    s_barrier
    ds_read_b128 v[32:35], v16 offset:24576
    ds_read_b64_tr_b16 v[36:37], v20 offset:49152
    ds_read_b64_tr_b16 v[38:39], v20 offset:50176
    ds_read_b64_tr_b16 v[40:41], v21 offset:49152
    ds_read_b64_tr_b16 v[42:43], v21 offset:50176
    ds_read_b128 v[44:47], v17 offset:24576
    ds_read_b64_tr_b16 v[48:49], v20 offset:53248
    ds_read_b64_tr_b16 v[50:51], v20 offset:54272
    ds_read_b64_tr_b16 v[52:53], v21 offset:53248
    ds_read_b64_tr_b16 v[54:55], v21 offset:54272
    s_waitcnt lgkmcnt(5)
    v_mfma_f32_32x32x16_bf16 v[64:79], v[36:39], v[32:35], v[64:79]
    v_mfma_f32_32x32x16_bf16 v[80:95], v[40:43], v[32:35], v[80:95]
    ds_read_b128 v[32:35], v18 offset:24576
    ds_read_b64_tr_b16 v[36:37], v20 offset:57344
    ds_read_b64_tr_b16 v[38:39], v20 offset:58368
    ds_read_b64_tr_b16 v[40:41], v21 offset:57344
    ds_read_b64_tr_b16 v[42:43], v21 offset:58368
    s_waitcnt lgkmcnt(5)
    v_mfma_f32_32x32x16_bf16 v[64:79], v[48:51], v[44:47], v[64:79]
    v_mfma_f32_32x32x16_bf16 v[80:95], v[52:55], v[44:47], v[80:95]
    ds_read_b128 v[44:47], v19 offset:24576
    ds_read_b64_tr_b16 v[48:49], v20 offset:61440
    ds_read_b64_tr_b16 v[50:51], v20 offset:62464
    ds_read_b64_tr_b16 v[52:53], v21 offset:61440
    ds_read_b64_tr_b16 v[54:55], v21 offset:62464
    s_waitcnt lgkmcnt(5)
    v_mfma_f32_32x32x16_bf16 v[64:79], v[36:39], v[32:35], v[64:79]
    v_mfma_f32_32x32x16_bf16 v[80:95], v[40:43], v[32:35], v[80:95]
    s_waitcnt lgkmcnt(0)
    v_mfma_f32_32x32x16_bf16 v[64:79], v[48:51], v[44:47], v[64:79]
    v_mfma_f32_32x32x16_bf16 v[80:95], v[52:55], v[44:47], v[80:95]
    s_barrier
    s_nop 15
    v_cvt_pk_bf16_f32 v124, v64, v65
    v_cvt_pk_bf16_f32 v125, v66, v67
    ds_write_b64 v30, v[124:125] offset:0
    v_cvt_pk_bf16_f32 v124, v68, v69
    v_cvt_pk_bf16_f32 v125, v70, v71
    ds_write_b64 v30, v[124:125] offset:16
    v_cvt_pk_bf16_f32 v124, v72, v73
    v_cvt_pk_bf16_f32 v125, v74, v75
    ds_write_b64 v30, v[124:125] offset:32
    v_cvt_pk_bf16_f32 v124, v76, v77
    v_cvt_pk_bf16_f32 v125, v78, v79
    ds_write_b64 v30, v[124:125] offset:48
    v_cvt_pk_bf16_f32 v124, v80, v81
    v_cvt_pk_bf16_f32 v125, v82, v83
    ds_write_b64 v30, v[124:125] offset:64
    v_cvt_pk_bf16_f32 v124, v84, v85
    v_cvt_pk_bf16_f32 v125, v86, v87
    ds_write_b64 v30, v[124:125] offset:80
    v_cvt_pk_bf16_f32 v124, v88, v89
    v_cvt_pk_bf16_f32 v125, v90, v91
    ds_write_b64 v30, v[124:125] offset:96
    v_cvt_pk_bf16_f32 v124, v92, v93
    v_cvt_pk_bf16_f32 v125, v94, v95
    ds_write_b64 v30, v[124:125] offset:112
    s_waitcnt lgkmcnt(0)
    s_barrier
    ds_read_b128 v[64:67], v26
    ds_read_b128 v[68:71], v27
    ds_read_b128 v[72:75], v28
    ds_read_b128 v[76:79], v29
    s_add_u32 s28, s70, 30932992
    s_addc_u32 s29, s71, 0
    s_mov_b32 s30, 81920
    s_mov_b32 s31, 0x00020000
    s_waitcnt vmcnt(0)
    s_waitcnt lgkmcnt(3)
    v_lshlrev_b32 v116, 16, v64
    v_and_b32 v117, 0xffff0000, v64
    v_lshlrev_b32 v124, 16, v100
    v_and_b32 v125, 0xffff0000, v100
    v_lshlrev_b32 v118, 16, v65
    v_and_b32 v119, 0xffff0000, v65
    v_lshlrev_b32 v126, 16, v101
    v_and_b32 v127, 0xffff0000, v101
    v_lshlrev_b32 v120, 16, v66
    v_and_b32 v121, 0xffff0000, v66
    v_lshlrev_b32 v128, 16, v102
    v_and_b32 v129, 0xffff0000, v102
    v_lshlrev_b32 v122, 16, v67
    v_and_b32 v123, 0xffff0000, v67
    v_lshlrev_b32 v130, 16, v103
    v_and_b32 v131, 0xffff0000, v103
    v_add_f32 v116, v116, v124
    v_add_f32 v117, v117, v125
    v_add_f32 v118, v118, v126
    v_add_f32 v119, v119, v127
    v_add_f32 v120, v120, v128
    v_add_f32 v121, v121, v129
    v_add_f32 v122, v122, v130
    v_add_f32 v123, v123, v131
    v_cvt_pk_bf16_f32 v64, v116, v117
    v_cvt_pk_bf16_f32 v65, v118, v119
    v_cvt_pk_bf16_f32 v66, v120, v121
    v_cvt_pk_bf16_f32 v67, v122, v123
    buffer_store_dwordx4 v[64:67], v22, s[16:19], 0 offen
    v_lshlrev_b32 v116, 16, v64
    v_and_b32 v117, 0xffff0000, v64
    v_lshlrev_b32 v118, 16, v65
    v_and_b32 v119, 0xffff0000, v65
    v_lshlrev_b32 v120, 16, v66
    v_and_b32 v121, 0xffff0000, v66
    v_lshlrev_b32 v122, 16, v67
    v_and_b32 v123, 0xffff0000, v67
    v_add_f32 v100, v116, v117
    v_mul_f32 v101, v116, v116
    v_fmac_f32 v101, v117, v117
    v_add_f32 v100, v100, v118
    v_fmac_f32 v101, v118, v118
    v_add_f32 v100, v100, v119
    v_fmac_f32 v101, v119, v119
    v_add_f32 v100, v100, v120
    v_fmac_f32 v101, v120, v120
    v_add_f32 v100, v100, v121
    v_fmac_f32 v101, v121, v121
    v_add_f32 v100, v100, v122
    v_fmac_f32 v101, v122, v122
    v_add_f32 v100, v100, v123
    v_fmac_f32 v101, v123, v123
    s_waitcnt lgkmcnt(2)
    v_lshlrev_b32 v116, 16, v68
    v_and_b32 v117, 0xffff0000, v68
    v_lshlrev_b32 v124, 16, v104
    v_and_b32 v125, 0xffff0000, v104
    v_lshlrev_b32 v118, 16, v69
    v_and_b32 v119, 0xffff0000, v69
    v_lshlrev_b32 v126, 16, v105
    v_and_b32 v127, 0xffff0000, v105
    v_lshlrev_b32 v120, 16, v70
    v_and_b32 v121, 0xffff0000, v70
    v_lshlrev_b32 v128, 16, v106
    v_and_b32 v129, 0xffff0000, v106
    v_lshlrev_b32 v122, 16, v71
    v_and_b32 v123, 0xffff0000, v71
    v_lshlrev_b32 v130, 16, v107
    v_and_b32 v131, 0xffff0000, v107
    v_add_f32 v116, v116, v124
    v_add_f32 v117, v117, v125
    v_add_f32 v118, v118, v126
    v_add_f32 v119, v119, v127
    v_add_f32 v120, v120, v128
    v_add_f32 v121, v121, v129
    v_add_f32 v122, v122, v130
    v_add_f32 v123, v123, v131
    v_cvt_pk_bf16_f32 v68, v116, v117
    v_cvt_pk_bf16_f32 v69, v118, v119
    v_cvt_pk_bf16_f32 v70, v120, v121
    v_cvt_pk_bf16_f32 v71, v122, v123
    buffer_store_dwordx4 v[68:71], v23, s[16:19], 0 offen
    v_lshlrev_b32 v116, 16, v68
    v_and_b32 v117, 0xffff0000, v68
    v_lshlrev_b32 v118, 16, v69
    v_and_b32 v119, 0xffff0000, v69
    v_lshlrev_b32 v120, 16, v70
    v_and_b32 v121, 0xffff0000, v70
    v_lshlrev_b32 v122, 16, v71
    v_and_b32 v123, 0xffff0000, v71
    v_add_f32 v104, v116, v117
    v_mul_f32 v105, v116, v116
    v_fmac_f32 v105, v117, v117
    v_add_f32 v104, v104, v118
    v_fmac_f32 v105, v118, v118
    v_add_f32 v104, v104, v119
    v_fmac_f32 v105, v119, v119
    v_add_f32 v104, v104, v120
    v_fmac_f32 v105, v120, v120
    v_add_f32 v104, v104, v121
    v_fmac_f32 v105, v121, v121
    v_add_f32 v104, v104, v122
    v_fmac_f32 v105, v122, v122
    v_add_f32 v104, v104, v123
    v_fmac_f32 v105, v123, v123
    s_waitcnt lgkmcnt(1)
    v_lshlrev_b32 v116, 16, v72
    v_and_b32 v117, 0xffff0000, v72
    v_lshlrev_b32 v124, 16, v108
    v_and_b32 v125, 0xffff0000, v108
    v_lshlrev_b32 v118, 16, v73
    v_and_b32 v119, 0xffff0000, v73
    v_lshlrev_b32 v126, 16, v109
    v_and_b32 v127, 0xffff0000, v109
    v_lshlrev_b32 v120, 16, v74
    v_and_b32 v121, 0xffff0000, v74
    v_lshlrev_b32 v128, 16, v110
    v_and_b32 v129, 0xffff0000, v110
    v_lshlrev_b32 v122, 16, v75
    v_and_b32 v123, 0xffff0000, v75
    v_lshlrev_b32 v130, 16, v111
    v_and_b32 v131, 0xffff0000, v111
    v_add_f32 v116, v116, v124
    v_add_f32 v117, v117, v125
    v_add_f32 v118, v118, v126
    v_add_f32 v119, v119, v127
    v_add_f32 v120, v120, v128
    v_add_f32 v121, v121, v129
    v_add_f32 v122, v122, v130
    v_add_f32 v123, v123, v131
    v_cvt_pk_bf16_f32 v72, v116, v117
    v_cvt_pk_bf16_f32 v73, v118, v119
    v_cvt_pk_bf16_f32 v74, v120, v121
    v_cvt_pk_bf16_f32 v75, v122, v123
    buffer_store_dwordx4 v[72:75], v24, s[16:19], 0 offen
    v_lshlrev_b32 v116, 16, v72
    v_and_b32 v117, 0xffff0000, v72
    v_lshlrev_b32 v118, 16, v73
    v_and_b32 v119, 0xffff0000, v73
    v_lshlrev_b32 v120, 16, v74
    v_and_b32 v121, 0xffff0000, v74
    v_lshlrev_b32 v122, 16, v75
    v_and_b32 v123, 0xffff0000, v75
    v_add_f32 v108, v116, v117
    v_mul_f32 v109, v116, v116
    v_fmac_f32 v109, v117, v117
    v_add_f32 v108, v108, v118
    v_fmac_f32 v109, v118, v118
    v_add_f32 v108, v108, v119
    v_fmac_f32 v109, v119, v119
    v_add_f32 v108, v108, v120
    v_fmac_f32 v109, v120, v120
    v_add_f32 v108, v108, v121
    v_fmac_f32 v109, v121, v121
    v_add_f32 v108, v108, v122
    v_fmac_f32 v109, v122, v122
    v_add_f32 v108, v108, v123
    v_fmac_f32 v109, v123, v123
    s_waitcnt lgkmcnt(0)
    v_lshlrev_b32 v116, 16, v76
    v_and_b32 v117, 0xffff0000, v76
    v_lshlrev_b32 v124, 16, v112
    v_and_b32 v125, 0xffff0000, v112
    v_lshlrev_b32 v118, 16, v77
    v_and_b32 v119, 0xffff0000, v77
    v_lshlrev_b32 v126, 16, v113
    v_and_b32 v127, 0xffff0000, v113
    v_lshlrev_b32 v120, 16, v78
    v_and_b32 v121, 0xffff0000, v78
    v_lshlrev_b32 v128, 16, v114
    v_and_b32 v129, 0xffff0000, v114
    v_lshlrev_b32 v122, 16, v79
    v_and_b32 v123, 0xffff0000, v79
    v_lshlrev_b32 v130, 16, v115
    v_and_b32 v131, 0xffff0000, v115
    v_add_f32 v116, v116, v124
    v_add_f32 v117, v117, v125
    v_add_f32 v118, v118, v126
    v_add_f32 v119, v119, v127
    v_add_f32 v120, v120, v128
    v_add_f32 v121, v121, v129
    v_add_f32 v122, v122, v130
    v_add_f32 v123, v123, v131
    v_cvt_pk_bf16_f32 v76, v116, v117
    v_cvt_pk_bf16_f32 v77, v118, v119
    v_cvt_pk_bf16_f32 v78, v120, v121
    v_cvt_pk_bf16_f32 v79, v122, v123
    buffer_store_dwordx4 v[76:79], v25, s[16:19], 0 offen
    v_lshlrev_b32 v116, 16, v76
    v_and_b32 v117, 0xffff0000, v76
    v_lshlrev_b32 v118, 16, v77
    v_and_b32 v119, 0xffff0000, v77
    v_lshlrev_b32 v120, 16, v78
    v_and_b32 v121, 0xffff0000, v78
    v_lshlrev_b32 v122, 16, v79
    v_and_b32 v123, 0xffff0000, v79
    v_add_f32 v112, v116, v117
    v_mul_f32 v113, v116, v116
    v_fmac_f32 v113, v117, v117
    v_add_f32 v112, v112, v118
    v_fmac_f32 v113, v118, v118
    v_add_f32 v112, v112, v119
    v_fmac_f32 v113, v119, v119
    v_add_f32 v112, v112, v120
    v_fmac_f32 v113, v120, v120
    v_add_f32 v112, v112, v121
    v_fmac_f32 v113, v121, v121
    v_add_f32 v112, v112, v122
    v_fmac_f32 v113, v122, v122
    v_add_f32 v112, v112, v123
    v_fmac_f32 v113, v123, v123
    s_nop 1
    v_add_f32_dpp v100, v100, v100 row_ror:8 row_mask:0xf bank_mask:0xf
    v_add_f32_dpp v101, v101, v101 row_ror:8 row_mask:0xf bank_mask:0xf
    v_add_f32_dpp v104, v104, v104 row_ror:8 row_mask:0xf bank_mask:0xf
    v_add_f32_dpp v105, v105, v105 row_ror:8 row_mask:0xf bank_mask:0xf
    v_add_f32_dpp v108, v108, v108 row_ror:8 row_mask:0xf bank_mask:0xf
    v_add_f32_dpp v109, v109, v109 row_ror:8 row_mask:0xf bank_mask:0xf
    v_add_f32_dpp v112, v112, v112 row_ror:8 row_mask:0xf bank_mask:0xf
    v_add_f32_dpp v113, v113, v113 row_ror:8 row_mask:0xf bank_mask:0xf
    s_nop 1
    v_add_f32_dpp v100, v100, v100 row_ror:4 row_mask:0xf bank_mask:0xf
    v_add_f32_dpp v101, v101, v101 row_ror:4 row_mask:0xf bank_mask:0xf
    v_add_f32_dpp v104, v104, v104 row_ror:4 row_mask:0xf bank_mask:0xf
    v_add_f32_dpp v105, v105, v105 row_ror:4 row_mask:0xf bank_mask:0xf
    v_add_f32_dpp v108, v108, v108 row_ror:4 row_mask:0xf bank_mask:0xf
    v_add_f32_dpp v109, v109, v109 row_ror:4 row_mask:0xf bank_mask:0xf
    v_add_f32_dpp v112, v112, v112 row_ror:4 row_mask:0xf bank_mask:0xf
    v_add_f32_dpp v113, v113, v113 row_ror:4 row_mask:0xf bank_mask:0xf
    s_nop 1
    v_add_f32_dpp v100, v100, v100 row_ror:2 row_mask:0xf bank_mask:0xf
    v_add_f32_dpp v101, v101, v101 row_ror:2 row_mask:0xf bank_mask:0xf
    v_add_f32_dpp v104, v104, v104 row_ror:2 row_mask:0xf bank_mask:0xf
    v_add_f32_dpp v105, v105, v105 row_ror:2 row_mask:0xf bank_mask:0xf
    v_add_f32_dpp v108, v108, v108 row_ror:2 row_mask:0xf bank_mask:0xf
    v_add_f32_dpp v109, v109, v109 row_ror:2 row_mask:0xf bank_mask:0xf
    v_add_f32_dpp v112, v112, v112 row_ror:2 row_mask:0xf bank_mask:0xf
    v_add_f32_dpp v113, v113, v113 row_ror:2 row_mask:0xf bank_mask:0xf
    s_nop 1
    v_add_f32_dpp v100, v100, v100 row_ror:1 row_mask:0xf bank_mask:0xf
    v_add_f32_dpp v101, v101, v101 row_ror:1 row_mask:0xf bank_mask:0xf
    v_add_f32_dpp v104, v104, v104 row_ror:1 row_mask:0xf bank_mask:0xf
    v_add_f32_dpp v105, v105, v105 row_ror:1 row_mask:0xf bank_mask:0xf
    v_add_f32_dpp v108, v108, v108 row_ror:1 row_mask:0xf bank_mask:0xf
    v_add_f32_dpp v109, v109, v109 row_ror:1 row_mask:0xf bank_mask:0xf
    v_add_f32_dpp v112, v112, v112 row_ror:1 row_mask:0xf bank_mask:0xf
    v_add_f32_dpp v113, v113, v113 row_ror:1 row_mask:0xf bank_mask:0xf
    v_lshrrev_b32 v2, 4, v0
    v_add_u32 v2, s38, v2
    s_mul_i32 s46, s37, 2048
    v_add_u32 v2, s46, v2
    v_lshlrev_b32 v2, 3, v2
    v_and_b32 v3, 15, v0
    v_cmp_eq_u32 vcc, 0, v3
    s_and_saveexec_b64 s[46:47], vcc
    buffer_store_dwordx2 v[100:101], v2, s[28:31], 0 offen offset:0
    buffer_store_dwordx2 v[104:105], v2, s[28:31], 0 offen offset:128
    buffer_store_dwordx2 v[108:109], v2, s[28:31], 0 offen offset:256
    buffer_store_dwordx2 v[112:113], v2, s[28:31], 0 offen offset:384
    s_mov_b64 exec, s[46:47]
g5b_kernel_end1:
    s_endpgm
.section .rodata,"a"
.p2align 6
.amdhsa_kernel k0_kernel
  .amdhsa_next_free_vgpr 64
  .amdhsa_next_free_sgpr 102
  .amdhsa_accum_offset 64
  .amdhsa_group_segment_fixed_size 0
  .amdhsa_kernarg_size 96
  .amdhsa_user_sgpr_count 2
  .amdhsa_user_sgpr_kernarg_segment_ptr 1
  .amdhsa_system_sgpr_workgroup_id_x 1
.end_amdhsa_kernel
.p2align 6
.amdhsa_kernel g1a_kernel
  .amdhsa_next_free_vgpr 216
  .amdhsa_next_free_sgpr 102
  .amdhsa_accum_offset 216
  .amdhsa_group_segment_fixed_size 0
  .amdhsa_kernarg_size 96
  .amdhsa_user_sgpr_count 2
  .amdhsa_user_sgpr_kernarg_segment_ptr 1
  .amdhsa_system_sgpr_workgroup_id_x 1
.end_amdhsa_kernel
.p2align 6
.amdhsa_kernel kva_kernel
  .amdhsa_next_free_vgpr 128
  .amdhsa_next_free_sgpr 102
  .amdhsa_accum_offset 128
  .amdhsa_group_segment_fixed_size 0
  .amdhsa_kernarg_size 96
  .amdhsa_user_sgpr_count 2
  .amdhsa_user_sgpr_kernarg_segment_ptr 1
  .amdhsa_system_sgpr_workgroup_id_x 1
.end_amdhsa_kernel
.p2align 6
.amdhsa_kernel oa_kernel
  .amdhsa_next_free_vgpr 136
  .amdhsa_next_free_sgpr 102
  .amdhsa_accum_offset 136
  .amdhsa_group_segment_fixed_size 0
  .amdhsa_kernarg_size 96
  .amdhsa_user_sgpr_count 2
  .amdhsa_user_sgpr_kernarg_segment_ptr 1
  .amdhsa_system_sgpr_workgroup_id_x 1
.end_amdhsa_kernel
.p2align 6
.amdhsa_kernel g2a_kernel
  .amdhsa_next_free_vgpr 136
  .amdhsa_next_free_sgpr 102
  .amdhsa_accum_offset 136
  .amdhsa_group_segment_fixed_size 0
  .amdhsa_kernarg_size 96
  .amdhsa_user_sgpr_count 2
  .amdhsa_user_sgpr_kernarg_segment_ptr 1
  .amdhsa_system_sgpr_workgroup_id_x 1
.end_amdhsa_kernel
.p2align 6
.amdhsa_kernel g3a_kernel
  .amdhsa_next_free_vgpr 208
  .amdhsa_next_free_sgpr 102
  .amdhsa_accum_offset 208
  .amdhsa_group_segment_fixed_size 0
  .amdhsa_kernarg_size 96
  .amdhsa_user_sgpr_count 2
  .amdhsa_user_sgpr_kernarg_segment_ptr 1
  .amdhsa_system_sgpr_workgroup_id_x 1
.end_amdhsa_kernel
.p2align 6
.amdhsa_kernel lna_kernel
  .amdhsa_next_free_vgpr 64
  .amdhsa_next_free_sgpr 102
  .amdhsa_accum_offset 64
  .amdhsa_group_segment_fixed_size 0
  .amdhsa_kernarg_size 96
  .amdhsa_user_sgpr_count 2
  .amdhsa_user_sgpr_kernarg_segment_ptr 1
  .amdhsa_system_sgpr_workgroup_id_x 1
.end_amdhsa_kernel
.p2align 6
.amdhsa_kernel g4a_kernel
  .amdhsa_next_free_vgpr 136
  .amdhsa_next_free_sgpr 102
  .amdhsa_accum_offset 136
  .amdhsa_group_segment_fixed_size 0
  .amdhsa_kernarg_size 96
  .amdhsa_user_sgpr_count 2
  .amdhsa_user_sgpr_kernarg_segment_ptr 1
  .amdhsa_system_sgpr_workgroup_id_x 1
.end_amdhsa_kernel
.p2align 6
.amdhsa_kernel g5a_kernel
  .amdhsa_next_free_vgpr 136
  .amdhsa_next_free_sgpr 102
  .amdhsa_accum_offset 136
  .amdhsa_group_segment_fixed_size 0
  .amdhsa_kernarg_size 96
  .amdhsa_user_sgpr_count 2
  .amdhsa_user_sgpr_kernarg_segment_ptr 1
  .amdhsa_system_sgpr_workgroup_id_x 1
.end_amdhsa_kernel
.p2align 6
.amdhsa_kernel g1b_kernel
  .amdhsa_next_free_vgpr 216
  .amdhsa_next_free_sgpr 102
  .amdhsa_accum_offset 216
  .amdhsa_group_segment_fixed_size 0
  .amdhsa_kernarg_size 96
  .amdhsa_user_sgpr_count 2
  .amdhsa_user_sgpr_kernarg_segment_ptr 1
  .amdhsa_system_sgpr_workgroup_id_x 1
.end_amdhsa_kernel
.p2align 6
.amdhsa_kernel kvb_kernel
  .amdhsa_next_free_vgpr 128
  .amdhsa_next_free_sgpr 102
  .amdhsa_accum_offset 128
  .amdhsa_group_segment_fixed_size 0
  .amdhsa_kernarg_size 96
  .amdhsa_user_sgpr_count 2
  .amdhsa_user_sgpr_kernarg_segment_ptr 1
  .amdhsa_system_sgpr_workgroup_id_x 1
.end_amdhsa_kernel
.p2align 6
.amdhsa_kernel ob_kernel
  .amdhsa_next_free_vgpr 136
  .amdhsa_next_free_sgpr 102
  .amdhsa_accum_offset 136
  .amdhsa_group_segment_fixed_size 0
  .amdhsa_kernarg_size 96
  .amdhsa_user_sgpr_count 2
  .amdhsa_user_sgpr_kernarg_segment_ptr 1
  .amdhsa_system_sgpr_workgroup_id_x 1
.end_amdhsa_kernel
.p2align 6
.amdhsa_kernel g2b_kernel
  .amdhsa_next_free_vgpr 136
  .amdhsa_next_free_sgpr 102
  .amdhsa_accum_offset 136
  .amdhsa_group_segment_fixed_size 0
  .amdhsa_kernarg_size 96
  .amdhsa_user_sgpr_count 2
  .amdhsa_user_sgpr_kernarg_segment_ptr 1
  .amdhsa_system_sgpr_workgroup_id_x 1
.end_amdhsa_kernel
.p2align 6
.amdhsa_kernel g3b_kernel
  .amdhsa_next_free_vgpr 208
  .amdhsa_next_free_sgpr 102
  .amdhsa_accum_offset 208
  .amdhsa_group_segment_fixed_size 0
  .amdhsa_kernarg_size 96
  .amdhsa_user_sgpr_count 2
  .amdhsa_user_sgpr_kernarg_segment_ptr 1
  .amdhsa_system_sgpr_workgroup_id_x 1
.end_amdhsa_kernel
.p2align 6
.amdhsa_kernel lnb_kernel
  .amdhsa_next_free_vgpr 64
  .amdhsa_next_free_sgpr 102
  .amdhsa_accum_offset 64
  .amdhsa_group_segment_fixed_size 0
  .amdhsa_kernarg_size 96
  .amdhsa_user_sgpr_count 2
  .amdhsa_user_sgpr_kernarg_segment_ptr 1
  .amdhsa_system_sgpr_workgroup_id_x 1
.end_amdhsa_kernel
.p2align 6
.amdhsa_kernel g4b_kernel
  .amdhsa_next_free_vgpr 136
  .amdhsa_next_free_sgpr 102
  .amdhsa_accum_offset 136
  .amdhsa_group_segment_fixed_size 0
  .amdhsa_kernarg_size 96
  .amdhsa_user_sgpr_count 2
  .amdhsa_user_sgpr_kernarg_segment_ptr 1
  .amdhsa_system_sgpr_workgroup_id_x 1
.end_amdhsa_kernel
.p2align 6
.amdhsa_kernel g5b_kernel
  .amdhsa_next_free_vgpr 136
  .amdhsa_next_free_sgpr 102
  .amdhsa_accum_offset 136
  .amdhsa_group_segment_fixed_size 0
  .amdhsa_kernarg_size 96
  .amdhsa_user_sgpr_count 2
  .amdhsa_user_sgpr_kernarg_segment_ptr 1
  .amdhsa_system_sgpr_workgroup_id_x 1
.end_amdhsa_kernel
```
